```python
import torch

def _softmax(x, axis=-1):
    return torch.softmax(x, dim=axis)

def _gelu(x):
    return torch.nn.functional.gelu(x, approximate='tanh')

def _silu(x):
    return torch.nn.functional.silu(x)

def _sigmoid(x):
    return torch.sigmoid(x)

def _layernorm(x, axis=-1, eps=1e-05):
    m = x.mean(dim=axis, keepdim=True)
    v = x.var(dim=axis, keepdim=True, unbiased=False)
    return (x - m) / torch.sqrt(v + eps)

def _scatter_add(tgt, idx, src, axis=0):
    return tgt.clone().index_add_(axis, idx, src)

def _segment_sum(src, seg, n):
    out = torch.zeros((n,) + src.shape[1:], dtype=src.dtype)
    return out.index_add_(0, seg, src)

def _pad(x, pw):
    flat = tuple((v for pair in reversed(pw) for v in pair))
    return torch.nn.functional.pad(x, flat)
kernel_name = 'gated_mix__memory_aug_recurrent_mem_tr__geglu_ffn__prompt'

def setup_inputs():

    _w = lambda a: (lambda t: t.to(torch.bfloat16) if t.is_floating_point() else t)(torch.as_tensor(a))

    def _A_setup():
        B, S, Dm = (1, 2048, 1024)
        H, Dh = (32, 128)
        M, seg = (8, 32)
        seg = min(seg, S)
        S = S // seg * seg
        return {'x': _w((lambda *s: torch.randn(*s, dtype=torch.bfloat16) * 0.05)(B, S, Dm)), 'mem0': _w((lambda *s: torch.randn(*s, dtype=torch.bfloat16) * 0.4)(B, M, Dm)), 'Wq': _w((lambda *s: torch.randn(*s, dtype=torch.bfloat16) * 6.4)(Dm, H, Dh) * Dm ** (-0.5)), 'Wk': _w((lambda *s: torch.randn(*s, dtype=torch.bfloat16) * 6.4)(Dm, H, Dh) * Dm ** (-0.5)), 'Wv': _w((lambda *s: torch.randn(*s, dtype=torch.bfloat16) * 0.4)(Dm, H, Dh) * Dm ** (-0.5)), 'Wo': _w((lambda *s: torch.randn(*s, dtype=torch.bfloat16) * 0.4)(H, Dh, Dm) * (H * Dh) ** (-0.5)), 'seg_len': seg}
    _A_in = _A_setup()

    def _B_setup():
        B, S, D, F = (1, 2048, 1024, 3584)
        return {'x': _w((lambda *s: torch.randn(*s, dtype=torch.bfloat16) * 0.05)(B, S, D)), 'w_gate': _w((lambda *s: torch.randn(*s, dtype=torch.bfloat16) * 0.05)(D, F)), 'w_up': _w((lambda *s: torch.randn(*s, dtype=torch.bfloat16) * 0.05)(D, F)), 'w_down': _w((lambda *s: torch.randn(*s, dtype=torch.bfloat16) * 0.05)(F, D))}
    _B_in = _B_setup()
    return {'A_x': _A_in['x'], 'A_mem0': _A_in['mem0'], 'A_Wq': _A_in['Wq'], 'A_Wk': _A_in['Wk'], 'A_Wv': _A_in['Wv'], 'A_Wo': _A_in['Wo'], 'A_seg_len': _A_in['seg_len'], 'B_x': _B_in['x'], 'B_w_gate': _B_in['w_gate'], 'B_w_up': _B_in['w_up'], 'B_w_down': _B_in['w_down'], 'gate_w': _w((lambda *s: torch.randn(*s, dtype=torch.bfloat16) * 0.05)(1024) * 16.0)}

def reference(A_x, A_mem0, A_Wq, A_Wk, A_Wv, A_Wo, A_seg_len, B_x, B_w_gate, B_w_up, B_w_down, gate_w):

    def _A_ref(x, mem0, Wq, Wk, Wv, Wo, seg_len):
        B, S, Dm = x.shape
        H, Dh = (Wq.shape[1], Wq.shape[2])
        M = mem0.shape[1]
        scale = Dh ** (-0.5)
        n_seg = S // seg_len
        L = M + seg_len
        idx = torch.arange(L)
        mask = (idx[:, None] < M) | (idx[:, None] >= idx[None, :])
        mem = mem0
        outs = []
        for s in range(n_seg):
            xs = x[:, s * seg_len:(s + 1) * seg_len, :].clone()
            h = torch.concatenate([mem, xs], axis=1)
            q = torch.einsum('btd,dhe->bhte', h, Wq)
            k = torch.einsum('btd,dhe->bhte', h, Wk)
            v = torch.einsum('btd,dhe->bhte', h, Wv)
            scores = torch.einsum('bhqe,bhke->bhqk', q, k) * scale
            scores = torch.where(mask[None, None], scores, -1000000000.0)
            p = _softmax(scores, axis=-1)
            o = torch.einsum('bhqk,bhke->bhqe', p, v)
            o = torch.einsum('bhte,hed->btd', o, Wo)
            mem = o[:, :M, :].clone()
            outs.append(o[:, M:, :])
        return torch.concatenate(outs, axis=1)

    def _B_ref(x, w_gate, w_up, w_down):
        return _gelu(x @ w_gate) * (x @ w_up) @ w_down
    x = A_x
    g = _sigmoid((x * gate_w).sum(-1, keepdims=True))
    a = _A_ref(x, A_mem0, A_Wq, A_Wk, A_Wv, A_Wo, A_seg_len)
    b = _B_ref(x, B_w_gate, B_w_up, B_w_down)
    return g * a + (1 - g) * b
```

```asm
; @launch grid=(256,1,1) block=(256,1,1) lds=163840
.amdgcn_target "amdgcn-amd-amdhsa--gfx950"
.text
.globl gated_mix__memory_aug_recurrent_mem_tr__geglu_ffn__prompt_kernel
.p2align 8
.type gated_mix__memory_aug_recurrent_mem_tr__geglu_ffn__prompt_kernel,@function
gated_mix__memory_aug_recurrent_mem_tr__geglu_ffn__prompt_kernel:
  s_cmp_ge_u32 s2, 256
  s_cbranch_scc1 L_end
  s_load_dwordx4 s[88:91], s[0:1], 96
  s_load_dwordx16 s[64:79], s[0:1], 0
  s_load_dwordx8 s[80:87], s[0:1], 64
  s_load_dwordx2 s[92:93], s[0:1], 112
  s_getreg_b32 s28, hwreg(HW_REG_XCC_ID, 0, 3)
  v_lshrrev_b32 v1, 6, v0
  v_and_b32 v0, 63, v0
  v_readfirstlane_b32 s30, v1
  v_lshlrev_b32 v1, 4, v0
  v_mov_b32 v2, 0
  v_mov_b32 v3, 0
  v_mov_b32 v4, 0
  v_mov_b32 v5, 0
  v_mov_b32 v6, 0
  v_mov_b32 v7, 0
  v_mov_b32 v8, 0
  v_mov_b32 v9, 0
  v_mov_b32 v10, 0
  v_mov_b32 v11, 0
  v_mov_b32 v12, 0
  v_mov_b32 v13, 0
  v_mov_b32 v14, 0
  v_mov_b32 v15, 0
  v_mov_b32 v16, 0
  v_mov_b32 v17, 0
  v_mov_b32 v18, 0
  v_mov_b32 v19, 0
  v_mov_b32 v20, 0
  v_mov_b32 v21, 0
  v_mov_b32 v22, 0
  v_mov_b32 v23, 0
  v_mov_b32 v24, 0
  v_mov_b32 v25, 0
  v_mov_b32 v26, 0
  v_mov_b32 v27, 0
  v_mov_b32 v28, 0
  v_mov_b32 v29, 0
  v_mov_b32 v30, 0
  v_mov_b32 v31, 0
  s_mov_b32 s94, 100000
  s_mov_b32 s29, 0
  s_waitcnt lgkmcnt(0)
  s_mov_b32 s20, s90
  s_mov_b32 s21, s91
  s_mov_b32 s22, 0x100
  s_mov_b32 s23, 0x20000
  s_mov_b32 s4, s92
  s_mov_b32 s5, s93
  s_mov_b32 s6, 0x10000000
  s_mov_b32 s7, 0x20000
  s_mov_b32 s8, s64
  s_mov_b32 s9, s65
  s_mov_b32 s10, 0x400000
  s_mov_b32 s11, 0x20000
  s_mov_b32 s12, s68
  s_mov_b32 s13, s69
  s_mov_b32 s14, 0x800000
  s_mov_b32 s15, 0x20000
  s_mov_b32 s16, s70
  s_mov_b32 s17, s71
  s_mov_b32 s18, 0x800000
  s_mov_b32 s19, 0x20000
  s_mov_b32 s24, s88
  s_mov_b32 s25, s89
  s_mov_b32 s26, 0x400000
  s_mov_b32 s27, 0x20000
  s_cmp_lg_u32 s30, 0
  s_cbranch_scc1 C_wait
  s_lshl_b32 s32, s28, 4
  v_mov_b32 v2, s32
  v_mov_b32 v3, 1
  s_mov_b64 exec, 1
  buffer_atomic_add v3, v2, s[20:23], 0 offen sc0
  s_waitcnt vmcnt(0)
  s_mov_b64 exec, -1
  v_readfirstlane_b32 s29, v3
  s_nop 0
  s_cmp_lt_u32 s29, 32
  s_cbranch_scc1 C_got
  v_mov_b32 v2, 128
  v_mov_b32 v3, 1
  s_mov_b64 exec, 1
  buffer_atomic_add v3, v2, s[20:23], 0 offen sc0
  s_waitcnt vmcnt(0)
  s_mov_b64 exec, -1
  v_readfirstlane_b32 s33, v3
  v_and_b32 v2, 0x70, v1
C_sp:
  buffer_load_dword v3, v2, s[20:23], 0 offen sc1
  s_waitcnt vmcnt(0)
  s_mov_b32 s34, 0
  v_readlane_b32 s40, v3, 0
  s_nop 0
  s_add_u32 s34, s34, s40
  v_readlane_b32 s41, v3, 1
  s_nop 0
  s_add_u32 s34, s34, s41
  v_readlane_b32 s42, v3, 2
  s_nop 0
  s_add_u32 s34, s34, s42
  v_readlane_b32 s43, v3, 3
  s_nop 0
  s_add_u32 s34, s34, s43
  v_readlane_b32 s44, v3, 4
  s_nop 0
  s_add_u32 s34, s34, s44
  v_readlane_b32 s45, v3, 5
  s_nop 0
  s_add_u32 s34, s34, s45
  v_readlane_b32 s46, v3, 6
  s_nop 0
  s_add_u32 s34, s34, s46
  v_readlane_b32 s47, v3, 7
  s_nop 0
  s_add_u32 s34, s34, s47
  s_cmp_ge_u32 s34, 256
  s_cbranch_scc1 C_all
  s_sleep 4
  s_sub_u32 s94, s94, 1
  s_cbranch_scc0 C_sp
  s_mov_b32 s94, 0
C_all:
  s_min_u32 s35, s40, 32
  s_sub_u32 s36, 32, s35
  s_mov_b32 s28, 0
  s_add_u32 s29, s35, s33
  s_cmp_lt_u32 s33, s36
  s_cbranch_scc1 C_got
  s_sub_u32 s33, s33, s36
  s_min_u32 s35, s41, 32
  s_sub_u32 s36, 32, s35
  s_mov_b32 s28, 1
  s_add_u32 s29, s35, s33
  s_cmp_lt_u32 s33, s36
  s_cbranch_scc1 C_got
  s_sub_u32 s33, s33, s36
  s_min_u32 s35, s42, 32
  s_sub_u32 s36, 32, s35
  s_mov_b32 s28, 2
  s_add_u32 s29, s35, s33
  s_cmp_lt_u32 s33, s36
  s_cbranch_scc1 C_got
  s_sub_u32 s33, s33, s36
  s_min_u32 s35, s43, 32
  s_sub_u32 s36, 32, s35
  s_mov_b32 s28, 3
  s_add_u32 s29, s35, s33
  s_cmp_lt_u32 s33, s36
  s_cbranch_scc1 C_got
  s_sub_u32 s33, s33, s36
  s_min_u32 s35, s44, 32
  s_sub_u32 s36, 32, s35
  s_mov_b32 s28, 4
  s_add_u32 s29, s35, s33
  s_cmp_lt_u32 s33, s36
  s_cbranch_scc1 C_got
  s_sub_u32 s33, s33, s36
  s_min_u32 s35, s45, 32
  s_sub_u32 s36, 32, s35
  s_mov_b32 s28, 5
  s_add_u32 s29, s35, s33
  s_cmp_lt_u32 s33, s36
  s_cbranch_scc1 C_got
  s_sub_u32 s33, s33, s36
  s_min_u32 s35, s46, 32
  s_sub_u32 s36, 32, s35
  s_mov_b32 s28, 6
  s_add_u32 s29, s35, s33
  s_cmp_lt_u32 s33, s36
  s_cbranch_scc1 C_got
  s_sub_u32 s33, s33, s36
  s_min_u32 s35, s47, 32
  s_sub_u32 s36, 32, s35
  s_mov_b32 s28, 7
  s_add_u32 s29, s35, s33
  s_cmp_lt_u32 s33, s36
  s_cbranch_scc1 C_got
  s_sub_u32 s33, s33, s36
C_got:
  s_lshl_b32 s32, s28, 8
  s_or_b32 s32, s32, s29
  v_mov_b32 v3, s32
  v_mov_b32 v2, 163836
  ds_write_b32 v2, v3
  s_waitcnt lgkmcnt(0)
C_wait:
  s_barrier
  v_mov_b32 v2, 163836
  ds_read_b32 v3, v2
  s_waitcnt lgkmcnt(0)
  v_readfirstlane_b32 s32, v3
  s_barrier
  s_and_b32 s29, s32, 31
  s_lshr_b32 s28, s32, 8
  s_and_b32 s28, s28, 7
  s_cmp_eq_u32 s28, 0
  s_cbranch_scc1 R_start
  s_cmp_eq_u32 s28, 2
  s_cbranch_scc1 R_start
  s_sub_u32 s31, s28, 2
  s_cmp_eq_u32 s28, 1
  s_cselect_b32 s31, 0, s31
  s_cmp_lg_u32 s28, 6
  s_cbranch_scc1 C_np
  s_cmp_lg_u32 s30, 0
  s_cbranch_scc1 G_start
  s_lshl_b32 s56, s29, 16
  s_add_u32 s56, s56, 7168
  s_add_u32 s57, s56, 8192
  s_mov_b64 exec, 1
  v_mov_b32 v4, 0
  v_mov_b32 v5, 0
  buffer_store_dword v4, off, s[4:7], s56 sc1
  buffer_store_dword v4, off, s[4:7], s57 sc1
  s_waitcnt vmcnt(0)
  s_memtime s[58:59]
  s_waitcnt lgkmcnt(0)
  buffer_load_dword v6, off, s[4:7], s56 sc1
  s_waitcnt vmcnt(0)
  s_memtime s[60:61]
  s_waitcnt lgkmcnt(0)
  s_sub_u32 s58, s58, s60
  v_max_u32 v4, s58, v4
  s_memtime s[58:59]
  s_waitcnt lgkmcnt(0)
  buffer_load_dword v6, off, s[4:7], s57 sc1
  s_waitcnt vmcnt(0)
  s_memtime s[60:61]
  s_waitcnt lgkmcnt(0)
  s_sub_u32 s58, s58, s60
  v_max_u32 v5, s58, v5
  buffer_store_dword v4, off, s[4:7], s56 sc1
  buffer_store_dword v4, off, s[4:7], s57 sc1
  s_waitcnt vmcnt(0)
  s_memtime s[58:59]
  s_waitcnt lgkmcnt(0)
  buffer_load_dword v6, off, s[4:7], s56 sc1
  s_waitcnt vmcnt(0)
  s_memtime s[60:61]
  s_waitcnt lgkmcnt(0)
  s_sub_u32 s58, s58, s60
  v_max_u32 v4, s58, v4
  s_memtime s[58:59]
  s_waitcnt lgkmcnt(0)
  buffer_load_dword v6, off, s[4:7], s57 sc1
  s_waitcnt vmcnt(0)
  s_memtime s[60:61]
  s_waitcnt lgkmcnt(0)
  s_sub_u32 s58, s58, s60
  v_max_u32 v5, s58, v5
  buffer_store_dword v4, off, s[4:7], s56 sc1
  buffer_store_dword v4, off, s[4:7], s57 sc1
  s_waitcnt vmcnt(0)
  s_memtime s[58:59]
  s_waitcnt lgkmcnt(0)
  buffer_load_dword v6, off, s[4:7], s56 sc1
  s_waitcnt vmcnt(0)
  s_memtime s[60:61]
  s_waitcnt lgkmcnt(0)
  s_sub_u32 s58, s58, s60
  v_max_u32 v4, s58, v4
  s_memtime s[58:59]
  s_waitcnt lgkmcnt(0)
  buffer_load_dword v6, off, s[4:7], s57 sc1
  s_waitcnt vmcnt(0)
  s_memtime s[60:61]
  s_waitcnt lgkmcnt(0)
  s_sub_u32 s58, s58, s60
  v_max_u32 v5, s58, v5
  buffer_atomic_umax v4, off, s[20:23], 0 offset:176
  buffer_atomic_umax v5, off, s[20:23], 0 offset:180
  v_mov_b32 v6, 1
  s_waitcnt vmcnt(0)
  buffer_atomic_add v6, off, s[20:23], 0 offset:160
  s_mov_b64 exec, -1
C_np:
  s_cmp_lg_u32 s32, 1823
  s_cbranch_scc1 G_start
  s_cmp_lg_u32 s30, 3
  s_cbranch_scc1 G_start
  v_lshlrev_b32 v2, 7, v0
  v_mov_b32 v3, 0
  s_mov_b32 s33, 2621440
  buffer_store_dword v3, v2, s[4:7], s33 offen sc1
  s_mov_b32 s33, 2629632
  buffer_store_dword v3, v2, s[4:7], s33 offen sc1
  s_mov_b32 s33, 2637824
  buffer_store_dword v3, v2, s[4:7], s33 offen sc1
  s_mov_b32 s33, 2646016
  buffer_store_dword v3, v2, s[4:7], s33 offen sc1
  s_mov_b32 s33, 2654208
  buffer_store_dword v3, v2, s[4:7], s33 offen sc1
  s_mov_b32 s33, 2662400
  buffer_store_dword v3, v2, s[4:7], s33 offen sc1
  s_mov_b32 s33, 2670592
  buffer_store_dword v3, v2, s[4:7], s33 offen sc1
  s_mov_b32 s33, 2678784
  buffer_store_dword v3, v2, s[4:7], s33 offen sc1
  s_waitcnt vmcnt(0)
  v_mov_b32 v2, 144
  v_mov_b32 v3, 1
  buffer_store_dword v3, v2, s[20:23], 0 offen sc1
  s_branch G_start
G_start:
  s_mov_b32 s53, 0
  s_mov_b32 s52, 0
  s_mov_b32 s48, 0
  s_mov_b32 s55, 0
  s_mov_b32 s54, 0
  s_lshl_b32 s49, s31, 4
  s_lshl_b32 s95, s30, 10
  v_mov_b32 v15, 1
  s_branch G_disp
G_next:
  s_mov_b32 s48, s47
  s_mov_b32 s54, s52
  s_mov_b32 s55, s53
G_next2:
  s_add_u32 s49, s49, 1
G_disp:
  s_cmp_lg_u32 s49, 0
  s_cbranch_scc1 d_1
  s_and_b32 s50, s29, 1
  s_add_u32 s50, s50, 0
  s_lshr_b32 s51, s29, 1
  s_add_u32 s51, s51, 0
  s_branch G_s_sv
d_1:
  s_cmp_lg_u32 s49, 1
  s_cbranch_scc1 d_2
  s_mov_b32 s47, 7
  s_branch G_epi
d_2:
  s_cmp_lg_u32 s49, 2
  s_cbranch_scc1 d_3
  s_and_b32 s50, s29, 7
  s_add_u32 s50, s50, 0
  s_lshr_b32 s51, s29, 3
  s_add_u32 s51, s51, 0
  s_branch G_s_up
d_3:
  s_cmp_lg_u32 s49, 3
  s_cbranch_scc1 d_4
  s_and_b32 s50, s29, 1
  s_add_u32 s50, s50, 3
  s_lshr_b32 s51, s29, 1
  s_add_u32 s51, s51, 0
  s_branch G_s_bk
d_4:
  s_cmp_lg_u32 s49, 4
  s_cbranch_scc1 d_5
  s_mov_b32 s47, 7
  s_branch G_epi
d_5:
  s_cmp_lg_u32 s49, 5
  s_cbranch_scc1 d_6
  s_and_b32 s50, s29, 7
  s_add_u32 s50, s50, 0
  s_lshr_b32 s51, s29, 3
  s_add_u32 s51, s51, 4
  s_branch G_s_dn
d_6:
  s_cmp_lg_u32 s49, 6
  s_cbranch_scc1 d_7
  s_mov_b32 s47, 7
  s_branch G_epi
d_7:
  s_cmp_lg_u32 s49, 16
  s_cbranch_scc1 d_8
  s_and_b32 s50, s29, 1
  s_add_u32 s50, s50, 0
  s_lshr_b32 s51, s29, 1
  s_add_u32 s51, s51, 16
  s_branch G_s_sv
d_8:
  s_cmp_lg_u32 s49, 17
  s_cbranch_scc1 d_9
  s_mov_b32 s47, 7
  s_branch G_epi
d_9:
  s_cmp_lg_u32 s49, 18
  s_cbranch_scc1 d_10
  s_and_b32 s50, s29, 7
  s_add_u32 s50, s50, 0
  s_lshr_b32 s51, s29, 3
  s_add_u32 s51, s51, 4
  s_branch G_s_up
d_10:
  s_cmp_lg_u32 s49, 19
  s_cbranch_scc1 d_11
  s_and_b32 s50, s29, 1
  s_add_u32 s50, s50, 3
  s_lshr_b32 s51, s29, 1
  s_add_u32 s51, s51, 0
  s_branch G_s_bv
d_11:
  s_cmp_lg_u32 s49, 20
  s_cbranch_scc1 d_12
  s_mov_b32 s47, 7
  s_branch G_epi
d_12:
  s_cmp_lg_u32 s49, 21
  s_cbranch_scc1 d_13
  s_and_b32 s50, s29, 7
  s_add_u32 s50, s50, 0
  s_lshr_b32 s51, s29, 3
  s_add_u32 s51, s51, 8
  s_branch G_s_dn
d_13:
  s_cmp_lg_u32 s49, 22
  s_cbranch_scc1 d_14
  s_mov_b32 s47, 7
  s_branch G_epi
d_14:
  s_cmp_lg_u32 s49, 32
  s_cbranch_scc1 d_15
  s_and_b32 s50, s29, 1
  s_add_u32 s50, s50, 0
  s_lshr_b32 s51, s29, 1
  s_add_u32 s51, s51, 0
  s_branch G_s_sk
d_15:
  s_cmp_lg_u32 s49, 33
  s_cbranch_scc1 d_16
  s_mov_b32 s47, 7
  s_branch G_epi
d_16:
  s_cmp_lg_u32 s49, 34
  s_cbranch_scc1 d_17
  s_and_b32 s50, s29, 7
  s_add_u32 s50, s50, 0
  s_lshr_b32 s51, s29, 3
  s_add_u32 s51, s51, 8
  s_branch G_s_up
d_17:
  s_cmp_lg_u32 s49, 35
  s_cbranch_scc1 d_18
  s_and_b32 s50, s29, 7
  s_add_u32 s50, s50, 0
  s_lshr_b32 s51, s29, 3
  s_add_u32 s51, s51, 24
  s_branch G_s_up
d_18:
  s_cmp_lg_u32 s49, 36
  s_cbranch_scc1 d_19
  s_mov_b32 s47, 7
  s_branch G_epi
d_19:
  s_cmp_lg_u32 s49, 37
  s_cbranch_scc1 d_20
  s_and_b32 s50, s29, 7
  s_add_u32 s50, s50, 0
  s_lshr_b32 s51, s29, 3
  s_add_u32 s51, s51, 12
  s_branch G_s_dn
d_20:
  s_cmp_lg_u32 s49, 38
  s_cbranch_scc1 d_21
  s_mov_b32 s47, 7
  s_branch G_epi
d_21:
  s_cmp_lg_u32 s49, 39
  s_cbranch_scc1 d_22
  s_mov_b32 s50, 7
  s_and_b32 s51, s29, 15
  s_cmp_lt_u32 s29, 16
  s_cbranch_scc1 G_s_bk
  s_branch G_s_bv
d_22:
  s_cmp_lg_u32 s49, 40
  s_cbranch_scc1 d_23
  s_mov_b32 s47, 7
  s_branch G_epi
d_23:
  s_cmp_lg_u32 s49, 48
  s_cbranch_scc1 d_24
  s_and_b32 s50, s29, 1
  s_add_u32 s50, s50, 0
  s_lshr_b32 s51, s29, 1
  s_add_u32 s51, s51, 16
  s_branch G_s_sk
d_24:
  s_cmp_lg_u32 s49, 49
  s_cbranch_scc1 d_25
  s_mov_b32 s47, 7
  s_branch G_epi
d_25:
  s_cmp_lg_u32 s49, 50
  s_cbranch_scc1 d_26
  s_and_b32 s50, s29, 7
  s_add_u32 s50, s50, 0
  s_lshr_b32 s51, s29, 3
  s_add_u32 s51, s51, 12
  s_branch G_s_up
d_26:
  s_cmp_lg_u32 s49, 51
  s_cbranch_scc1 d_27
  s_and_b32 s50, s29, 1
  s_add_u32 s50, s50, 0
  s_lshr_b32 s51, s29, 1
  s_add_u32 s51, s51, 0
  s_branch G_s_bq
d_27:
  s_cmp_lg_u32 s49, 52
  s_cbranch_scc1 d_28
  s_and_b32 s50, s29, 7
  s_add_u32 s50, s50, 0
  s_lshr_b32 s51, s29, 3
  s_add_u32 s51, s51, 0
  s_branch G_s_dn
d_28:
  s_cmp_lg_u32 s49, 53
  s_cbranch_scc1 d_29
  s_and_b32 s50, s29, 1
  s_add_u32 s50, s50, 6
  s_lshr_b32 s51, s29, 1
  s_add_u32 s51, s51, 0
  s_branch G_s_bq
d_29:
  s_cmp_lg_u32 s49, 54
  s_cbranch_scc1 d_30
  s_mov_b32 s47, 7
  s_branch G_epi
d_30:
  s_cmp_lg_u32 s49, 64
  s_cbranch_scc1 d_31
  s_and_b32 s50, s29, 1
  s_add_u32 s50, s50, 1
  s_lshr_b32 s51, s29, 1
  s_add_u32 s51, s51, 0
  s_branch G_s_bk
d_31:
  s_cmp_lg_u32 s49, 65
  s_cbranch_scc1 d_32
  s_mov_b32 s47, 7
  s_branch G_epi
d_32:
  s_cmp_lg_u32 s49, 66
  s_cbranch_scc1 d_33
  s_and_b32 s50, s29, 7
  s_add_u32 s50, s50, 0
  s_lshr_b32 s51, s29, 3
  s_add_u32 s51, s51, 16
  s_branch G_s_up
d_33:
  s_cmp_lg_u32 s49, 67
  s_cbranch_scc1 d_34
  s_and_b32 s50, s29, 1
  s_add_u32 s50, s50, 5
  s_lshr_b32 s51, s29, 1
  s_add_u32 s51, s51, 0
  s_branch G_s_bk
d_34:
  s_cmp_lg_u32 s49, 68
  s_cbranch_scc1 d_35
  s_and_b32 s50, s29, 1
  s_add_u32 s50, s50, 2
  s_lshr_b32 s51, s29, 1
  s_add_u32 s51, s51, 0
  s_branch G_s_bq
d_35:
  s_cmp_lg_u32 s49, 69
  s_cbranch_scc1 d_36
  s_mov_b32 s47, 7
  s_branch G_epi
d_36:
  s_cmp_lg_u32 s49, 80
  s_cbranch_scc1 d_37
  s_and_b32 s50, s29, 1
  s_add_u32 s50, s50, 1
  s_lshr_b32 s51, s29, 1
  s_add_u32 s51, s51, 0
  s_branch G_s_bv
d_37:
  s_cmp_lg_u32 s49, 81
  s_cbranch_scc1 d_38
  s_mov_b32 s47, 7
  s_branch G_epi
d_38:
  s_cmp_lg_u32 s49, 82
  s_cbranch_scc1 d_39
  s_and_b32 s50, s29, 7
  s_add_u32 s50, s50, 0
  s_lshr_b32 s51, s29, 3
  s_add_u32 s51, s51, 20
  s_branch G_s_up
d_39:
  s_cmp_lg_u32 s49, 83
  s_cbranch_scc1 d_40
  s_and_b32 s50, s29, 1
  s_add_u32 s50, s50, 5
  s_lshr_b32 s51, s29, 1
  s_add_u32 s51, s51, 0
  s_branch G_s_bv
d_40:
  s_cmp_lg_u32 s49, 84
  s_cbranch_scc1 d_41
  s_and_b32 s50, s29, 1
  s_add_u32 s50, s50, 4
  s_lshr_b32 s51, s29, 1
  s_add_u32 s51, s51, 0
  s_branch G_s_bq
d_41:
  s_cmp_lg_u32 s49, 85
  s_cbranch_scc1 d_42
  s_mov_b32 s47, 7
  s_branch G_epi
d_42:
  s_branch T_start
G_s_bk:
  s_mov_b32 s47, 1
  s_mov_b32 s96, 16
  s_mov_b32 s45, 524288
  s_lshr_b32 s56, s30, 1
  s_and_b32 s57, s30, 1
  s_mov_b32 s12, s70
  s_mov_b32 s13, s71
  s_mov_b32 s14, 0x800000
  s_mov_b32 s15, 0x20000
  s_mov_b32 s16, s70
  s_mov_b32 s17, s71
  s_mov_b32 s18, 0x800000
  s_mov_b32 s19, 0x20000
  s_mov_b32 s40, 0
  s_mov_b32 s41, 131072
  s_mov_b32 s42, 262144
  s_mov_b32 s43, 393216
  v_lshrrev_b32 v16, 4, v0
  s_lshl_b32 s58, s56, 2
  v_or_b32 v17, s58, v16
  v_bfe_u32 v18, v0, 1, 3
  v_xor_b32 v17, v17, v18
  v_lshlrev_b32 v17, 5, v17
  v_and_b32 v18, 1, v0
  v_lshl_add_u32 v17, v18, 4, v17
  s_lshl_b32 s58, s30, 2
  v_add_u32 v16, s58, v16
  v_mul_u32_u24 v16, 8192, v16
  s_lshl_b32 s58, s51, 9
  v_add3_u32 v3, v16, v17, s58
  v_add_u32 v24, 256, v3
  s_mov_b32 s8, s64
  s_mov_b32 s9, s65
  s_mov_b32 s10, 0x400000
  s_mov_b32 s11, 0x20000
  s_mov_b32 s32, 0
  s_mov_b32 s33, 65536
  s_mov_b32 s34, 131072
  s_mov_b32 s35, 196608
  s_mov_b32 s36, 262144
  s_mov_b32 s37, 327680
  s_mov_b32 s38, 393216
  s_mov_b32 s39, 458752
  s_mov_b32 s44, 128
  v_lshrrev_b32 v16, 4, v0
  s_lshl_b32 s58, s57, 2
  v_or_b32 v16, s58, v16
  v_and_b32 v17, 7, v0
  v_xor_b32 v16, v16, v17
  v_lshrrev_b32 v17, 3, v0
  v_lshlrev_b32 v17, 11, v17
  v_lshl_add_u32 v16, v16, 4, v17
  s_lshl_b32 s58, s50, 19
  s_lshl_b32 s59, s30, 14
  s_add_u32 s58, s58, s59
  v_add_u32 v2, s58, v16
  v_and_b32 v16, 15, v0
  v_lshrrev_b32 v17, 4, v0
  v_lshrrev_b32 v18, 1, v16
  v_xor_b32 v17, v17, v18
  v_lshlrev_b32 v16, 7, v16
  v_lshl_add_u32 v16, v17, 4, v16
  s_mul_i32 s58, s56, 16384
  s_add_u32 s58, s58, 98304
  v_add_u32 v4, s58, v16
  v_xor_b32 v5, 64, v4
  s_add_u32 m0, s95, 0
  s_nop 0
  buffer_load_dwordx4 v3, s[12:15], s40 offen  lds
  s_add_u32 m0, s95, 98304
  s_nop 0
  buffer_load_dwordx4 v2, s[8:11], s32 offen sc1 lds
  s_add_u32 m0, s95, 4096
  s_nop 0
  buffer_load_dwordx4 v3, s[12:15], s41 offen  lds
  s_add_u32 m0, s95, 102400
  s_nop 0
  buffer_load_dwordx4 v2, s[8:11], s33 offen sc1 lds
  s_add_u32 m0, s95, 8192
  s_nop 0
  buffer_load_dwordx4 v3, s[12:15], s42 offen  lds
  s_add_u32 m0, s95, 106496
  s_nop 0
  buffer_load_dwordx4 v2, s[8:11], s34 offen sc1 lds
  s_add_u32 m0, s95, 12288
  s_nop 0
  buffer_load_dwordx4 v3, s[12:15], s43 offen  lds
  s_add_u32 m0, s95, 110592
  s_nop 0
  buffer_load_dwordx4 v2, s[8:11], s35 offen sc1 lds
  s_add_u32 m0, s95, 16384
  s_nop 0
  buffer_load_dwordx4 v24, s[16:19], s40 offen  lds
  s_add_u32 m0, s95, 114688
  s_nop 0
  buffer_load_dwordx4 v2, s[8:11], s36 offen sc1 lds
  s_add_u32 m0, s95, 20480
  s_nop 0
  buffer_load_dwordx4 v24, s[16:19], s41 offen  lds
  s_add_u32 m0, s95, 118784
  s_nop 0
  buffer_load_dwordx4 v2, s[8:11], s37 offen sc1 lds
  s_add_u32 m0, s95, 24576
  s_nop 0
  buffer_load_dwordx4 v24, s[16:19], s42 offen  lds
  s_add_u32 m0, s95, 122880
  s_nop 0
  buffer_load_dwordx4 v2, s[8:11], s38 offen sc1 lds
  s_add_u32 m0, s95, 28672
  s_nop 0
  buffer_load_dwordx4 v24, s[16:19], s43 offen  lds
  s_add_u32 m0, s95, 126976
  s_nop 0
  buffer_load_dwordx4 v2, s[8:11], s39 offen sc1 lds
  v_add_u32 v2, s44, v2
  v_add_u32 v3, s45, v3
  v_add_u32 v24, s45, v24
  s_add_u32 m0, s95, 32768
  s_nop 0
  buffer_load_dwordx4 v3, s[12:15], s40 offen  lds
  s_add_u32 m0, s95, 131072
  s_nop 0
  buffer_load_dwordx4 v2, s[8:11], s32 offen sc1 lds
  s_add_u32 m0, s95, 36864
  s_nop 0
  buffer_load_dwordx4 v3, s[12:15], s41 offen  lds
  s_add_u32 m0, s95, 135168
  s_nop 0
  buffer_load_dwordx4 v2, s[8:11], s33 offen sc1 lds
  s_add_u32 m0, s95, 40960
  s_nop 0
  buffer_load_dwordx4 v3, s[12:15], s42 offen  lds
  s_add_u32 m0, s95, 139264
  s_nop 0
  buffer_load_dwordx4 v2, s[8:11], s34 offen sc1 lds
  s_add_u32 m0, s95, 45056
  s_nop 0
  buffer_load_dwordx4 v3, s[12:15], s43 offen  lds
  s_add_u32 m0, s95, 143360
  s_nop 0
  buffer_load_dwordx4 v2, s[8:11], s35 offen sc1 lds
  s_add_u32 m0, s95, 49152
  s_nop 0
  buffer_load_dwordx4 v24, s[16:19], s40 offen  lds
  s_add_u32 m0, s95, 147456
  s_nop 0
  buffer_load_dwordx4 v2, s[8:11], s36 offen sc1 lds
  s_add_u32 m0, s95, 53248
  s_nop 0
  buffer_load_dwordx4 v24, s[16:19], s41 offen  lds
  s_add_u32 m0, s95, 151552
  s_nop 0
  buffer_load_dwordx4 v2, s[8:11], s37 offen sc1 lds
  s_add_u32 m0, s95, 57344
  s_nop 0
  buffer_load_dwordx4 v24, s[16:19], s42 offen  lds
  s_add_u32 m0, s95, 155648
  s_nop 0
  buffer_load_dwordx4 v2, s[8:11], s38 offen sc1 lds
  s_add_u32 m0, s95, 61440
  s_nop 0
  buffer_load_dwordx4 v24, s[16:19], s43 offen  lds
  s_add_u32 m0, s95, 159744
  s_nop 0
  buffer_load_dwordx4 v2, s[8:11], s39 offen sc1 lds
  v_add_u32 v2, s44, v2
  v_add_u32 v3, s45, v3
  v_add_u32 v24, s45, v24
  s_lshl_b32 s58, s50, 4
  s_and_b32 s59, s51, 15
  s_add_u32 s58, s58, s59
  s_lshl_b32 s58, s58, 2
  s_add_u32 s58, s58, s30
  s_lshl_b32 s58, s58, 13
  v_lshlrev_b32 v16, 7, v0
  buffer_load_dword v22, v16, s[8:11], s58 offen
  v_lshrrev_b32 v16, 4, v0
  v_bfe_u32 v17, v0, 2, 2
  v_lshl_add_u32 v16, v16, 3, v17
  v_lshlrev_b32 v16, 8, v16
  v_and_b32 v17, 3, v0
  v_lshl_add_u32 v16, v17, 3, v16
  v_bfe_u32 v17, v0, 2, 3
  v_lshl_add_u32 v16, v17, 5, v16
  s_lshl_b32 s58, s57, 14
  v_add_u32 v16, s58, v16
  v_xor_b32 v6, 0, v16
  v_xor_b32 v7, 32, v16
  v_xor_b32 v8, 64, v16
  v_xor_b32 v9, 96, v16
  v_xor_b32 v10, 128, v16
  v_xor_b32 v11, 160, v16
  v_xor_b32 v12, 192, v16
  v_xor_b32 v13, 224, v16
  s_lshl_b32 s58, s50, 21
  s_lshl_b32 s59, s56, 20
  s_add_u32 s58, s58, s59
  s_lshl_b32 s59, s51, 14
  s_add_u32 s58, s58, s59
  s_lshl_b32 s59, s57, 13
  s_add_u32 s58, s58, s59
  s_add_u32 s52, s58, 33554432
  s_lshl_b32 s58, s50, 7
  s_add_u32 s58, s58, 2621568
  s_cmp_eq_u32 s30, 0
  s_cselect_b32 s53, s58, 0
  s_branch G_epi
G_s_bq:
  s_mov_b32 s47, 1
  s_mov_b32 s96, 16
  s_mov_b32 s45, 524288
  s_lshr_b32 s56, s30, 1
  s_and_b32 s57, s30, 1
  s_mov_b32 s12, s68
  s_mov_b32 s13, s69
  s_mov_b32 s14, 0x800000
  s_mov_b32 s15, 0x20000
  s_mov_b32 s16, s68
  s_mov_b32 s17, s69
  s_mov_b32 s18, 0x800000
  s_mov_b32 s19, 0x20000
  s_mov_b32 s40, 0
  s_mov_b32 s41, 131072
  s_mov_b32 s42, 262144
  s_mov_b32 s43, 393216
  v_lshrrev_b32 v16, 4, v0
  s_lshl_b32 s58, s56, 2
  v_or_b32 v17, s58, v16
  v_bfe_u32 v18, v0, 1, 3
  v_xor_b32 v17, v17, v18
  v_lshlrev_b32 v17, 5, v17
  v_and_b32 v18, 1, v0
  v_lshl_add_u32 v17, v18, 4, v17
  s_lshl_b32 s58, s30, 2
  v_add_u32 v16, s58, v16
  v_mul_u32_u24 v16, 8192, v16
  s_lshl_b32 s58, s51, 9
  v_add3_u32 v3, v16, v17, s58
  v_add_u32 v24, 256, v3
  s_mov_b32 s8, s64
  s_mov_b32 s9, s65
  s_mov_b32 s10, 0x400000
  s_mov_b32 s11, 0x20000
  s_mov_b32 s32, 0
  s_mov_b32 s33, 65536
  s_mov_b32 s34, 131072
  s_mov_b32 s35, 196608
  s_mov_b32 s36, 262144
  s_mov_b32 s37, 327680
  s_mov_b32 s38, 393216
  s_mov_b32 s39, 458752
  s_mov_b32 s44, 128
  v_lshrrev_b32 v16, 4, v0
  s_lshl_b32 s58, s57, 2
  v_or_b32 v16, s58, v16
  v_and_b32 v17, 7, v0
  v_xor_b32 v16, v16, v17
  v_lshrrev_b32 v17, 3, v0
  v_lshlrev_b32 v17, 11, v17
  v_lshl_add_u32 v16, v16, 4, v17
  s_lshl_b32 s58, s50, 19
  s_lshl_b32 s59, s30, 14
  s_add_u32 s58, s58, s59
  v_add_u32 v2, s58, v16
  v_and_b32 v16, 15, v0
  v_lshrrev_b32 v17, 4, v0
  v_lshrrev_b32 v18, 1, v16
  v_xor_b32 v17, v17, v18
  v_lshlrev_b32 v16, 7, v16
  v_lshl_add_u32 v16, v17, 4, v16
  s_mul_i32 s58, s56, 16384
  s_add_u32 s58, s58, 98304
  v_add_u32 v4, s58, v16
  v_xor_b32 v5, 64, v4
  s_add_u32 m0, s95, 0
  s_nop 0
  buffer_load_dwordx4 v3, s[12:15], s40 offen  lds
  s_add_u32 m0, s95, 98304
  s_nop 0
  buffer_load_dwordx4 v2, s[8:11], s32 offen sc1 lds
  s_add_u32 m0, s95, 4096
  s_nop 0
  buffer_load_dwordx4 v3, s[12:15], s41 offen  lds
  s_add_u32 m0, s95, 102400
  s_nop 0
  buffer_load_dwordx4 v2, s[8:11], s33 offen sc1 lds
  s_add_u32 m0, s95, 8192
  s_nop 0
  buffer_load_dwordx4 v3, s[12:15], s42 offen  lds
  s_add_u32 m0, s95, 106496
  s_nop 0
  buffer_load_dwordx4 v2, s[8:11], s34 offen sc1 lds
  s_add_u32 m0, s95, 12288
  s_nop 0
  buffer_load_dwordx4 v3, s[12:15], s43 offen  lds
  s_add_u32 m0, s95, 110592
  s_nop 0
  buffer_load_dwordx4 v2, s[8:11], s35 offen sc1 lds
  s_add_u32 m0, s95, 16384
  s_nop 0
  buffer_load_dwordx4 v24, s[16:19], s40 offen  lds
  s_add_u32 m0, s95, 114688
  s_nop 0
  buffer_load_dwordx4 v2, s[8:11], s36 offen sc1 lds
  s_add_u32 m0, s95, 20480
  s_nop 0
  buffer_load_dwordx4 v24, s[16:19], s41 offen  lds
  s_add_u32 m0, s95, 118784
  s_nop 0
  buffer_load_dwordx4 v2, s[8:11], s37 offen sc1 lds
  s_add_u32 m0, s95, 24576
  s_nop 0
  buffer_load_dwordx4 v24, s[16:19], s42 offen  lds
  s_add_u32 m0, s95, 122880
  s_nop 0
  buffer_load_dwordx4 v2, s[8:11], s38 offen sc1 lds
  s_add_u32 m0, s95, 28672
  s_nop 0
  buffer_load_dwordx4 v24, s[16:19], s43 offen  lds
  s_add_u32 m0, s95, 126976
  s_nop 0
  buffer_load_dwordx4 v2, s[8:11], s39 offen sc1 lds
  v_add_u32 v2, s44, v2
  v_add_u32 v3, s45, v3
  v_add_u32 v24, s45, v24
  s_add_u32 m0, s95, 32768
  s_nop 0
  buffer_load_dwordx4 v3, s[12:15], s40 offen  lds
  s_add_u32 m0, s95, 131072
  s_nop 0
  buffer_load_dwordx4 v2, s[8:11], s32 offen sc1 lds
  s_add_u32 m0, s95, 36864
  s_nop 0
  buffer_load_dwordx4 v3, s[12:15], s41 offen  lds
  s_add_u32 m0, s95, 135168
  s_nop 0
  buffer_load_dwordx4 v2, s[8:11], s33 offen sc1 lds
  s_add_u32 m0, s95, 40960
  s_nop 0
  buffer_load_dwordx4 v3, s[12:15], s42 offen  lds
  s_add_u32 m0, s95, 139264
  s_nop 0
  buffer_load_dwordx4 v2, s[8:11], s34 offen sc1 lds
  s_add_u32 m0, s95, 45056
  s_nop 0
  buffer_load_dwordx4 v3, s[12:15], s43 offen  lds
  s_add_u32 m0, s95, 143360
  s_nop 0
  buffer_load_dwordx4 v2, s[8:11], s35 offen sc1 lds
  s_add_u32 m0, s95, 49152
  s_nop 0
  buffer_load_dwordx4 v24, s[16:19], s40 offen  lds
  s_add_u32 m0, s95, 147456
  s_nop 0
  buffer_load_dwordx4 v2, s[8:11], s36 offen sc1 lds
  s_add_u32 m0, s95, 53248
  s_nop 0
  buffer_load_dwordx4 v24, s[16:19], s41 offen  lds
  s_add_u32 m0, s95, 151552
  s_nop 0
  buffer_load_dwordx4 v2, s[8:11], s37 offen sc1 lds
  s_add_u32 m0, s95, 57344
  s_nop 0
  buffer_load_dwordx4 v24, s[16:19], s42 offen  lds
  s_add_u32 m0, s95, 155648
  s_nop 0
  buffer_load_dwordx4 v2, s[8:11], s38 offen sc1 lds
  s_add_u32 m0, s95, 61440
  s_nop 0
  buffer_load_dwordx4 v24, s[16:19], s43 offen  lds
  s_add_u32 m0, s95, 159744
  s_nop 0
  buffer_load_dwordx4 v2, s[8:11], s39 offen sc1 lds
  v_add_u32 v2, s44, v2
  v_add_u32 v3, s45, v3
  v_add_u32 v24, s45, v24
  s_lshl_b32 s58, s50, 4
  s_and_b32 s59, s51, 15
  s_add_u32 s58, s58, s59
  s_lshl_b32 s58, s58, 2
  s_add_u32 s58, s58, s30
  s_lshl_b32 s58, s58, 13
  v_lshlrev_b32 v16, 7, v0
  buffer_load_dword v22, v16, s[8:11], s58 offen
  v_lshrrev_b32 v16, 4, v0
  v_bfe_u32 v17, v0, 2, 2
  v_lshl_add_u32 v16, v16, 3, v17
  v_lshlrev_b32 v16, 8, v16
  v_and_b32 v17, 3, v0
  v_lshl_add_u32 v16, v17, 3, v16
  v_bfe_u32 v17, v0, 2, 3
  v_lshl_add_u32 v16, v17, 5, v16
  s_lshl_b32 s58, s57, 14
  v_add_u32 v16, s58, v16
  v_xor_b32 v6, 0, v16
  v_xor_b32 v7, 32, v16
  v_xor_b32 v8, 64, v16
  v_xor_b32 v9, 96, v16
  v_xor_b32 v10, 128, v16
  v_xor_b32 v11, 160, v16
  v_xor_b32 v12, 192, v16
  v_xor_b32 v13, 224, v16
  s_lshl_b32 s58, s50, 21
  s_lshl_b32 s59, s56, 20
  s_add_u32 s58, s58, s59
  s_lshl_b32 s59, s51, 14
  s_add_u32 s58, s58, s59
  s_lshl_b32 s59, s57, 13
  s_add_u32 s58, s58, s59
  s_add_u32 s52, s58, 67108864
  s_lshl_b32 s58, s50, 7
  s_add_u32 s58, s58, 2623488
  s_cmp_eq_u32 s30, 0
  s_cselect_b32 s53, s58, 0
  s_branch G_epi
G_s_bv:
  s_mov_b32 s47, 2
  s_mov_b32 s96, 16
  s_mov_b32 s45, 524288
  s_lshr_b32 s56, s30, 1
  s_and_b32 s57, s30, 1
  s_mov_b32 s12, s72
  s_mov_b32 s13, s73
  s_mov_b32 s14, 0x800000
  s_mov_b32 s15, 0x20000
  s_mov_b32 s16, s72
  s_mov_b32 s17, s73
  s_mov_b32 s18, 0x800000
  s_mov_b32 s19, 0x20000
  s_mov_b32 s40, 0
  s_mov_b32 s41, 131072
  s_mov_b32 s42, 262144
  s_mov_b32 s43, 393216
  v_lshrrev_b32 v16, 4, v0
  s_lshl_b32 s58, s56, 2
  v_or_b32 v17, s58, v16
  v_bfe_u32 v18, v0, 1, 3
  v_xor_b32 v17, v17, v18
  v_lshlrev_b32 v17, 5, v17
  v_and_b32 v18, 1, v0
  v_lshl_add_u32 v17, v18, 4, v17
  s_lshl_b32 s58, s30, 2
  v_add_u32 v16, s58, v16
  v_mul_u32_u24 v16, 8192, v16
  s_lshl_b32 s58, s51, 9
  v_add3_u32 v3, v16, v17, s58
  v_add_u32 v24, 256, v3
  s_mov_b32 s8, s64
  s_mov_b32 s9, s65
  s_mov_b32 s10, 0x400000
  s_mov_b32 s11, 0x20000
  s_mov_b32 s32, 0
  s_mov_b32 s33, 65536
  s_mov_b32 s34, 131072
  s_mov_b32 s35, 196608
  s_mov_b32 s36, 262144
  s_mov_b32 s37, 327680
  s_mov_b32 s38, 393216
  s_mov_b32 s39, 458752
  s_mov_b32 s44, 128
  v_lshrrev_b32 v16, 4, v0
  s_lshl_b32 s58, s57, 2
  v_or_b32 v16, s58, v16
  v_and_b32 v17, 7, v0
  v_xor_b32 v16, v16, v17
  v_lshrrev_b32 v17, 3, v0
  v_lshlrev_b32 v17, 11, v17
  v_lshl_add_u32 v16, v16, 4, v17
  s_lshl_b32 s58, s50, 19
  s_lshl_b32 s59, s30, 14
  s_add_u32 s58, s58, s59
  v_add_u32 v2, s58, v16
  v_and_b32 v16, 15, v0
  v_lshrrev_b32 v17, 4, v0
  v_lshrrev_b32 v18, 1, v16
  v_xor_b32 v17, v17, v18
  v_lshlrev_b32 v16, 7, v16
  v_lshl_add_u32 v16, v17, 4, v16
  s_mul_i32 s58, s56, 16384
  s_add_u32 s58, s58, 98304
  v_add_u32 v4, s58, v16
  v_xor_b32 v5, 64, v4
  s_add_u32 m0, s95, 0
  s_nop 0
  buffer_load_dwordx4 v3, s[12:15], s40 offen  lds
  s_add_u32 m0, s95, 98304
  s_nop 0
  buffer_load_dwordx4 v2, s[8:11], s32 offen sc1 lds
  s_add_u32 m0, s95, 4096
  s_nop 0
  buffer_load_dwordx4 v3, s[12:15], s41 offen  lds
  s_add_u32 m0, s95, 102400
  s_nop 0
  buffer_load_dwordx4 v2, s[8:11], s33 offen sc1 lds
  s_add_u32 m0, s95, 8192
  s_nop 0
  buffer_load_dwordx4 v3, s[12:15], s42 offen  lds
  s_add_u32 m0, s95, 106496
  s_nop 0
  buffer_load_dwordx4 v2, s[8:11], s34 offen sc1 lds
  s_add_u32 m0, s95, 12288
  s_nop 0
  buffer_load_dwordx4 v3, s[12:15], s43 offen  lds
  s_add_u32 m0, s95, 110592
  s_nop 0
  buffer_load_dwordx4 v2, s[8:11], s35 offen sc1 lds
  s_add_u32 m0, s95, 16384
  s_nop 0
  buffer_load_dwordx4 v24, s[16:19], s40 offen  lds
  s_add_u32 m0, s95, 114688
  s_nop 0
  buffer_load_dwordx4 v2, s[8:11], s36 offen sc1 lds
  s_add_u32 m0, s95, 20480
  s_nop 0
  buffer_load_dwordx4 v24, s[16:19], s41 offen  lds
  s_add_u32 m0, s95, 118784
  s_nop 0
  buffer_load_dwordx4 v2, s[8:11], s37 offen sc1 lds
  s_add_u32 m0, s95, 24576
  s_nop 0
  buffer_load_dwordx4 v24, s[16:19], s42 offen  lds
  s_add_u32 m0, s95, 122880
  s_nop 0
  buffer_load_dwordx4 v2, s[8:11], s38 offen sc1 lds
  s_add_u32 m0, s95, 28672
  s_nop 0
  buffer_load_dwordx4 v24, s[16:19], s43 offen  lds
  s_add_u32 m0, s95, 126976
  s_nop 0
  buffer_load_dwordx4 v2, s[8:11], s39 offen sc1 lds
  v_add_u32 v2, s44, v2
  v_add_u32 v3, s45, v3
  v_add_u32 v24, s45, v24
  s_add_u32 m0, s95, 32768
  s_nop 0
  buffer_load_dwordx4 v3, s[12:15], s40 offen  lds
  s_add_u32 m0, s95, 131072
  s_nop 0
  buffer_load_dwordx4 v2, s[8:11], s32 offen sc1 lds
  s_add_u32 m0, s95, 36864
  s_nop 0
  buffer_load_dwordx4 v3, s[12:15], s41 offen  lds
  s_add_u32 m0, s95, 135168
  s_nop 0
  buffer_load_dwordx4 v2, s[8:11], s33 offen sc1 lds
  s_add_u32 m0, s95, 40960
  s_nop 0
  buffer_load_dwordx4 v3, s[12:15], s42 offen  lds
  s_add_u32 m0, s95, 139264
  s_nop 0
  buffer_load_dwordx4 v2, s[8:11], s34 offen sc1 lds
  s_add_u32 m0, s95, 45056
  s_nop 0
  buffer_load_dwordx4 v3, s[12:15], s43 offen  lds
  s_add_u32 m0, s95, 143360
  s_nop 0
  buffer_load_dwordx4 v2, s[8:11], s35 offen sc1 lds
  s_add_u32 m0, s95, 49152
  s_nop 0
  buffer_load_dwordx4 v24, s[16:19], s40 offen  lds
  s_add_u32 m0, s95, 147456
  s_nop 0
  buffer_load_dwordx4 v2, s[8:11], s36 offen sc1 lds
  s_add_u32 m0, s95, 53248
  s_nop 0
  buffer_load_dwordx4 v24, s[16:19], s41 offen  lds
  s_add_u32 m0, s95, 151552
  s_nop 0
  buffer_load_dwordx4 v2, s[8:11], s37 offen sc1 lds
  s_add_u32 m0, s95, 57344
  s_nop 0
  buffer_load_dwordx4 v24, s[16:19], s42 offen  lds
  s_add_u32 m0, s95, 155648
  s_nop 0
  buffer_load_dwordx4 v2, s[8:11], s38 offen sc1 lds
  s_add_u32 m0, s95, 61440
  s_nop 0
  buffer_load_dwordx4 v24, s[16:19], s43 offen  lds
  s_add_u32 m0, s95, 159744
  s_nop 0
  buffer_load_dwordx4 v2, s[8:11], s39 offen sc1 lds
  v_add_u32 v2, s44, v2
  v_add_u32 v3, s45, v3
  v_add_u32 v24, s45, v24
  s_lshl_b32 s58, s50, 4
  s_and_b32 s59, s51, 15
  s_add_u32 s58, s58, s59
  s_lshl_b32 s58, s58, 2
  s_add_u32 s58, s58, s30
  s_lshl_b32 s58, s58, 13
  v_lshlrev_b32 v16, 7, v0
  buffer_load_dword v22, v16, s[8:11], s58 offen
  v_lshrrev_b32 v16, 4, v0
  v_bfe_u32 v17, v0, 2, 2
  v_lshl_add_u32 v16, v16, 3, v17
  v_lshlrev_b32 v16, 8, v16
  v_and_b32 v17, 3, v0
  v_lshl_add_u32 v16, v17, 3, v16
  v_bfe_u32 v17, v0, 2, 3
  v_lshl_add_u32 v16, v17, 5, v16
  s_lshl_b32 s58, s57, 14
  v_add_u32 v16, s58, v16
  v_xor_b32 v6, 0, v16
  v_xor_b32 v7, 32, v16
  v_xor_b32 v8, 64, v16
  v_xor_b32 v9, 96, v16
  v_xor_b32 v10, 128, v16
  v_xor_b32 v11, 160, v16
  v_xor_b32 v12, 192, v16
  v_xor_b32 v13, 224, v16
  s_lshl_b32 s58, s50, 21
  s_lshl_b32 s59, s56, 20
  s_add_u32 s58, s58, s59
  s_lshl_b32 s59, s51, 14
  s_add_u32 s58, s58, s59
  s_lshl_b32 s59, s57, 13
  s_add_u32 s58, s58, s59
  s_add_u32 s52, s58, 50331648
  s_lshl_b32 s58, s50, 7
  s_add_u32 s58, s58, 2621568
  s_cmp_eq_u32 s30, 0
  s_cselect_b32 s53, s58, 0
  s_branch G_epi
G_s_up:
  s_mov_b32 s47, 3
  s_mov_b32 s96, 16
  s_mov_b32 s45, 458752
  s_lshr_b32 s56, s30, 1
  s_and_b32 s57, s30, 1
  s_mov_b32 s12, s80
  s_mov_b32 s13, s81
  s_mov_b32 s14, 0x700000
  s_mov_b32 s15, 0x20000
  s_mov_b32 s16, s82
  s_mov_b32 s17, s83
  s_mov_b32 s18, 0x700000
  s_mov_b32 s19, 0x20000
  s_mov_b32 s40, 0
  s_mov_b32 s41, 114688
  s_mov_b32 s42, 229376
  s_mov_b32 s43, 344064
  v_lshrrev_b32 v16, 4, v0
  s_lshl_b32 s58, s56, 2
  v_or_b32 v17, s58, v16
  v_bfe_u32 v18, v0, 1, 3
  v_xor_b32 v17, v17, v18
  v_lshlrev_b32 v17, 5, v17
  v_and_b32 v18, 1, v0
  v_lshl_add_u32 v17, v18, 4, v17
  s_lshl_b32 s58, s30, 2
  v_add_u32 v16, s58, v16
  v_mul_u32_u24 v16, 7168, v16
  s_lshl_b32 s58, s51, 8
  v_add3_u32 v3, v16, v17, s58
  v_add_u32 v24, 0, v3
  s_mov_b32 s8, s64
  s_mov_b32 s9, s65
  s_mov_b32 s10, 0x400000
  s_mov_b32 s11, 0x20000
  s_mov_b32 s32, 0
  s_mov_b32 s33, 65536
  s_mov_b32 s34, 131072
  s_mov_b32 s35, 196608
  s_mov_b32 s36, 262144
  s_mov_b32 s37, 327680
  s_mov_b32 s38, 393216
  s_mov_b32 s39, 458752
  s_mov_b32 s44, 128
  v_lshrrev_b32 v16, 4, v0
  s_lshl_b32 s58, s57, 2
  v_or_b32 v16, s58, v16
  v_and_b32 v17, 7, v0
  v_xor_b32 v16, v16, v17
  v_lshrrev_b32 v17, 3, v0
  v_lshlrev_b32 v17, 11, v17
  v_lshl_add_u32 v16, v16, 4, v17
  s_lshl_b32 s58, s50, 19
  s_lshl_b32 s59, s30, 14
  s_add_u32 s58, s58, s59
  v_add_u32 v2, s58, v16
  v_and_b32 v16, 15, v0
  v_lshrrev_b32 v17, 4, v0
  v_lshrrev_b32 v18, 1, v16
  v_xor_b32 v17, v17, v18
  v_lshlrev_b32 v16, 7, v16
  v_lshl_add_u32 v16, v17, 4, v16
  s_mul_i32 s58, s56, 16384
  s_add_u32 s58, s58, 98304
  v_add_u32 v4, s58, v16
  v_xor_b32 v5, 64, v4
  s_add_u32 m0, s95, 0
  s_nop 0
  buffer_load_dwordx4 v3, s[12:15], s40 offen nt lds
  s_add_u32 m0, s95, 98304
  s_nop 0
  buffer_load_dwordx4 v2, s[8:11], s32 offen sc1 lds
  s_add_u32 m0, s95, 4096
  s_nop 0
  buffer_load_dwordx4 v3, s[12:15], s41 offen nt lds
  s_add_u32 m0, s95, 102400
  s_nop 0
  buffer_load_dwordx4 v2, s[8:11], s33 offen sc1 lds
  s_add_u32 m0, s95, 8192
  s_nop 0
  buffer_load_dwordx4 v3, s[12:15], s42 offen nt lds
  s_add_u32 m0, s95, 106496
  s_nop 0
  buffer_load_dwordx4 v2, s[8:11], s34 offen sc1 lds
  s_add_u32 m0, s95, 12288
  s_nop 0
  buffer_load_dwordx4 v3, s[12:15], s43 offen nt lds
  s_add_u32 m0, s95, 110592
  s_nop 0
  buffer_load_dwordx4 v2, s[8:11], s35 offen sc1 lds
  s_add_u32 m0, s95, 16384
  s_nop 0
  buffer_load_dwordx4 v24, s[16:19], s40 offen nt lds
  s_add_u32 m0, s95, 114688
  s_nop 0
  buffer_load_dwordx4 v2, s[8:11], s36 offen sc1 lds
  s_add_u32 m0, s95, 20480
  s_nop 0
  buffer_load_dwordx4 v24, s[16:19], s41 offen nt lds
  s_add_u32 m0, s95, 118784
  s_nop 0
  buffer_load_dwordx4 v2, s[8:11], s37 offen sc1 lds
  s_add_u32 m0, s95, 24576
  s_nop 0
  buffer_load_dwordx4 v24, s[16:19], s42 offen nt lds
  s_add_u32 m0, s95, 122880
  s_nop 0
  buffer_load_dwordx4 v2, s[8:11], s38 offen sc1 lds
  s_add_u32 m0, s95, 28672
  s_nop 0
  buffer_load_dwordx4 v24, s[16:19], s43 offen nt lds
  s_add_u32 m0, s95, 126976
  s_nop 0
  buffer_load_dwordx4 v2, s[8:11], s39 offen sc1 lds
  v_add_u32 v2, s44, v2
  v_add_u32 v3, s45, v3
  v_add_u32 v24, s45, v24
  s_add_u32 m0, s95, 32768
  s_nop 0
  buffer_load_dwordx4 v3, s[12:15], s40 offen nt lds
  s_add_u32 m0, s95, 131072
  s_nop 0
  buffer_load_dwordx4 v2, s[8:11], s32 offen sc1 lds
  s_add_u32 m0, s95, 36864
  s_nop 0
  buffer_load_dwordx4 v3, s[12:15], s41 offen nt lds
  s_add_u32 m0, s95, 135168
  s_nop 0
  buffer_load_dwordx4 v2, s[8:11], s33 offen sc1 lds
  s_add_u32 m0, s95, 40960
  s_nop 0
  buffer_load_dwordx4 v3, s[12:15], s42 offen nt lds
  s_add_u32 m0, s95, 139264
  s_nop 0
  buffer_load_dwordx4 v2, s[8:11], s34 offen sc1 lds
  s_add_u32 m0, s95, 45056
  s_nop 0
  buffer_load_dwordx4 v3, s[12:15], s43 offen nt lds
  s_add_u32 m0, s95, 143360
  s_nop 0
  buffer_load_dwordx4 v2, s[8:11], s35 offen sc1 lds
  s_add_u32 m0, s95, 49152
  s_nop 0
  buffer_load_dwordx4 v24, s[16:19], s40 offen nt lds
  s_add_u32 m0, s95, 147456
  s_nop 0
  buffer_load_dwordx4 v2, s[8:11], s36 offen sc1 lds
  s_add_u32 m0, s95, 53248
  s_nop 0
  buffer_load_dwordx4 v24, s[16:19], s41 offen nt lds
  s_add_u32 m0, s95, 151552
  s_nop 0
  buffer_load_dwordx4 v2, s[8:11], s37 offen sc1 lds
  s_add_u32 m0, s95, 57344
  s_nop 0
  buffer_load_dwordx4 v24, s[16:19], s42 offen nt lds
  s_add_u32 m0, s95, 155648
  s_nop 0
  buffer_load_dwordx4 v2, s[8:11], s38 offen sc1 lds
  s_add_u32 m0, s95, 61440
  s_nop 0
  buffer_load_dwordx4 v24, s[16:19], s43 offen nt lds
  s_add_u32 m0, s95, 159744
  s_nop 0
  buffer_load_dwordx4 v2, s[8:11], s39 offen sc1 lds
  v_add_u32 v2, s44, v2
  v_add_u32 v3, s45, v3
  v_add_u32 v24, s45, v24
  s_lshl_b32 s58, s50, 4
  s_and_b32 s59, s51, 15
  s_add_u32 s58, s58, s59
  s_lshl_b32 s58, s58, 2
  s_add_u32 s58, s58, s30
  s_lshl_b32 s58, s58, 13
  v_lshlrev_b32 v16, 7, v0
  buffer_load_dword v22, v16, s[8:11], s58 offen
  v_lshrrev_b32 v16, 4, v0
  v_bfe_u32 v17, v0, 2, 2
  v_lshl_add_u32 v16, v16, 3, v17
  v_lshlrev_b32 v16, 8, v16
  v_and_b32 v17, 3, v0
  v_lshl_add_u32 v16, v17, 3, v16
  v_bfe_u32 v17, v0, 2, 3
  v_lshl_add_u32 v16, v17, 5, v16
  s_lshl_b32 s58, s57, 7
  v_xor_b32 v16, s58, v16
  v_xor_b32 v6, 0, v16
  v_xor_b32 v7, 32, v16
  v_xor_b32 v8, 64, v16
  v_xor_b32 v9, 96, v16
  v_xor_b32 v10, 16384, v16
  v_xor_b32 v11, 16416, v16
  v_xor_b32 v12, 16448, v16
  v_xor_b32 v13, 16480, v16
  s_lshl_b32 s58, s50, 1
  s_add_u32 s58, s58, s56
  s_mul_i32 s58, s58, 917504
  s_lshl_b32 s59, s51, 12
  s_add_u32 s58, s58, s59
  s_lshl_b32 s59, s57, 11
  s_mul_i32 s60, s51, 37
  s_lshr_b32 s60, s60, 8
  s_lshl_b32 s60, s60, 3
  s_add_u32 s50, s50, s60
  s_add_u32 s58, s58, s59
  s_add_u32 s52, s58, 100663296
  s_lshl_b32 s58, s50, 7
  s_add_u32 s58, s58, 2624512
  s_cmp_eq_u32 s30, 0
  s_cselect_b32 s53, s58, 0
  s_branch G_epi
G_s_sk:
  s_mov_b32 s47, 4
  s_mov_b32 s96, 16
  s_mov_b32 s45, 524288
  s_lshr_b32 s56, s30, 1
  s_and_b32 s57, s30, 1
  s_mov_b32 s12, s70
  s_mov_b32 s13, s71
  s_mov_b32 s14, 0x800000
  s_mov_b32 s15, 0x20000
  s_mov_b32 s16, s70
  s_mov_b32 s17, s71
  s_mov_b32 s18, 0x800000
  s_mov_b32 s19, 0x20000
  s_mov_b32 s40, 0
  s_mov_b32 s41, 131072
  s_mov_b32 s42, 262144
  s_mov_b32 s43, 393216
  v_lshrrev_b32 v16, 4, v0
  s_lshl_b32 s58, s56, 2
  v_or_b32 v17, s58, v16
  v_bfe_u32 v18, v0, 1, 3
  v_xor_b32 v17, v17, v18
  v_lshlrev_b32 v17, 5, v17
  v_and_b32 v18, 1, v0
  v_lshl_add_u32 v17, v18, 4, v17
  s_lshl_b32 s58, s30, 2
  v_add_u32 v16, s58, v16
  v_mul_u32_u24 v16, 8192, v16
  s_lshl_b32 s58, s51, 8
  v_add3_u32 v3, v16, v17, s58
  v_add_u32 v24, 256, v3
  s_mov_b32 s8, s64
  s_mov_b32 s9, s65
  s_mov_b32 s10, 0x400000
  s_mov_b32 s11, 0x20000
  s_mov_b32 s32, 0
  s_mov_b32 s33, 65536
  s_mov_b32 s34, 131072
  s_mov_b32 s35, 196608
  s_mov_b32 s44, 128
  v_lshrrev_b32 v16, 4, v0
  s_lshl_b32 s58, s57, 2
  v_or_b32 v16, s58, v16
  v_and_b32 v17, 7, v0
  v_xor_b32 v16, v16, v17
  v_lshrrev_b32 v17, 3, v0
  v_lshlrev_b32 v17, 11, v17
  v_lshl_add_u32 v16, v16, 4, v17
  s_lshl_b32 s58, s50, 18
  s_lshl_b32 s59, s30, 14
  s_add_u32 s58, s58, s59
  v_add_u32 v2, s58, v16
  v_and_b32 v16, 15, v0
  v_lshrrev_b32 v17, 4, v0
  v_lshrrev_b32 v18, 1, v16
  v_xor_b32 v17, v17, v18
  v_lshlrev_b32 v16, 7, v16
  v_lshl_add_u32 v16, v17, 4, v16
  s_mul_i32 s58, s56, 8192
  s_add_u32 s58, s58, 98304
  v_add_u32 v4, s58, v16
  v_xor_b32 v5, 64, v4
  s_add_u32 m0, s95, 0
  s_nop 0
  buffer_load_dwordx4 v3, s[12:15], s40 offen  lds
  s_add_u32 m0, s95, 98304
  s_nop 0
  buffer_load_dwordx4 v2, s[8:11], s32 offen sc1 lds
  s_add_u32 m0, s95, 4096
  s_nop 0
  buffer_load_dwordx4 v3, s[12:15], s41 offen  lds
  s_add_u32 m0, s95, 102400
  s_nop 0
  buffer_load_dwordx4 v2, s[8:11], s33 offen sc1 lds
  s_add_u32 m0, s95, 8192
  s_nop 0
  buffer_load_dwordx4 v3, s[12:15], s42 offen  lds
  s_add_u32 m0, s95, 106496
  s_nop 0
  buffer_load_dwordx4 v2, s[8:11], s34 offen sc1 lds
  s_add_u32 m0, s95, 12288
  s_nop 0
  buffer_load_dwordx4 v3, s[12:15], s43 offen  lds
  s_add_u32 m0, s95, 110592
  s_nop 0
  buffer_load_dwordx4 v2, s[8:11], s35 offen sc1 lds
  v_add_u32 v2, s44, v2
  v_add_u32 v3, s45, v3
  s_add_u32 m0, s95, 16384
  s_nop 0
  buffer_load_dwordx4 v3, s[12:15], s40 offen  lds
  s_add_u32 m0, s95, 114688
  s_nop 0
  buffer_load_dwordx4 v2, s[8:11], s32 offen sc1 lds
  s_add_u32 m0, s95, 20480
  s_nop 0
  buffer_load_dwordx4 v3, s[12:15], s41 offen  lds
  s_add_u32 m0, s95, 118784
  s_nop 0
  buffer_load_dwordx4 v2, s[8:11], s33 offen sc1 lds
  s_add_u32 m0, s95, 24576
  s_nop 0
  buffer_load_dwordx4 v3, s[12:15], s42 offen  lds
  s_add_u32 m0, s95, 122880
  s_nop 0
  buffer_load_dwordx4 v2, s[8:11], s34 offen sc1 lds
  s_add_u32 m0, s95, 28672
  s_nop 0
  buffer_load_dwordx4 v3, s[12:15], s43 offen  lds
  s_add_u32 m0, s95, 126976
  s_nop 0
  buffer_load_dwordx4 v2, s[8:11], s35 offen sc1 lds
  v_add_u32 v2, s44, v2
  v_add_u32 v3, s45, v3
  s_add_u32 m0, s95, 32768
  s_nop 0
  buffer_load_dwordx4 v3, s[12:15], s40 offen  lds
  s_add_u32 m0, s95, 131072
  s_nop 0
  buffer_load_dwordx4 v2, s[8:11], s32 offen sc1 lds
  s_add_u32 m0, s95, 36864
  s_nop 0
  buffer_load_dwordx4 v3, s[12:15], s41 offen  lds
  s_add_u32 m0, s95, 135168
  s_nop 0
  buffer_load_dwordx4 v2, s[8:11], s33 offen sc1 lds
  s_add_u32 m0, s95, 40960
  s_nop 0
  buffer_load_dwordx4 v3, s[12:15], s42 offen  lds
  s_add_u32 m0, s95, 139264
  s_nop 0
  buffer_load_dwordx4 v2, s[8:11], s34 offen sc1 lds
  s_add_u32 m0, s95, 45056
  s_nop 0
  buffer_load_dwordx4 v3, s[12:15], s43 offen  lds
  s_add_u32 m0, s95, 143360
  s_nop 0
  buffer_load_dwordx4 v2, s[8:11], s35 offen sc1 lds
  v_add_u32 v2, s44, v2
  v_add_u32 v3, s45, v3
  s_add_u32 m0, s95, 49152
  s_nop 0
  buffer_load_dwordx4 v3, s[12:15], s40 offen  lds
  s_add_u32 m0, s95, 147456
  s_nop 0
  buffer_load_dwordx4 v2, s[8:11], s32 offen sc1 lds
  s_add_u32 m0, s95, 53248
  s_nop 0
  buffer_load_dwordx4 v3, s[12:15], s41 offen  lds
  s_add_u32 m0, s95, 151552
  s_nop 0
  buffer_load_dwordx4 v2, s[8:11], s33 offen sc1 lds
  s_add_u32 m0, s95, 57344
  s_nop 0
  buffer_load_dwordx4 v3, s[12:15], s42 offen  lds
  s_add_u32 m0, s95, 155648
  s_nop 0
  buffer_load_dwordx4 v2, s[8:11], s34 offen sc1 lds
  s_add_u32 m0, s95, 61440
  s_nop 0
  buffer_load_dwordx4 v3, s[12:15], s43 offen  lds
  s_add_u32 m0, s95, 159744
  s_nop 0
  buffer_load_dwordx4 v2, s[8:11], s35 offen sc1 lds
  v_add_u32 v2, s44, v2
  v_add_u32 v3, s45, v3
  v_lshrrev_b32 v16, 4, v0
  v_bfe_u32 v17, v0, 2, 2
  v_lshl_add_u32 v16, v16, 3, v17
  v_lshlrev_b32 v16, 8, v16
  v_and_b32 v17, 3, v0
  v_lshl_add_u32 v16, v17, 3, v16
  v_bfe_u32 v17, v0, 2, 3
  v_lshl_add_u32 v16, v17, 5, v16
  s_lshl_b32 s58, s57, 7
  v_xor_b32 v16, s58, v16
  v_xor_b32 v6, 0, v16
  v_xor_b32 v7, 32, v16
  v_xor_b32 v8, 64, v16
  v_xor_b32 v9, 96, v16
  s_lshl_b32 s58, s50, 20
  s_lshl_b32 s59, s56, 19
  s_add_u32 s58, s58, s59
  s_lshl_b32 s59, s51, 13
  s_add_u32 s58, s58, s59
  s_lshl_b32 s59, s57, 11
  s_add_u32 s58, s58, s59
  s_add_u32 s52, s58, 33554432
  s_lshl_b32 s58, s50, 7
  s_add_u32 s58, s58, 2621440
  s_cmp_eq_u32 s30, 0
  s_cselect_b32 s53, s58, 0
  s_branch G_l_ss
G_s_sv:
  s_mov_b32 s47, 5
  s_mov_b32 s96, 16
  s_mov_b32 s45, 524288
  s_lshr_b32 s56, s30, 1
  s_and_b32 s57, s30, 1
  s_mov_b32 s12, s72
  s_mov_b32 s13, s73
  s_mov_b32 s14, 0x800000
  s_mov_b32 s15, 0x20000
  s_mov_b32 s16, s72
  s_mov_b32 s17, s73
  s_mov_b32 s18, 0x800000
  s_mov_b32 s19, 0x20000
  s_mov_b32 s40, 0
  s_mov_b32 s41, 131072
  s_mov_b32 s42, 262144
  s_mov_b32 s43, 393216
  v_lshrrev_b32 v16, 4, v0
  s_lshl_b32 s58, s56, 2
  v_or_b32 v17, s58, v16
  v_bfe_u32 v18, v0, 1, 3
  v_xor_b32 v17, v17, v18
  v_lshlrev_b32 v17, 5, v17
  v_and_b32 v18, 1, v0
  v_lshl_add_u32 v17, v18, 4, v17
  s_lshl_b32 s58, s30, 2
  v_add_u32 v16, s58, v16
  v_mul_u32_u24 v16, 8192, v16
  s_lshl_b32 s58, s51, 8
  v_add3_u32 v3, v16, v17, s58
  v_add_u32 v24, 256, v3
  s_mov_b32 s8, s64
  s_mov_b32 s9, s65
  s_mov_b32 s10, 0x400000
  s_mov_b32 s11, 0x20000
  s_mov_b32 s32, 0
  s_mov_b32 s33, 65536
  s_mov_b32 s34, 131072
  s_mov_b32 s35, 196608
  s_mov_b32 s44, 128
  v_lshrrev_b32 v16, 4, v0
  s_lshl_b32 s58, s57, 2
  v_or_b32 v16, s58, v16
  v_and_b32 v17, 7, v0
  v_xor_b32 v16, v16, v17
  v_lshrrev_b32 v17, 3, v0
  v_lshlrev_b32 v17, 11, v17
  v_lshl_add_u32 v16, v16, 4, v17
  s_lshl_b32 s58, s50, 18
  s_lshl_b32 s59, s30, 14
  s_add_u32 s58, s58, s59
  v_add_u32 v2, s58, v16
  v_and_b32 v16, 15, v0
  v_lshrrev_b32 v17, 4, v0
  v_lshrrev_b32 v18, 1, v16
  v_xor_b32 v17, v17, v18
  v_lshlrev_b32 v16, 7, v16
  v_lshl_add_u32 v16, v17, 4, v16
  s_mul_i32 s58, s56, 8192
  s_add_u32 s58, s58, 98304
  v_add_u32 v4, s58, v16
  v_xor_b32 v5, 64, v4
  s_add_u32 m0, s95, 0
  s_nop 0
  buffer_load_dwordx4 v3, s[12:15], s40 offen  lds
  s_add_u32 m0, s95, 98304
  s_nop 0
  buffer_load_dwordx4 v2, s[8:11], s32 offen sc1 lds
  s_add_u32 m0, s95, 4096
  s_nop 0
  buffer_load_dwordx4 v3, s[12:15], s41 offen  lds
  s_add_u32 m0, s95, 102400
  s_nop 0
  buffer_load_dwordx4 v2, s[8:11], s33 offen sc1 lds
  s_add_u32 m0, s95, 8192
  s_nop 0
  buffer_load_dwordx4 v3, s[12:15], s42 offen  lds
  s_add_u32 m0, s95, 106496
  s_nop 0
  buffer_load_dwordx4 v2, s[8:11], s34 offen sc1 lds
  s_add_u32 m0, s95, 12288
  s_nop 0
  buffer_load_dwordx4 v3, s[12:15], s43 offen  lds
  s_add_u32 m0, s95, 110592
  s_nop 0
  buffer_load_dwordx4 v2, s[8:11], s35 offen sc1 lds
  v_add_u32 v2, s44, v2
  v_add_u32 v3, s45, v3
  s_add_u32 m0, s95, 16384
  s_nop 0
  buffer_load_dwordx4 v3, s[12:15], s40 offen  lds
  s_add_u32 m0, s95, 114688
  s_nop 0
  buffer_load_dwordx4 v2, s[8:11], s32 offen sc1 lds
  s_add_u32 m0, s95, 20480
  s_nop 0
  buffer_load_dwordx4 v3, s[12:15], s41 offen  lds
  s_add_u32 m0, s95, 118784
  s_nop 0
  buffer_load_dwordx4 v2, s[8:11], s33 offen sc1 lds
  s_add_u32 m0, s95, 24576
  s_nop 0
  buffer_load_dwordx4 v3, s[12:15], s42 offen  lds
  s_add_u32 m0, s95, 122880
  s_nop 0
  buffer_load_dwordx4 v2, s[8:11], s34 offen sc1 lds
  s_add_u32 m0, s95, 28672
  s_nop 0
  buffer_load_dwordx4 v3, s[12:15], s43 offen  lds
  s_add_u32 m0, s95, 126976
  s_nop 0
  buffer_load_dwordx4 v2, s[8:11], s35 offen sc1 lds
  v_add_u32 v2, s44, v2
  v_add_u32 v3, s45, v3
  s_add_u32 m0, s95, 32768
  s_nop 0
  buffer_load_dwordx4 v3, s[12:15], s40 offen  lds
  s_add_u32 m0, s95, 131072
  s_nop 0
  buffer_load_dwordx4 v2, s[8:11], s32 offen sc1 lds
  s_add_u32 m0, s95, 36864
  s_nop 0
  buffer_load_dwordx4 v3, s[12:15], s41 offen  lds
  s_add_u32 m0, s95, 135168
  s_nop 0
  buffer_load_dwordx4 v2, s[8:11], s33 offen sc1 lds
  s_add_u32 m0, s95, 40960
  s_nop 0
  buffer_load_dwordx4 v3, s[12:15], s42 offen  lds
  s_add_u32 m0, s95, 139264
  s_nop 0
  buffer_load_dwordx4 v2, s[8:11], s34 offen sc1 lds
  s_add_u32 m0, s95, 45056
  s_nop 0
  buffer_load_dwordx4 v3, s[12:15], s43 offen  lds
  s_add_u32 m0, s95, 143360
  s_nop 0
  buffer_load_dwordx4 v2, s[8:11], s35 offen sc1 lds
  v_add_u32 v2, s44, v2
  v_add_u32 v3, s45, v3
  s_add_u32 m0, s95, 49152
  s_nop 0
  buffer_load_dwordx4 v3, s[12:15], s40 offen  lds
  s_add_u32 m0, s95, 147456
  s_nop 0
  buffer_load_dwordx4 v2, s[8:11], s32 offen sc1 lds
  s_add_u32 m0, s95, 53248
  s_nop 0
  buffer_load_dwordx4 v3, s[12:15], s41 offen  lds
  s_add_u32 m0, s95, 151552
  s_nop 0
  buffer_load_dwordx4 v2, s[8:11], s33 offen sc1 lds
  s_add_u32 m0, s95, 57344
  s_nop 0
  buffer_load_dwordx4 v3, s[12:15], s42 offen  lds
  s_add_u32 m0, s95, 155648
  s_nop 0
  buffer_load_dwordx4 v2, s[8:11], s34 offen sc1 lds
  s_add_u32 m0, s95, 61440
  s_nop 0
  buffer_load_dwordx4 v3, s[12:15], s43 offen  lds
  s_add_u32 m0, s95, 159744
  s_nop 0
  buffer_load_dwordx4 v2, s[8:11], s35 offen sc1 lds
  v_add_u32 v2, s44, v2
  v_add_u32 v3, s45, v3
  v_lshrrev_b32 v16, 4, v0
  v_bfe_u32 v17, v0, 2, 2
  v_lshl_add_u32 v16, v16, 3, v17
  v_lshlrev_b32 v16, 8, v16
  v_and_b32 v17, 3, v0
  v_lshl_add_u32 v16, v17, 3, v16
  v_bfe_u32 v17, v0, 2, 3
  v_lshl_add_u32 v16, v17, 5, v16
  s_lshl_b32 s58, s57, 7
  v_xor_b32 v16, s58, v16
  v_xor_b32 v6, 0, v16
  v_xor_b32 v7, 32, v16
  v_xor_b32 v8, 64, v16
  v_xor_b32 v9, 96, v16
  s_lshl_b32 s58, s50, 20
  s_lshl_b32 s59, s56, 19
  s_add_u32 s58, s58, s59
  s_lshl_b32 s59, s51, 13
  s_add_u32 s58, s58, s59
  s_lshl_b32 s59, s57, 12
  s_add_u32 s58, s58, s59
  s_add_u32 s52, s58, 50331648
  s_lshl_b32 s58, s50, 7
  s_add_u32 s58, s58, 2621440
  s_cmp_eq_u32 s30, 0
  s_cselect_b32 s53, s58, 0
  s_branch G_l_sn
G_s_dn:
  s_lshr_b32 s56, s51, 2
  s_lshl_b32 s56, s56, 3
  s_add_u32 s56, s56, s50
  s_lshl_b32 s56, s56, 7
  v_mov_b32 v17, 0x280c00
spin_43:
  buffer_load_dword v16, v17, s[4:7], s56 offen sc1
  s_waitcnt vmcnt(0)
  v_readfirstlane_b32 s57, v16
  s_nop 0
  s_cmp_ge_u32 s57, 7
  s_cbranch_scc1 spun_44
  s_sleep 4
  s_sub_u32 s94, s94, 1
  s_cbranch_scc0 spin_43
  s_mov_b32 s94, 0
spun_44:
  s_mov_b32 s47, 6
  s_mov_b32 s96, 14
  s_mov_b32 s45, 131072
  s_lshr_b32 s56, s30, 1
  s_and_b32 s57, s30, 1
  s_mov_b32 s12, s84
  s_mov_b32 s13, s85
  s_mov_b32 s14, 0x700000
  s_mov_b32 s15, 0x20000
  s_mov_b32 s16, s84
  s_mov_b32 s17, s85
  s_mov_b32 s18, 0x700000
  s_mov_b32 s19, 0x20000
  s_mov_b32 s40, 0
  s_mov_b32 s41, 16384
  s_mov_b32 s42, 65536
  s_mov_b32 s43, 81920
  v_lshrrev_b32 v16, 4, v0
  s_lshl_b32 s58, s56, 2
  v_or_b32 v17, s58, v16
  v_bfe_u32 v18, v0, 1, 3
  v_xor_b32 v17, v17, v18
  v_lshlrev_b32 v17, 5, v17
  v_and_b32 v18, 1, v0
  v_lshl_add_u32 v17, v18, 4, v17
  s_lshl_b32 s58, s57, 2
  s_add_u32 s58, s58, s56
  s_lshl_b32 s58, s58, 2
  v_add_u32 v16, s58, v16
  v_mul_u32_u24 v16, 2048, v16
  s_lshr_b32 s60, s51, 2
  s_and_b32 s51, s51, 3
  s_mul_i32 s59, s60, 1835008
  v_add_u32 v16, s59, v16
  s_lshl_b32 s58, s51, 9
  v_add3_u32 v3, v16, v17, s58
  v_add_u32 v24, 256, v3
  s_mov_b32 s8, s92
  s_mov_b32 s9, s93
  s_mov_b32 s10, 0x10000000
  s_mov_b32 s11, 0x20000
  s_mov_b32 s32, 100663296
  s_mov_b32 s33, 100892672
  s_mov_b32 s34, 101122048
  s_mov_b32 s35, 101351424
  s_mov_b32 s36, 101580800
  s_mov_b32 s37, 101810176
  s_mov_b32 s38, 102039552
  s_mov_b32 s39, 102268928
  s_mov_b32 s44, 2048
  s_lshl_b32 s58, s50, 4
  s_add_u32 s58, s58, s56
  s_mul_i32 s58, s58, 112
  s_add_u32 s58, s58, s57
  s_mul_i32 s59, s60, 28
  s_add_u32 s58, s58, s59
  s_lshl_b32 s58, s58, 10
  v_add_u32 v2, s58, v1
  s_lshl_b32 s58, s56, 14
  s_add_u32 s58, s58, 98304
  v_add_u32 v4, s58, v1
  v_add_u32 v5, 1024, v4
  s_add_u32 m0, s95, 0
  s_nop 0
  buffer_load_dwordx4 v3, s[12:15], s40 offen nt lds
  s_add_u32 m0, s95, 98304
  s_nop 0
  buffer_load_dwordx4 v2, s[8:11], s32 offen sc1 lds
  s_add_u32 m0, s95, 4096
  s_nop 0
  buffer_load_dwordx4 v3, s[12:15], s41 offen nt lds
  s_add_u32 m0, s95, 102400
  s_nop 0
  buffer_load_dwordx4 v2, s[8:11], s33 offen sc1 lds
  s_add_u32 m0, s95, 8192
  s_nop 0
  buffer_load_dwordx4 v3, s[12:15], s42 offen nt lds
  s_add_u32 m0, s95, 106496
  s_nop 0
  buffer_load_dwordx4 v2, s[8:11], s34 offen sc1 lds
  s_add_u32 m0, s95, 12288
  s_nop 0
  buffer_load_dwordx4 v3, s[12:15], s43 offen nt lds
  s_add_u32 m0, s95, 110592
  s_nop 0
  buffer_load_dwordx4 v2, s[8:11], s35 offen sc1 lds
  s_add_u32 m0, s95, 16384
  s_nop 0
  buffer_load_dwordx4 v24, s[16:19], s40 offen nt lds
  s_add_u32 m0, s95, 114688
  s_nop 0
  buffer_load_dwordx4 v2, s[8:11], s36 offen sc1 lds
  s_add_u32 m0, s95, 20480
  s_nop 0
  buffer_load_dwordx4 v24, s[16:19], s41 offen nt lds
  s_add_u32 m0, s95, 118784
  s_nop 0
  buffer_load_dwordx4 v2, s[8:11], s37 offen sc1 lds
  s_add_u32 m0, s95, 24576
  s_nop 0
  buffer_load_dwordx4 v24, s[16:19], s42 offen nt lds
  s_add_u32 m0, s95, 122880
  s_nop 0
  buffer_load_dwordx4 v2, s[8:11], s38 offen sc1 lds
  s_add_u32 m0, s95, 28672
  s_nop 0
  buffer_load_dwordx4 v24, s[16:19], s43 offen nt lds
  s_add_u32 m0, s95, 126976
  s_nop 0
  buffer_load_dwordx4 v2, s[8:11], s39 offen sc1 lds
  v_add_u32 v2, s44, v2
  v_add_u32 v3, s45, v3
  v_add_u32 v24, s45, v24
  s_add_u32 m0, s95, 32768
  s_nop 0
  buffer_load_dwordx4 v3, s[12:15], s40 offen nt lds
  s_add_u32 m0, s95, 131072
  s_nop 0
  buffer_load_dwordx4 v2, s[8:11], s32 offen sc1 lds
  s_add_u32 m0, s95, 36864
  s_nop 0
  buffer_load_dwordx4 v3, s[12:15], s41 offen nt lds
  s_add_u32 m0, s95, 135168
  s_nop 0
  buffer_load_dwordx4 v2, s[8:11], s33 offen sc1 lds
  s_add_u32 m0, s95, 40960
  s_nop 0
  buffer_load_dwordx4 v3, s[12:15], s42 offen nt lds
  s_add_u32 m0, s95, 139264
  s_nop 0
  buffer_load_dwordx4 v2, s[8:11], s34 offen sc1 lds
  s_add_u32 m0, s95, 45056
  s_nop 0
  buffer_load_dwordx4 v3, s[12:15], s43 offen nt lds
  s_add_u32 m0, s95, 143360
  s_nop 0
  buffer_load_dwordx4 v2, s[8:11], s35 offen sc1 lds
  s_add_u32 m0, s95, 49152
  s_nop 0
  buffer_load_dwordx4 v24, s[16:19], s40 offen nt lds
  s_add_u32 m0, s95, 147456
  s_nop 0
  buffer_load_dwordx4 v2, s[8:11], s36 offen sc1 lds
  s_add_u32 m0, s95, 53248
  s_nop 0
  buffer_load_dwordx4 v24, s[16:19], s41 offen nt lds
  s_add_u32 m0, s95, 151552
  s_nop 0
  buffer_load_dwordx4 v2, s[8:11], s37 offen sc1 lds
  s_add_u32 m0, s95, 57344
  s_nop 0
  buffer_load_dwordx4 v24, s[16:19], s42 offen nt lds
  s_add_u32 m0, s95, 155648
  s_nop 0
  buffer_load_dwordx4 v2, s[8:11], s38 offen sc1 lds
  s_add_u32 m0, s95, 61440
  s_nop 0
  buffer_load_dwordx4 v24, s[16:19], s43 offen nt lds
  s_add_u32 m0, s95, 159744
  s_nop 0
  buffer_load_dwordx4 v2, s[8:11], s39 offen sc1 lds
  v_add_u32 v2, s44, v2
  v_add_u32 v3, s45, v3
  v_add_u32 v24, s45, v24
  v_lshrrev_b32 v16, 4, v0
  v_bfe_u32 v17, v0, 2, 2
  v_lshl_add_u32 v16, v16, 3, v17
  v_lshlrev_b32 v16, 8, v16
  v_and_b32 v17, 3, v0
  v_lshl_add_u32 v16, v17, 3, v16
  v_bfe_u32 v17, v0, 2, 3
  v_lshl_add_u32 v16, v17, 5, v16
  s_lshl_b32 s58, s57, 14
  v_add_u32 v16, s58, v16
  v_xor_b32 v6, 0, v16
  v_xor_b32 v7, 32, v16
  v_xor_b32 v8, 64, v16
  v_xor_b32 v9, 96, v16
  v_xor_b32 v10, 128, v16
  v_xor_b32 v11, 160, v16
  v_xor_b32 v12, 192, v16
  v_xor_b32 v13, 224, v16
  s_lshl_b32 s58, s50, 19
  s_lshl_b32 s59, s56, 18
  s_add_u32 s58, s58, s59
  s_lshl_b32 s59, s51, 14
  s_add_u32 s58, s58, s59
  s_lshl_b32 s59, s60, 22
  s_add_u32 s58, s58, s59
  s_lshl_b32 s59, s57, 13
  s_add_u32 s58, s58, s59
  s_add_u32 s52, s58, 117440512
  s_lshl_b32 s58, s50, 7
  s_add_u32 s58, s58, 2628608
  s_cmp_eq_u32 s30, 0
  s_cselect_b32 s53, s58, 0
  s_branch G_epi
G_epi:
  s_cmp_eq_u32 s48, 1
  s_cbranch_scc1 G_e_1
  s_cmp_eq_u32 s48, 2
  s_cbranch_scc1 G_e_2
  s_cmp_eq_u32 s48, 3
  s_cbranch_scc1 G_e_3
  s_cmp_eq_u32 s48, 4
  s_cbranch_scc1 G_e_4
  s_cmp_eq_u32 s48, 5
  s_cbranch_scc1 G_e_5
  s_cmp_eq_u32 s48, 6
  s_cbranch_scc1 G_e_6
  v_mov_b32 v17, 0x90
spin_45:
  buffer_load_dword v16, v17, s[20:23], 0 offen sc1
  s_waitcnt vmcnt(0)
  v_readfirstlane_b32 s57, v16
  s_nop 0
  s_cmp_ge_u32 s57, 1
  s_cbranch_scc1 spun_46
  s_sleep 4
  s_sub_u32 s94, s94, 1
  s_cbranch_scc0 spin_45
  s_mov_b32 s94, 0
spun_46:
  s_waitcnt vmcnt(0)
  s_branch G_ld
G_e_1:
  s_nop 11
  s_add_u32 s56, s54, 0
  v_accvgpr_read_b32 v80, a0
  v_accvgpr_read_b32 v81, a1
  v_accvgpr_read_b32 v82, a2
  v_accvgpr_read_b32 v83, a3
  v_accvgpr_read_b32 v84, a4
  v_accvgpr_read_b32 v85, a5
  v_accvgpr_read_b32 v86, a6
  v_accvgpr_read_b32 v87, a7
  v_cvt_pk_bf16_f32 v64, v80, v81
  v_cvt_pk_bf16_f32 v65, v82, v83
  v_cvt_pk_bf16_f32 v66, v84, v85
  v_cvt_pk_bf16_f32 v67, v86, v87
  buffer_store_dwordx4 v[64:67], v1, s[4:7], s56 offen offset:0 sc1
  v_accvgpr_read_b32 v80, a8
  v_accvgpr_read_b32 v81, a9
  v_accvgpr_read_b32 v82, a10
  v_accvgpr_read_b32 v83, a11
  v_accvgpr_read_b32 v84, a12
  v_accvgpr_read_b32 v85, a13
  v_accvgpr_read_b32 v86, a14
  v_accvgpr_read_b32 v87, a15
  v_cvt_pk_bf16_f32 v68, v80, v81
  v_cvt_pk_bf16_f32 v69, v82, v83
  v_cvt_pk_bf16_f32 v70, v84, v85
  v_cvt_pk_bf16_f32 v71, v86, v87
  buffer_store_dwordx4 v[68:71], v1, s[4:7], s56 offen offset:1024 sc1
  v_accvgpr_read_b32 v80, a16
  v_accvgpr_read_b32 v81, a17
  v_accvgpr_read_b32 v82, a18
  v_accvgpr_read_b32 v83, a19
  v_accvgpr_read_b32 v84, a20
  v_accvgpr_read_b32 v85, a21
  v_accvgpr_read_b32 v86, a22
  v_accvgpr_read_b32 v87, a23
  v_cvt_pk_bf16_f32 v72, v80, v81
  v_cvt_pk_bf16_f32 v73, v82, v83
  v_cvt_pk_bf16_f32 v74, v84, v85
  v_cvt_pk_bf16_f32 v75, v86, v87
  buffer_store_dwordx4 v[72:75], v1, s[4:7], s56 offen offset:2048 sc1
  v_accvgpr_read_b32 v80, a24
  v_accvgpr_read_b32 v81, a25
  v_accvgpr_read_b32 v82, a26
  v_accvgpr_read_b32 v83, a27
  v_accvgpr_read_b32 v84, a28
  v_accvgpr_read_b32 v85, a29
  v_accvgpr_read_b32 v86, a30
  v_accvgpr_read_b32 v87, a31
  v_cvt_pk_bf16_f32 v76, v80, v81
  v_cvt_pk_bf16_f32 v77, v82, v83
  v_cvt_pk_bf16_f32 v78, v84, v85
  v_cvt_pk_bf16_f32 v79, v86, v87
  buffer_store_dwordx4 v[76:79], v1, s[4:7], s56 offen offset:3072 sc1
  s_add_u32 s56, s54, 4096
  v_accvgpr_read_b32 v80, a32
  v_accvgpr_read_b32 v81, a33
  v_accvgpr_read_b32 v82, a34
  v_accvgpr_read_b32 v83, a35
  v_accvgpr_read_b32 v84, a36
  v_accvgpr_read_b32 v85, a37
  v_accvgpr_read_b32 v86, a38
  v_accvgpr_read_b32 v87, a39
  v_cvt_pk_bf16_f32 v64, v80, v81
  v_cvt_pk_bf16_f32 v65, v82, v83
  v_cvt_pk_bf16_f32 v66, v84, v85
  v_cvt_pk_bf16_f32 v67, v86, v87
  buffer_store_dwordx4 v[64:67], v1, s[4:7], s56 offen offset:0 sc1
  v_accvgpr_read_b32 v80, a40
  v_accvgpr_read_b32 v81, a41
  v_accvgpr_read_b32 v82, a42
  v_accvgpr_read_b32 v83, a43
  v_accvgpr_read_b32 v84, a44
  v_accvgpr_read_b32 v85, a45
  v_accvgpr_read_b32 v86, a46
  v_accvgpr_read_b32 v87, a47
  v_cvt_pk_bf16_f32 v68, v80, v81
  v_cvt_pk_bf16_f32 v69, v82, v83
  v_cvt_pk_bf16_f32 v70, v84, v85
  v_cvt_pk_bf16_f32 v71, v86, v87
  buffer_store_dwordx4 v[68:71], v1, s[4:7], s56 offen offset:1024 sc1
  v_accvgpr_read_b32 v80, a48
  v_accvgpr_read_b32 v81, a49
  v_accvgpr_read_b32 v82, a50
  v_accvgpr_read_b32 v83, a51
  v_accvgpr_read_b32 v84, a52
  v_accvgpr_read_b32 v85, a53
  v_accvgpr_read_b32 v86, a54
  v_accvgpr_read_b32 v87, a55
  v_cvt_pk_bf16_f32 v72, v80, v81
  v_cvt_pk_bf16_f32 v73, v82, v83
  v_cvt_pk_bf16_f32 v74, v84, v85
  v_cvt_pk_bf16_f32 v75, v86, v87
  buffer_store_dwordx4 v[72:75], v1, s[4:7], s56 offen offset:2048 sc1
  v_accvgpr_read_b32 v80, a56
  v_accvgpr_read_b32 v81, a57
  v_accvgpr_read_b32 v82, a58
  v_accvgpr_read_b32 v83, a59
  v_accvgpr_read_b32 v84, a60
  v_accvgpr_read_b32 v85, a61
  v_accvgpr_read_b32 v86, a62
  v_accvgpr_read_b32 v87, a63
  v_cvt_pk_bf16_f32 v76, v80, v81
  v_cvt_pk_bf16_f32 v77, v82, v83
  v_cvt_pk_bf16_f32 v78, v84, v85
  v_cvt_pk_bf16_f32 v79, v86, v87
  buffer_store_dwordx4 v[76:79], v1, s[4:7], s56 offen offset:3072 sc1
  s_add_u32 s56, s54, 262144
  v_accvgpr_read_b32 v80, a64
  v_accvgpr_read_b32 v81, a65
  v_accvgpr_read_b32 v82, a66
  v_accvgpr_read_b32 v83, a67
  v_accvgpr_read_b32 v84, a68
  v_accvgpr_read_b32 v85, a69
  v_accvgpr_read_b32 v86, a70
  v_accvgpr_read_b32 v87, a71
  v_cvt_pk_bf16_f32 v64, v80, v81
  v_cvt_pk_bf16_f32 v65, v82, v83
  v_cvt_pk_bf16_f32 v66, v84, v85
  v_cvt_pk_bf16_f32 v67, v86, v87
  buffer_store_dwordx4 v[64:67], v1, s[4:7], s56 offen offset:0 sc1
  v_accvgpr_read_b32 v80, a72
  v_accvgpr_read_b32 v81, a73
  v_accvgpr_read_b32 v82, a74
  v_accvgpr_read_b32 v83, a75
  v_accvgpr_read_b32 v84, a76
  v_accvgpr_read_b32 v85, a77
  v_accvgpr_read_b32 v86, a78
  v_accvgpr_read_b32 v87, a79
  v_cvt_pk_bf16_f32 v68, v80, v81
  v_cvt_pk_bf16_f32 v69, v82, v83
  v_cvt_pk_bf16_f32 v70, v84, v85
  v_cvt_pk_bf16_f32 v71, v86, v87
  buffer_store_dwordx4 v[68:71], v1, s[4:7], s56 offen offset:1024 sc1
  v_accvgpr_read_b32 v80, a80
  v_accvgpr_read_b32 v81, a81
  v_accvgpr_read_b32 v82, a82
  v_accvgpr_read_b32 v83, a83
  v_accvgpr_read_b32 v84, a84
  v_accvgpr_read_b32 v85, a85
  v_accvgpr_read_b32 v86, a86
  v_accvgpr_read_b32 v87, a87
  v_cvt_pk_bf16_f32 v72, v80, v81
  v_cvt_pk_bf16_f32 v73, v82, v83
  v_cvt_pk_bf16_f32 v74, v84, v85
  v_cvt_pk_bf16_f32 v75, v86, v87
  buffer_store_dwordx4 v[72:75], v1, s[4:7], s56 offen offset:2048 sc1
  v_accvgpr_read_b32 v80, a88
  v_accvgpr_read_b32 v81, a89
  v_accvgpr_read_b32 v82, a90
  v_accvgpr_read_b32 v83, a91
  v_accvgpr_read_b32 v84, a92
  v_accvgpr_read_b32 v85, a93
  v_accvgpr_read_b32 v86, a94
  v_accvgpr_read_b32 v87, a95
  v_cvt_pk_bf16_f32 v76, v80, v81
  v_cvt_pk_bf16_f32 v77, v82, v83
  v_cvt_pk_bf16_f32 v78, v84, v85
  v_cvt_pk_bf16_f32 v79, v86, v87
  buffer_store_dwordx4 v[76:79], v1, s[4:7], s56 offen offset:3072 sc1
  s_add_u32 s56, s54, 266240
  v_accvgpr_read_b32 v80, a96
  v_accvgpr_read_b32 v81, a97
  v_accvgpr_read_b32 v82, a98
  v_accvgpr_read_b32 v83, a99
  v_accvgpr_read_b32 v84, a100
  v_accvgpr_read_b32 v85, a101
  v_accvgpr_read_b32 v86, a102
  v_accvgpr_read_b32 v87, a103
  v_cvt_pk_bf16_f32 v64, v80, v81
  v_cvt_pk_bf16_f32 v65, v82, v83
  v_cvt_pk_bf16_f32 v66, v84, v85
  v_cvt_pk_bf16_f32 v67, v86, v87
  buffer_store_dwordx4 v[64:67], v1, s[4:7], s56 offen offset:0 sc1
  v_accvgpr_read_b32 v80, a104
  v_accvgpr_read_b32 v81, a105
  v_accvgpr_read_b32 v82, a106
  v_accvgpr_read_b32 v83, a107
  v_accvgpr_read_b32 v84, a108
  v_accvgpr_read_b32 v85, a109
  v_accvgpr_read_b32 v86, a110
  v_accvgpr_read_b32 v87, a111
  v_cvt_pk_bf16_f32 v68, v80, v81
  v_cvt_pk_bf16_f32 v69, v82, v83
  v_cvt_pk_bf16_f32 v70, v84, v85
  v_cvt_pk_bf16_f32 v71, v86, v87
  buffer_store_dwordx4 v[68:71], v1, s[4:7], s56 offen offset:1024 sc1
  v_accvgpr_read_b32 v80, a112
  v_accvgpr_read_b32 v81, a113
  v_accvgpr_read_b32 v82, a114
  v_accvgpr_read_b32 v83, a115
  v_accvgpr_read_b32 v84, a116
  v_accvgpr_read_b32 v85, a117
  v_accvgpr_read_b32 v86, a118
  v_accvgpr_read_b32 v87, a119
  v_cvt_pk_bf16_f32 v72, v80, v81
  v_cvt_pk_bf16_f32 v73, v82, v83
  v_cvt_pk_bf16_f32 v74, v84, v85
  v_cvt_pk_bf16_f32 v75, v86, v87
  buffer_store_dwordx4 v[72:75], v1, s[4:7], s56 offen offset:2048 sc1
  v_accvgpr_read_b32 v80, a120
  v_accvgpr_read_b32 v81, a121
  v_accvgpr_read_b32 v82, a122
  v_accvgpr_read_b32 v83, a123
  v_accvgpr_read_b32 v84, a124
  v_accvgpr_read_b32 v85, a125
  v_accvgpr_read_b32 v86, a126
  v_accvgpr_read_b32 v87, a127
  v_cvt_pk_bf16_f32 v76, v80, v81
  v_cvt_pk_bf16_f32 v77, v82, v83
  v_cvt_pk_bf16_f32 v78, v84, v85
  v_cvt_pk_bf16_f32 v79, v86, v87
  buffer_store_dwordx4 v[76:79], v1, s[4:7], s56 offen offset:3072 sc1
  s_add_u32 s56, s54, 524288
  v_accvgpr_read_b32 v80, a128
  v_accvgpr_read_b32 v81, a129
  v_accvgpr_read_b32 v82, a130
  v_accvgpr_read_b32 v83, a131
  v_accvgpr_read_b32 v84, a132
  v_accvgpr_read_b32 v85, a133
  v_accvgpr_read_b32 v86, a134
  v_accvgpr_read_b32 v87, a135
  v_cvt_pk_bf16_f32 v64, v80, v81
  v_cvt_pk_bf16_f32 v65, v82, v83
  v_cvt_pk_bf16_f32 v66, v84, v85
  v_cvt_pk_bf16_f32 v67, v86, v87
  buffer_store_dwordx4 v[64:67], v1, s[4:7], s56 offen offset:0 sc1
  v_accvgpr_read_b32 v80, a136
  v_accvgpr_read_b32 v81, a137
  v_accvgpr_read_b32 v82, a138
  v_accvgpr_read_b32 v83, a139
  v_accvgpr_read_b32 v84, a140
  v_accvgpr_read_b32 v85, a141
  v_accvgpr_read_b32 v86, a142
  v_accvgpr_read_b32 v87, a143
  v_cvt_pk_bf16_f32 v68, v80, v81
  v_cvt_pk_bf16_f32 v69, v82, v83
  v_cvt_pk_bf16_f32 v70, v84, v85
  v_cvt_pk_bf16_f32 v71, v86, v87
  buffer_store_dwordx4 v[68:71], v1, s[4:7], s56 offen offset:1024 sc1
  v_accvgpr_read_b32 v80, a144
  v_accvgpr_read_b32 v81, a145
  v_accvgpr_read_b32 v82, a146
  v_accvgpr_read_b32 v83, a147
  v_accvgpr_read_b32 v84, a148
  v_accvgpr_read_b32 v85, a149
  v_accvgpr_read_b32 v86, a150
  v_accvgpr_read_b32 v87, a151
  v_cvt_pk_bf16_f32 v72, v80, v81
  v_cvt_pk_bf16_f32 v73, v82, v83
  v_cvt_pk_bf16_f32 v74, v84, v85
  v_cvt_pk_bf16_f32 v75, v86, v87
  buffer_store_dwordx4 v[72:75], v1, s[4:7], s56 offen offset:2048 sc1
  v_accvgpr_read_b32 v80, a152
  v_accvgpr_read_b32 v81, a153
  v_accvgpr_read_b32 v82, a154
  v_accvgpr_read_b32 v83, a155
  v_accvgpr_read_b32 v84, a156
  v_accvgpr_read_b32 v85, a157
  v_accvgpr_read_b32 v86, a158
  v_accvgpr_read_b32 v87, a159
  v_cvt_pk_bf16_f32 v76, v80, v81
  v_cvt_pk_bf16_f32 v77, v82, v83
  v_cvt_pk_bf16_f32 v78, v84, v85
  v_cvt_pk_bf16_f32 v79, v86, v87
  buffer_store_dwordx4 v[76:79], v1, s[4:7], s56 offen offset:3072 sc1
  s_add_u32 s56, s54, 528384
  v_accvgpr_read_b32 v80, a160
  v_accvgpr_read_b32 v81, a161
  v_accvgpr_read_b32 v82, a162
  v_accvgpr_read_b32 v83, a163
  v_accvgpr_read_b32 v84, a164
  v_accvgpr_read_b32 v85, a165
  v_accvgpr_read_b32 v86, a166
  v_accvgpr_read_b32 v87, a167
  v_cvt_pk_bf16_f32 v64, v80, v81
  v_cvt_pk_bf16_f32 v65, v82, v83
  v_cvt_pk_bf16_f32 v66, v84, v85
  v_cvt_pk_bf16_f32 v67, v86, v87
  buffer_store_dwordx4 v[64:67], v1, s[4:7], s56 offen offset:0 sc1
  v_accvgpr_read_b32 v80, a168
  v_accvgpr_read_b32 v81, a169
  v_accvgpr_read_b32 v82, a170
  v_accvgpr_read_b32 v83, a171
  v_accvgpr_read_b32 v84, a172
  v_accvgpr_read_b32 v85, a173
  v_accvgpr_read_b32 v86, a174
  v_accvgpr_read_b32 v87, a175
  v_cvt_pk_bf16_f32 v68, v80, v81
  v_cvt_pk_bf16_f32 v69, v82, v83
  v_cvt_pk_bf16_f32 v70, v84, v85
  v_cvt_pk_bf16_f32 v71, v86, v87
  buffer_store_dwordx4 v[68:71], v1, s[4:7], s56 offen offset:1024 sc1
  v_accvgpr_read_b32 v80, a176
  v_accvgpr_read_b32 v81, a177
  v_accvgpr_read_b32 v82, a178
  v_accvgpr_read_b32 v83, a179
  v_accvgpr_read_b32 v84, a180
  v_accvgpr_read_b32 v85, a181
  v_accvgpr_read_b32 v86, a182
  v_accvgpr_read_b32 v87, a183
  v_cvt_pk_bf16_f32 v72, v80, v81
  v_cvt_pk_bf16_f32 v73, v82, v83
  v_cvt_pk_bf16_f32 v74, v84, v85
  v_cvt_pk_bf16_f32 v75, v86, v87
  buffer_store_dwordx4 v[72:75], v1, s[4:7], s56 offen offset:2048 sc1
  v_accvgpr_read_b32 v80, a184
  v_accvgpr_read_b32 v81, a185
  v_accvgpr_read_b32 v82, a186
  v_accvgpr_read_b32 v83, a187
  v_accvgpr_read_b32 v84, a188
  v_accvgpr_read_b32 v85, a189
  v_accvgpr_read_b32 v86, a190
  v_accvgpr_read_b32 v87, a191
  v_cvt_pk_bf16_f32 v76, v80, v81
  v_cvt_pk_bf16_f32 v77, v82, v83
  v_cvt_pk_bf16_f32 v78, v84, v85
  v_cvt_pk_bf16_f32 v79, v86, v87
  buffer_store_dwordx4 v[76:79], v1, s[4:7], s56 offen offset:3072 sc1
  s_add_u32 s56, s54, 786432
  v_accvgpr_read_b32 v80, a192
  v_accvgpr_read_b32 v81, a193
  v_accvgpr_read_b32 v82, a194
  v_accvgpr_read_b32 v83, a195
  v_accvgpr_read_b32 v84, a196
  v_accvgpr_read_b32 v85, a197
  v_accvgpr_read_b32 v86, a198
  v_accvgpr_read_b32 v87, a199
  v_cvt_pk_bf16_f32 v64, v80, v81
  v_cvt_pk_bf16_f32 v65, v82, v83
  v_cvt_pk_bf16_f32 v66, v84, v85
  v_cvt_pk_bf16_f32 v67, v86, v87
  buffer_store_dwordx4 v[64:67], v1, s[4:7], s56 offen offset:0 sc1
  v_accvgpr_read_b32 v80, a200
  v_accvgpr_read_b32 v81, a201
  v_accvgpr_read_b32 v82, a202
  v_accvgpr_read_b32 v83, a203
  v_accvgpr_read_b32 v84, a204
  v_accvgpr_read_b32 v85, a205
  v_accvgpr_read_b32 v86, a206
  v_accvgpr_read_b32 v87, a207
  v_cvt_pk_bf16_f32 v68, v80, v81
  v_cvt_pk_bf16_f32 v69, v82, v83
  v_cvt_pk_bf16_f32 v70, v84, v85
  v_cvt_pk_bf16_f32 v71, v86, v87
  buffer_store_dwordx4 v[68:71], v1, s[4:7], s56 offen offset:1024 sc1
  v_accvgpr_read_b32 v80, a208
  v_accvgpr_read_b32 v81, a209
  v_accvgpr_read_b32 v82, a210
  v_accvgpr_read_b32 v83, a211
  v_accvgpr_read_b32 v84, a212
  v_accvgpr_read_b32 v85, a213
  v_accvgpr_read_b32 v86, a214
  v_accvgpr_read_b32 v87, a215
  v_cvt_pk_bf16_f32 v72, v80, v81
  v_cvt_pk_bf16_f32 v73, v82, v83
  v_cvt_pk_bf16_f32 v74, v84, v85
  v_cvt_pk_bf16_f32 v75, v86, v87
  buffer_store_dwordx4 v[72:75], v1, s[4:7], s56 offen offset:2048 sc1
  v_accvgpr_read_b32 v80, a216
  v_accvgpr_read_b32 v81, a217
  v_accvgpr_read_b32 v82, a218
  v_accvgpr_read_b32 v83, a219
  v_accvgpr_read_b32 v84, a220
  v_accvgpr_read_b32 v85, a221
  v_accvgpr_read_b32 v86, a222
  v_accvgpr_read_b32 v87, a223
  v_cvt_pk_bf16_f32 v76, v80, v81
  v_cvt_pk_bf16_f32 v77, v82, v83
  v_cvt_pk_bf16_f32 v78, v84, v85
  v_cvt_pk_bf16_f32 v79, v86, v87
  buffer_store_dwordx4 v[76:79], v1, s[4:7], s56 offen offset:3072 sc1
  s_add_u32 s56, s54, 790528
  v_accvgpr_read_b32 v80, a224
  v_accvgpr_read_b32 v81, a225
  v_accvgpr_read_b32 v82, a226
  v_accvgpr_read_b32 v83, a227
  v_accvgpr_read_b32 v84, a228
  v_accvgpr_read_b32 v85, a229
  v_accvgpr_read_b32 v86, a230
  v_accvgpr_read_b32 v87, a231
  v_cvt_pk_bf16_f32 v64, v80, v81
  v_cvt_pk_bf16_f32 v65, v82, v83
  v_cvt_pk_bf16_f32 v66, v84, v85
  v_cvt_pk_bf16_f32 v67, v86, v87
  buffer_store_dwordx4 v[64:67], v1, s[4:7], s56 offen offset:0 sc1
  v_accvgpr_read_b32 v80, a232
  v_accvgpr_read_b32 v81, a233
  v_accvgpr_read_b32 v82, a234
  v_accvgpr_read_b32 v83, a235
  v_accvgpr_read_b32 v84, a236
  v_accvgpr_read_b32 v85, a237
  v_accvgpr_read_b32 v86, a238
  v_accvgpr_read_b32 v87, a239
  v_cvt_pk_bf16_f32 v68, v80, v81
  v_cvt_pk_bf16_f32 v69, v82, v83
  v_cvt_pk_bf16_f32 v70, v84, v85
  v_cvt_pk_bf16_f32 v71, v86, v87
  buffer_store_dwordx4 v[68:71], v1, s[4:7], s56 offen offset:1024 sc1
  v_accvgpr_read_b32 v80, a240
  v_accvgpr_read_b32 v81, a241
  v_accvgpr_read_b32 v82, a242
  v_accvgpr_read_b32 v83, a243
  v_accvgpr_read_b32 v84, a244
  v_accvgpr_read_b32 v85, a245
  v_accvgpr_read_b32 v86, a246
  v_accvgpr_read_b32 v87, a247
  v_cvt_pk_bf16_f32 v72, v80, v81
  v_cvt_pk_bf16_f32 v73, v82, v83
  v_cvt_pk_bf16_f32 v74, v84, v85
  v_cvt_pk_bf16_f32 v75, v86, v87
  buffer_store_dwordx4 v[72:75], v1, s[4:7], s56 offen offset:2048 sc1
  v_accvgpr_read_b32 v80, a248
  v_accvgpr_read_b32 v81, a249
  v_accvgpr_read_b32 v82, a250
  v_accvgpr_read_b32 v83, a251
  v_accvgpr_read_b32 v84, a252
  v_accvgpr_read_b32 v85, a253
  v_accvgpr_read_b32 v86, a254
  v_accvgpr_read_b32 v87, a255
  v_cvt_pk_bf16_f32 v76, v80, v81
  v_cvt_pk_bf16_f32 v77, v82, v83
  v_cvt_pk_bf16_f32 v78, v84, v85
  v_cvt_pk_bf16_f32 v79, v86, v87
  buffer_store_dwordx4 v[76:79], v1, s[4:7], s56 offen offset:3072 sc1
  s_waitcnt vmcnt(32)
  s_branch G_ld
G_e_2:
  s_nop 11
  s_add_u32 s56, s54, 0
  v_accvgpr_read_b32 v80, a0
  v_accvgpr_read_b32 v81, a1
  v_accvgpr_read_b32 v82, a2
  v_accvgpr_read_b32 v83, a3
  v_accvgpr_read_b32 v84, a32
  v_accvgpr_read_b32 v85, a33
  v_accvgpr_read_b32 v86, a34
  v_accvgpr_read_b32 v87, a35
  v_cvt_pk_bf16_f32 v64, v80, v81
  v_cvt_pk_bf16_f32 v65, v82, v83
  v_cvt_pk_bf16_f32 v66, v84, v85
  v_cvt_pk_bf16_f32 v67, v86, v87
  buffer_store_dwordx4 v[64:67], v1, s[4:7], s56 offen offset:0 sc1
  v_accvgpr_read_b32 v80, a4
  v_accvgpr_read_b32 v81, a5
  v_accvgpr_read_b32 v82, a6
  v_accvgpr_read_b32 v83, a7
  v_accvgpr_read_b32 v84, a36
  v_accvgpr_read_b32 v85, a37
  v_accvgpr_read_b32 v86, a38
  v_accvgpr_read_b32 v87, a39
  v_cvt_pk_bf16_f32 v68, v80, v81
  v_cvt_pk_bf16_f32 v69, v82, v83
  v_cvt_pk_bf16_f32 v70, v84, v85
  v_cvt_pk_bf16_f32 v71, v86, v87
  buffer_store_dwordx4 v[68:71], v1, s[4:7], s56 offen offset:1024 sc1
  v_accvgpr_read_b32 v80, a8
  v_accvgpr_read_b32 v81, a9
  v_accvgpr_read_b32 v82, a10
  v_accvgpr_read_b32 v83, a11
  v_accvgpr_read_b32 v84, a40
  v_accvgpr_read_b32 v85, a41
  v_accvgpr_read_b32 v86, a42
  v_accvgpr_read_b32 v87, a43
  v_cvt_pk_bf16_f32 v72, v80, v81
  v_cvt_pk_bf16_f32 v73, v82, v83
  v_cvt_pk_bf16_f32 v74, v84, v85
  v_cvt_pk_bf16_f32 v75, v86, v87
  buffer_store_dwordx4 v[72:75], v1, s[4:7], s56 offen offset:2048 sc1
  v_accvgpr_read_b32 v80, a12
  v_accvgpr_read_b32 v81, a13
  v_accvgpr_read_b32 v82, a14
  v_accvgpr_read_b32 v83, a15
  v_accvgpr_read_b32 v84, a44
  v_accvgpr_read_b32 v85, a45
  v_accvgpr_read_b32 v86, a46
  v_accvgpr_read_b32 v87, a47
  v_cvt_pk_bf16_f32 v76, v80, v81
  v_cvt_pk_bf16_f32 v77, v82, v83
  v_cvt_pk_bf16_f32 v78, v84, v85
  v_cvt_pk_bf16_f32 v79, v86, v87
  buffer_store_dwordx4 v[76:79], v1, s[4:7], s56 offen offset:3072 sc1
  s_add_u32 s56, s54, 4096
  v_accvgpr_read_b32 v80, a16
  v_accvgpr_read_b32 v81, a17
  v_accvgpr_read_b32 v82, a18
  v_accvgpr_read_b32 v83, a19
  v_accvgpr_read_b32 v84, a48
  v_accvgpr_read_b32 v85, a49
  v_accvgpr_read_b32 v86, a50
  v_accvgpr_read_b32 v87, a51
  v_cvt_pk_bf16_f32 v64, v80, v81
  v_cvt_pk_bf16_f32 v65, v82, v83
  v_cvt_pk_bf16_f32 v66, v84, v85
  v_cvt_pk_bf16_f32 v67, v86, v87
  buffer_store_dwordx4 v[64:67], v1, s[4:7], s56 offen offset:0 sc1
  v_accvgpr_read_b32 v80, a20
  v_accvgpr_read_b32 v81, a21
  v_accvgpr_read_b32 v82, a22
  v_accvgpr_read_b32 v83, a23
  v_accvgpr_read_b32 v84, a52
  v_accvgpr_read_b32 v85, a53
  v_accvgpr_read_b32 v86, a54
  v_accvgpr_read_b32 v87, a55
  v_cvt_pk_bf16_f32 v68, v80, v81
  v_cvt_pk_bf16_f32 v69, v82, v83
  v_cvt_pk_bf16_f32 v70, v84, v85
  v_cvt_pk_bf16_f32 v71, v86, v87
  buffer_store_dwordx4 v[68:71], v1, s[4:7], s56 offen offset:1024 sc1
  v_accvgpr_read_b32 v80, a24
  v_accvgpr_read_b32 v81, a25
  v_accvgpr_read_b32 v82, a26
  v_accvgpr_read_b32 v83, a27
  v_accvgpr_read_b32 v84, a56
  v_accvgpr_read_b32 v85, a57
  v_accvgpr_read_b32 v86, a58
  v_accvgpr_read_b32 v87, a59
  v_cvt_pk_bf16_f32 v72, v80, v81
  v_cvt_pk_bf16_f32 v73, v82, v83
  v_cvt_pk_bf16_f32 v74, v84, v85
  v_cvt_pk_bf16_f32 v75, v86, v87
  buffer_store_dwordx4 v[72:75], v1, s[4:7], s56 offen offset:2048 sc1
  v_accvgpr_read_b32 v80, a28
  v_accvgpr_read_b32 v81, a29
  v_accvgpr_read_b32 v82, a30
  v_accvgpr_read_b32 v83, a31
  v_accvgpr_read_b32 v84, a60
  v_accvgpr_read_b32 v85, a61
  v_accvgpr_read_b32 v86, a62
  v_accvgpr_read_b32 v87, a63
  v_cvt_pk_bf16_f32 v76, v80, v81
  v_cvt_pk_bf16_f32 v77, v82, v83
  v_cvt_pk_bf16_f32 v78, v84, v85
  v_cvt_pk_bf16_f32 v79, v86, v87
  buffer_store_dwordx4 v[76:79], v1, s[4:7], s56 offen offset:3072 sc1
  s_add_u32 s56, s54, 262144
  v_accvgpr_read_b32 v80, a64
  v_accvgpr_read_b32 v81, a65
  v_accvgpr_read_b32 v82, a66
  v_accvgpr_read_b32 v83, a67
  v_accvgpr_read_b32 v84, a96
  v_accvgpr_read_b32 v85, a97
  v_accvgpr_read_b32 v86, a98
  v_accvgpr_read_b32 v87, a99
  v_cvt_pk_bf16_f32 v64, v80, v81
  v_cvt_pk_bf16_f32 v65, v82, v83
  v_cvt_pk_bf16_f32 v66, v84, v85
  v_cvt_pk_bf16_f32 v67, v86, v87
  buffer_store_dwordx4 v[64:67], v1, s[4:7], s56 offen offset:0 sc1
  v_accvgpr_read_b32 v80, a68
  v_accvgpr_read_b32 v81, a69
  v_accvgpr_read_b32 v82, a70
  v_accvgpr_read_b32 v83, a71
  v_accvgpr_read_b32 v84, a100
  v_accvgpr_read_b32 v85, a101
  v_accvgpr_read_b32 v86, a102
  v_accvgpr_read_b32 v87, a103
  v_cvt_pk_bf16_f32 v68, v80, v81
  v_cvt_pk_bf16_f32 v69, v82, v83
  v_cvt_pk_bf16_f32 v70, v84, v85
  v_cvt_pk_bf16_f32 v71, v86, v87
  buffer_store_dwordx4 v[68:71], v1, s[4:7], s56 offen offset:1024 sc1
  v_accvgpr_read_b32 v80, a72
  v_accvgpr_read_b32 v81, a73
  v_accvgpr_read_b32 v82, a74
  v_accvgpr_read_b32 v83, a75
  v_accvgpr_read_b32 v84, a104
  v_accvgpr_read_b32 v85, a105
  v_accvgpr_read_b32 v86, a106
  v_accvgpr_read_b32 v87, a107
  v_cvt_pk_bf16_f32 v72, v80, v81
  v_cvt_pk_bf16_f32 v73, v82, v83
  v_cvt_pk_bf16_f32 v74, v84, v85
  v_cvt_pk_bf16_f32 v75, v86, v87
  buffer_store_dwordx4 v[72:75], v1, s[4:7], s56 offen offset:2048 sc1
  v_accvgpr_read_b32 v80, a76
  v_accvgpr_read_b32 v81, a77
  v_accvgpr_read_b32 v82, a78
  v_accvgpr_read_b32 v83, a79
  v_accvgpr_read_b32 v84, a108
  v_accvgpr_read_b32 v85, a109
  v_accvgpr_read_b32 v86, a110
  v_accvgpr_read_b32 v87, a111
  v_cvt_pk_bf16_f32 v76, v80, v81
  v_cvt_pk_bf16_f32 v77, v82, v83
  v_cvt_pk_bf16_f32 v78, v84, v85
  v_cvt_pk_bf16_f32 v79, v86, v87
  buffer_store_dwordx4 v[76:79], v1, s[4:7], s56 offen offset:3072 sc1
  s_add_u32 s56, s54, 266240
  v_accvgpr_read_b32 v80, a80
  v_accvgpr_read_b32 v81, a81
  v_accvgpr_read_b32 v82, a82
  v_accvgpr_read_b32 v83, a83
  v_accvgpr_read_b32 v84, a112
  v_accvgpr_read_b32 v85, a113
  v_accvgpr_read_b32 v86, a114
  v_accvgpr_read_b32 v87, a115
  v_cvt_pk_bf16_f32 v64, v80, v81
  v_cvt_pk_bf16_f32 v65, v82, v83
  v_cvt_pk_bf16_f32 v66, v84, v85
  v_cvt_pk_bf16_f32 v67, v86, v87
  buffer_store_dwordx4 v[64:67], v1, s[4:7], s56 offen offset:0 sc1
  v_accvgpr_read_b32 v80, a84
  v_accvgpr_read_b32 v81, a85
  v_accvgpr_read_b32 v82, a86
  v_accvgpr_read_b32 v83, a87
  v_accvgpr_read_b32 v84, a116
  v_accvgpr_read_b32 v85, a117
  v_accvgpr_read_b32 v86, a118
  v_accvgpr_read_b32 v87, a119
  v_cvt_pk_bf16_f32 v68, v80, v81
  v_cvt_pk_bf16_f32 v69, v82, v83
  v_cvt_pk_bf16_f32 v70, v84, v85
  v_cvt_pk_bf16_f32 v71, v86, v87
  buffer_store_dwordx4 v[68:71], v1, s[4:7], s56 offen offset:1024 sc1
  v_accvgpr_read_b32 v80, a88
  v_accvgpr_read_b32 v81, a89
  v_accvgpr_read_b32 v82, a90
  v_accvgpr_read_b32 v83, a91
  v_accvgpr_read_b32 v84, a120
  v_accvgpr_read_b32 v85, a121
  v_accvgpr_read_b32 v86, a122
  v_accvgpr_read_b32 v87, a123
  v_cvt_pk_bf16_f32 v72, v80, v81
  v_cvt_pk_bf16_f32 v73, v82, v83
  v_cvt_pk_bf16_f32 v74, v84, v85
  v_cvt_pk_bf16_f32 v75, v86, v87
  buffer_store_dwordx4 v[72:75], v1, s[4:7], s56 offen offset:2048 sc1
  v_accvgpr_read_b32 v80, a92
  v_accvgpr_read_b32 v81, a93
  v_accvgpr_read_b32 v82, a94
  v_accvgpr_read_b32 v83, a95
  v_accvgpr_read_b32 v84, a124
  v_accvgpr_read_b32 v85, a125
  v_accvgpr_read_b32 v86, a126
  v_accvgpr_read_b32 v87, a127
  v_cvt_pk_bf16_f32 v76, v80, v81
  v_cvt_pk_bf16_f32 v77, v82, v83
  v_cvt_pk_bf16_f32 v78, v84, v85
  v_cvt_pk_bf16_f32 v79, v86, v87
  buffer_store_dwordx4 v[76:79], v1, s[4:7], s56 offen offset:3072 sc1
  s_add_u32 s56, s54, 524288
  v_accvgpr_read_b32 v80, a128
  v_accvgpr_read_b32 v81, a129
  v_accvgpr_read_b32 v82, a130
  v_accvgpr_read_b32 v83, a131
  v_accvgpr_read_b32 v84, a160
  v_accvgpr_read_b32 v85, a161
  v_accvgpr_read_b32 v86, a162
  v_accvgpr_read_b32 v87, a163
  v_cvt_pk_bf16_f32 v64, v80, v81
  v_cvt_pk_bf16_f32 v65, v82, v83
  v_cvt_pk_bf16_f32 v66, v84, v85
  v_cvt_pk_bf16_f32 v67, v86, v87
  buffer_store_dwordx4 v[64:67], v1, s[4:7], s56 offen offset:0 sc1
  v_accvgpr_read_b32 v80, a132
  v_accvgpr_read_b32 v81, a133
  v_accvgpr_read_b32 v82, a134
  v_accvgpr_read_b32 v83, a135
  v_accvgpr_read_b32 v84, a164
  v_accvgpr_read_b32 v85, a165
  v_accvgpr_read_b32 v86, a166
  v_accvgpr_read_b32 v87, a167
  v_cvt_pk_bf16_f32 v68, v80, v81
  v_cvt_pk_bf16_f32 v69, v82, v83
  v_cvt_pk_bf16_f32 v70, v84, v85
  v_cvt_pk_bf16_f32 v71, v86, v87
  buffer_store_dwordx4 v[68:71], v1, s[4:7], s56 offen offset:1024 sc1
  v_accvgpr_read_b32 v80, a136
  v_accvgpr_read_b32 v81, a137
  v_accvgpr_read_b32 v82, a138
  v_accvgpr_read_b32 v83, a139
  v_accvgpr_read_b32 v84, a168
  v_accvgpr_read_b32 v85, a169
  v_accvgpr_read_b32 v86, a170
  v_accvgpr_read_b32 v87, a171
  v_cvt_pk_bf16_f32 v72, v80, v81
  v_cvt_pk_bf16_f32 v73, v82, v83
  v_cvt_pk_bf16_f32 v74, v84, v85
  v_cvt_pk_bf16_f32 v75, v86, v87
  buffer_store_dwordx4 v[72:75], v1, s[4:7], s56 offen offset:2048 sc1
  v_accvgpr_read_b32 v80, a140
  v_accvgpr_read_b32 v81, a141
  v_accvgpr_read_b32 v82, a142
  v_accvgpr_read_b32 v83, a143
  v_accvgpr_read_b32 v84, a172
  v_accvgpr_read_b32 v85, a173
  v_accvgpr_read_b32 v86, a174
  v_accvgpr_read_b32 v87, a175
  v_cvt_pk_bf16_f32 v76, v80, v81
  v_cvt_pk_bf16_f32 v77, v82, v83
  v_cvt_pk_bf16_f32 v78, v84, v85
  v_cvt_pk_bf16_f32 v79, v86, v87
  buffer_store_dwordx4 v[76:79], v1, s[4:7], s56 offen offset:3072 sc1
  s_add_u32 s56, s54, 528384
  v_accvgpr_read_b32 v80, a144
  v_accvgpr_read_b32 v81, a145
  v_accvgpr_read_b32 v82, a146
  v_accvgpr_read_b32 v83, a147
  v_accvgpr_read_b32 v84, a176
  v_accvgpr_read_b32 v85, a177
  v_accvgpr_read_b32 v86, a178
  v_accvgpr_read_b32 v87, a179
  v_cvt_pk_bf16_f32 v64, v80, v81
  v_cvt_pk_bf16_f32 v65, v82, v83
  v_cvt_pk_bf16_f32 v66, v84, v85
  v_cvt_pk_bf16_f32 v67, v86, v87
  buffer_store_dwordx4 v[64:67], v1, s[4:7], s56 offen offset:0 sc1
  v_accvgpr_read_b32 v80, a148
  v_accvgpr_read_b32 v81, a149
  v_accvgpr_read_b32 v82, a150
  v_accvgpr_read_b32 v83, a151
  v_accvgpr_read_b32 v84, a180
  v_accvgpr_read_b32 v85, a181
  v_accvgpr_read_b32 v86, a182
  v_accvgpr_read_b32 v87, a183
  v_cvt_pk_bf16_f32 v68, v80, v81
  v_cvt_pk_bf16_f32 v69, v82, v83
  v_cvt_pk_bf16_f32 v70, v84, v85
  v_cvt_pk_bf16_f32 v71, v86, v87
  buffer_store_dwordx4 v[68:71], v1, s[4:7], s56 offen offset:1024 sc1
  v_accvgpr_read_b32 v80, a152
  v_accvgpr_read_b32 v81, a153
  v_accvgpr_read_b32 v82, a154
  v_accvgpr_read_b32 v83, a155
  v_accvgpr_read_b32 v84, a184
  v_accvgpr_read_b32 v85, a185
  v_accvgpr_read_b32 v86, a186
  v_accvgpr_read_b32 v87, a187
  v_cvt_pk_bf16_f32 v72, v80, v81
  v_cvt_pk_bf16_f32 v73, v82, v83
  v_cvt_pk_bf16_f32 v74, v84, v85
  v_cvt_pk_bf16_f32 v75, v86, v87
  buffer_store_dwordx4 v[72:75], v1, s[4:7], s56 offen offset:2048 sc1
  v_accvgpr_read_b32 v80, a156
  v_accvgpr_read_b32 v81, a157
  v_accvgpr_read_b32 v82, a158
  v_accvgpr_read_b32 v83, a159
  v_accvgpr_read_b32 v84, a188
  v_accvgpr_read_b32 v85, a189
  v_accvgpr_read_b32 v86, a190
  v_accvgpr_read_b32 v87, a191
  v_cvt_pk_bf16_f32 v76, v80, v81
  v_cvt_pk_bf16_f32 v77, v82, v83
  v_cvt_pk_bf16_f32 v78, v84, v85
  v_cvt_pk_bf16_f32 v79, v86, v87
  buffer_store_dwordx4 v[76:79], v1, s[4:7], s56 offen offset:3072 sc1
  s_add_u32 s56, s54, 786432
  v_accvgpr_read_b32 v80, a192
  v_accvgpr_read_b32 v81, a193
  v_accvgpr_read_b32 v82, a194
  v_accvgpr_read_b32 v83, a195
  v_accvgpr_read_b32 v84, a224
  v_accvgpr_read_b32 v85, a225
  v_accvgpr_read_b32 v86, a226
  v_accvgpr_read_b32 v87, a227
  v_cvt_pk_bf16_f32 v64, v80, v81
  v_cvt_pk_bf16_f32 v65, v82, v83
  v_cvt_pk_bf16_f32 v66, v84, v85
  v_cvt_pk_bf16_f32 v67, v86, v87
  buffer_store_dwordx4 v[64:67], v1, s[4:7], s56 offen offset:0 sc1
  v_accvgpr_read_b32 v80, a196
  v_accvgpr_read_b32 v81, a197
  v_accvgpr_read_b32 v82, a198
  v_accvgpr_read_b32 v83, a199
  v_accvgpr_read_b32 v84, a228
  v_accvgpr_read_b32 v85, a229
  v_accvgpr_read_b32 v86, a230
  v_accvgpr_read_b32 v87, a231
  v_cvt_pk_bf16_f32 v68, v80, v81
  v_cvt_pk_bf16_f32 v69, v82, v83
  v_cvt_pk_bf16_f32 v70, v84, v85
  v_cvt_pk_bf16_f32 v71, v86, v87
  buffer_store_dwordx4 v[68:71], v1, s[4:7], s56 offen offset:1024 sc1
  v_accvgpr_read_b32 v80, a200
  v_accvgpr_read_b32 v81, a201
  v_accvgpr_read_b32 v82, a202
  v_accvgpr_read_b32 v83, a203
  v_accvgpr_read_b32 v84, a232
  v_accvgpr_read_b32 v85, a233
  v_accvgpr_read_b32 v86, a234
  v_accvgpr_read_b32 v87, a235
  v_cvt_pk_bf16_f32 v72, v80, v81
  v_cvt_pk_bf16_f32 v73, v82, v83
  v_cvt_pk_bf16_f32 v74, v84, v85
  v_cvt_pk_bf16_f32 v75, v86, v87
  buffer_store_dwordx4 v[72:75], v1, s[4:7], s56 offen offset:2048 sc1
  v_accvgpr_read_b32 v80, a204
  v_accvgpr_read_b32 v81, a205
  v_accvgpr_read_b32 v82, a206
  v_accvgpr_read_b32 v83, a207
  v_accvgpr_read_b32 v84, a236
  v_accvgpr_read_b32 v85, a237
  v_accvgpr_read_b32 v86, a238
  v_accvgpr_read_b32 v87, a239
  v_cvt_pk_bf16_f32 v76, v80, v81
  v_cvt_pk_bf16_f32 v77, v82, v83
  v_cvt_pk_bf16_f32 v78, v84, v85
  v_cvt_pk_bf16_f32 v79, v86, v87
  buffer_store_dwordx4 v[76:79], v1, s[4:7], s56 offen offset:3072 sc1
  s_add_u32 s56, s54, 790528
  v_accvgpr_read_b32 v80, a208
  v_accvgpr_read_b32 v81, a209
  v_accvgpr_read_b32 v82, a210
  v_accvgpr_read_b32 v83, a211
  v_accvgpr_read_b32 v84, a240
  v_accvgpr_read_b32 v85, a241
  v_accvgpr_read_b32 v86, a242
  v_accvgpr_read_b32 v87, a243
  v_cvt_pk_bf16_f32 v64, v80, v81
  v_cvt_pk_bf16_f32 v65, v82, v83
  v_cvt_pk_bf16_f32 v66, v84, v85
  v_cvt_pk_bf16_f32 v67, v86, v87
  buffer_store_dwordx4 v[64:67], v1, s[4:7], s56 offen offset:0 sc1
  v_accvgpr_read_b32 v80, a212
  v_accvgpr_read_b32 v81, a213
  v_accvgpr_read_b32 v82, a214
  v_accvgpr_read_b32 v83, a215
  v_accvgpr_read_b32 v84, a244
  v_accvgpr_read_b32 v85, a245
  v_accvgpr_read_b32 v86, a246
  v_accvgpr_read_b32 v87, a247
  v_cvt_pk_bf16_f32 v68, v80, v81
  v_cvt_pk_bf16_f32 v69, v82, v83
  v_cvt_pk_bf16_f32 v70, v84, v85
  v_cvt_pk_bf16_f32 v71, v86, v87
  buffer_store_dwordx4 v[68:71], v1, s[4:7], s56 offen offset:1024 sc1
  v_accvgpr_read_b32 v80, a216
  v_accvgpr_read_b32 v81, a217
  v_accvgpr_read_b32 v82, a218
  v_accvgpr_read_b32 v83, a219
  v_accvgpr_read_b32 v84, a248
  v_accvgpr_read_b32 v85, a249
  v_accvgpr_read_b32 v86, a250
  v_accvgpr_read_b32 v87, a251
  v_cvt_pk_bf16_f32 v72, v80, v81
  v_cvt_pk_bf16_f32 v73, v82, v83
  v_cvt_pk_bf16_f32 v74, v84, v85
  v_cvt_pk_bf16_f32 v75, v86, v87
  buffer_store_dwordx4 v[72:75], v1, s[4:7], s56 offen offset:2048 sc1
  v_accvgpr_read_b32 v80, a220
  v_accvgpr_read_b32 v81, a221
  v_accvgpr_read_b32 v82, a222
  v_accvgpr_read_b32 v83, a223
  v_accvgpr_read_b32 v84, a252
  v_accvgpr_read_b32 v85, a253
  v_accvgpr_read_b32 v86, a254
  v_accvgpr_read_b32 v87, a255
  v_cvt_pk_bf16_f32 v76, v80, v81
  v_cvt_pk_bf16_f32 v77, v82, v83
  v_cvt_pk_bf16_f32 v78, v84, v85
  v_cvt_pk_bf16_f32 v79, v86, v87
  buffer_store_dwordx4 v[76:79], v1, s[4:7], s56 offen offset:3072 sc1
  s_waitcnt vmcnt(32)
  s_branch G_ld
G_e_3:
  s_nop 11
  s_mov_b32 s57, 0xbdd2d3e8
  v_mov_b32 v104, 0xc0135761
  s_add_u32 s56, s54, 0
  v_accvgpr_read_b32 v80, a0
  v_accvgpr_read_b32 v81, a1
  v_accvgpr_read_b32 v82, a2
  v_accvgpr_read_b32 v83, a3
  v_accvgpr_read_b32 v84, a4
  v_accvgpr_read_b32 v85, a5
  v_accvgpr_read_b32 v86, a6
  v_accvgpr_read_b32 v87, a7
  v_mul_f32 v96, v80, v80
  v_mul_f32 v97, v81, v81
  v_mul_f32 v98, v82, v82
  v_mul_f32 v99, v83, v83
  v_mul_f32 v100, v84, v84
  v_mul_f32 v101, v85, v85
  v_mul_f32 v102, v86, v86
  v_mul_f32 v103, v87, v87
  v_fma_f32 v96, v96, s57, v104
  v_fma_f32 v97, v97, s57, v104
  v_fma_f32 v98, v98, s57, v104
  v_fma_f32 v99, v99, s57, v104
  v_fma_f32 v100, v100, s57, v104
  v_fma_f32 v101, v101, s57, v104
  v_fma_f32 v102, v102, s57, v104
  v_fma_f32 v103, v103, s57, v104
  v_mul_f32 v96, v96, v80
  v_mul_f32 v97, v97, v81
  v_mul_f32 v98, v98, v82
  v_mul_f32 v99, v99, v83
  v_mul_f32 v100, v100, v84
  v_mul_f32 v101, v101, v85
  v_mul_f32 v102, v102, v86
  v_mul_f32 v103, v103, v87
  v_exp_f32 v96, v96
  v_accvgpr_read_b32 v88, a16
  v_exp_f32 v97, v97
  v_accvgpr_read_b32 v89, a17
  v_exp_f32 v98, v98
  v_accvgpr_read_b32 v90, a18
  v_exp_f32 v99, v99
  v_accvgpr_read_b32 v91, a19
  v_exp_f32 v100, v100
  v_accvgpr_read_b32 v92, a20
  v_exp_f32 v101, v101
  v_accvgpr_read_b32 v93, a21
  v_exp_f32 v102, v102
  v_accvgpr_read_b32 v94, a22
  v_exp_f32 v103, v103
  v_accvgpr_read_b32 v95, a23
  v_add_f32 v96, 1.0, v96
  v_add_f32 v97, 1.0, v97
  v_add_f32 v98, 1.0, v98
  v_add_f32 v99, 1.0, v99
  v_add_f32 v100, 1.0, v100
  v_add_f32 v101, 1.0, v101
  v_add_f32 v102, 1.0, v102
  v_add_f32 v103, 1.0, v103
  v_rcp_f32 v96, v96
  v_mul_f32 v80, v80, v88
  v_rcp_f32 v97, v97
  v_mul_f32 v81, v81, v89
  v_rcp_f32 v98, v98
  v_mul_f32 v82, v82, v90
  v_rcp_f32 v99, v99
  v_mul_f32 v83, v83, v91
  v_rcp_f32 v100, v100
  v_mul_f32 v84, v84, v92
  v_rcp_f32 v101, v101
  v_mul_f32 v85, v85, v93
  v_rcp_f32 v102, v102
  v_mul_f32 v86, v86, v94
  v_rcp_f32 v103, v103
  v_mul_f32 v87, v87, v95
  v_mul_f32 v80, v80, v96
  v_mul_f32 v81, v81, v97
  v_mul_f32 v82, v82, v98
  v_mul_f32 v83, v83, v99
  v_mul_f32 v84, v84, v100
  v_mul_f32 v85, v85, v101
  v_mul_f32 v86, v86, v102
  v_mul_f32 v87, v87, v103
  v_cvt_pk_bf16_f32 v64, v80, v81
  v_cvt_pk_bf16_f32 v65, v82, v83
  v_cvt_pk_bf16_f32 v66, v84, v85
  v_cvt_pk_bf16_f32 v67, v86, v87
  buffer_store_dwordx4 v[64:67], v1, s[4:7], s56 offen offset:0 sc1
  v_accvgpr_read_b32 v80, a8
  v_accvgpr_read_b32 v81, a9
  v_accvgpr_read_b32 v82, a10
  v_accvgpr_read_b32 v83, a11
  v_accvgpr_read_b32 v84, a12
  v_accvgpr_read_b32 v85, a13
  v_accvgpr_read_b32 v86, a14
  v_accvgpr_read_b32 v87, a15
  v_mul_f32 v96, v80, v80
  v_mul_f32 v97, v81, v81
  v_mul_f32 v98, v82, v82
  v_mul_f32 v99, v83, v83
  v_mul_f32 v100, v84, v84
  v_mul_f32 v101, v85, v85
  v_mul_f32 v102, v86, v86
  v_mul_f32 v103, v87, v87
  v_fma_f32 v96, v96, s57, v104
  v_fma_f32 v97, v97, s57, v104
  v_fma_f32 v98, v98, s57, v104
  v_fma_f32 v99, v99, s57, v104
  v_fma_f32 v100, v100, s57, v104
  v_fma_f32 v101, v101, s57, v104
  v_fma_f32 v102, v102, s57, v104
  v_fma_f32 v103, v103, s57, v104
  v_mul_f32 v96, v96, v80
  v_mul_f32 v97, v97, v81
  v_mul_f32 v98, v98, v82
  v_mul_f32 v99, v99, v83
  v_mul_f32 v100, v100, v84
  v_mul_f32 v101, v101, v85
  v_mul_f32 v102, v102, v86
  v_mul_f32 v103, v103, v87
  v_exp_f32 v96, v96
  v_accvgpr_read_b32 v88, a24
  v_exp_f32 v97, v97
  v_accvgpr_read_b32 v89, a25
  v_exp_f32 v98, v98
  v_accvgpr_read_b32 v90, a26
  v_exp_f32 v99, v99
  v_accvgpr_read_b32 v91, a27
  v_exp_f32 v100, v100
  v_accvgpr_read_b32 v92, a28
  v_exp_f32 v101, v101
  v_accvgpr_read_b32 v93, a29
  v_exp_f32 v102, v102
  v_accvgpr_read_b32 v94, a30
  v_exp_f32 v103, v103
  v_accvgpr_read_b32 v95, a31
  v_add_f32 v96, 1.0, v96
  v_add_f32 v97, 1.0, v97
  v_add_f32 v98, 1.0, v98
  v_add_f32 v99, 1.0, v99
  v_add_f32 v100, 1.0, v100
  v_add_f32 v101, 1.0, v101
  v_add_f32 v102, 1.0, v102
  v_add_f32 v103, 1.0, v103
  v_rcp_f32 v96, v96
  v_mul_f32 v80, v80, v88
  v_rcp_f32 v97, v97
  v_mul_f32 v81, v81, v89
  v_rcp_f32 v98, v98
  v_mul_f32 v82, v82, v90
  v_rcp_f32 v99, v99
  v_mul_f32 v83, v83, v91
  v_rcp_f32 v100, v100
  v_mul_f32 v84, v84, v92
  v_rcp_f32 v101, v101
  v_mul_f32 v85, v85, v93
  v_rcp_f32 v102, v102
  v_mul_f32 v86, v86, v94
  v_rcp_f32 v103, v103
  v_mul_f32 v87, v87, v95
  v_mul_f32 v80, v80, v96
  v_mul_f32 v81, v81, v97
  v_mul_f32 v82, v82, v98
  v_mul_f32 v83, v83, v99
  v_mul_f32 v84, v84, v100
  v_mul_f32 v85, v85, v101
  v_mul_f32 v86, v86, v102
  v_mul_f32 v87, v87, v103
  v_cvt_pk_bf16_f32 v68, v80, v81
  v_cvt_pk_bf16_f32 v69, v82, v83
  v_cvt_pk_bf16_f32 v70, v84, v85
  v_cvt_pk_bf16_f32 v71, v86, v87
  buffer_store_dwordx4 v[68:71], v1, s[4:7], s56 offen offset:1024 sc1
  s_add_u32 s56, s54, 114688
  v_accvgpr_read_b32 v80, a32
  v_accvgpr_read_b32 v81, a33
  v_accvgpr_read_b32 v82, a34
  v_accvgpr_read_b32 v83, a35
  v_accvgpr_read_b32 v84, a36
  v_accvgpr_read_b32 v85, a37
  v_accvgpr_read_b32 v86, a38
  v_accvgpr_read_b32 v87, a39
  v_mul_f32 v96, v80, v80
  v_mul_f32 v97, v81, v81
  v_mul_f32 v98, v82, v82
  v_mul_f32 v99, v83, v83
  v_mul_f32 v100, v84, v84
  v_mul_f32 v101, v85, v85
  v_mul_f32 v102, v86, v86
  v_mul_f32 v103, v87, v87
  v_fma_f32 v96, v96, s57, v104
  v_fma_f32 v97, v97, s57, v104
  v_fma_f32 v98, v98, s57, v104
  v_fma_f32 v99, v99, s57, v104
  v_fma_f32 v100, v100, s57, v104
  v_fma_f32 v101, v101, s57, v104
  v_fma_f32 v102, v102, s57, v104
  v_fma_f32 v103, v103, s57, v104
  v_mul_f32 v96, v96, v80
  v_mul_f32 v97, v97, v81
  v_mul_f32 v98, v98, v82
  v_mul_f32 v99, v99, v83
  v_mul_f32 v100, v100, v84
  v_mul_f32 v101, v101, v85
  v_mul_f32 v102, v102, v86
  v_mul_f32 v103, v103, v87
  v_exp_f32 v96, v96
  v_accvgpr_read_b32 v88, a48
  v_exp_f32 v97, v97
  v_accvgpr_read_b32 v89, a49
  v_exp_f32 v98, v98
  v_accvgpr_read_b32 v90, a50
  v_exp_f32 v99, v99
  v_accvgpr_read_b32 v91, a51
  v_exp_f32 v100, v100
  v_accvgpr_read_b32 v92, a52
  v_exp_f32 v101, v101
  v_accvgpr_read_b32 v93, a53
  v_exp_f32 v102, v102
  v_accvgpr_read_b32 v94, a54
  v_exp_f32 v103, v103
  v_accvgpr_read_b32 v95, a55
  v_add_f32 v96, 1.0, v96
  v_add_f32 v97, 1.0, v97
  v_add_f32 v98, 1.0, v98
  v_add_f32 v99, 1.0, v99
  v_add_f32 v100, 1.0, v100
  v_add_f32 v101, 1.0, v101
  v_add_f32 v102, 1.0, v102
  v_add_f32 v103, 1.0, v103
  v_rcp_f32 v96, v96
  v_mul_f32 v80, v80, v88
  v_rcp_f32 v97, v97
  v_mul_f32 v81, v81, v89
  v_rcp_f32 v98, v98
  v_mul_f32 v82, v82, v90
  v_rcp_f32 v99, v99
  v_mul_f32 v83, v83, v91
  v_rcp_f32 v100, v100
  v_mul_f32 v84, v84, v92
  v_rcp_f32 v101, v101
  v_mul_f32 v85, v85, v93
  v_rcp_f32 v102, v102
  v_mul_f32 v86, v86, v94
  v_rcp_f32 v103, v103
  v_mul_f32 v87, v87, v95
  v_mul_f32 v80, v80, v96
  v_mul_f32 v81, v81, v97
  v_mul_f32 v82, v82, v98
  v_mul_f32 v83, v83, v99
  v_mul_f32 v84, v84, v100
  v_mul_f32 v85, v85, v101
  v_mul_f32 v86, v86, v102
  v_mul_f32 v87, v87, v103
  v_cvt_pk_bf16_f32 v72, v80, v81
  v_cvt_pk_bf16_f32 v73, v82, v83
  v_cvt_pk_bf16_f32 v74, v84, v85
  v_cvt_pk_bf16_f32 v75, v86, v87
  buffer_store_dwordx4 v[72:75], v1, s[4:7], s56 offen offset:0 sc1
  v_accvgpr_read_b32 v80, a40
  v_accvgpr_read_b32 v81, a41
  v_accvgpr_read_b32 v82, a42
  v_accvgpr_read_b32 v83, a43
  v_accvgpr_read_b32 v84, a44
  v_accvgpr_read_b32 v85, a45
  v_accvgpr_read_b32 v86, a46
  v_accvgpr_read_b32 v87, a47
  v_mul_f32 v96, v80, v80
  v_mul_f32 v97, v81, v81
  v_mul_f32 v98, v82, v82
  v_mul_f32 v99, v83, v83
  v_mul_f32 v100, v84, v84
  v_mul_f32 v101, v85, v85
  v_mul_f32 v102, v86, v86
  v_mul_f32 v103, v87, v87
  v_fma_f32 v96, v96, s57, v104
  v_fma_f32 v97, v97, s57, v104
  v_fma_f32 v98, v98, s57, v104
  v_fma_f32 v99, v99, s57, v104
  v_fma_f32 v100, v100, s57, v104
  v_fma_f32 v101, v101, s57, v104
  v_fma_f32 v102, v102, s57, v104
  v_fma_f32 v103, v103, s57, v104
  v_mul_f32 v96, v96, v80
  v_mul_f32 v97, v97, v81
  v_mul_f32 v98, v98, v82
  v_mul_f32 v99, v99, v83
  v_mul_f32 v100, v100, v84
  v_mul_f32 v101, v101, v85
  v_mul_f32 v102, v102, v86
  v_mul_f32 v103, v103, v87
  v_exp_f32 v96, v96
  v_accvgpr_read_b32 v88, a56
  v_exp_f32 v97, v97
  v_accvgpr_read_b32 v89, a57
  v_exp_f32 v98, v98
  v_accvgpr_read_b32 v90, a58
  v_exp_f32 v99, v99
  v_accvgpr_read_b32 v91, a59
  v_exp_f32 v100, v100
  v_accvgpr_read_b32 v92, a60
  v_exp_f32 v101, v101
  v_accvgpr_read_b32 v93, a61
  v_exp_f32 v102, v102
  v_accvgpr_read_b32 v94, a62
  v_exp_f32 v103, v103
  v_accvgpr_read_b32 v95, a63
  v_add_f32 v96, 1.0, v96
  v_add_f32 v97, 1.0, v97
  v_add_f32 v98, 1.0, v98
  v_add_f32 v99, 1.0, v99
  v_add_f32 v100, 1.0, v100
  v_add_f32 v101, 1.0, v101
  v_add_f32 v102, 1.0, v102
  v_add_f32 v103, 1.0, v103
  v_rcp_f32 v96, v96
  v_mul_f32 v80, v80, v88
  v_rcp_f32 v97, v97
  v_mul_f32 v81, v81, v89
  v_rcp_f32 v98, v98
  v_mul_f32 v82, v82, v90
  v_rcp_f32 v99, v99
  v_mul_f32 v83, v83, v91
  v_rcp_f32 v100, v100
  v_mul_f32 v84, v84, v92
  v_rcp_f32 v101, v101
  v_mul_f32 v85, v85, v93
  v_rcp_f32 v102, v102
  v_mul_f32 v86, v86, v94
  v_rcp_f32 v103, v103
  v_mul_f32 v87, v87, v95
  v_mul_f32 v80, v80, v96
  v_mul_f32 v81, v81, v97
  v_mul_f32 v82, v82, v98
  v_mul_f32 v83, v83, v99
  v_mul_f32 v84, v84, v100
  v_mul_f32 v85, v85, v101
  v_mul_f32 v86, v86, v102
  v_mul_f32 v87, v87, v103
  v_cvt_pk_bf16_f32 v76, v80, v81
  v_cvt_pk_bf16_f32 v77, v82, v83
  v_cvt_pk_bf16_f32 v78, v84, v85
  v_cvt_pk_bf16_f32 v79, v86, v87
  buffer_store_dwordx4 v[76:79], v1, s[4:7], s56 offen offset:1024 sc1
  s_add_u32 s56, s54, 229376
  v_accvgpr_read_b32 v80, a64
  v_accvgpr_read_b32 v81, a65
  v_accvgpr_read_b32 v82, a66
  v_accvgpr_read_b32 v83, a67
  v_accvgpr_read_b32 v84, a68
  v_accvgpr_read_b32 v85, a69
  v_accvgpr_read_b32 v86, a70
  v_accvgpr_read_b32 v87, a71
  v_mul_f32 v96, v80, v80
  v_mul_f32 v97, v81, v81
  v_mul_f32 v98, v82, v82
  v_mul_f32 v99, v83, v83
  v_mul_f32 v100, v84, v84
  v_mul_f32 v101, v85, v85
  v_mul_f32 v102, v86, v86
  v_mul_f32 v103, v87, v87
  v_fma_f32 v96, v96, s57, v104
  v_fma_f32 v97, v97, s57, v104
  v_fma_f32 v98, v98, s57, v104
  v_fma_f32 v99, v99, s57, v104
  v_fma_f32 v100, v100, s57, v104
  v_fma_f32 v101, v101, s57, v104
  v_fma_f32 v102, v102, s57, v104
  v_fma_f32 v103, v103, s57, v104
  v_mul_f32 v96, v96, v80
  v_mul_f32 v97, v97, v81
  v_mul_f32 v98, v98, v82
  v_mul_f32 v99, v99, v83
  v_mul_f32 v100, v100, v84
  v_mul_f32 v101, v101, v85
  v_mul_f32 v102, v102, v86
  v_mul_f32 v103, v103, v87
  v_exp_f32 v96, v96
  v_accvgpr_read_b32 v88, a80
  v_exp_f32 v97, v97
  v_accvgpr_read_b32 v89, a81
  v_exp_f32 v98, v98
  v_accvgpr_read_b32 v90, a82
  v_exp_f32 v99, v99
  v_accvgpr_read_b32 v91, a83
  v_exp_f32 v100, v100
  v_accvgpr_read_b32 v92, a84
  v_exp_f32 v101, v101
  v_accvgpr_read_b32 v93, a85
  v_exp_f32 v102, v102
  v_accvgpr_read_b32 v94, a86
  v_exp_f32 v103, v103
  v_accvgpr_read_b32 v95, a87
  v_add_f32 v96, 1.0, v96
  v_add_f32 v97, 1.0, v97
  v_add_f32 v98, 1.0, v98
  v_add_f32 v99, 1.0, v99
  v_add_f32 v100, 1.0, v100
  v_add_f32 v101, 1.0, v101
  v_add_f32 v102, 1.0, v102
  v_add_f32 v103, 1.0, v103
  v_rcp_f32 v96, v96
  v_mul_f32 v80, v80, v88
  v_rcp_f32 v97, v97
  v_mul_f32 v81, v81, v89
  v_rcp_f32 v98, v98
  v_mul_f32 v82, v82, v90
  v_rcp_f32 v99, v99
  v_mul_f32 v83, v83, v91
  v_rcp_f32 v100, v100
  v_mul_f32 v84, v84, v92
  v_rcp_f32 v101, v101
  v_mul_f32 v85, v85, v93
  v_rcp_f32 v102, v102
  v_mul_f32 v86, v86, v94
  v_rcp_f32 v103, v103
  v_mul_f32 v87, v87, v95
  v_mul_f32 v80, v80, v96
  v_mul_f32 v81, v81, v97
  v_mul_f32 v82, v82, v98
  v_mul_f32 v83, v83, v99
  v_mul_f32 v84, v84, v100
  v_mul_f32 v85, v85, v101
  v_mul_f32 v86, v86, v102
  v_mul_f32 v87, v87, v103
  v_cvt_pk_bf16_f32 v64, v80, v81
  v_cvt_pk_bf16_f32 v65, v82, v83
  v_cvt_pk_bf16_f32 v66, v84, v85
  v_cvt_pk_bf16_f32 v67, v86, v87
  buffer_store_dwordx4 v[64:67], v1, s[4:7], s56 offen offset:0 sc1
  v_accvgpr_read_b32 v80, a72
  v_accvgpr_read_b32 v81, a73
  v_accvgpr_read_b32 v82, a74
  v_accvgpr_read_b32 v83, a75
  v_accvgpr_read_b32 v84, a76
  v_accvgpr_read_b32 v85, a77
  v_accvgpr_read_b32 v86, a78
  v_accvgpr_read_b32 v87, a79
  v_mul_f32 v96, v80, v80
  v_mul_f32 v97, v81, v81
  v_mul_f32 v98, v82, v82
  v_mul_f32 v99, v83, v83
  v_mul_f32 v100, v84, v84
  v_mul_f32 v101, v85, v85
  v_mul_f32 v102, v86, v86
  v_mul_f32 v103, v87, v87
  v_fma_f32 v96, v96, s57, v104
  v_fma_f32 v97, v97, s57, v104
  v_fma_f32 v98, v98, s57, v104
  v_fma_f32 v99, v99, s57, v104
  v_fma_f32 v100, v100, s57, v104
  v_fma_f32 v101, v101, s57, v104
  v_fma_f32 v102, v102, s57, v104
  v_fma_f32 v103, v103, s57, v104
  v_mul_f32 v96, v96, v80
  v_mul_f32 v97, v97, v81
  v_mul_f32 v98, v98, v82
  v_mul_f32 v99, v99, v83
  v_mul_f32 v100, v100, v84
  v_mul_f32 v101, v101, v85
  v_mul_f32 v102, v102, v86
  v_mul_f32 v103, v103, v87
  v_exp_f32 v96, v96
  v_accvgpr_read_b32 v88, a88
  v_exp_f32 v97, v97
  v_accvgpr_read_b32 v89, a89
  v_exp_f32 v98, v98
  v_accvgpr_read_b32 v90, a90
  v_exp_f32 v99, v99
  v_accvgpr_read_b32 v91, a91
  v_exp_f32 v100, v100
  v_accvgpr_read_b32 v92, a92
  v_exp_f32 v101, v101
  v_accvgpr_read_b32 v93, a93
  v_exp_f32 v102, v102
  v_accvgpr_read_b32 v94, a94
  v_exp_f32 v103, v103
  v_accvgpr_read_b32 v95, a95
  v_add_f32 v96, 1.0, v96
  v_add_f32 v97, 1.0, v97
  v_add_f32 v98, 1.0, v98
  v_add_f32 v99, 1.0, v99
  v_add_f32 v100, 1.0, v100
  v_add_f32 v101, 1.0, v101
  v_add_f32 v102, 1.0, v102
  v_add_f32 v103, 1.0, v103
  v_rcp_f32 v96, v96
  v_mul_f32 v80, v80, v88
  v_rcp_f32 v97, v97
  v_mul_f32 v81, v81, v89
  v_rcp_f32 v98, v98
  v_mul_f32 v82, v82, v90
  v_rcp_f32 v99, v99
  v_mul_f32 v83, v83, v91
  v_rcp_f32 v100, v100
  v_mul_f32 v84, v84, v92
  v_rcp_f32 v101, v101
  v_mul_f32 v85, v85, v93
  v_rcp_f32 v102, v102
  v_mul_f32 v86, v86, v94
  v_rcp_f32 v103, v103
  v_mul_f32 v87, v87, v95
  v_mul_f32 v80, v80, v96
  v_mul_f32 v81, v81, v97
  v_mul_f32 v82, v82, v98
  v_mul_f32 v83, v83, v99
  v_mul_f32 v84, v84, v100
  v_mul_f32 v85, v85, v101
  v_mul_f32 v86, v86, v102
  v_mul_f32 v87, v87, v103
  v_cvt_pk_bf16_f32 v68, v80, v81
  v_cvt_pk_bf16_f32 v69, v82, v83
  v_cvt_pk_bf16_f32 v70, v84, v85
  v_cvt_pk_bf16_f32 v71, v86, v87
  buffer_store_dwordx4 v[68:71], v1, s[4:7], s56 offen offset:1024 sc1
  s_add_u32 s56, s54, 344064
  v_accvgpr_read_b32 v80, a96
  v_accvgpr_read_b32 v81, a97
  v_accvgpr_read_b32 v82, a98
  v_accvgpr_read_b32 v83, a99
  v_accvgpr_read_b32 v84, a100
  v_accvgpr_read_b32 v85, a101
  v_accvgpr_read_b32 v86, a102
  v_accvgpr_read_b32 v87, a103
  v_mul_f32 v96, v80, v80
  v_mul_f32 v97, v81, v81
  v_mul_f32 v98, v82, v82
  v_mul_f32 v99, v83, v83
  v_mul_f32 v100, v84, v84
  v_mul_f32 v101, v85, v85
  v_mul_f32 v102, v86, v86
  v_mul_f32 v103, v87, v87
  v_fma_f32 v96, v96, s57, v104
  v_fma_f32 v97, v97, s57, v104
  v_fma_f32 v98, v98, s57, v104
  v_fma_f32 v99, v99, s57, v104
  v_fma_f32 v100, v100, s57, v104
  v_fma_f32 v101, v101, s57, v104
  v_fma_f32 v102, v102, s57, v104
  v_fma_f32 v103, v103, s57, v104
  v_mul_f32 v96, v96, v80
  v_mul_f32 v97, v97, v81
  v_mul_f32 v98, v98, v82
  v_mul_f32 v99, v99, v83
  v_mul_f32 v100, v100, v84
  v_mul_f32 v101, v101, v85
  v_mul_f32 v102, v102, v86
  v_mul_f32 v103, v103, v87
  v_exp_f32 v96, v96
  v_accvgpr_read_b32 v88, a112
  v_exp_f32 v97, v97
  v_accvgpr_read_b32 v89, a113
  v_exp_f32 v98, v98
  v_accvgpr_read_b32 v90, a114
  v_exp_f32 v99, v99
  v_accvgpr_read_b32 v91, a115
  v_exp_f32 v100, v100
  v_accvgpr_read_b32 v92, a116
  v_exp_f32 v101, v101
  v_accvgpr_read_b32 v93, a117
  v_exp_f32 v102, v102
  v_accvgpr_read_b32 v94, a118
  v_exp_f32 v103, v103
  v_accvgpr_read_b32 v95, a119
  v_add_f32 v96, 1.0, v96
  v_add_f32 v97, 1.0, v97
  v_add_f32 v98, 1.0, v98
  v_add_f32 v99, 1.0, v99
  v_add_f32 v100, 1.0, v100
  v_add_f32 v101, 1.0, v101
  v_add_f32 v102, 1.0, v102
  v_add_f32 v103, 1.0, v103
  v_rcp_f32 v96, v96
  v_mul_f32 v80, v80, v88
  v_rcp_f32 v97, v97
  v_mul_f32 v81, v81, v89
  v_rcp_f32 v98, v98
  v_mul_f32 v82, v82, v90
  v_rcp_f32 v99, v99
  v_mul_f32 v83, v83, v91
  v_rcp_f32 v100, v100
  v_mul_f32 v84, v84, v92
  v_rcp_f32 v101, v101
  v_mul_f32 v85, v85, v93
  v_rcp_f32 v102, v102
  v_mul_f32 v86, v86, v94
  v_rcp_f32 v103, v103
  v_mul_f32 v87, v87, v95
  v_mul_f32 v80, v80, v96
  v_mul_f32 v81, v81, v97
  v_mul_f32 v82, v82, v98
  v_mul_f32 v83, v83, v99
  v_mul_f32 v84, v84, v100
  v_mul_f32 v85, v85, v101
  v_mul_f32 v86, v86, v102
  v_mul_f32 v87, v87, v103
  v_cvt_pk_bf16_f32 v72, v80, v81
  v_cvt_pk_bf16_f32 v73, v82, v83
  v_cvt_pk_bf16_f32 v74, v84, v85
  v_cvt_pk_bf16_f32 v75, v86, v87
  buffer_store_dwordx4 v[72:75], v1, s[4:7], s56 offen offset:0 sc1
  v_accvgpr_read_b32 v80, a104
  v_accvgpr_read_b32 v81, a105
  v_accvgpr_read_b32 v82, a106
  v_accvgpr_read_b32 v83, a107
  v_accvgpr_read_b32 v84, a108
  v_accvgpr_read_b32 v85, a109
  v_accvgpr_read_b32 v86, a110
  v_accvgpr_read_b32 v87, a111
  v_mul_f32 v96, v80, v80
  v_mul_f32 v97, v81, v81
  v_mul_f32 v98, v82, v82
  v_mul_f32 v99, v83, v83
  v_mul_f32 v100, v84, v84
  v_mul_f32 v101, v85, v85
  v_mul_f32 v102, v86, v86
  v_mul_f32 v103, v87, v87
  v_fma_f32 v96, v96, s57, v104
  v_fma_f32 v97, v97, s57, v104
  v_fma_f32 v98, v98, s57, v104
  v_fma_f32 v99, v99, s57, v104
  v_fma_f32 v100, v100, s57, v104
  v_fma_f32 v101, v101, s57, v104
  v_fma_f32 v102, v102, s57, v104
  v_fma_f32 v103, v103, s57, v104
  v_mul_f32 v96, v96, v80
  v_mul_f32 v97, v97, v81
  v_mul_f32 v98, v98, v82
  v_mul_f32 v99, v99, v83
  v_mul_f32 v100, v100, v84
  v_mul_f32 v101, v101, v85
  v_mul_f32 v102, v102, v86
  v_mul_f32 v103, v103, v87
  v_exp_f32 v96, v96
  v_accvgpr_read_b32 v88, a120
  v_exp_f32 v97, v97
  v_accvgpr_read_b32 v89, a121
  v_exp_f32 v98, v98
  v_accvgpr_read_b32 v90, a122
  v_exp_f32 v99, v99
  v_accvgpr_read_b32 v91, a123
  v_exp_f32 v100, v100
  v_accvgpr_read_b32 v92, a124
  v_exp_f32 v101, v101
  v_accvgpr_read_b32 v93, a125
  v_exp_f32 v102, v102
  v_accvgpr_read_b32 v94, a126
  v_exp_f32 v103, v103
  v_accvgpr_read_b32 v95, a127
  v_add_f32 v96, 1.0, v96
  v_add_f32 v97, 1.0, v97
  v_add_f32 v98, 1.0, v98
  v_add_f32 v99, 1.0, v99
  v_add_f32 v100, 1.0, v100
  v_add_f32 v101, 1.0, v101
  v_add_f32 v102, 1.0, v102
  v_add_f32 v103, 1.0, v103
  v_rcp_f32 v96, v96
  v_mul_f32 v80, v80, v88
  v_rcp_f32 v97, v97
  v_mul_f32 v81, v81, v89
  v_rcp_f32 v98, v98
  v_mul_f32 v82, v82, v90
  v_rcp_f32 v99, v99
  v_mul_f32 v83, v83, v91
  v_rcp_f32 v100, v100
  v_mul_f32 v84, v84, v92
  v_rcp_f32 v101, v101
  v_mul_f32 v85, v85, v93
  v_rcp_f32 v102, v102
  v_mul_f32 v86, v86, v94
  v_rcp_f32 v103, v103
  v_mul_f32 v87, v87, v95
  v_mul_f32 v80, v80, v96
  v_mul_f32 v81, v81, v97
  v_mul_f32 v82, v82, v98
  v_mul_f32 v83, v83, v99
  v_mul_f32 v84, v84, v100
  v_mul_f32 v85, v85, v101
  v_mul_f32 v86, v86, v102
  v_mul_f32 v87, v87, v103
  v_cvt_pk_bf16_f32 v76, v80, v81
  v_cvt_pk_bf16_f32 v77, v82, v83
  v_cvt_pk_bf16_f32 v78, v84, v85
  v_cvt_pk_bf16_f32 v79, v86, v87
  buffer_store_dwordx4 v[76:79], v1, s[4:7], s56 offen offset:1024 sc1
  s_add_u32 s56, s54, 458752
  v_accvgpr_read_b32 v80, a128
  v_accvgpr_read_b32 v81, a129
  v_accvgpr_read_b32 v82, a130
  v_accvgpr_read_b32 v83, a131
  v_accvgpr_read_b32 v84, a132
  v_accvgpr_read_b32 v85, a133
  v_accvgpr_read_b32 v86, a134
  v_accvgpr_read_b32 v87, a135
  v_mul_f32 v96, v80, v80
  v_mul_f32 v97, v81, v81
  v_mul_f32 v98, v82, v82
  v_mul_f32 v99, v83, v83
  v_mul_f32 v100, v84, v84
  v_mul_f32 v101, v85, v85
  v_mul_f32 v102, v86, v86
  v_mul_f32 v103, v87, v87
  v_fma_f32 v96, v96, s57, v104
  v_fma_f32 v97, v97, s57, v104
  v_fma_f32 v98, v98, s57, v104
  v_fma_f32 v99, v99, s57, v104
  v_fma_f32 v100, v100, s57, v104
  v_fma_f32 v101, v101, s57, v104
  v_fma_f32 v102, v102, s57, v104
  v_fma_f32 v103, v103, s57, v104
  v_mul_f32 v96, v96, v80
  v_mul_f32 v97, v97, v81
  v_mul_f32 v98, v98, v82
  v_mul_f32 v99, v99, v83
  v_mul_f32 v100, v100, v84
  v_mul_f32 v101, v101, v85
  v_mul_f32 v102, v102, v86
  v_mul_f32 v103, v103, v87
  v_exp_f32 v96, v96
  v_accvgpr_read_b32 v88, a144
  v_exp_f32 v97, v97
  v_accvgpr_read_b32 v89, a145
  v_exp_f32 v98, v98
  v_accvgpr_read_b32 v90, a146
  v_exp_f32 v99, v99
  v_accvgpr_read_b32 v91, a147
  v_exp_f32 v100, v100
  v_accvgpr_read_b32 v92, a148
  v_exp_f32 v101, v101
  v_accvgpr_read_b32 v93, a149
  v_exp_f32 v102, v102
  v_accvgpr_read_b32 v94, a150
  v_exp_f32 v103, v103
  v_accvgpr_read_b32 v95, a151
  v_add_f32 v96, 1.0, v96
  v_add_f32 v97, 1.0, v97
  v_add_f32 v98, 1.0, v98
  v_add_f32 v99, 1.0, v99
  v_add_f32 v100, 1.0, v100
  v_add_f32 v101, 1.0, v101
  v_add_f32 v102, 1.0, v102
  v_add_f32 v103, 1.0, v103
  v_rcp_f32 v96, v96
  v_mul_f32 v80, v80, v88
  v_rcp_f32 v97, v97
  v_mul_f32 v81, v81, v89
  v_rcp_f32 v98, v98
  v_mul_f32 v82, v82, v90
  v_rcp_f32 v99, v99
  v_mul_f32 v83, v83, v91
  v_rcp_f32 v100, v100
  v_mul_f32 v84, v84, v92
  v_rcp_f32 v101, v101
  v_mul_f32 v85, v85, v93
  v_rcp_f32 v102, v102
  v_mul_f32 v86, v86, v94
  v_rcp_f32 v103, v103
  v_mul_f32 v87, v87, v95
  v_mul_f32 v80, v80, v96
  v_mul_f32 v81, v81, v97
  v_mul_f32 v82, v82, v98
  v_mul_f32 v83, v83, v99
  v_mul_f32 v84, v84, v100
  v_mul_f32 v85, v85, v101
  v_mul_f32 v86, v86, v102
  v_mul_f32 v87, v87, v103
  v_cvt_pk_bf16_f32 v64, v80, v81
  v_cvt_pk_bf16_f32 v65, v82, v83
  v_cvt_pk_bf16_f32 v66, v84, v85
  v_cvt_pk_bf16_f32 v67, v86, v87
  buffer_store_dwordx4 v[64:67], v1, s[4:7], s56 offen offset:0 sc1
  v_accvgpr_read_b32 v80, a136
  v_accvgpr_read_b32 v81, a137
  v_accvgpr_read_b32 v82, a138
  v_accvgpr_read_b32 v83, a139
  v_accvgpr_read_b32 v84, a140
  v_accvgpr_read_b32 v85, a141
  v_accvgpr_read_b32 v86, a142
  v_accvgpr_read_b32 v87, a143
  v_mul_f32 v96, v80, v80
  v_mul_f32 v97, v81, v81
  v_mul_f32 v98, v82, v82
  v_mul_f32 v99, v83, v83
  v_mul_f32 v100, v84, v84
  v_mul_f32 v101, v85, v85
  v_mul_f32 v102, v86, v86
  v_mul_f32 v103, v87, v87
  v_fma_f32 v96, v96, s57, v104
  v_fma_f32 v97, v97, s57, v104
  v_fma_f32 v98, v98, s57, v104
  v_fma_f32 v99, v99, s57, v104
  v_fma_f32 v100, v100, s57, v104
  v_fma_f32 v101, v101, s57, v104
  v_fma_f32 v102, v102, s57, v104
  v_fma_f32 v103, v103, s57, v104
  v_mul_f32 v96, v96, v80
  v_mul_f32 v97, v97, v81
  v_mul_f32 v98, v98, v82
  v_mul_f32 v99, v99, v83
  v_mul_f32 v100, v100, v84
  v_mul_f32 v101, v101, v85
  v_mul_f32 v102, v102, v86
  v_mul_f32 v103, v103, v87
  v_exp_f32 v96, v96
  v_accvgpr_read_b32 v88, a152
  v_exp_f32 v97, v97
  v_accvgpr_read_b32 v89, a153
  v_exp_f32 v98, v98
  v_accvgpr_read_b32 v90, a154
  v_exp_f32 v99, v99
  v_accvgpr_read_b32 v91, a155
  v_exp_f32 v100, v100
  v_accvgpr_read_b32 v92, a156
  v_exp_f32 v101, v101
  v_accvgpr_read_b32 v93, a157
  v_exp_f32 v102, v102
  v_accvgpr_read_b32 v94, a158
  v_exp_f32 v103, v103
  v_accvgpr_read_b32 v95, a159
  v_add_f32 v96, 1.0, v96
  v_add_f32 v97, 1.0, v97
  v_add_f32 v98, 1.0, v98
  v_add_f32 v99, 1.0, v99
  v_add_f32 v100, 1.0, v100
  v_add_f32 v101, 1.0, v101
  v_add_f32 v102, 1.0, v102
  v_add_f32 v103, 1.0, v103
  v_rcp_f32 v96, v96
  v_mul_f32 v80, v80, v88
  v_rcp_f32 v97, v97
  v_mul_f32 v81, v81, v89
  v_rcp_f32 v98, v98
  v_mul_f32 v82, v82, v90
  v_rcp_f32 v99, v99
  v_mul_f32 v83, v83, v91
  v_rcp_f32 v100, v100
  v_mul_f32 v84, v84, v92
  v_rcp_f32 v101, v101
  v_mul_f32 v85, v85, v93
  v_rcp_f32 v102, v102
  v_mul_f32 v86, v86, v94
  v_rcp_f32 v103, v103
  v_mul_f32 v87, v87, v95
  v_mul_f32 v80, v80, v96
  v_mul_f32 v81, v81, v97
  v_mul_f32 v82, v82, v98
  v_mul_f32 v83, v83, v99
  v_mul_f32 v84, v84, v100
  v_mul_f32 v85, v85, v101
  v_mul_f32 v86, v86, v102
  v_mul_f32 v87, v87, v103
  v_cvt_pk_bf16_f32 v68, v80, v81
  v_cvt_pk_bf16_f32 v69, v82, v83
  v_cvt_pk_bf16_f32 v70, v84, v85
  v_cvt_pk_bf16_f32 v71, v86, v87
  buffer_store_dwordx4 v[68:71], v1, s[4:7], s56 offen offset:1024 sc1
  s_add_u32 s56, s54, 573440
  v_accvgpr_read_b32 v80, a160
  v_accvgpr_read_b32 v81, a161
  v_accvgpr_read_b32 v82, a162
  v_accvgpr_read_b32 v83, a163
  v_accvgpr_read_b32 v84, a164
  v_accvgpr_read_b32 v85, a165
  v_accvgpr_read_b32 v86, a166
  v_accvgpr_read_b32 v87, a167
  v_mul_f32 v96, v80, v80
  v_mul_f32 v97, v81, v81
  v_mul_f32 v98, v82, v82
  v_mul_f32 v99, v83, v83
  v_mul_f32 v100, v84, v84
  v_mul_f32 v101, v85, v85
  v_mul_f32 v102, v86, v86
  v_mul_f32 v103, v87, v87
  v_fma_f32 v96, v96, s57, v104
  v_fma_f32 v97, v97, s57, v104
  v_fma_f32 v98, v98, s57, v104
  v_fma_f32 v99, v99, s57, v104
  v_fma_f32 v100, v100, s57, v104
  v_fma_f32 v101, v101, s57, v104
  v_fma_f32 v102, v102, s57, v104
  v_fma_f32 v103, v103, s57, v104
  v_mul_f32 v96, v96, v80
  v_mul_f32 v97, v97, v81
  v_mul_f32 v98, v98, v82
  v_mul_f32 v99, v99, v83
  v_mul_f32 v100, v100, v84
  v_mul_f32 v101, v101, v85
  v_mul_f32 v102, v102, v86
  v_mul_f32 v103, v103, v87
  v_exp_f32 v96, v96
  v_accvgpr_read_b32 v88, a176
  v_exp_f32 v97, v97
  v_accvgpr_read_b32 v89, a177
  v_exp_f32 v98, v98
  v_accvgpr_read_b32 v90, a178
  v_exp_f32 v99, v99
  v_accvgpr_read_b32 v91, a179
  v_exp_f32 v100, v100
  v_accvgpr_read_b32 v92, a180
  v_exp_f32 v101, v101
  v_accvgpr_read_b32 v93, a181
  v_exp_f32 v102, v102
  v_accvgpr_read_b32 v94, a182
  v_exp_f32 v103, v103
  v_accvgpr_read_b32 v95, a183
  v_add_f32 v96, 1.0, v96
  v_add_f32 v97, 1.0, v97
  v_add_f32 v98, 1.0, v98
  v_add_f32 v99, 1.0, v99
  v_add_f32 v100, 1.0, v100
  v_add_f32 v101, 1.0, v101
  v_add_f32 v102, 1.0, v102
  v_add_f32 v103, 1.0, v103
  v_rcp_f32 v96, v96
  v_mul_f32 v80, v80, v88
  v_rcp_f32 v97, v97
  v_mul_f32 v81, v81, v89
  v_rcp_f32 v98, v98
  v_mul_f32 v82, v82, v90
  v_rcp_f32 v99, v99
  v_mul_f32 v83, v83, v91
  v_rcp_f32 v100, v100
  v_mul_f32 v84, v84, v92
  v_rcp_f32 v101, v101
  v_mul_f32 v85, v85, v93
  v_rcp_f32 v102, v102
  v_mul_f32 v86, v86, v94
  v_rcp_f32 v103, v103
  v_mul_f32 v87, v87, v95
  v_mul_f32 v80, v80, v96
  v_mul_f32 v81, v81, v97
  v_mul_f32 v82, v82, v98
  v_mul_f32 v83, v83, v99
  v_mul_f32 v84, v84, v100
  v_mul_f32 v85, v85, v101
  v_mul_f32 v86, v86, v102
  v_mul_f32 v87, v87, v103
  v_cvt_pk_bf16_f32 v72, v80, v81
  v_cvt_pk_bf16_f32 v73, v82, v83
  v_cvt_pk_bf16_f32 v74, v84, v85
  v_cvt_pk_bf16_f32 v75, v86, v87
  buffer_store_dwordx4 v[72:75], v1, s[4:7], s56 offen offset:0 sc1
  v_accvgpr_read_b32 v80, a168
  v_accvgpr_read_b32 v81, a169
  v_accvgpr_read_b32 v82, a170
  v_accvgpr_read_b32 v83, a171
  v_accvgpr_read_b32 v84, a172
  v_accvgpr_read_b32 v85, a173
  v_accvgpr_read_b32 v86, a174
  v_accvgpr_read_b32 v87, a175
  v_mul_f32 v96, v80, v80
  v_mul_f32 v97, v81, v81
  v_mul_f32 v98, v82, v82
  v_mul_f32 v99, v83, v83
  v_mul_f32 v100, v84, v84
  v_mul_f32 v101, v85, v85
  v_mul_f32 v102, v86, v86
  v_mul_f32 v103, v87, v87
  v_fma_f32 v96, v96, s57, v104
  v_fma_f32 v97, v97, s57, v104
  v_fma_f32 v98, v98, s57, v104
  v_fma_f32 v99, v99, s57, v104
  v_fma_f32 v100, v100, s57, v104
  v_fma_f32 v101, v101, s57, v104
  v_fma_f32 v102, v102, s57, v104
  v_fma_f32 v103, v103, s57, v104
  v_mul_f32 v96, v96, v80
  v_mul_f32 v97, v97, v81
  v_mul_f32 v98, v98, v82
  v_mul_f32 v99, v99, v83
  v_mul_f32 v100, v100, v84
  v_mul_f32 v101, v101, v85
  v_mul_f32 v102, v102, v86
  v_mul_f32 v103, v103, v87
  v_exp_f32 v96, v96
  v_accvgpr_read_b32 v88, a184
  v_exp_f32 v97, v97
  v_accvgpr_read_b32 v89, a185
  v_exp_f32 v98, v98
  v_accvgpr_read_b32 v90, a186
  v_exp_f32 v99, v99
  v_accvgpr_read_b32 v91, a187
  v_exp_f32 v100, v100
  v_accvgpr_read_b32 v92, a188
  v_exp_f32 v101, v101
  v_accvgpr_read_b32 v93, a189
  v_exp_f32 v102, v102
  v_accvgpr_read_b32 v94, a190
  v_exp_f32 v103, v103
  v_accvgpr_read_b32 v95, a191
  v_add_f32 v96, 1.0, v96
  v_add_f32 v97, 1.0, v97
  v_add_f32 v98, 1.0, v98
  v_add_f32 v99, 1.0, v99
  v_add_f32 v100, 1.0, v100
  v_add_f32 v101, 1.0, v101
  v_add_f32 v102, 1.0, v102
  v_add_f32 v103, 1.0, v103
  v_rcp_f32 v96, v96
  v_mul_f32 v80, v80, v88
  v_rcp_f32 v97, v97
  v_mul_f32 v81, v81, v89
  v_rcp_f32 v98, v98
  v_mul_f32 v82, v82, v90
  v_rcp_f32 v99, v99
  v_mul_f32 v83, v83, v91
  v_rcp_f32 v100, v100
  v_mul_f32 v84, v84, v92
  v_rcp_f32 v101, v101
  v_mul_f32 v85, v85, v93
  v_rcp_f32 v102, v102
  v_mul_f32 v86, v86, v94
  v_rcp_f32 v103, v103
  v_mul_f32 v87, v87, v95
  v_mul_f32 v80, v80, v96
  v_mul_f32 v81, v81, v97
  v_mul_f32 v82, v82, v98
  v_mul_f32 v83, v83, v99
  v_mul_f32 v84, v84, v100
  v_mul_f32 v85, v85, v101
  v_mul_f32 v86, v86, v102
  v_mul_f32 v87, v87, v103
  v_cvt_pk_bf16_f32 v76, v80, v81
  v_cvt_pk_bf16_f32 v77, v82, v83
  v_cvt_pk_bf16_f32 v78, v84, v85
  v_cvt_pk_bf16_f32 v79, v86, v87
  buffer_store_dwordx4 v[76:79], v1, s[4:7], s56 offen offset:1024 sc1
  s_add_u32 s56, s54, 688128
  v_accvgpr_read_b32 v80, a192
  v_accvgpr_read_b32 v81, a193
  v_accvgpr_read_b32 v82, a194
  v_accvgpr_read_b32 v83, a195
  v_accvgpr_read_b32 v84, a196
  v_accvgpr_read_b32 v85, a197
  v_accvgpr_read_b32 v86, a198
  v_accvgpr_read_b32 v87, a199
  v_mul_f32 v96, v80, v80
  v_mul_f32 v97, v81, v81
  v_mul_f32 v98, v82, v82
  v_mul_f32 v99, v83, v83
  v_mul_f32 v100, v84, v84
  v_mul_f32 v101, v85, v85
  v_mul_f32 v102, v86, v86
  v_mul_f32 v103, v87, v87
  v_fma_f32 v96, v96, s57, v104
  v_fma_f32 v97, v97, s57, v104
  v_fma_f32 v98, v98, s57, v104
  v_fma_f32 v99, v99, s57, v104
  v_fma_f32 v100, v100, s57, v104
  v_fma_f32 v101, v101, s57, v104
  v_fma_f32 v102, v102, s57, v104
  v_fma_f32 v103, v103, s57, v104
  v_mul_f32 v96, v96, v80
  v_mul_f32 v97, v97, v81
  v_mul_f32 v98, v98, v82
  v_mul_f32 v99, v99, v83
  v_mul_f32 v100, v100, v84
  v_mul_f32 v101, v101, v85
  v_mul_f32 v102, v102, v86
  v_mul_f32 v103, v103, v87
  v_exp_f32 v96, v96
  v_accvgpr_read_b32 v88, a208
  v_exp_f32 v97, v97
  v_accvgpr_read_b32 v89, a209
  v_exp_f32 v98, v98
  v_accvgpr_read_b32 v90, a210
  v_exp_f32 v99, v99
  v_accvgpr_read_b32 v91, a211
  v_exp_f32 v100, v100
  v_accvgpr_read_b32 v92, a212
  v_exp_f32 v101, v101
  v_accvgpr_read_b32 v93, a213
  v_exp_f32 v102, v102
  v_accvgpr_read_b32 v94, a214
  v_exp_f32 v103, v103
  v_accvgpr_read_b32 v95, a215
  v_add_f32 v96, 1.0, v96
  v_add_f32 v97, 1.0, v97
  v_add_f32 v98, 1.0, v98
  v_add_f32 v99, 1.0, v99
  v_add_f32 v100, 1.0, v100
  v_add_f32 v101, 1.0, v101
  v_add_f32 v102, 1.0, v102
  v_add_f32 v103, 1.0, v103
  v_rcp_f32 v96, v96
  v_mul_f32 v80, v80, v88
  v_rcp_f32 v97, v97
  v_mul_f32 v81, v81, v89
  v_rcp_f32 v98, v98
  v_mul_f32 v82, v82, v90
  v_rcp_f32 v99, v99
  v_mul_f32 v83, v83, v91
  v_rcp_f32 v100, v100
  v_mul_f32 v84, v84, v92
  v_rcp_f32 v101, v101
  v_mul_f32 v85, v85, v93
  v_rcp_f32 v102, v102
  v_mul_f32 v86, v86, v94
  v_rcp_f32 v103, v103
  v_mul_f32 v87, v87, v95
  v_mul_f32 v80, v80, v96
  v_mul_f32 v81, v81, v97
  v_mul_f32 v82, v82, v98
  v_mul_f32 v83, v83, v99
  v_mul_f32 v84, v84, v100
  v_mul_f32 v85, v85, v101
  v_mul_f32 v86, v86, v102
  v_mul_f32 v87, v87, v103
  v_cvt_pk_bf16_f32 v64, v80, v81
  v_cvt_pk_bf16_f32 v65, v82, v83
  v_cvt_pk_bf16_f32 v66, v84, v85
  v_cvt_pk_bf16_f32 v67, v86, v87
  buffer_store_dwordx4 v[64:67], v1, s[4:7], s56 offen offset:0 sc1
  v_accvgpr_read_b32 v80, a200
  v_accvgpr_read_b32 v81, a201
  v_accvgpr_read_b32 v82, a202
  v_accvgpr_read_b32 v83, a203
  v_accvgpr_read_b32 v84, a204
  v_accvgpr_read_b32 v85, a205
  v_accvgpr_read_b32 v86, a206
  v_accvgpr_read_b32 v87, a207
  v_mul_f32 v96, v80, v80
  v_mul_f32 v97, v81, v81
  v_mul_f32 v98, v82, v82
  v_mul_f32 v99, v83, v83
  v_mul_f32 v100, v84, v84
  v_mul_f32 v101, v85, v85
  v_mul_f32 v102, v86, v86
  v_mul_f32 v103, v87, v87
  v_fma_f32 v96, v96, s57, v104
  v_fma_f32 v97, v97, s57, v104
  v_fma_f32 v98, v98, s57, v104
  v_fma_f32 v99, v99, s57, v104
  v_fma_f32 v100, v100, s57, v104
  v_fma_f32 v101, v101, s57, v104
  v_fma_f32 v102, v102, s57, v104
  v_fma_f32 v103, v103, s57, v104
  v_mul_f32 v96, v96, v80
  v_mul_f32 v97, v97, v81
  v_mul_f32 v98, v98, v82
  v_mul_f32 v99, v99, v83
  v_mul_f32 v100, v100, v84
  v_mul_f32 v101, v101, v85
  v_mul_f32 v102, v102, v86
  v_mul_f32 v103, v103, v87
  v_exp_f32 v96, v96
  v_accvgpr_read_b32 v88, a216
  v_exp_f32 v97, v97
  v_accvgpr_read_b32 v89, a217
  v_exp_f32 v98, v98
  v_accvgpr_read_b32 v90, a218
  v_exp_f32 v99, v99
  v_accvgpr_read_b32 v91, a219
  v_exp_f32 v100, v100
  v_accvgpr_read_b32 v92, a220
  v_exp_f32 v101, v101
  v_accvgpr_read_b32 v93, a221
  v_exp_f32 v102, v102
  v_accvgpr_read_b32 v94, a222
  v_exp_f32 v103, v103
  v_accvgpr_read_b32 v95, a223
  v_add_f32 v96, 1.0, v96
  v_add_f32 v97, 1.0, v97
  v_add_f32 v98, 1.0, v98
  v_add_f32 v99, 1.0, v99
  v_add_f32 v100, 1.0, v100
  v_add_f32 v101, 1.0, v101
  v_add_f32 v102, 1.0, v102
  v_add_f32 v103, 1.0, v103
  v_rcp_f32 v96, v96
  v_mul_f32 v80, v80, v88
  v_rcp_f32 v97, v97
  v_mul_f32 v81, v81, v89
  v_rcp_f32 v98, v98
  v_mul_f32 v82, v82, v90
  v_rcp_f32 v99, v99
  v_mul_f32 v83, v83, v91
  v_rcp_f32 v100, v100
  v_mul_f32 v84, v84, v92
  v_rcp_f32 v101, v101
  v_mul_f32 v85, v85, v93
  v_rcp_f32 v102, v102
  v_mul_f32 v86, v86, v94
  v_rcp_f32 v103, v103
  v_mul_f32 v87, v87, v95
  v_mul_f32 v80, v80, v96
  v_mul_f32 v81, v81, v97
  v_mul_f32 v82, v82, v98
  v_mul_f32 v83, v83, v99
  v_mul_f32 v84, v84, v100
  v_mul_f32 v85, v85, v101
  v_mul_f32 v86, v86, v102
  v_mul_f32 v87, v87, v103
  v_cvt_pk_bf16_f32 v68, v80, v81
  v_cvt_pk_bf16_f32 v69, v82, v83
  v_cvt_pk_bf16_f32 v70, v84, v85
  v_cvt_pk_bf16_f32 v71, v86, v87
  buffer_store_dwordx4 v[68:71], v1, s[4:7], s56 offen offset:1024 sc1
  s_add_u32 s56, s54, 802816
  v_accvgpr_read_b32 v80, a224
  v_accvgpr_read_b32 v81, a225
  v_accvgpr_read_b32 v82, a226
  v_accvgpr_read_b32 v83, a227
  v_accvgpr_read_b32 v84, a228
  v_accvgpr_read_b32 v85, a229
  v_accvgpr_read_b32 v86, a230
  v_accvgpr_read_b32 v87, a231
  v_mul_f32 v96, v80, v80
  v_mul_f32 v97, v81, v81
  v_mul_f32 v98, v82, v82
  v_mul_f32 v99, v83, v83
  v_mul_f32 v100, v84, v84
  v_mul_f32 v101, v85, v85
  v_mul_f32 v102, v86, v86
  v_mul_f32 v103, v87, v87
  v_fma_f32 v96, v96, s57, v104
  v_fma_f32 v97, v97, s57, v104
  v_fma_f32 v98, v98, s57, v104
  v_fma_f32 v99, v99, s57, v104
  v_fma_f32 v100, v100, s57, v104
  v_fma_f32 v101, v101, s57, v104
  v_fma_f32 v102, v102, s57, v104
  v_fma_f32 v103, v103, s57, v104
  v_mul_f32 v96, v96, v80
  v_mul_f32 v97, v97, v81
  v_mul_f32 v98, v98, v82
  v_mul_f32 v99, v99, v83
  v_mul_f32 v100, v100, v84
  v_mul_f32 v101, v101, v85
  v_mul_f32 v102, v102, v86
  v_mul_f32 v103, v103, v87
  v_exp_f32 v96, v96
  v_accvgpr_read_b32 v88, a240
  v_exp_f32 v97, v97
  v_accvgpr_read_b32 v89, a241
  v_exp_f32 v98, v98
  v_accvgpr_read_b32 v90, a242
  v_exp_f32 v99, v99
  v_accvgpr_read_b32 v91, a243
  v_exp_f32 v100, v100
  v_accvgpr_read_b32 v92, a244
  v_exp_f32 v101, v101
  v_accvgpr_read_b32 v93, a245
  v_exp_f32 v102, v102
  v_accvgpr_read_b32 v94, a246
  v_exp_f32 v103, v103
  v_accvgpr_read_b32 v95, a247
  v_add_f32 v96, 1.0, v96
  v_add_f32 v97, 1.0, v97
  v_add_f32 v98, 1.0, v98
  v_add_f32 v99, 1.0, v99
  v_add_f32 v100, 1.0, v100
  v_add_f32 v101, 1.0, v101
  v_add_f32 v102, 1.0, v102
  v_add_f32 v103, 1.0, v103
  v_rcp_f32 v96, v96
  v_mul_f32 v80, v80, v88
  v_rcp_f32 v97, v97
  v_mul_f32 v81, v81, v89
  v_rcp_f32 v98, v98
  v_mul_f32 v82, v82, v90
  v_rcp_f32 v99, v99
  v_mul_f32 v83, v83, v91
  v_rcp_f32 v100, v100
  v_mul_f32 v84, v84, v92
  v_rcp_f32 v101, v101
  v_mul_f32 v85, v85, v93
  v_rcp_f32 v102, v102
  v_mul_f32 v86, v86, v94
  v_rcp_f32 v103, v103
  v_mul_f32 v87, v87, v95
  v_mul_f32 v80, v80, v96
  v_mul_f32 v81, v81, v97
  v_mul_f32 v82, v82, v98
  v_mul_f32 v83, v83, v99
  v_mul_f32 v84, v84, v100
  v_mul_f32 v85, v85, v101
  v_mul_f32 v86, v86, v102
  v_mul_f32 v87, v87, v103
  v_cvt_pk_bf16_f32 v72, v80, v81
  v_cvt_pk_bf16_f32 v73, v82, v83
  v_cvt_pk_bf16_f32 v74, v84, v85
  v_cvt_pk_bf16_f32 v75, v86, v87
  buffer_store_dwordx4 v[72:75], v1, s[4:7], s56 offen offset:0 sc1
  v_accvgpr_read_b32 v80, a232
  v_accvgpr_read_b32 v81, a233
  v_accvgpr_read_b32 v82, a234
  v_accvgpr_read_b32 v83, a235
  v_accvgpr_read_b32 v84, a236
  v_accvgpr_read_b32 v85, a237
  v_accvgpr_read_b32 v86, a238
  v_accvgpr_read_b32 v87, a239
  v_mul_f32 v96, v80, v80
  v_mul_f32 v97, v81, v81
  v_mul_f32 v98, v82, v82
  v_mul_f32 v99, v83, v83
  v_mul_f32 v100, v84, v84
  v_mul_f32 v101, v85, v85
  v_mul_f32 v102, v86, v86
  v_mul_f32 v103, v87, v87
  v_fma_f32 v96, v96, s57, v104
  v_fma_f32 v97, v97, s57, v104
  v_fma_f32 v98, v98, s57, v104
  v_fma_f32 v99, v99, s57, v104
  v_fma_f32 v100, v100, s57, v104
  v_fma_f32 v101, v101, s57, v104
  v_fma_f32 v102, v102, s57, v104
  v_fma_f32 v103, v103, s57, v104
  v_mul_f32 v96, v96, v80
  v_mul_f32 v97, v97, v81
  v_mul_f32 v98, v98, v82
  v_mul_f32 v99, v99, v83
  v_mul_f32 v100, v100, v84
  v_mul_f32 v101, v101, v85
  v_mul_f32 v102, v102, v86
  v_mul_f32 v103, v103, v87
  v_exp_f32 v96, v96
  v_accvgpr_read_b32 v88, a248
  v_exp_f32 v97, v97
  v_accvgpr_read_b32 v89, a249
  v_exp_f32 v98, v98
  v_accvgpr_read_b32 v90, a250
  v_exp_f32 v99, v99
  v_accvgpr_read_b32 v91, a251
  v_exp_f32 v100, v100
  v_accvgpr_read_b32 v92, a252
  v_exp_f32 v101, v101
  v_accvgpr_read_b32 v93, a253
  v_exp_f32 v102, v102
  v_accvgpr_read_b32 v94, a254
  v_exp_f32 v103, v103
  v_accvgpr_read_b32 v95, a255
  v_add_f32 v96, 1.0, v96
  v_add_f32 v97, 1.0, v97
  v_add_f32 v98, 1.0, v98
  v_add_f32 v99, 1.0, v99
  v_add_f32 v100, 1.0, v100
  v_add_f32 v101, 1.0, v101
  v_add_f32 v102, 1.0, v102
  v_add_f32 v103, 1.0, v103
  v_rcp_f32 v96, v96
  v_mul_f32 v80, v80, v88
  v_rcp_f32 v97, v97
  v_mul_f32 v81, v81, v89
  v_rcp_f32 v98, v98
  v_mul_f32 v82, v82, v90
  v_rcp_f32 v99, v99
  v_mul_f32 v83, v83, v91
  v_rcp_f32 v100, v100
  v_mul_f32 v84, v84, v92
  v_rcp_f32 v101, v101
  v_mul_f32 v85, v85, v93
  v_rcp_f32 v102, v102
  v_mul_f32 v86, v86, v94
  v_rcp_f32 v103, v103
  v_mul_f32 v87, v87, v95
  v_mul_f32 v80, v80, v96
  v_mul_f32 v81, v81, v97
  v_mul_f32 v82, v82, v98
  v_mul_f32 v83, v83, v99
  v_mul_f32 v84, v84, v100
  v_mul_f32 v85, v85, v101
  v_mul_f32 v86, v86, v102
  v_mul_f32 v87, v87, v103
  v_cvt_pk_bf16_f32 v76, v80, v81
  v_cvt_pk_bf16_f32 v77, v82, v83
  v_cvt_pk_bf16_f32 v78, v84, v85
  v_cvt_pk_bf16_f32 v79, v86, v87
  buffer_store_dwordx4 v[76:79], v1, s[4:7], s56 offen offset:1024 sc1
  s_waitcnt vmcnt(16)
  s_branch G_ld
G_e_4:
  s_nop 11
  s_add_u32 s56, s54, 0
  v_accvgpr_read_b32 v80, a0
  v_accvgpr_read_b32 v81, a1
  v_accvgpr_read_b32 v82, a2
  v_accvgpr_read_b32 v83, a3
  v_accvgpr_read_b32 v84, a4
  v_accvgpr_read_b32 v85, a5
  v_accvgpr_read_b32 v86, a6
  v_accvgpr_read_b32 v87, a7
  v_cvt_pk_bf16_f32 v64, v80, v81
  v_cvt_pk_bf16_f32 v65, v82, v83
  v_cvt_pk_bf16_f32 v66, v84, v85
  v_cvt_pk_bf16_f32 v67, v86, v87
  buffer_store_dwordx4 v[64:67], v1, s[4:7], s56 offen offset:0 sc1
  v_accvgpr_read_b32 v80, a8
  v_accvgpr_read_b32 v81, a9
  v_accvgpr_read_b32 v82, a10
  v_accvgpr_read_b32 v83, a11
  v_accvgpr_read_b32 v84, a12
  v_accvgpr_read_b32 v85, a13
  v_accvgpr_read_b32 v86, a14
  v_accvgpr_read_b32 v87, a15
  v_cvt_pk_bf16_f32 v68, v80, v81
  v_cvt_pk_bf16_f32 v69, v82, v83
  v_cvt_pk_bf16_f32 v70, v84, v85
  v_cvt_pk_bf16_f32 v71, v86, v87
  buffer_store_dwordx4 v[68:71], v1, s[4:7], s56 offen offset:1024 sc1
  s_add_u32 s56, s54, 4096
  v_accvgpr_read_b32 v80, a16
  v_accvgpr_read_b32 v81, a17
  v_accvgpr_read_b32 v82, a18
  v_accvgpr_read_b32 v83, a19
  v_accvgpr_read_b32 v84, a20
  v_accvgpr_read_b32 v85, a21
  v_accvgpr_read_b32 v86, a22
  v_accvgpr_read_b32 v87, a23
  v_cvt_pk_bf16_f32 v72, v80, v81
  v_cvt_pk_bf16_f32 v73, v82, v83
  v_cvt_pk_bf16_f32 v74, v84, v85
  v_cvt_pk_bf16_f32 v75, v86, v87
  buffer_store_dwordx4 v[72:75], v1, s[4:7], s56 offen offset:0 sc1
  v_accvgpr_read_b32 v80, a24
  v_accvgpr_read_b32 v81, a25
  v_accvgpr_read_b32 v82, a26
  v_accvgpr_read_b32 v83, a27
  v_accvgpr_read_b32 v84, a28
  v_accvgpr_read_b32 v85, a29
  v_accvgpr_read_b32 v86, a30
  v_accvgpr_read_b32 v87, a31
  v_cvt_pk_bf16_f32 v76, v80, v81
  v_cvt_pk_bf16_f32 v77, v82, v83
  v_cvt_pk_bf16_f32 v78, v84, v85
  v_cvt_pk_bf16_f32 v79, v86, v87
  buffer_store_dwordx4 v[76:79], v1, s[4:7], s56 offen offset:1024 sc1
  s_add_u32 s56, s54, 262144
  v_accvgpr_read_b32 v80, a32
  v_accvgpr_read_b32 v81, a33
  v_accvgpr_read_b32 v82, a34
  v_accvgpr_read_b32 v83, a35
  v_accvgpr_read_b32 v84, a36
  v_accvgpr_read_b32 v85, a37
  v_accvgpr_read_b32 v86, a38
  v_accvgpr_read_b32 v87, a39
  v_cvt_pk_bf16_f32 v64, v80, v81
  v_cvt_pk_bf16_f32 v65, v82, v83
  v_cvt_pk_bf16_f32 v66, v84, v85
  v_cvt_pk_bf16_f32 v67, v86, v87
  buffer_store_dwordx4 v[64:67], v1, s[4:7], s56 offen offset:0 sc1
  v_accvgpr_read_b32 v80, a40
  v_accvgpr_read_b32 v81, a41
  v_accvgpr_read_b32 v82, a42
  v_accvgpr_read_b32 v83, a43
  v_accvgpr_read_b32 v84, a44
  v_accvgpr_read_b32 v85, a45
  v_accvgpr_read_b32 v86, a46
  v_accvgpr_read_b32 v87, a47
  v_cvt_pk_bf16_f32 v68, v80, v81
  v_cvt_pk_bf16_f32 v69, v82, v83
  v_cvt_pk_bf16_f32 v70, v84, v85
  v_cvt_pk_bf16_f32 v71, v86, v87
  buffer_store_dwordx4 v[68:71], v1, s[4:7], s56 offen offset:1024 sc1
  s_add_u32 s56, s54, 266240
  v_accvgpr_read_b32 v80, a48
  v_accvgpr_read_b32 v81, a49
  v_accvgpr_read_b32 v82, a50
  v_accvgpr_read_b32 v83, a51
  v_accvgpr_read_b32 v84, a52
  v_accvgpr_read_b32 v85, a53
  v_accvgpr_read_b32 v86, a54
  v_accvgpr_read_b32 v87, a55
  v_cvt_pk_bf16_f32 v72, v80, v81
  v_cvt_pk_bf16_f32 v73, v82, v83
  v_cvt_pk_bf16_f32 v74, v84, v85
  v_cvt_pk_bf16_f32 v75, v86, v87
  buffer_store_dwordx4 v[72:75], v1, s[4:7], s56 offen offset:0 sc1
  v_accvgpr_read_b32 v80, a56
  v_accvgpr_read_b32 v81, a57
  v_accvgpr_read_b32 v82, a58
  v_accvgpr_read_b32 v83, a59
  v_accvgpr_read_b32 v84, a60
  v_accvgpr_read_b32 v85, a61
  v_accvgpr_read_b32 v86, a62
  v_accvgpr_read_b32 v87, a63
  v_cvt_pk_bf16_f32 v76, v80, v81
  v_cvt_pk_bf16_f32 v77, v82, v83
  v_cvt_pk_bf16_f32 v78, v84, v85
  v_cvt_pk_bf16_f32 v79, v86, v87
  buffer_store_dwordx4 v[76:79], v1, s[4:7], s56 offen offset:1024 sc1
  s_waitcnt vmcnt(8)
  s_branch G_ld
G_e_5:
  s_nop 11
  s_add_u32 s56, s54, 0
  v_accvgpr_read_b32 v80, a0
  v_accvgpr_read_b32 v81, a1
  v_accvgpr_read_b32 v82, a2
  v_accvgpr_read_b32 v83, a3
  v_accvgpr_read_b32 v84, a16
  v_accvgpr_read_b32 v85, a17
  v_accvgpr_read_b32 v86, a18
  v_accvgpr_read_b32 v87, a19
  v_cvt_pk_bf16_f32 v64, v80, v81
  v_cvt_pk_bf16_f32 v65, v82, v83
  v_cvt_pk_bf16_f32 v66, v84, v85
  v_cvt_pk_bf16_f32 v67, v86, v87
  buffer_store_dwordx4 v[64:67], v1, s[4:7], s56 offen offset:0 sc1
  v_accvgpr_read_b32 v80, a4
  v_accvgpr_read_b32 v81, a5
  v_accvgpr_read_b32 v82, a6
  v_accvgpr_read_b32 v83, a7
  v_accvgpr_read_b32 v84, a20
  v_accvgpr_read_b32 v85, a21
  v_accvgpr_read_b32 v86, a22
  v_accvgpr_read_b32 v87, a23
  v_cvt_pk_bf16_f32 v68, v80, v81
  v_cvt_pk_bf16_f32 v69, v82, v83
  v_cvt_pk_bf16_f32 v70, v84, v85
  v_cvt_pk_bf16_f32 v71, v86, v87
  buffer_store_dwordx4 v[68:71], v1, s[4:7], s56 offen offset:1024 sc1
  v_accvgpr_read_b32 v80, a8
  v_accvgpr_read_b32 v81, a9
  v_accvgpr_read_b32 v82, a10
  v_accvgpr_read_b32 v83, a11
  v_accvgpr_read_b32 v84, a24
  v_accvgpr_read_b32 v85, a25
  v_accvgpr_read_b32 v86, a26
  v_accvgpr_read_b32 v87, a27
  v_cvt_pk_bf16_f32 v72, v80, v81
  v_cvt_pk_bf16_f32 v73, v82, v83
  v_cvt_pk_bf16_f32 v74, v84, v85
  v_cvt_pk_bf16_f32 v75, v86, v87
  buffer_store_dwordx4 v[72:75], v1, s[4:7], s56 offen offset:2048 sc1
  v_accvgpr_read_b32 v80, a12
  v_accvgpr_read_b32 v81, a13
  v_accvgpr_read_b32 v82, a14
  v_accvgpr_read_b32 v83, a15
  v_accvgpr_read_b32 v84, a28
  v_accvgpr_read_b32 v85, a29
  v_accvgpr_read_b32 v86, a30
  v_accvgpr_read_b32 v87, a31
  v_cvt_pk_bf16_f32 v76, v80, v81
  v_cvt_pk_bf16_f32 v77, v82, v83
  v_cvt_pk_bf16_f32 v78, v84, v85
  v_cvt_pk_bf16_f32 v79, v86, v87
  buffer_store_dwordx4 v[76:79], v1, s[4:7], s56 offen offset:3072 sc1
  s_add_u32 s56, s54, 262144
  v_accvgpr_read_b32 v80, a32
  v_accvgpr_read_b32 v81, a33
  v_accvgpr_read_b32 v82, a34
  v_accvgpr_read_b32 v83, a35
  v_accvgpr_read_b32 v84, a48
  v_accvgpr_read_b32 v85, a49
  v_accvgpr_read_b32 v86, a50
  v_accvgpr_read_b32 v87, a51
  v_cvt_pk_bf16_f32 v64, v80, v81
  v_cvt_pk_bf16_f32 v65, v82, v83
  v_cvt_pk_bf16_f32 v66, v84, v85
  v_cvt_pk_bf16_f32 v67, v86, v87
  buffer_store_dwordx4 v[64:67], v1, s[4:7], s56 offen offset:0 sc1
  v_accvgpr_read_b32 v80, a36
  v_accvgpr_read_b32 v81, a37
  v_accvgpr_read_b32 v82, a38
  v_accvgpr_read_b32 v83, a39
  v_accvgpr_read_b32 v84, a52
  v_accvgpr_read_b32 v85, a53
  v_accvgpr_read_b32 v86, a54
  v_accvgpr_read_b32 v87, a55
  v_cvt_pk_bf16_f32 v68, v80, v81
  v_cvt_pk_bf16_f32 v69, v82, v83
  v_cvt_pk_bf16_f32 v70, v84, v85
  v_cvt_pk_bf16_f32 v71, v86, v87
  buffer_store_dwordx4 v[68:71], v1, s[4:7], s56 offen offset:1024 sc1
  v_accvgpr_read_b32 v80, a40
  v_accvgpr_read_b32 v81, a41
  v_accvgpr_read_b32 v82, a42
  v_accvgpr_read_b32 v83, a43
  v_accvgpr_read_b32 v84, a56
  v_accvgpr_read_b32 v85, a57
  v_accvgpr_read_b32 v86, a58
  v_accvgpr_read_b32 v87, a59
  v_cvt_pk_bf16_f32 v72, v80, v81
  v_cvt_pk_bf16_f32 v73, v82, v83
  v_cvt_pk_bf16_f32 v74, v84, v85
  v_cvt_pk_bf16_f32 v75, v86, v87
  buffer_store_dwordx4 v[72:75], v1, s[4:7], s56 offen offset:2048 sc1
  v_accvgpr_read_b32 v80, a44
  v_accvgpr_read_b32 v81, a45
  v_accvgpr_read_b32 v82, a46
  v_accvgpr_read_b32 v83, a47
  v_accvgpr_read_b32 v84, a60
  v_accvgpr_read_b32 v85, a61
  v_accvgpr_read_b32 v86, a62
  v_accvgpr_read_b32 v87, a63
  v_cvt_pk_bf16_f32 v76, v80, v81
  v_cvt_pk_bf16_f32 v77, v82, v83
  v_cvt_pk_bf16_f32 v78, v84, v85
  v_cvt_pk_bf16_f32 v79, v86, v87
  buffer_store_dwordx4 v[76:79], v1, s[4:7], s56 offen offset:3072 sc1
  s_waitcnt vmcnt(8)
  s_branch G_ld
G_e_6:
  s_nop 11
  s_add_u32 s56, s54, 0
  v_accvgpr_read_b32 v80, a0
  v_accvgpr_read_b32 v81, a1
  v_accvgpr_read_b32 v82, a2
  v_accvgpr_read_b32 v83, a3
  v_accvgpr_read_b32 v84, a4
  v_accvgpr_read_b32 v85, a5
  v_accvgpr_read_b32 v86, a6
  v_accvgpr_read_b32 v87, a7
  v_cvt_pk_bf16_f32 v64, v80, v81
  v_cvt_pk_bf16_f32 v65, v82, v83
  v_cvt_pk_bf16_f32 v66, v84, v85
  v_cvt_pk_bf16_f32 v67, v86, v87
  buffer_store_dwordx4 v[64:67], v1, s[4:7], s56 offen offset:0 sc1
  v_accvgpr_read_b32 v80, a8
  v_accvgpr_read_b32 v81, a9
  v_accvgpr_read_b32 v82, a10
  v_accvgpr_read_b32 v83, a11
  v_accvgpr_read_b32 v84, a12
  v_accvgpr_read_b32 v85, a13
  v_accvgpr_read_b32 v86, a14
  v_accvgpr_read_b32 v87, a15
  v_cvt_pk_bf16_f32 v68, v80, v81
  v_cvt_pk_bf16_f32 v69, v82, v83
  v_cvt_pk_bf16_f32 v70, v84, v85
  v_cvt_pk_bf16_f32 v71, v86, v87
  buffer_store_dwordx4 v[68:71], v1, s[4:7], s56 offen offset:2048 sc1
  v_accvgpr_read_b32 v80, a32
  v_accvgpr_read_b32 v81, a33
  v_accvgpr_read_b32 v82, a34
  v_accvgpr_read_b32 v83, a35
  v_accvgpr_read_b32 v84, a36
  v_accvgpr_read_b32 v85, a37
  v_accvgpr_read_b32 v86, a38
  v_accvgpr_read_b32 v87, a39
  v_cvt_pk_bf16_f32 v72, v80, v81
  v_cvt_pk_bf16_f32 v73, v82, v83
  v_cvt_pk_bf16_f32 v74, v84, v85
  v_cvt_pk_bf16_f32 v75, v86, v87
  buffer_store_dwordx4 v[72:75], v1, s[4:7], s56 offen offset:1024 sc1
  v_accvgpr_read_b32 v80, a40
  v_accvgpr_read_b32 v81, a41
  v_accvgpr_read_b32 v82, a42
  v_accvgpr_read_b32 v83, a43
  v_accvgpr_read_b32 v84, a44
  v_accvgpr_read_b32 v85, a45
  v_accvgpr_read_b32 v86, a46
  v_accvgpr_read_b32 v87, a47
  v_cvt_pk_bf16_f32 v76, v80, v81
  v_cvt_pk_bf16_f32 v77, v82, v83
  v_cvt_pk_bf16_f32 v78, v84, v85
  v_cvt_pk_bf16_f32 v79, v86, v87
  buffer_store_dwordx4 v[76:79], v1, s[4:7], s56 offen offset:3072 sc1
  s_add_u32 s56, s54, 4096
  v_accvgpr_read_b32 v80, a16
  v_accvgpr_read_b32 v81, a17
  v_accvgpr_read_b32 v82, a18
  v_accvgpr_read_b32 v83, a19
  v_accvgpr_read_b32 v84, a20
  v_accvgpr_read_b32 v85, a21
  v_accvgpr_read_b32 v86, a22
  v_accvgpr_read_b32 v87, a23
  v_cvt_pk_bf16_f32 v64, v80, v81
  v_cvt_pk_bf16_f32 v65, v82, v83
  v_cvt_pk_bf16_f32 v66, v84, v85
  v_cvt_pk_bf16_f32 v67, v86, v87
  buffer_store_dwordx4 v[64:67], v1, s[4:7], s56 offen offset:0 sc1
  v_accvgpr_read_b32 v80, a24
  v_accvgpr_read_b32 v81, a25
  v_accvgpr_read_b32 v82, a26
  v_accvgpr_read_b32 v83, a27
  v_accvgpr_read_b32 v84, a28
  v_accvgpr_read_b32 v85, a29
  v_accvgpr_read_b32 v86, a30
  v_accvgpr_read_b32 v87, a31
  v_cvt_pk_bf16_f32 v68, v80, v81
  v_cvt_pk_bf16_f32 v69, v82, v83
  v_cvt_pk_bf16_f32 v70, v84, v85
  v_cvt_pk_bf16_f32 v71, v86, v87
  buffer_store_dwordx4 v[68:71], v1, s[4:7], s56 offen offset:2048 sc1
  v_accvgpr_read_b32 v80, a48
  v_accvgpr_read_b32 v81, a49
  v_accvgpr_read_b32 v82, a50
  v_accvgpr_read_b32 v83, a51
  v_accvgpr_read_b32 v84, a52
  v_accvgpr_read_b32 v85, a53
  v_accvgpr_read_b32 v86, a54
  v_accvgpr_read_b32 v87, a55
  v_cvt_pk_bf16_f32 v72, v80, v81
  v_cvt_pk_bf16_f32 v73, v82, v83
  v_cvt_pk_bf16_f32 v74, v84, v85
  v_cvt_pk_bf16_f32 v75, v86, v87
  buffer_store_dwordx4 v[72:75], v1, s[4:7], s56 offen offset:1024 sc1
  v_accvgpr_read_b32 v80, a56
  v_accvgpr_read_b32 v81, a57
  v_accvgpr_read_b32 v82, a58
  v_accvgpr_read_b32 v83, a59
  v_accvgpr_read_b32 v84, a60
  v_accvgpr_read_b32 v85, a61
  v_accvgpr_read_b32 v86, a62
  v_accvgpr_read_b32 v87, a63
  v_cvt_pk_bf16_f32 v76, v80, v81
  v_cvt_pk_bf16_f32 v77, v82, v83
  v_cvt_pk_bf16_f32 v78, v84, v85
  v_cvt_pk_bf16_f32 v79, v86, v87
  buffer_store_dwordx4 v[76:79], v1, s[4:7], s56 offen offset:3072 sc1
  s_add_u32 s56, s54, 65536
  v_accvgpr_read_b32 v80, a64
  v_accvgpr_read_b32 v81, a65
  v_accvgpr_read_b32 v82, a66
  v_accvgpr_read_b32 v83, a67
  v_accvgpr_read_b32 v84, a68
  v_accvgpr_read_b32 v85, a69
  v_accvgpr_read_b32 v86, a70
  v_accvgpr_read_b32 v87, a71
  v_cvt_pk_bf16_f32 v64, v80, v81
  v_cvt_pk_bf16_f32 v65, v82, v83
  v_cvt_pk_bf16_f32 v66, v84, v85
  v_cvt_pk_bf16_f32 v67, v86, v87
  buffer_store_dwordx4 v[64:67], v1, s[4:7], s56 offen offset:0 sc1
  v_accvgpr_read_b32 v80, a72
  v_accvgpr_read_b32 v81, a73
  v_accvgpr_read_b32 v82, a74
  v_accvgpr_read_b32 v83, a75
  v_accvgpr_read_b32 v84, a76
  v_accvgpr_read_b32 v85, a77
  v_accvgpr_read_b32 v86, a78
  v_accvgpr_read_b32 v87, a79
  v_cvt_pk_bf16_f32 v68, v80, v81
  v_cvt_pk_bf16_f32 v69, v82, v83
  v_cvt_pk_bf16_f32 v70, v84, v85
  v_cvt_pk_bf16_f32 v71, v86, v87
  buffer_store_dwordx4 v[68:71], v1, s[4:7], s56 offen offset:2048 sc1
  v_accvgpr_read_b32 v80, a96
  v_accvgpr_read_b32 v81, a97
  v_accvgpr_read_b32 v82, a98
  v_accvgpr_read_b32 v83, a99
  v_accvgpr_read_b32 v84, a100
  v_accvgpr_read_b32 v85, a101
  v_accvgpr_read_b32 v86, a102
  v_accvgpr_read_b32 v87, a103
  v_cvt_pk_bf16_f32 v72, v80, v81
  v_cvt_pk_bf16_f32 v73, v82, v83
  v_cvt_pk_bf16_f32 v74, v84, v85
  v_cvt_pk_bf16_f32 v75, v86, v87
  buffer_store_dwordx4 v[72:75], v1, s[4:7], s56 offen offset:1024 sc1
  v_accvgpr_read_b32 v80, a104
  v_accvgpr_read_b32 v81, a105
  v_accvgpr_read_b32 v82, a106
  v_accvgpr_read_b32 v83, a107
  v_accvgpr_read_b32 v84, a108
  v_accvgpr_read_b32 v85, a109
  v_accvgpr_read_b32 v86, a110
  v_accvgpr_read_b32 v87, a111
  v_cvt_pk_bf16_f32 v76, v80, v81
  v_cvt_pk_bf16_f32 v77, v82, v83
  v_cvt_pk_bf16_f32 v78, v84, v85
  v_cvt_pk_bf16_f32 v79, v86, v87
  buffer_store_dwordx4 v[76:79], v1, s[4:7], s56 offen offset:3072 sc1
  s_add_u32 s56, s54, 69632
  v_accvgpr_read_b32 v80, a80
  v_accvgpr_read_b32 v81, a81
  v_accvgpr_read_b32 v82, a82
  v_accvgpr_read_b32 v83, a83
  v_accvgpr_read_b32 v84, a84
  v_accvgpr_read_b32 v85, a85
  v_accvgpr_read_b32 v86, a86
  v_accvgpr_read_b32 v87, a87
  v_cvt_pk_bf16_f32 v64, v80, v81
  v_cvt_pk_bf16_f32 v65, v82, v83
  v_cvt_pk_bf16_f32 v66, v84, v85
  v_cvt_pk_bf16_f32 v67, v86, v87
  buffer_store_dwordx4 v[64:67], v1, s[4:7], s56 offen offset:0 sc1
  v_accvgpr_read_b32 v80, a88
  v_accvgpr_read_b32 v81, a89
  v_accvgpr_read_b32 v82, a90
  v_accvgpr_read_b32 v83, a91
  v_accvgpr_read_b32 v84, a92
  v_accvgpr_read_b32 v85, a93
  v_accvgpr_read_b32 v86, a94
  v_accvgpr_read_b32 v87, a95
  v_cvt_pk_bf16_f32 v68, v80, v81
  v_cvt_pk_bf16_f32 v69, v82, v83
  v_cvt_pk_bf16_f32 v70, v84, v85
  v_cvt_pk_bf16_f32 v71, v86, v87
  buffer_store_dwordx4 v[68:71], v1, s[4:7], s56 offen offset:2048 sc1
  v_accvgpr_read_b32 v80, a112
  v_accvgpr_read_b32 v81, a113
  v_accvgpr_read_b32 v82, a114
  v_accvgpr_read_b32 v83, a115
  v_accvgpr_read_b32 v84, a116
  v_accvgpr_read_b32 v85, a117
  v_accvgpr_read_b32 v86, a118
  v_accvgpr_read_b32 v87, a119
  v_cvt_pk_bf16_f32 v72, v80, v81
  v_cvt_pk_bf16_f32 v73, v82, v83
  v_cvt_pk_bf16_f32 v74, v84, v85
  v_cvt_pk_bf16_f32 v75, v86, v87
  buffer_store_dwordx4 v[72:75], v1, s[4:7], s56 offen offset:1024 sc1
  v_accvgpr_read_b32 v80, a120
  v_accvgpr_read_b32 v81, a121
  v_accvgpr_read_b32 v82, a122
  v_accvgpr_read_b32 v83, a123
  v_accvgpr_read_b32 v84, a124
  v_accvgpr_read_b32 v85, a125
  v_accvgpr_read_b32 v86, a126
  v_accvgpr_read_b32 v87, a127
  v_cvt_pk_bf16_f32 v76, v80, v81
  v_cvt_pk_bf16_f32 v77, v82, v83
  v_cvt_pk_bf16_f32 v78, v84, v85
  v_cvt_pk_bf16_f32 v79, v86, v87
  buffer_store_dwordx4 v[76:79], v1, s[4:7], s56 offen offset:3072 sc1
  s_add_u32 s56, s54, 131072
  v_accvgpr_read_b32 v80, a128
  v_accvgpr_read_b32 v81, a129
  v_accvgpr_read_b32 v82, a130
  v_accvgpr_read_b32 v83, a131
  v_accvgpr_read_b32 v84, a132
  v_accvgpr_read_b32 v85, a133
  v_accvgpr_read_b32 v86, a134
  v_accvgpr_read_b32 v87, a135
  v_cvt_pk_bf16_f32 v64, v80, v81
  v_cvt_pk_bf16_f32 v65, v82, v83
  v_cvt_pk_bf16_f32 v66, v84, v85
  v_cvt_pk_bf16_f32 v67, v86, v87
  buffer_store_dwordx4 v[64:67], v1, s[4:7], s56 offen offset:0 sc1
  v_accvgpr_read_b32 v80, a136
  v_accvgpr_read_b32 v81, a137
  v_accvgpr_read_b32 v82, a138
  v_accvgpr_read_b32 v83, a139
  v_accvgpr_read_b32 v84, a140
  v_accvgpr_read_b32 v85, a141
  v_accvgpr_read_b32 v86, a142
  v_accvgpr_read_b32 v87, a143
  v_cvt_pk_bf16_f32 v68, v80, v81
  v_cvt_pk_bf16_f32 v69, v82, v83
  v_cvt_pk_bf16_f32 v70, v84, v85
  v_cvt_pk_bf16_f32 v71, v86, v87
  buffer_store_dwordx4 v[68:71], v1, s[4:7], s56 offen offset:2048 sc1
  v_accvgpr_read_b32 v80, a160
  v_accvgpr_read_b32 v81, a161
  v_accvgpr_read_b32 v82, a162
  v_accvgpr_read_b32 v83, a163
  v_accvgpr_read_b32 v84, a164
  v_accvgpr_read_b32 v85, a165
  v_accvgpr_read_b32 v86, a166
  v_accvgpr_read_b32 v87, a167
  v_cvt_pk_bf16_f32 v72, v80, v81
  v_cvt_pk_bf16_f32 v73, v82, v83
  v_cvt_pk_bf16_f32 v74, v84, v85
  v_cvt_pk_bf16_f32 v75, v86, v87
  buffer_store_dwordx4 v[72:75], v1, s[4:7], s56 offen offset:1024 sc1
  v_accvgpr_read_b32 v80, a168
  v_accvgpr_read_b32 v81, a169
  v_accvgpr_read_b32 v82, a170
  v_accvgpr_read_b32 v83, a171
  v_accvgpr_read_b32 v84, a172
  v_accvgpr_read_b32 v85, a173
  v_accvgpr_read_b32 v86, a174
  v_accvgpr_read_b32 v87, a175
  v_cvt_pk_bf16_f32 v76, v80, v81
  v_cvt_pk_bf16_f32 v77, v82, v83
  v_cvt_pk_bf16_f32 v78, v84, v85
  v_cvt_pk_bf16_f32 v79, v86, v87
  buffer_store_dwordx4 v[76:79], v1, s[4:7], s56 offen offset:3072 sc1
  s_add_u32 s56, s54, 135168
  v_accvgpr_read_b32 v80, a144
  v_accvgpr_read_b32 v81, a145
  v_accvgpr_read_b32 v82, a146
  v_accvgpr_read_b32 v83, a147
  v_accvgpr_read_b32 v84, a148
  v_accvgpr_read_b32 v85, a149
  v_accvgpr_read_b32 v86, a150
  v_accvgpr_read_b32 v87, a151
  v_cvt_pk_bf16_f32 v64, v80, v81
  v_cvt_pk_bf16_f32 v65, v82, v83
  v_cvt_pk_bf16_f32 v66, v84, v85
  v_cvt_pk_bf16_f32 v67, v86, v87
  buffer_store_dwordx4 v[64:67], v1, s[4:7], s56 offen offset:0 sc1
  v_accvgpr_read_b32 v80, a152
  v_accvgpr_read_b32 v81, a153
  v_accvgpr_read_b32 v82, a154
  v_accvgpr_read_b32 v83, a155
  v_accvgpr_read_b32 v84, a156
  v_accvgpr_read_b32 v85, a157
  v_accvgpr_read_b32 v86, a158
  v_accvgpr_read_b32 v87, a159
  v_cvt_pk_bf16_f32 v68, v80, v81
  v_cvt_pk_bf16_f32 v69, v82, v83
  v_cvt_pk_bf16_f32 v70, v84, v85
  v_cvt_pk_bf16_f32 v71, v86, v87
  buffer_store_dwordx4 v[68:71], v1, s[4:7], s56 offen offset:2048 sc1
  v_accvgpr_read_b32 v80, a176
  v_accvgpr_read_b32 v81, a177
  v_accvgpr_read_b32 v82, a178
  v_accvgpr_read_b32 v83, a179
  v_accvgpr_read_b32 v84, a180
  v_accvgpr_read_b32 v85, a181
  v_accvgpr_read_b32 v86, a182
  v_accvgpr_read_b32 v87, a183
  v_cvt_pk_bf16_f32 v72, v80, v81
  v_cvt_pk_bf16_f32 v73, v82, v83
  v_cvt_pk_bf16_f32 v74, v84, v85
  v_cvt_pk_bf16_f32 v75, v86, v87
  buffer_store_dwordx4 v[72:75], v1, s[4:7], s56 offen offset:1024 sc1
  v_accvgpr_read_b32 v80, a184
  v_accvgpr_read_b32 v81, a185
  v_accvgpr_read_b32 v82, a186
  v_accvgpr_read_b32 v83, a187
  v_accvgpr_read_b32 v84, a188
  v_accvgpr_read_b32 v85, a189
  v_accvgpr_read_b32 v86, a190
  v_accvgpr_read_b32 v87, a191
  v_cvt_pk_bf16_f32 v76, v80, v81
  v_cvt_pk_bf16_f32 v77, v82, v83
  v_cvt_pk_bf16_f32 v78, v84, v85
  v_cvt_pk_bf16_f32 v79, v86, v87
  buffer_store_dwordx4 v[76:79], v1, s[4:7], s56 offen offset:3072 sc1
  s_add_u32 s56, s54, 196608
  v_accvgpr_read_b32 v80, a192
  v_accvgpr_read_b32 v81, a193
  v_accvgpr_read_b32 v82, a194
  v_accvgpr_read_b32 v83, a195
  v_accvgpr_read_b32 v84, a196
  v_accvgpr_read_b32 v85, a197
  v_accvgpr_read_b32 v86, a198
  v_accvgpr_read_b32 v87, a199
  v_cvt_pk_bf16_f32 v64, v80, v81
  v_cvt_pk_bf16_f32 v65, v82, v83
  v_cvt_pk_bf16_f32 v66, v84, v85
  v_cvt_pk_bf16_f32 v67, v86, v87
  buffer_store_dwordx4 v[64:67], v1, s[4:7], s56 offen offset:0 sc1
  v_accvgpr_read_b32 v80, a200
  v_accvgpr_read_b32 v81, a201
  v_accvgpr_read_b32 v82, a202
  v_accvgpr_read_b32 v83, a203
  v_accvgpr_read_b32 v84, a204
  v_accvgpr_read_b32 v85, a205
  v_accvgpr_read_b32 v86, a206
  v_accvgpr_read_b32 v87, a207
  v_cvt_pk_bf16_f32 v68, v80, v81
  v_cvt_pk_bf16_f32 v69, v82, v83
  v_cvt_pk_bf16_f32 v70, v84, v85
  v_cvt_pk_bf16_f32 v71, v86, v87
  buffer_store_dwordx4 v[68:71], v1, s[4:7], s56 offen offset:2048 sc1
  v_accvgpr_read_b32 v80, a224
  v_accvgpr_read_b32 v81, a225
  v_accvgpr_read_b32 v82, a226
  v_accvgpr_read_b32 v83, a227
  v_accvgpr_read_b32 v84, a228
  v_accvgpr_read_b32 v85, a229
  v_accvgpr_read_b32 v86, a230
  v_accvgpr_read_b32 v87, a231
  v_cvt_pk_bf16_f32 v72, v80, v81
  v_cvt_pk_bf16_f32 v73, v82, v83
  v_cvt_pk_bf16_f32 v74, v84, v85
  v_cvt_pk_bf16_f32 v75, v86, v87
  buffer_store_dwordx4 v[72:75], v1, s[4:7], s56 offen offset:1024 sc1
  v_accvgpr_read_b32 v80, a232
  v_accvgpr_read_b32 v81, a233
  v_accvgpr_read_b32 v82, a234
  v_accvgpr_read_b32 v83, a235
  v_accvgpr_read_b32 v84, a236
  v_accvgpr_read_b32 v85, a237
  v_accvgpr_read_b32 v86, a238
  v_accvgpr_read_b32 v87, a239
  v_cvt_pk_bf16_f32 v76, v80, v81
  v_cvt_pk_bf16_f32 v77, v82, v83
  v_cvt_pk_bf16_f32 v78, v84, v85
  v_cvt_pk_bf16_f32 v79, v86, v87
  buffer_store_dwordx4 v[76:79], v1, s[4:7], s56 offen offset:3072 sc1
  s_add_u32 s56, s54, 200704
  v_accvgpr_read_b32 v80, a208
  v_accvgpr_read_b32 v81, a209
  v_accvgpr_read_b32 v82, a210
  v_accvgpr_read_b32 v83, a211
  v_accvgpr_read_b32 v84, a212
  v_accvgpr_read_b32 v85, a213
  v_accvgpr_read_b32 v86, a214
  v_accvgpr_read_b32 v87, a215
  v_cvt_pk_bf16_f32 v64, v80, v81
  v_cvt_pk_bf16_f32 v65, v82, v83
  v_cvt_pk_bf16_f32 v66, v84, v85
  v_cvt_pk_bf16_f32 v67, v86, v87
  buffer_store_dwordx4 v[64:67], v1, s[4:7], s56 offen offset:0 sc1
  v_accvgpr_read_b32 v80, a216
  v_accvgpr_read_b32 v81, a217
  v_accvgpr_read_b32 v82, a218
  v_accvgpr_read_b32 v83, a219
  v_accvgpr_read_b32 v84, a220
  v_accvgpr_read_b32 v85, a221
  v_accvgpr_read_b32 v86, a222
  v_accvgpr_read_b32 v87, a223
  v_cvt_pk_bf16_f32 v68, v80, v81
  v_cvt_pk_bf16_f32 v69, v82, v83
  v_cvt_pk_bf16_f32 v70, v84, v85
  v_cvt_pk_bf16_f32 v71, v86, v87
  buffer_store_dwordx4 v[68:71], v1, s[4:7], s56 offen offset:2048 sc1
  v_accvgpr_read_b32 v80, a240
  v_accvgpr_read_b32 v81, a241
  v_accvgpr_read_b32 v82, a242
  v_accvgpr_read_b32 v83, a243
  v_accvgpr_read_b32 v84, a244
  v_accvgpr_read_b32 v85, a245
  v_accvgpr_read_b32 v86, a246
  v_accvgpr_read_b32 v87, a247
  v_cvt_pk_bf16_f32 v72, v80, v81
  v_cvt_pk_bf16_f32 v73, v82, v83
  v_cvt_pk_bf16_f32 v74, v84, v85
  v_cvt_pk_bf16_f32 v75, v86, v87
  buffer_store_dwordx4 v[72:75], v1, s[4:7], s56 offen offset:1024 sc1
  v_accvgpr_read_b32 v80, a248
  v_accvgpr_read_b32 v81, a249
  v_accvgpr_read_b32 v82, a250
  v_accvgpr_read_b32 v83, a251
  v_accvgpr_read_b32 v84, a252
  v_accvgpr_read_b32 v85, a253
  v_accvgpr_read_b32 v86, a254
  v_accvgpr_read_b32 v87, a255
  v_cvt_pk_bf16_f32 v76, v80, v81
  v_cvt_pk_bf16_f32 v77, v82, v83
  v_cvt_pk_bf16_f32 v78, v84, v85
  v_cvt_pk_bf16_f32 v79, v86, v87
  buffer_store_dwordx4 v[76:79], v1, s[4:7], s56 offen offset:3072 sc1
  s_waitcnt vmcnt(32)
  s_branch G_ld
G_ld:
  s_cmp_eq_u32 s47, 1
  s_cbranch_scc1 G_l_bs
  s_cmp_eq_u32 s47, 3
  s_cbranch_scc1 G_l_us
  s_cmp_eq_u32 s47, 2
  s_cbranch_scc1 G_l_bn
  s_cmp_eq_u32 s47, 6
  s_cbranch_scc1 G_l_us
  v_mov_b32 v17, 0x90
spin_47:
  buffer_load_dword v16, v17, s[20:23], 0 offen sc1
  s_waitcnt vmcnt(0)
  v_readfirstlane_b32 s57, v16
  s_nop 0
  s_cmp_ge_u32 s57, 1
  s_cbranch_scc1 spun_48
  s_sleep 4
  s_sub_u32 s94, s94, 1
  s_cbranch_scc0 spin_47
  s_mov_b32 s94, 0
spun_48:
  s_barrier
  s_cmp_eq_u32 s55, 0
  s_cbranch_scc1 nf_49
  v_mov_b32 v14, s55
  s_mov_b64 exec, 1
  buffer_atomic_add v15, v14, s[4:7], 0 offen
  s_mov_b64 exec, -1
  s_mov_b32 s55, 0
nf_49:
  s_mov_b32 s48, 0
  s_branch G_next2
G_l_bs:
  s_barrier
  ds_read_b128 v[128:131], v4 offset:0
  ds_read_b64_tr_b16 v[160:161], v6 offset:0
  ds_read_b64_tr_b16 v[162:163], v6 offset:1024
  ds_read_b128 v[132:135], v4 offset:2048
  ds_read_b64_tr_b16 v[164:165], v7 offset:0
  ds_read_b64_tr_b16 v[166:167], v7 offset:1024
  ds_read_b128 v[136:139], v4 offset:4096
  ds_read_b64_tr_b16 v[168:169], v8 offset:0
  ds_read_b64_tr_b16 v[170:171], v8 offset:1024
  ds_read_b128 v[140:143], v4 offset:6144
  ds_read_b64_tr_b16 v[172:173], v9 offset:0
  ds_read_b64_tr_b16 v[174:175], v9 offset:1024
  ds_read_b128 v[144:147], v4 offset:8192
  ds_read_b64_tr_b16 v[176:177], v10 offset:0
  ds_read_b64_tr_b16 v[178:179], v10 offset:1024
  ds_read_b128 v[148:151], v4 offset:10240
  ds_read_b64_tr_b16 v[180:181], v11 offset:0
  ds_read_b64_tr_b16 v[182:183], v11 offset:1024
  ds_read_b128 v[152:155], v4 offset:12288
  ds_read_b64_tr_b16 v[184:185], v12 offset:0
  ds_read_b64_tr_b16 v[186:187], v12 offset:1024
  ds_read_b128 v[156:159], v4 offset:14336
  ds_read_b64_tr_b16 v[188:189], v13 offset:0
  ds_read_b64_tr_b16 v[190:191], v13 offset:1024
  s_sub_u32 s46, s96, 4
  s_mov_b32 s97, 0
  s_add_u32 s62, s95, 0x10000
  s_mov_b32 s61, 0x8000
  s_waitcnt lgkmcnt(0)
  v_mfma_f32_16x16x32_bf16 a[0:3], v[160:163], v[128:131], 0
  ds_read_b128 v[192:195], v5 offset:0
  s_add_u32 m0, s62, 0
  s_nop 0
  buffer_load_dwordx4 v3, s[12:15], s40 offen  lds
  v_mfma_f32_16x16x32_bf16 a[4:7], v[164:167], v[128:131], 0
  v_mfma_f32_16x16x32_bf16 a[8:11], v[168:171], v[128:131], 0
  ds_read_b64_tr_b16 v[224:225], v6 offset:8192
  v_mfma_f32_16x16x32_bf16 a[12:15], v[172:175], v[128:131], 0
  v_mfma_f32_16x16x32_bf16 a[16:19], v[176:179], v[128:131], 0
  ds_read_b64_tr_b16 v[226:227], v6 offset:9216
  v_mfma_f32_16x16x32_bf16 a[20:23], v[180:183], v[128:131], 0
  v_mfma_f32_16x16x32_bf16 a[24:27], v[184:187], v[128:131], 0
  ds_read_b128 v[196:199], v5 offset:2048
  s_add_u32 m0, s62, 16384
  s_nop 0
  buffer_load_dwordx4 v24, s[16:19], s40 offen  lds
  v_mfma_f32_16x16x32_bf16 a[28:31], v[188:191], v[128:131], 0
  v_mfma_f32_16x16x32_bf16 a[32:35], v[160:163], v[132:135], 0
  ds_read_b64_tr_b16 v[228:229], v7 offset:8192
  v_mfma_f32_16x16x32_bf16 a[36:39], v[164:167], v[132:135], 0
  v_mfma_f32_16x16x32_bf16 a[40:43], v[168:171], v[132:135], 0
  ds_read_b64_tr_b16 v[230:231], v7 offset:9216
  v_mfma_f32_16x16x32_bf16 a[44:47], v[172:175], v[132:135], 0
  v_mfma_f32_16x16x32_bf16 a[48:51], v[176:179], v[132:135], 0
  ds_read_b128 v[200:203], v5 offset:4096
  s_add_u32 m0, s62, 4096
  s_nop 0
  buffer_load_dwordx4 v3, s[12:15], s41 offen  lds
  v_mfma_f32_16x16x32_bf16 a[52:55], v[180:183], v[132:135], 0
  v_mfma_f32_16x16x32_bf16 a[56:59], v[184:187], v[132:135], 0
  ds_read_b64_tr_b16 v[232:233], v8 offset:8192
  v_mfma_f32_16x16x32_bf16 a[60:63], v[188:191], v[132:135], 0
  v_mfma_f32_16x16x32_bf16 a[64:67], v[160:163], v[136:139], 0
  ds_read_b64_tr_b16 v[234:235], v8 offset:9216
  v_mfma_f32_16x16x32_bf16 a[68:71], v[164:167], v[136:139], 0
  v_mfma_f32_16x16x32_bf16 a[72:75], v[168:171], v[136:139], 0
  ds_read_b128 v[204:207], v5 offset:6144
  v_mfma_f32_16x16x32_bf16 a[76:79], v[172:175], v[136:139], 0
  s_add_u32 m0, s62, 20480
  s_nop 0
  buffer_load_dwordx4 v24, s[16:19], s41 offen  lds
  v_mfma_f32_16x16x32_bf16 a[80:83], v[176:179], v[136:139], 0
  ds_read_b64_tr_b16 v[236:237], v9 offset:8192
  v_mfma_f32_16x16x32_bf16 a[84:87], v[180:183], v[136:139], 0
  v_mfma_f32_16x16x32_bf16 a[88:91], v[184:187], v[136:139], 0
  ds_read_b64_tr_b16 v[238:239], v9 offset:9216
  v_mfma_f32_16x16x32_bf16 a[92:95], v[188:191], v[136:139], 0
  v_mfma_f32_16x16x32_bf16 a[96:99], v[160:163], v[140:143], 0
  ds_read_b128 v[208:211], v5 offset:8192
  v_mfma_f32_16x16x32_bf16 a[100:103], v[164:167], v[140:143], 0
  s_add_u32 m0, s62, 8192
  s_nop 0
  buffer_load_dwordx4 v3, s[12:15], s42 offen  lds
  v_mfma_f32_16x16x32_bf16 a[104:107], v[168:171], v[140:143], 0
  ds_read_b64_tr_b16 v[240:241], v10 offset:8192
  v_mfma_f32_16x16x32_bf16 a[108:111], v[172:175], v[140:143], 0
  v_mfma_f32_16x16x32_bf16 a[112:115], v[176:179], v[140:143], 0
  ds_read_b64_tr_b16 v[242:243], v10 offset:9216
  v_mfma_f32_16x16x32_bf16 a[116:119], v[180:183], v[140:143], 0
  v_mfma_f32_16x16x32_bf16 a[120:123], v[184:187], v[140:143], 0
  ds_read_b128 v[212:215], v5 offset:10240
  v_mfma_f32_16x16x32_bf16 a[124:127], v[188:191], v[140:143], 0
  s_add_u32 m0, s62, 24576
  s_nop 0
  buffer_load_dwordx4 v24, s[16:19], s42 offen  lds
  v_mfma_f32_16x16x32_bf16 a[128:131], v[160:163], v[144:147], 0
  ds_read_b64_tr_b16 v[244:245], v11 offset:8192
  v_mfma_f32_16x16x32_bf16 a[132:135], v[164:167], v[144:147], 0
  v_mfma_f32_16x16x32_bf16 a[136:139], v[168:171], v[144:147], 0
  ds_read_b64_tr_b16 v[246:247], v11 offset:9216
  v_mfma_f32_16x16x32_bf16 a[140:143], v[172:175], v[144:147], 0
  v_mfma_f32_16x16x32_bf16 a[144:147], v[176:179], v[144:147], 0
  ds_read_b128 v[216:219], v5 offset:12288
  v_mfma_f32_16x16x32_bf16 a[148:151], v[180:183], v[144:147], 0
  v_mfma_f32_16x16x32_bf16 a[152:155], v[184:187], v[144:147], 0
  s_add_u32 m0, s62, 12288
  s_nop 0
  buffer_load_dwordx4 v3, s[12:15], s43 offen  lds
  ds_read_b64_tr_b16 v[248:249], v12 offset:8192
  v_mfma_f32_16x16x32_bf16 a[156:159], v[188:191], v[144:147], 0
  v_mfma_f32_16x16x32_bf16 a[160:163], v[160:163], v[148:151], 0
  ds_read_b64_tr_b16 v[250:251], v12 offset:9216
  v_mfma_f32_16x16x32_bf16 a[164:167], v[164:167], v[148:151], 0
  v_mfma_f32_16x16x32_bf16 a[168:171], v[168:171], v[148:151], 0
  ds_read_b128 v[220:223], v5 offset:14336
  v_mfma_f32_16x16x32_bf16 a[172:175], v[172:175], v[148:151], 0
  v_mfma_f32_16x16x32_bf16 a[176:179], v[176:179], v[148:151], 0
  s_add_u32 m0, s62, 28672
  s_nop 0
  buffer_load_dwordx4 v24, s[16:19], s43 offen  lds
  v_add_u32 v3, s45, v3
  v_add_u32 v24, s45, v24
  ds_read_b64_tr_b16 v[252:253], v13 offset:8192
  v_mfma_f32_16x16x32_bf16 a[180:183], v[180:183], v[148:151], 0
  v_mfma_f32_16x16x32_bf16 a[184:187], v[184:187], v[148:151], 0
  ds_read_b64_tr_b16 v[254:255], v13 offset:9216
  v_mfma_f32_16x16x32_bf16 a[188:191], v[188:191], v[148:151], 0
  v_mfma_f32_16x16x32_bf16 a[192:195], v[160:163], v[152:155], 0
  v_mfma_f32_16x16x32_bf16 a[196:199], v[164:167], v[152:155], 0
  v_mfma_f32_16x16x32_bf16 a[200:203], v[168:171], v[152:155], 0
  v_mfma_f32_16x16x32_bf16 a[204:207], v[172:175], v[152:155], 0
  v_mfma_f32_16x16x32_bf16 a[208:211], v[176:179], v[152:155], 0
  v_mfma_f32_16x16x32_bf16 a[212:215], v[180:183], v[152:155], 0
  v_mfma_f32_16x16x32_bf16 a[216:219], v[184:187], v[152:155], 0
  v_mfma_f32_16x16x32_bf16 a[220:223], v[188:191], v[152:155], 0
  v_mfma_f32_16x16x32_bf16 a[224:227], v[160:163], v[156:159], 0
  s_add_u32 s62, s95, s97
  s_cmp_eq_u32 s97, 0x10000
  v_mfma_f32_16x16x32_bf16 a[228:231], v[164:167], v[156:159], 0
  s_cselect_b32 s63, 0xffff0000, s61
  s_add_u32 s97, s97, s63
  v_mfma_f32_16x16x32_bf16 a[232:235], v[168:171], v[156:159], 0
  v_add_u32 v6, s63, v6
  v_add_u32 v7, s63, v7
  v_mfma_f32_16x16x32_bf16 a[236:239], v[172:175], v[156:159], 0
  v_add_u32 v8, s63, v8
  v_add_u32 v9, s63, v9
  v_mfma_f32_16x16x32_bf16 a[240:243], v[176:179], v[156:159], 0
  v_add_u32 v10, s63, v10
  v_add_u32 v11, s63, v11
  v_mfma_f32_16x16x32_bf16 a[244:247], v[180:183], v[156:159], 0
  v_add_u32 v12, s63, v12
  v_add_u32 v13, s63, v13
  v_mfma_f32_16x16x32_bf16 a[248:251], v[184:187], v[156:159], 0
  v_mfma_f32_16x16x32_bf16 a[252:255], v[188:191], v[156:159], 0
  s_waitcnt lgkmcnt(0)
  s_barrier
  v_mfma_f32_16x16x32_bf16 a[0:3], v[224:227], v[192:195], a[0:3]
  ds_read_b128 v[128:131], v4 offset:32768
  s_add_u32 m0, s95, 98304
  s_nop 0
  buffer_load_dwordx4 v2, s[8:11], s32 offen sc1 lds
  v_mfma_f32_16x16x32_bf16 a[4:7], v[228:231], v[192:195], a[4:7]
  v_mfma_f32_16x16x32_bf16 a[8:11], v[232:235], v[192:195], a[8:11]
  ds_read_b64_tr_b16 v[160:161], v6 offset:0
  v_mfma_f32_16x16x32_bf16 a[12:15], v[236:239], v[192:195], a[12:15]
  v_mfma_f32_16x16x32_bf16 a[16:19], v[240:243], v[192:195], a[16:19]
  ds_read_b64_tr_b16 v[162:163], v6 offset:1024
  v_mfma_f32_16x16x32_bf16 a[20:23], v[244:247], v[192:195], a[20:23]
  s_add_u32 m0, s95, 102400
  s_nop 0
  buffer_load_dwordx4 v2, s[8:11], s33 offen sc1 lds
  v_mfma_f32_16x16x32_bf16 a[24:27], v[248:251], v[192:195], a[24:27]
  ds_read_b128 v[132:135], v4 offset:34816
  v_mfma_f32_16x16x32_bf16 a[28:31], v[252:255], v[192:195], a[28:31]
  v_mfma_f32_16x16x32_bf16 a[32:35], v[224:227], v[196:199], a[32:35]
  ds_read_b64_tr_b16 v[164:165], v7 offset:0
  v_mfma_f32_16x16x32_bf16 a[36:39], v[228:231], v[196:199], a[36:39]
  v_mfma_f32_16x16x32_bf16 a[40:43], v[232:235], v[196:199], a[40:43]
  s_add_u32 m0, s95, 106496
  s_nop 0
  buffer_load_dwordx4 v2, s[8:11], s34 offen sc1 lds
  ds_read_b64_tr_b16 v[166:167], v7 offset:1024
  v_mfma_f32_16x16x32_bf16 a[44:47], v[236:239], v[196:199], a[44:47]
  v_mfma_f32_16x16x32_bf16 a[48:51], v[240:243], v[196:199], a[48:51]
  ds_read_b128 v[136:139], v4 offset:36864
  v_mfma_f32_16x16x32_bf16 a[52:55], v[244:247], v[196:199], a[52:55]
  v_mfma_f32_16x16x32_bf16 a[56:59], v[248:251], v[196:199], a[56:59]
  ds_read_b64_tr_b16 v[168:169], v8 offset:0
  s_add_u32 m0, s95, 110592
  s_nop 0
  buffer_load_dwordx4 v2, s[8:11], s35 offen sc1 lds
  v_mfma_f32_16x16x32_bf16 a[60:63], v[252:255], v[196:199], a[60:63]
  v_mfma_f32_16x16x32_bf16 a[64:67], v[224:227], v[200:203], a[64:67]
  ds_read_b64_tr_b16 v[170:171], v8 offset:1024
  v_mfma_f32_16x16x32_bf16 a[68:71], v[228:231], v[200:203], a[68:71]
  v_mfma_f32_16x16x32_bf16 a[72:75], v[232:235], v[200:203], a[72:75]
  ds_read_b128 v[140:143], v4 offset:38912
  v_mfma_f32_16x16x32_bf16 a[76:79], v[236:239], v[200:203], a[76:79]
  s_add_u32 m0, s95, 114688
  s_nop 0
  buffer_load_dwordx4 v2, s[8:11], s36 offen sc1 lds
  v_mfma_f32_16x16x32_bf16 a[80:83], v[240:243], v[200:203], a[80:83]
  ds_read_b64_tr_b16 v[172:173], v9 offset:0
  v_mfma_f32_16x16x32_bf16 a[84:87], v[244:247], v[200:203], a[84:87]
  v_mfma_f32_16x16x32_bf16 a[88:91], v[248:251], v[200:203], a[88:91]
  ds_read_b64_tr_b16 v[174:175], v9 offset:1024
  v_mfma_f32_16x16x32_bf16 a[92:95], v[252:255], v[200:203], a[92:95]
  v_mfma_f32_16x16x32_bf16 a[96:99], v[224:227], v[204:207], a[96:99]
  s_add_u32 m0, s95, 118784
  s_nop 0
  buffer_load_dwordx4 v2, s[8:11], s37 offen sc1 lds
  ds_read_b128 v[144:147], v4 offset:40960
  v_mfma_f32_16x16x32_bf16 a[100:103], v[228:231], v[204:207], a[100:103]
  v_mfma_f32_16x16x32_bf16 a[104:107], v[232:235], v[204:207], a[104:107]
  ds_read_b64_tr_b16 v[176:177], v10 offset:0
  v_mfma_f32_16x16x32_bf16 a[108:111], v[236:239], v[204:207], a[108:111]
  v_mfma_f32_16x16x32_bf16 a[112:115], v[240:243], v[204:207], a[112:115]
  ds_read_b64_tr_b16 v[178:179], v10 offset:1024
  s_add_u32 m0, s95, 122880
  s_nop 0
  buffer_load_dwordx4 v2, s[8:11], s38 offen sc1 lds
  v_mfma_f32_16x16x32_bf16 a[116:119], v[244:247], v[204:207], a[116:119]
  v_mfma_f32_16x16x32_bf16 a[120:123], v[248:251], v[204:207], a[120:123]
  ds_read_b128 v[148:151], v4 offset:43008
  v_mfma_f32_16x16x32_bf16 a[124:127], v[252:255], v[204:207], a[124:127]
  v_mfma_f32_16x16x32_bf16 a[128:131], v[224:227], v[208:211], a[128:131]
  ds_read_b64_tr_b16 v[180:181], v11 offset:0
  v_mfma_f32_16x16x32_bf16 a[132:135], v[228:231], v[208:211], a[132:135]
  s_add_u32 m0, s95, 126976
  s_nop 0
  buffer_load_dwordx4 v2, s[8:11], s39 offen sc1 lds
  v_add_u32 v2, s44, v2
  v_mfma_f32_16x16x32_bf16 a[136:139], v[232:235], v[208:211], a[136:139]
  ds_read_b64_tr_b16 v[182:183], v11 offset:1024
  v_mfma_f32_16x16x32_bf16 a[140:143], v[236:239], v[208:211], a[140:143]
  v_mfma_f32_16x16x32_bf16 a[144:147], v[240:243], v[208:211], a[144:147]
  ds_read_b128 v[152:155], v4 offset:45056
  v_mfma_f32_16x16x32_bf16 a[148:151], v[244:247], v[208:211], a[148:151]
  v_mfma_f32_16x16x32_bf16 a[152:155], v[248:251], v[208:211], a[152:155]
  ds_read_b64_tr_b16 v[184:185], v12 offset:0
  v_mfma_f32_16x16x32_bf16 a[156:159], v[252:255], v[208:211], a[156:159]
  v_mfma_f32_16x16x32_bf16 a[160:163], v[224:227], v[212:215], a[160:163]
  ds_read_b64_tr_b16 v[186:187], v12 offset:1024
  v_mfma_f32_16x16x32_bf16 a[164:167], v[228:231], v[212:215], a[164:167]
  v_mfma_f32_16x16x32_bf16 a[168:171], v[232:235], v[212:215], a[168:171]
  ds_read_b128 v[156:159], v4 offset:47104
  v_mfma_f32_16x16x32_bf16 a[172:175], v[236:239], v[212:215], a[172:175]
  v_mfma_f32_16x16x32_bf16 a[176:179], v[240:243], v[212:215], a[176:179]
  ds_read_b64_tr_b16 v[188:189], v13 offset:0
  v_mfma_f32_16x16x32_bf16 a[180:183], v[244:247], v[212:215], a[180:183]
  v_mfma_f32_16x16x32_bf16 a[184:187], v[248:251], v[212:215], a[184:187]
  ds_read_b64_tr_b16 v[190:191], v13 offset:1024
  v_mfma_f32_16x16x32_bf16 a[188:191], v[252:255], v[212:215], a[188:191]
  v_mfma_f32_16x16x32_bf16 a[192:195], v[224:227], v[216:219], a[192:195]
  v_mfma_f32_16x16x32_bf16 a[196:199], v[228:231], v[216:219], a[196:199]
  v_mfma_f32_16x16x32_bf16 a[200:203], v[232:235], v[216:219], a[200:203]
  v_mfma_f32_16x16x32_bf16 a[204:207], v[236:239], v[216:219], a[204:207]
  v_mfma_f32_16x16x32_bf16 a[208:211], v[240:243], v[216:219], a[208:211]
  v_mfma_f32_16x16x32_bf16 a[212:215], v[244:247], v[216:219], a[212:215]
  v_mfma_f32_16x16x32_bf16 a[216:219], v[248:251], v[216:219], a[216:219]
  v_mfma_f32_16x16x32_bf16 a[220:223], v[252:255], v[216:219], a[220:223]
  v_mfma_f32_16x16x32_bf16 a[224:227], v[224:227], v[220:223], a[224:227]
  v_mfma_f32_16x16x32_bf16 a[228:231], v[228:231], v[220:223], a[228:231]
  v_mfma_f32_16x16x32_bf16 a[232:235], v[232:235], v[220:223], a[232:235]
  v_mfma_f32_16x16x32_bf16 a[236:239], v[236:239], v[220:223], a[236:239]
  v_mfma_f32_16x16x32_bf16 a[240:243], v[240:243], v[220:223], a[240:243]
  v_mfma_f32_16x16x32_bf16 a[244:247], v[244:247], v[220:223], a[244:247]
  v_mfma_f32_16x16x32_bf16 a[248:251], v[248:251], v[220:223], a[248:251]
  v_mfma_f32_16x16x32_bf16 a[252:255], v[252:255], v[220:223], a[252:255]
  s_waitcnt lgkmcnt(0)
  v_mfma_f32_16x16x32_bf16 a[0:3], v[160:163], v[128:131], a[0:3]
  ds_read_b128 v[192:195], v5 offset:32768
  s_add_u32 m0, s62, 0
  s_nop 0
  buffer_load_dwordx4 v3, s[12:15], s40 offen  lds
  v_mfma_f32_16x16x32_bf16 a[4:7], v[164:167], v[128:131], a[4:7]
  v_mfma_f32_16x16x32_bf16 a[8:11], v[168:171], v[128:131], a[8:11]
  ds_read_b64_tr_b16 v[224:225], v6 offset:8192
  v_mfma_f32_16x16x32_bf16 a[12:15], v[172:175], v[128:131], a[12:15]
  v_mfma_f32_16x16x32_bf16 a[16:19], v[176:179], v[128:131], a[16:19]
  ds_read_b64_tr_b16 v[226:227], v6 offset:9216
  v_mfma_f32_16x16x32_bf16 a[20:23], v[180:183], v[128:131], a[20:23]
  v_mfma_f32_16x16x32_bf16 a[24:27], v[184:187], v[128:131], a[24:27]
  ds_read_b128 v[196:199], v5 offset:34816
  s_add_u32 m0, s62, 16384
  s_nop 0
  buffer_load_dwordx4 v24, s[16:19], s40 offen  lds
  v_mfma_f32_16x16x32_bf16 a[28:31], v[188:191], v[128:131], a[28:31]
  v_mfma_f32_16x16x32_bf16 a[32:35], v[160:163], v[132:135], a[32:35]
  ds_read_b64_tr_b16 v[228:229], v7 offset:8192
  v_mfma_f32_16x16x32_bf16 a[36:39], v[164:167], v[132:135], a[36:39]
  v_mfma_f32_16x16x32_bf16 a[40:43], v[168:171], v[132:135], a[40:43]
  ds_read_b64_tr_b16 v[230:231], v7 offset:9216
  v_mfma_f32_16x16x32_bf16 a[44:47], v[172:175], v[132:135], a[44:47]
  v_mfma_f32_16x16x32_bf16 a[48:51], v[176:179], v[132:135], a[48:51]
  ds_read_b128 v[200:203], v5 offset:36864
  s_add_u32 m0, s62, 4096
  s_nop 0
  buffer_load_dwordx4 v3, s[12:15], s41 offen  lds
  v_mfma_f32_16x16x32_bf16 a[52:55], v[180:183], v[132:135], a[52:55]
  v_mfma_f32_16x16x32_bf16 a[56:59], v[184:187], v[132:135], a[56:59]
  ds_read_b64_tr_b16 v[232:233], v8 offset:8192
  v_mfma_f32_16x16x32_bf16 a[60:63], v[188:191], v[132:135], a[60:63]
  v_mfma_f32_16x16x32_bf16 a[64:67], v[160:163], v[136:139], a[64:67]
  ds_read_b64_tr_b16 v[234:235], v8 offset:9216
  v_mfma_f32_16x16x32_bf16 a[68:71], v[164:167], v[136:139], a[68:71]
  v_mfma_f32_16x16x32_bf16 a[72:75], v[168:171], v[136:139], a[72:75]
  ds_read_b128 v[204:207], v5 offset:38912
  v_mfma_f32_16x16x32_bf16 a[76:79], v[172:175], v[136:139], a[76:79]
  s_add_u32 m0, s62, 20480
  s_nop 0
  buffer_load_dwordx4 v24, s[16:19], s41 offen  lds
  v_mfma_f32_16x16x32_bf16 a[80:83], v[176:179], v[136:139], a[80:83]
  ds_read_b64_tr_b16 v[236:237], v9 offset:8192
  v_mfma_f32_16x16x32_bf16 a[84:87], v[180:183], v[136:139], a[84:87]
  v_mfma_f32_16x16x32_bf16 a[88:91], v[184:187], v[136:139], a[88:91]
  ds_read_b64_tr_b16 v[238:239], v9 offset:9216
  v_mfma_f32_16x16x32_bf16 a[92:95], v[188:191], v[136:139], a[92:95]
  v_mfma_f32_16x16x32_bf16 a[96:99], v[160:163], v[140:143], a[96:99]
  ds_read_b128 v[208:211], v5 offset:40960
  v_mfma_f32_16x16x32_bf16 a[100:103], v[164:167], v[140:143], a[100:103]
  s_add_u32 m0, s62, 8192
  s_nop 0
  buffer_load_dwordx4 v3, s[12:15], s42 offen  lds
  v_mfma_f32_16x16x32_bf16 a[104:107], v[168:171], v[140:143], a[104:107]
  ds_read_b64_tr_b16 v[240:241], v10 offset:8192
  v_mfma_f32_16x16x32_bf16 a[108:111], v[172:175], v[140:143], a[108:111]
  v_mfma_f32_16x16x32_bf16 a[112:115], v[176:179], v[140:143], a[112:115]
  ds_read_b64_tr_b16 v[242:243], v10 offset:9216
  v_mfma_f32_16x16x32_bf16 a[116:119], v[180:183], v[140:143], a[116:119]
  v_mfma_f32_16x16x32_bf16 a[120:123], v[184:187], v[140:143], a[120:123]
  ds_read_b128 v[212:215], v5 offset:43008
  v_mfma_f32_16x16x32_bf16 a[124:127], v[188:191], v[140:143], a[124:127]
  s_add_u32 m0, s62, 24576
  s_nop 0
  buffer_load_dwordx4 v24, s[16:19], s42 offen  lds
  v_mfma_f32_16x16x32_bf16 a[128:131], v[160:163], v[144:147], a[128:131]
  ds_read_b64_tr_b16 v[244:245], v11 offset:8192
  v_mfma_f32_16x16x32_bf16 a[132:135], v[164:167], v[144:147], a[132:135]
  v_mfma_f32_16x16x32_bf16 a[136:139], v[168:171], v[144:147], a[136:139]
  ds_read_b64_tr_b16 v[246:247], v11 offset:9216
  v_mfma_f32_16x16x32_bf16 a[140:143], v[172:175], v[144:147], a[140:143]
  v_mfma_f32_16x16x32_bf16 a[144:147], v[176:179], v[144:147], a[144:147]
  ds_read_b128 v[216:219], v5 offset:45056
  v_mfma_f32_16x16x32_bf16 a[148:151], v[180:183], v[144:147], a[148:151]
  v_mfma_f32_16x16x32_bf16 a[152:155], v[184:187], v[144:147], a[152:155]
  s_add_u32 m0, s62, 12288
  s_nop 0
  buffer_load_dwordx4 v3, s[12:15], s43 offen  lds
  ds_read_b64_tr_b16 v[248:249], v12 offset:8192
  v_mfma_f32_16x16x32_bf16 a[156:159], v[188:191], v[144:147], a[156:159]
  v_mfma_f32_16x16x32_bf16 a[160:163], v[160:163], v[148:151], a[160:163]
  ds_read_b64_tr_b16 v[250:251], v12 offset:9216
  v_mfma_f32_16x16x32_bf16 a[164:167], v[164:167], v[148:151], a[164:167]
  v_mfma_f32_16x16x32_bf16 a[168:171], v[168:171], v[148:151], a[168:171]
  ds_read_b128 v[220:223], v5 offset:47104
  v_mfma_f32_16x16x32_bf16 a[172:175], v[172:175], v[148:151], a[172:175]
  v_mfma_f32_16x16x32_bf16 a[176:179], v[176:179], v[148:151], a[176:179]
  s_add_u32 m0, s62, 28672
  s_nop 0
  buffer_load_dwordx4 v24, s[16:19], s43 offen  lds
  v_add_u32 v3, s45, v3
  v_add_u32 v24, s45, v24
  ds_read_b64_tr_b16 v[252:253], v13 offset:8192
  v_mfma_f32_16x16x32_bf16 a[180:183], v[180:183], v[148:151], a[180:183]
  v_mfma_f32_16x16x32_bf16 a[184:187], v[184:187], v[148:151], a[184:187]
  ds_read_b64_tr_b16 v[254:255], v13 offset:9216
  v_mfma_f32_16x16x32_bf16 a[188:191], v[188:191], v[148:151], a[188:191]
  v_mfma_f32_16x16x32_bf16 a[192:195], v[160:163], v[152:155], a[192:195]
  v_mfma_f32_16x16x32_bf16 a[196:199], v[164:167], v[152:155], a[196:199]
  v_mfma_f32_16x16x32_bf16 a[200:203], v[168:171], v[152:155], a[200:203]
  v_mfma_f32_16x16x32_bf16 a[204:207], v[172:175], v[152:155], a[204:207]
  v_mfma_f32_16x16x32_bf16 a[208:211], v[176:179], v[152:155], a[208:211]
  v_mfma_f32_16x16x32_bf16 a[212:215], v[180:183], v[152:155], a[212:215]
  v_mfma_f32_16x16x32_bf16 a[216:219], v[184:187], v[152:155], a[216:219]
  v_mfma_f32_16x16x32_bf16 a[220:223], v[188:191], v[152:155], a[220:223]
  v_mfma_f32_16x16x32_bf16 a[224:227], v[160:163], v[156:159], a[224:227]
  s_add_u32 s62, s95, s97
  s_cmp_eq_u32 s97, 0x10000
  v_mfma_f32_16x16x32_bf16 a[228:231], v[164:167], v[156:159], a[228:231]
  s_cselect_b32 s63, 0xffff0000, s61
  s_add_u32 s97, s97, s63
  v_mfma_f32_16x16x32_bf16 a[232:235], v[168:171], v[156:159], a[232:235]
  v_add_u32 v6, s63, v6
  v_add_u32 v7, s63, v7
  v_mfma_f32_16x16x32_bf16 a[236:239], v[172:175], v[156:159], a[236:239]
  v_add_u32 v8, s63, v8
  v_add_u32 v9, s63, v9
  v_mfma_f32_16x16x32_bf16 a[240:243], v[176:179], v[156:159], a[240:243]
  v_add_u32 v10, s63, v10
  v_add_u32 v11, s63, v11
  v_mfma_f32_16x16x32_bf16 a[244:247], v[180:183], v[156:159], a[244:247]
  v_add_u32 v12, s63, v12
  v_add_u32 v13, s63, v13
  v_mfma_f32_16x16x32_bf16 a[248:251], v[184:187], v[156:159], a[248:251]
  v_mfma_f32_16x16x32_bf16 a[252:255], v[188:191], v[156:159], a[252:255]
  s_waitcnt vmcnt(8) lgkmcnt(0)
  s_barrier
  s_cmp_eq_u32 s55, 0
  s_cbranch_scc1 nf_50
  v_mov_b32 v14, s55
  s_mov_b64 exec, 1
  buffer_atomic_add v15, v14, s[4:7], 0 offen
  s_mov_b64 exec, -1
  s_mov_b32 s55, 0
nf_50:
  v_mfma_f32_16x16x32_bf16 a[0:3], v[224:227], v[192:195], a[0:3]
  ds_read_b128 v[128:131], v4 offset:0
  s_add_u32 m0, s95, 131072
  s_nop 0
  buffer_load_dwordx4 v2, s[8:11], s32 offen sc1 lds
  v_mfma_f32_16x16x32_bf16 a[4:7], v[228:231], v[192:195], a[4:7]
  v_mfma_f32_16x16x32_bf16 a[8:11], v[232:235], v[192:195], a[8:11]
  ds_read_b64_tr_b16 v[160:161], v6 offset:0
  v_mfma_f32_16x16x32_bf16 a[12:15], v[236:239], v[192:195], a[12:15]
  v_mfma_f32_16x16x32_bf16 a[16:19], v[240:243], v[192:195], a[16:19]
  ds_read_b64_tr_b16 v[162:163], v6 offset:1024
  v_mfma_f32_16x16x32_bf16 a[20:23], v[244:247], v[192:195], a[20:23]
  s_add_u32 m0, s95, 135168
  s_nop 0
  buffer_load_dwordx4 v2, s[8:11], s33 offen sc1 lds
  v_mfma_f32_16x16x32_bf16 a[24:27], v[248:251], v[192:195], a[24:27]
  ds_read_b128 v[132:135], v4 offset:2048
  v_mfma_f32_16x16x32_bf16 a[28:31], v[252:255], v[192:195], a[28:31]
  v_mfma_f32_16x16x32_bf16 a[32:35], v[224:227], v[196:199], a[32:35]
  ds_read_b64_tr_b16 v[164:165], v7 offset:0
  v_mfma_f32_16x16x32_bf16 a[36:39], v[228:231], v[196:199], a[36:39]
  v_mfma_f32_16x16x32_bf16 a[40:43], v[232:235], v[196:199], a[40:43]
  s_add_u32 m0, s95, 139264
  s_nop 0
  buffer_load_dwordx4 v2, s[8:11], s34 offen sc1 lds
  ds_read_b64_tr_b16 v[166:167], v7 offset:1024
  v_mfma_f32_16x16x32_bf16 a[44:47], v[236:239], v[196:199], a[44:47]
  v_mfma_f32_16x16x32_bf16 a[48:51], v[240:243], v[196:199], a[48:51]
  ds_read_b128 v[136:139], v4 offset:4096
  v_mfma_f32_16x16x32_bf16 a[52:55], v[244:247], v[196:199], a[52:55]
  v_mfma_f32_16x16x32_bf16 a[56:59], v[248:251], v[196:199], a[56:59]
  ds_read_b64_tr_b16 v[168:169], v8 offset:0
  s_add_u32 m0, s95, 143360
  s_nop 0
  buffer_load_dwordx4 v2, s[8:11], s35 offen sc1 lds
  v_mfma_f32_16x16x32_bf16 a[60:63], v[252:255], v[196:199], a[60:63]
  v_mfma_f32_16x16x32_bf16 a[64:67], v[224:227], v[200:203], a[64:67]
  ds_read_b64_tr_b16 v[170:171], v8 offset:1024
  v_mfma_f32_16x16x32_bf16 a[68:71], v[228:231], v[200:203], a[68:71]
  v_mfma_f32_16x16x32_bf16 a[72:75], v[232:235], v[200:203], a[72:75]
  ds_read_b128 v[140:143], v4 offset:6144
  v_mfma_f32_16x16x32_bf16 a[76:79], v[236:239], v[200:203], a[76:79]
  s_add_u32 m0, s95, 147456
  s_nop 0
  buffer_load_dwordx4 v2, s[8:11], s36 offen sc1 lds
  v_mfma_f32_16x16x32_bf16 a[80:83], v[240:243], v[200:203], a[80:83]
  ds_read_b64_tr_b16 v[172:173], v9 offset:0
  v_mfma_f32_16x16x32_bf16 a[84:87], v[244:247], v[200:203], a[84:87]
  v_mfma_f32_16x16x32_bf16 a[88:91], v[248:251], v[200:203], a[88:91]
  ds_read_b64_tr_b16 v[174:175], v9 offset:1024
  v_mfma_f32_16x16x32_bf16 a[92:95], v[252:255], v[200:203], a[92:95]
  v_mfma_f32_16x16x32_bf16 a[96:99], v[224:227], v[204:207], a[96:99]
  s_add_u32 m0, s95, 151552
  s_nop 0
  buffer_load_dwordx4 v2, s[8:11], s37 offen sc1 lds
  ds_read_b128 v[144:147], v4 offset:8192
  v_mfma_f32_16x16x32_bf16 a[100:103], v[228:231], v[204:207], a[100:103]
  v_mfma_f32_16x16x32_bf16 a[104:107], v[232:235], v[204:207], a[104:107]
  ds_read_b64_tr_b16 v[176:177], v10 offset:0
  v_mfma_f32_16x16x32_bf16 a[108:111], v[236:239], v[204:207], a[108:111]
  v_mfma_f32_16x16x32_bf16 a[112:115], v[240:243], v[204:207], a[112:115]
  ds_read_b64_tr_b16 v[178:179], v10 offset:1024
  s_add_u32 m0, s95, 155648
  s_nop 0
  buffer_load_dwordx4 v2, s[8:11], s38 offen sc1 lds
  v_mfma_f32_16x16x32_bf16 a[116:119], v[244:247], v[204:207], a[116:119]
  v_mfma_f32_16x16x32_bf16 a[120:123], v[248:251], v[204:207], a[120:123]
  ds_read_b128 v[148:151], v4 offset:10240
  v_mfma_f32_16x16x32_bf16 a[124:127], v[252:255], v[204:207], a[124:127]
  v_mfma_f32_16x16x32_bf16 a[128:131], v[224:227], v[208:211], a[128:131]
  ds_read_b64_tr_b16 v[180:181], v11 offset:0
  v_mfma_f32_16x16x32_bf16 a[132:135], v[228:231], v[208:211], a[132:135]
  s_add_u32 m0, s95, 159744
  s_nop 0
  buffer_load_dwordx4 v2, s[8:11], s39 offen sc1 lds
  v_add_u32 v2, s44, v2
  v_mfma_f32_16x16x32_bf16 a[136:139], v[232:235], v[208:211], a[136:139]
  ds_read_b64_tr_b16 v[182:183], v11 offset:1024
  v_mfma_f32_16x16x32_bf16 a[140:143], v[236:239], v[208:211], a[140:143]
  v_mfma_f32_16x16x32_bf16 a[144:147], v[240:243], v[208:211], a[144:147]
  ds_read_b128 v[152:155], v4 offset:12288
  v_mfma_f32_16x16x32_bf16 a[148:151], v[244:247], v[208:211], a[148:151]
  v_mfma_f32_16x16x32_bf16 a[152:155], v[248:251], v[208:211], a[152:155]
  ds_read_b64_tr_b16 v[184:185], v12 offset:0
  v_mfma_f32_16x16x32_bf16 a[156:159], v[252:255], v[208:211], a[156:159]
  v_mfma_f32_16x16x32_bf16 a[160:163], v[224:227], v[212:215], a[160:163]
  ds_read_b64_tr_b16 v[186:187], v12 offset:1024
  v_mfma_f32_16x16x32_bf16 a[164:167], v[228:231], v[212:215], a[164:167]
  v_mfma_f32_16x16x32_bf16 a[168:171], v[232:235], v[212:215], a[168:171]
  ds_read_b128 v[156:159], v4 offset:14336
  v_mfma_f32_16x16x32_bf16 a[172:175], v[236:239], v[212:215], a[172:175]
  v_mfma_f32_16x16x32_bf16 a[176:179], v[240:243], v[212:215], a[176:179]
  ds_read_b64_tr_b16 v[188:189], v13 offset:0
  v_mfma_f32_16x16x32_bf16 a[180:183], v[244:247], v[212:215], a[180:183]
  v_mfma_f32_16x16x32_bf16 a[184:187], v[248:251], v[212:215], a[184:187]
  ds_read_b64_tr_b16 v[190:191], v13 offset:1024
  v_mfma_f32_16x16x32_bf16 a[188:191], v[252:255], v[212:215], a[188:191]
  v_mfma_f32_16x16x32_bf16 a[192:195], v[224:227], v[216:219], a[192:195]
  v_mfma_f32_16x16x32_bf16 a[196:199], v[228:231], v[216:219], a[196:199]
  v_mfma_f32_16x16x32_bf16 a[200:203], v[232:235], v[216:219], a[200:203]
  v_mfma_f32_16x16x32_bf16 a[204:207], v[236:239], v[216:219], a[204:207]
  v_mfma_f32_16x16x32_bf16 a[208:211], v[240:243], v[216:219], a[208:211]
  v_mfma_f32_16x16x32_bf16 a[212:215], v[244:247], v[216:219], a[212:215]
  v_mfma_f32_16x16x32_bf16 a[216:219], v[248:251], v[216:219], a[216:219]
  v_mfma_f32_16x16x32_bf16 a[220:223], v[252:255], v[216:219], a[220:223]
  v_mfma_f32_16x16x32_bf16 a[224:227], v[224:227], v[220:223], a[224:227]
  v_mfma_f32_16x16x32_bf16 a[228:231], v[228:231], v[220:223], a[228:231]
  v_mfma_f32_16x16x32_bf16 a[232:235], v[232:235], v[220:223], a[232:235]
  v_mfma_f32_16x16x32_bf16 a[236:239], v[236:239], v[220:223], a[236:239]
  v_mfma_f32_16x16x32_bf16 a[240:243], v[240:243], v[220:223], a[240:243]
  v_mfma_f32_16x16x32_bf16 a[244:247], v[244:247], v[220:223], a[244:247]
  v_mfma_f32_16x16x32_bf16 a[248:251], v[248:251], v[220:223], a[248:251]
  v_mfma_f32_16x16x32_bf16 a[252:255], v[252:255], v[220:223], a[252:255]
  s_waitcnt lgkmcnt(0)
G_l_bs_l:
  v_mfma_f32_16x16x32_bf16 a[0:3], v[160:163], v[128:131], a[0:3]
  ds_read_b128 v[192:195], v5 offset:0
  s_add_u32 m0, s62, 0
  s_nop 0
  buffer_load_dwordx4 v3, s[12:15], s40 offen  lds
  v_mfma_f32_16x16x32_bf16 a[4:7], v[164:167], v[128:131], a[4:7]
  v_mfma_f32_16x16x32_bf16 a[8:11], v[168:171], v[128:131], a[8:11]
  ds_read_b64_tr_b16 v[224:225], v6 offset:8192
  v_mfma_f32_16x16x32_bf16 a[12:15], v[172:175], v[128:131], a[12:15]
  v_mfma_f32_16x16x32_bf16 a[16:19], v[176:179], v[128:131], a[16:19]
  ds_read_b64_tr_b16 v[226:227], v6 offset:9216
  v_mfma_f32_16x16x32_bf16 a[20:23], v[180:183], v[128:131], a[20:23]
  v_mfma_f32_16x16x32_bf16 a[24:27], v[184:187], v[128:131], a[24:27]
  ds_read_b128 v[196:199], v5 offset:2048
  s_add_u32 m0, s62, 16384
  s_nop 0
  buffer_load_dwordx4 v24, s[16:19], s40 offen  lds
  v_mfma_f32_16x16x32_bf16 a[28:31], v[188:191], v[128:131], a[28:31]
  v_mfma_f32_16x16x32_bf16 a[32:35], v[160:163], v[132:135], a[32:35]
  ds_read_b64_tr_b16 v[228:229], v7 offset:8192
  v_mfma_f32_16x16x32_bf16 a[36:39], v[164:167], v[132:135], a[36:39]
  v_mfma_f32_16x16x32_bf16 a[40:43], v[168:171], v[132:135], a[40:43]
  ds_read_b64_tr_b16 v[230:231], v7 offset:9216
  v_mfma_f32_16x16x32_bf16 a[44:47], v[172:175], v[132:135], a[44:47]
  v_mfma_f32_16x16x32_bf16 a[48:51], v[176:179], v[132:135], a[48:51]
  ds_read_b128 v[200:203], v5 offset:4096
  s_add_u32 m0, s62, 4096
  s_nop 0
  buffer_load_dwordx4 v3, s[12:15], s41 offen  lds
  v_mfma_f32_16x16x32_bf16 a[52:55], v[180:183], v[132:135], a[52:55]
  v_mfma_f32_16x16x32_bf16 a[56:59], v[184:187], v[132:135], a[56:59]
  ds_read_b64_tr_b16 v[232:233], v8 offset:8192
  v_mfma_f32_16x16x32_bf16 a[60:63], v[188:191], v[132:135], a[60:63]
  v_mfma_f32_16x16x32_bf16 a[64:67], v[160:163], v[136:139], a[64:67]
  ds_read_b64_tr_b16 v[234:235], v8 offset:9216
  v_mfma_f32_16x16x32_bf16 a[68:71], v[164:167], v[136:139], a[68:71]
  v_mfma_f32_16x16x32_bf16 a[72:75], v[168:171], v[136:139], a[72:75]
  ds_read_b128 v[204:207], v5 offset:6144
  v_mfma_f32_16x16x32_bf16 a[76:79], v[172:175], v[136:139], a[76:79]
  s_add_u32 m0, s62, 20480
  s_nop 0
  buffer_load_dwordx4 v24, s[16:19], s41 offen  lds
  v_mfma_f32_16x16x32_bf16 a[80:83], v[176:179], v[136:139], a[80:83]
  ds_read_b64_tr_b16 v[236:237], v9 offset:8192
  v_mfma_f32_16x16x32_bf16 a[84:87], v[180:183], v[136:139], a[84:87]
  v_mfma_f32_16x16x32_bf16 a[88:91], v[184:187], v[136:139], a[88:91]
  ds_read_b64_tr_b16 v[238:239], v9 offset:9216
  v_mfma_f32_16x16x32_bf16 a[92:95], v[188:191], v[136:139], a[92:95]
  v_mfma_f32_16x16x32_bf16 a[96:99], v[160:163], v[140:143], a[96:99]
  ds_read_b128 v[208:211], v5 offset:8192
  v_mfma_f32_16x16x32_bf16 a[100:103], v[164:167], v[140:143], a[100:103]
  s_add_u32 m0, s62, 8192
  s_nop 0
  buffer_load_dwordx4 v3, s[12:15], s42 offen  lds
  v_mfma_f32_16x16x32_bf16 a[104:107], v[168:171], v[140:143], a[104:107]
  ds_read_b64_tr_b16 v[240:241], v10 offset:8192
  v_mfma_f32_16x16x32_bf16 a[108:111], v[172:175], v[140:143], a[108:111]
  v_mfma_f32_16x16x32_bf16 a[112:115], v[176:179], v[140:143], a[112:115]
  ds_read_b64_tr_b16 v[242:243], v10 offset:9216
  v_mfma_f32_16x16x32_bf16 a[116:119], v[180:183], v[140:143], a[116:119]
  v_mfma_f32_16x16x32_bf16 a[120:123], v[184:187], v[140:143], a[120:123]
  ds_read_b128 v[212:215], v5 offset:10240
  v_mfma_f32_16x16x32_bf16 a[124:127], v[188:191], v[140:143], a[124:127]
  s_add_u32 m0, s62, 24576
  s_nop 0
  buffer_load_dwordx4 v24, s[16:19], s42 offen  lds
  v_mfma_f32_16x16x32_bf16 a[128:131], v[160:163], v[144:147], a[128:131]
  ds_read_b64_tr_b16 v[244:245], v11 offset:8192
  v_mfma_f32_16x16x32_bf16 a[132:135], v[164:167], v[144:147], a[132:135]
  v_mfma_f32_16x16x32_bf16 a[136:139], v[168:171], v[144:147], a[136:139]
  ds_read_b64_tr_b16 v[246:247], v11 offset:9216
  v_mfma_f32_16x16x32_bf16 a[140:143], v[172:175], v[144:147], a[140:143]
  v_mfma_f32_16x16x32_bf16 a[144:147], v[176:179], v[144:147], a[144:147]
  ds_read_b128 v[216:219], v5 offset:12288
  v_mfma_f32_16x16x32_bf16 a[148:151], v[180:183], v[144:147], a[148:151]
  v_mfma_f32_16x16x32_bf16 a[152:155], v[184:187], v[144:147], a[152:155]
  s_add_u32 m0, s62, 12288
  s_nop 0
  buffer_load_dwordx4 v3, s[12:15], s43 offen  lds
  ds_read_b64_tr_b16 v[248:249], v12 offset:8192
  v_mfma_f32_16x16x32_bf16 a[156:159], v[188:191], v[144:147], a[156:159]
  v_mfma_f32_16x16x32_bf16 a[160:163], v[160:163], v[148:151], a[160:163]
  ds_read_b64_tr_b16 v[250:251], v12 offset:9216
  v_mfma_f32_16x16x32_bf16 a[164:167], v[164:167], v[148:151], a[164:167]
  v_mfma_f32_16x16x32_bf16 a[168:171], v[168:171], v[148:151], a[168:171]
  ds_read_b128 v[220:223], v5 offset:14336
  v_mfma_f32_16x16x32_bf16 a[172:175], v[172:175], v[148:151], a[172:175]
  v_mfma_f32_16x16x32_bf16 a[176:179], v[176:179], v[148:151], a[176:179]
  s_add_u32 m0, s62, 28672
  s_nop 0
  buffer_load_dwordx4 v24, s[16:19], s43 offen  lds
  v_add_u32 v3, s45, v3
  v_add_u32 v24, s45, v24
  ds_read_b64_tr_b16 v[252:253], v13 offset:8192
  v_mfma_f32_16x16x32_bf16 a[180:183], v[180:183], v[148:151], a[180:183]
  v_mfma_f32_16x16x32_bf16 a[184:187], v[184:187], v[148:151], a[184:187]
  ds_read_b64_tr_b16 v[254:255], v13 offset:9216
  v_mfma_f32_16x16x32_bf16 a[188:191], v[188:191], v[148:151], a[188:191]
  v_mfma_f32_16x16x32_bf16 a[192:195], v[160:163], v[152:155], a[192:195]
  v_mfma_f32_16x16x32_bf16 a[196:199], v[164:167], v[152:155], a[196:199]
  v_mfma_f32_16x16x32_bf16 a[200:203], v[168:171], v[152:155], a[200:203]
  v_mfma_f32_16x16x32_bf16 a[204:207], v[172:175], v[152:155], a[204:207]
  v_mfma_f32_16x16x32_bf16 a[208:211], v[176:179], v[152:155], a[208:211]
  v_mfma_f32_16x16x32_bf16 a[212:215], v[180:183], v[152:155], a[212:215]
  v_mfma_f32_16x16x32_bf16 a[216:219], v[184:187], v[152:155], a[216:219]
  v_mfma_f32_16x16x32_bf16 a[220:223], v[188:191], v[152:155], a[220:223]
  v_mfma_f32_16x16x32_bf16 a[224:227], v[160:163], v[156:159], a[224:227]
  s_add_u32 s62, s95, s97
  s_cmp_eq_u32 s97, 0x10000
  v_mfma_f32_16x16x32_bf16 a[228:231], v[164:167], v[156:159], a[228:231]
  s_cselect_b32 s63, 0xffff0000, s61
  s_add_u32 s97, s97, s63
  v_mfma_f32_16x16x32_bf16 a[232:235], v[168:171], v[156:159], a[232:235]
  v_add_u32 v6, s63, v6
  v_add_u32 v7, s63, v7
  v_mfma_f32_16x16x32_bf16 a[236:239], v[172:175], v[156:159], a[236:239]
  v_add_u32 v8, s63, v8
  v_add_u32 v9, s63, v9
  v_mfma_f32_16x16x32_bf16 a[240:243], v[176:179], v[156:159], a[240:243]
  v_add_u32 v10, s63, v10
  v_add_u32 v11, s63, v11
  v_mfma_f32_16x16x32_bf16 a[244:247], v[180:183], v[156:159], a[244:247]
  v_add_u32 v12, s63, v12
  v_add_u32 v13, s63, v13
  v_mfma_f32_16x16x32_bf16 a[248:251], v[184:187], v[156:159], a[248:251]
  v_mfma_f32_16x16x32_bf16 a[252:255], v[188:191], v[156:159], a[252:255]
  s_waitcnt vmcnt(8) lgkmcnt(0)
  s_barrier
  v_mfma_f32_16x16x32_bf16 a[0:3], v[224:227], v[192:195], a[0:3]
  ds_read_b128 v[128:131], v4 offset:32768
  s_add_u32 m0, s95, 98304
  s_nop 0
  buffer_load_dwordx4 v2, s[8:11], s32 offen sc1 lds
  v_mfma_f32_16x16x32_bf16 a[4:7], v[228:231], v[192:195], a[4:7]
  v_mfma_f32_16x16x32_bf16 a[8:11], v[232:235], v[192:195], a[8:11]
  ds_read_b64_tr_b16 v[160:161], v6 offset:0
  v_mfma_f32_16x16x32_bf16 a[12:15], v[236:239], v[192:195], a[12:15]
  v_mfma_f32_16x16x32_bf16 a[16:19], v[240:243], v[192:195], a[16:19]
  ds_read_b64_tr_b16 v[162:163], v6 offset:1024
  v_mfma_f32_16x16x32_bf16 a[20:23], v[244:247], v[192:195], a[20:23]
  s_add_u32 m0, s95, 102400
  s_nop 0
  buffer_load_dwordx4 v2, s[8:11], s33 offen sc1 lds
  v_mfma_f32_16x16x32_bf16 a[24:27], v[248:251], v[192:195], a[24:27]
  ds_read_b128 v[132:135], v4 offset:34816
  v_mfma_f32_16x16x32_bf16 a[28:31], v[252:255], v[192:195], a[28:31]
  v_mfma_f32_16x16x32_bf16 a[32:35], v[224:227], v[196:199], a[32:35]
  ds_read_b64_tr_b16 v[164:165], v7 offset:0
  v_mfma_f32_16x16x32_bf16 a[36:39], v[228:231], v[196:199], a[36:39]
  v_mfma_f32_16x16x32_bf16 a[40:43], v[232:235], v[196:199], a[40:43]
  s_add_u32 m0, s95, 106496
  s_nop 0
  buffer_load_dwordx4 v2, s[8:11], s34 offen sc1 lds
  ds_read_b64_tr_b16 v[166:167], v7 offset:1024
  v_mfma_f32_16x16x32_bf16 a[44:47], v[236:239], v[196:199], a[44:47]
  v_mfma_f32_16x16x32_bf16 a[48:51], v[240:243], v[196:199], a[48:51]
  ds_read_b128 v[136:139], v4 offset:36864
  v_mfma_f32_16x16x32_bf16 a[52:55], v[244:247], v[196:199], a[52:55]
  v_mfma_f32_16x16x32_bf16 a[56:59], v[248:251], v[196:199], a[56:59]
  ds_read_b64_tr_b16 v[168:169], v8 offset:0
  s_add_u32 m0, s95, 110592
  s_nop 0
  buffer_load_dwordx4 v2, s[8:11], s35 offen sc1 lds
  v_mfma_f32_16x16x32_bf16 a[60:63], v[252:255], v[196:199], a[60:63]
  v_mfma_f32_16x16x32_bf16 a[64:67], v[224:227], v[200:203], a[64:67]
  ds_read_b64_tr_b16 v[170:171], v8 offset:1024
  v_mfma_f32_16x16x32_bf16 a[68:71], v[228:231], v[200:203], a[68:71]
  v_mfma_f32_16x16x32_bf16 a[72:75], v[232:235], v[200:203], a[72:75]
  ds_read_b128 v[140:143], v4 offset:38912
  v_mfma_f32_16x16x32_bf16 a[76:79], v[236:239], v[200:203], a[76:79]
  s_add_u32 m0, s95, 114688
  s_nop 0
  buffer_load_dwordx4 v2, s[8:11], s36 offen sc1 lds
  v_mfma_f32_16x16x32_bf16 a[80:83], v[240:243], v[200:203], a[80:83]
  ds_read_b64_tr_b16 v[172:173], v9 offset:0
  v_mfma_f32_16x16x32_bf16 a[84:87], v[244:247], v[200:203], a[84:87]
  v_mfma_f32_16x16x32_bf16 a[88:91], v[248:251], v[200:203], a[88:91]
  ds_read_b64_tr_b16 v[174:175], v9 offset:1024
  v_mfma_f32_16x16x32_bf16 a[92:95], v[252:255], v[200:203], a[92:95]
  v_mfma_f32_16x16x32_bf16 a[96:99], v[224:227], v[204:207], a[96:99]
  s_add_u32 m0, s95, 118784
  s_nop 0
  buffer_load_dwordx4 v2, s[8:11], s37 offen sc1 lds
  ds_read_b128 v[144:147], v4 offset:40960
  v_mfma_f32_16x16x32_bf16 a[100:103], v[228:231], v[204:207], a[100:103]
  v_mfma_f32_16x16x32_bf16 a[104:107], v[232:235], v[204:207], a[104:107]
  ds_read_b64_tr_b16 v[176:177], v10 offset:0
  v_mfma_f32_16x16x32_bf16 a[108:111], v[236:239], v[204:207], a[108:111]
  v_mfma_f32_16x16x32_bf16 a[112:115], v[240:243], v[204:207], a[112:115]
  ds_read_b64_tr_b16 v[178:179], v10 offset:1024
  s_add_u32 m0, s95, 122880
  s_nop 0
  buffer_load_dwordx4 v2, s[8:11], s38 offen sc1 lds
  v_mfma_f32_16x16x32_bf16 a[116:119], v[244:247], v[204:207], a[116:119]
  v_mfma_f32_16x16x32_bf16 a[120:123], v[248:251], v[204:207], a[120:123]
  ds_read_b128 v[148:151], v4 offset:43008
  v_mfma_f32_16x16x32_bf16 a[124:127], v[252:255], v[204:207], a[124:127]
  v_mfma_f32_16x16x32_bf16 a[128:131], v[224:227], v[208:211], a[128:131]
  ds_read_b64_tr_b16 v[180:181], v11 offset:0
  v_mfma_f32_16x16x32_bf16 a[132:135], v[228:231], v[208:211], a[132:135]
  s_add_u32 m0, s95, 126976
  s_nop 0
  buffer_load_dwordx4 v2, s[8:11], s39 offen sc1 lds
  v_add_u32 v2, s44, v2
  v_mfma_f32_16x16x32_bf16 a[136:139], v[232:235], v[208:211], a[136:139]
  ds_read_b64_tr_b16 v[182:183], v11 offset:1024
  v_mfma_f32_16x16x32_bf16 a[140:143], v[236:239], v[208:211], a[140:143]
  v_mfma_f32_16x16x32_bf16 a[144:147], v[240:243], v[208:211], a[144:147]
  ds_read_b128 v[152:155], v4 offset:45056
  v_mfma_f32_16x16x32_bf16 a[148:151], v[244:247], v[208:211], a[148:151]
  v_mfma_f32_16x16x32_bf16 a[152:155], v[248:251], v[208:211], a[152:155]
  ds_read_b64_tr_b16 v[184:185], v12 offset:0
  v_mfma_f32_16x16x32_bf16 a[156:159], v[252:255], v[208:211], a[156:159]
  v_mfma_f32_16x16x32_bf16 a[160:163], v[224:227], v[212:215], a[160:163]
  ds_read_b64_tr_b16 v[186:187], v12 offset:1024
  v_mfma_f32_16x16x32_bf16 a[164:167], v[228:231], v[212:215], a[164:167]
  v_mfma_f32_16x16x32_bf16 a[168:171], v[232:235], v[212:215], a[168:171]
  ds_read_b128 v[156:159], v4 offset:47104
  v_mfma_f32_16x16x32_bf16 a[172:175], v[236:239], v[212:215], a[172:175]
  v_mfma_f32_16x16x32_bf16 a[176:179], v[240:243], v[212:215], a[176:179]
  ds_read_b64_tr_b16 v[188:189], v13 offset:0
  v_mfma_f32_16x16x32_bf16 a[180:183], v[244:247], v[212:215], a[180:183]
  v_mfma_f32_16x16x32_bf16 a[184:187], v[248:251], v[212:215], a[184:187]
  ds_read_b64_tr_b16 v[190:191], v13 offset:1024
  v_mfma_f32_16x16x32_bf16 a[188:191], v[252:255], v[212:215], a[188:191]
  v_mfma_f32_16x16x32_bf16 a[192:195], v[224:227], v[216:219], a[192:195]
  v_mfma_f32_16x16x32_bf16 a[196:199], v[228:231], v[216:219], a[196:199]
  v_mfma_f32_16x16x32_bf16 a[200:203], v[232:235], v[216:219], a[200:203]
  v_mfma_f32_16x16x32_bf16 a[204:207], v[236:239], v[216:219], a[204:207]
  v_mfma_f32_16x16x32_bf16 a[208:211], v[240:243], v[216:219], a[208:211]
  v_mfma_f32_16x16x32_bf16 a[212:215], v[244:247], v[216:219], a[212:215]
  v_mfma_f32_16x16x32_bf16 a[216:219], v[248:251], v[216:219], a[216:219]
  v_mfma_f32_16x16x32_bf16 a[220:223], v[252:255], v[216:219], a[220:223]
  v_mfma_f32_16x16x32_bf16 a[224:227], v[224:227], v[220:223], a[224:227]
  v_mfma_f32_16x16x32_bf16 a[228:231], v[228:231], v[220:223], a[228:231]
  v_mfma_f32_16x16x32_bf16 a[232:235], v[232:235], v[220:223], a[232:235]
  v_mfma_f32_16x16x32_bf16 a[236:239], v[236:239], v[220:223], a[236:239]
  v_mfma_f32_16x16x32_bf16 a[240:243], v[240:243], v[220:223], a[240:243]
  v_mfma_f32_16x16x32_bf16 a[244:247], v[244:247], v[220:223], a[244:247]
  v_mfma_f32_16x16x32_bf16 a[248:251], v[248:251], v[220:223], a[248:251]
  v_mfma_f32_16x16x32_bf16 a[252:255], v[252:255], v[220:223], a[252:255]
  s_waitcnt lgkmcnt(0)
  v_mfma_f32_16x16x32_bf16 a[0:3], v[160:163], v[128:131], a[0:3]
  ds_read_b128 v[192:195], v5 offset:32768
  s_add_u32 m0, s62, 0
  s_nop 0
  buffer_load_dwordx4 v3, s[12:15], s40 offen  lds
  v_mfma_f32_16x16x32_bf16 a[4:7], v[164:167], v[128:131], a[4:7]
  v_mfma_f32_16x16x32_bf16 a[8:11], v[168:171], v[128:131], a[8:11]
  ds_read_b64_tr_b16 v[224:225], v6 offset:8192
  v_mfma_f32_16x16x32_bf16 a[12:15], v[172:175], v[128:131], a[12:15]
  v_mfma_f32_16x16x32_bf16 a[16:19], v[176:179], v[128:131], a[16:19]
  ds_read_b64_tr_b16 v[226:227], v6 offset:9216
  v_mfma_f32_16x16x32_bf16 a[20:23], v[180:183], v[128:131], a[20:23]
  v_mfma_f32_16x16x32_bf16 a[24:27], v[184:187], v[128:131], a[24:27]
  ds_read_b128 v[196:199], v5 offset:34816
  s_add_u32 m0, s62, 16384
  s_nop 0
  buffer_load_dwordx4 v24, s[16:19], s40 offen  lds
  v_mfma_f32_16x16x32_bf16 a[28:31], v[188:191], v[128:131], a[28:31]
  v_mfma_f32_16x16x32_bf16 a[32:35], v[160:163], v[132:135], a[32:35]
  ds_read_b64_tr_b16 v[228:229], v7 offset:8192
  v_mfma_f32_16x16x32_bf16 a[36:39], v[164:167], v[132:135], a[36:39]
  v_mfma_f32_16x16x32_bf16 a[40:43], v[168:171], v[132:135], a[40:43]
  ds_read_b64_tr_b16 v[230:231], v7 offset:9216
  v_mfma_f32_16x16x32_bf16 a[44:47], v[172:175], v[132:135], a[44:47]
  v_mfma_f32_16x16x32_bf16 a[48:51], v[176:179], v[132:135], a[48:51]
  ds_read_b128 v[200:203], v5 offset:36864
  s_add_u32 m0, s62, 4096
  s_nop 0
  buffer_load_dwordx4 v3, s[12:15], s41 offen  lds
  v_mfma_f32_16x16x32_bf16 a[52:55], v[180:183], v[132:135], a[52:55]
  v_mfma_f32_16x16x32_bf16 a[56:59], v[184:187], v[132:135], a[56:59]
  ds_read_b64_tr_b16 v[232:233], v8 offset:8192
  v_mfma_f32_16x16x32_bf16 a[60:63], v[188:191], v[132:135], a[60:63]
  v_mfma_f32_16x16x32_bf16 a[64:67], v[160:163], v[136:139], a[64:67]
  ds_read_b64_tr_b16 v[234:235], v8 offset:9216
  v_mfma_f32_16x16x32_bf16 a[68:71], v[164:167], v[136:139], a[68:71]
  v_mfma_f32_16x16x32_bf16 a[72:75], v[168:171], v[136:139], a[72:75]
  ds_read_b128 v[204:207], v5 offset:38912
  v_mfma_f32_16x16x32_bf16 a[76:79], v[172:175], v[136:139], a[76:79]
  s_add_u32 m0, s62, 20480
  s_nop 0
  buffer_load_dwordx4 v24, s[16:19], s41 offen  lds
  v_mfma_f32_16x16x32_bf16 a[80:83], v[176:179], v[136:139], a[80:83]
  ds_read_b64_tr_b16 v[236:237], v9 offset:8192
  v_mfma_f32_16x16x32_bf16 a[84:87], v[180:183], v[136:139], a[84:87]
  v_mfma_f32_16x16x32_bf16 a[88:91], v[184:187], v[136:139], a[88:91]
  ds_read_b64_tr_b16 v[238:239], v9 offset:9216
  v_mfma_f32_16x16x32_bf16 a[92:95], v[188:191], v[136:139], a[92:95]
  v_mfma_f32_16x16x32_bf16 a[96:99], v[160:163], v[140:143], a[96:99]
  ds_read_b128 v[208:211], v5 offset:40960
  v_mfma_f32_16x16x32_bf16 a[100:103], v[164:167], v[140:143], a[100:103]
  s_add_u32 m0, s62, 8192
  s_nop 0
  buffer_load_dwordx4 v3, s[12:15], s42 offen  lds
  v_mfma_f32_16x16x32_bf16 a[104:107], v[168:171], v[140:143], a[104:107]
  ds_read_b64_tr_b16 v[240:241], v10 offset:8192
  v_mfma_f32_16x16x32_bf16 a[108:111], v[172:175], v[140:143], a[108:111]
  v_mfma_f32_16x16x32_bf16 a[112:115], v[176:179], v[140:143], a[112:115]
  ds_read_b64_tr_b16 v[242:243], v10 offset:9216
  v_mfma_f32_16x16x32_bf16 a[116:119], v[180:183], v[140:143], a[116:119]
  v_mfma_f32_16x16x32_bf16 a[120:123], v[184:187], v[140:143], a[120:123]
  ds_read_b128 v[212:215], v5 offset:43008
  v_mfma_f32_16x16x32_bf16 a[124:127], v[188:191], v[140:143], a[124:127]
  s_add_u32 m0, s62, 24576
  s_nop 0
  buffer_load_dwordx4 v24, s[16:19], s42 offen  lds
  v_mfma_f32_16x16x32_bf16 a[128:131], v[160:163], v[144:147], a[128:131]
  ds_read_b64_tr_b16 v[244:245], v11 offset:8192
  v_mfma_f32_16x16x32_bf16 a[132:135], v[164:167], v[144:147], a[132:135]
  v_mfma_f32_16x16x32_bf16 a[136:139], v[168:171], v[144:147], a[136:139]
  ds_read_b64_tr_b16 v[246:247], v11 offset:9216
  v_mfma_f32_16x16x32_bf16 a[140:143], v[172:175], v[144:147], a[140:143]
  v_mfma_f32_16x16x32_bf16 a[144:147], v[176:179], v[144:147], a[144:147]
  ds_read_b128 v[216:219], v5 offset:45056
  v_mfma_f32_16x16x32_bf16 a[148:151], v[180:183], v[144:147], a[148:151]
  v_mfma_f32_16x16x32_bf16 a[152:155], v[184:187], v[144:147], a[152:155]
  s_add_u32 m0, s62, 12288
  s_nop 0
  buffer_load_dwordx4 v3, s[12:15], s43 offen  lds
  ds_read_b64_tr_b16 v[248:249], v12 offset:8192
  v_mfma_f32_16x16x32_bf16 a[156:159], v[188:191], v[144:147], a[156:159]
  v_mfma_f32_16x16x32_bf16 a[160:163], v[160:163], v[148:151], a[160:163]
  ds_read_b64_tr_b16 v[250:251], v12 offset:9216
  v_mfma_f32_16x16x32_bf16 a[164:167], v[164:167], v[148:151], a[164:167]
  v_mfma_f32_16x16x32_bf16 a[168:171], v[168:171], v[148:151], a[168:171]
  ds_read_b128 v[220:223], v5 offset:47104
  v_mfma_f32_16x16x32_bf16 a[172:175], v[172:175], v[148:151], a[172:175]
  v_mfma_f32_16x16x32_bf16 a[176:179], v[176:179], v[148:151], a[176:179]
  s_add_u32 m0, s62, 28672
  s_nop 0
  buffer_load_dwordx4 v24, s[16:19], s43 offen  lds
  v_add_u32 v3, s45, v3
  v_add_u32 v24, s45, v24
  ds_read_b64_tr_b16 v[252:253], v13 offset:8192
  v_mfma_f32_16x16x32_bf16 a[180:183], v[180:183], v[148:151], a[180:183]
  v_mfma_f32_16x16x32_bf16 a[184:187], v[184:187], v[148:151], a[184:187]
  ds_read_b64_tr_b16 v[254:255], v13 offset:9216
  v_mfma_f32_16x16x32_bf16 a[188:191], v[188:191], v[148:151], a[188:191]
  v_mfma_f32_16x16x32_bf16 a[192:195], v[160:163], v[152:155], a[192:195]
  v_mfma_f32_16x16x32_bf16 a[196:199], v[164:167], v[152:155], a[196:199]
  v_mfma_f32_16x16x32_bf16 a[200:203], v[168:171], v[152:155], a[200:203]
  v_mfma_f32_16x16x32_bf16 a[204:207], v[172:175], v[152:155], a[204:207]
  v_mfma_f32_16x16x32_bf16 a[208:211], v[176:179], v[152:155], a[208:211]
  v_mfma_f32_16x16x32_bf16 a[212:215], v[180:183], v[152:155], a[212:215]
  v_mfma_f32_16x16x32_bf16 a[216:219], v[184:187], v[152:155], a[216:219]
  v_mfma_f32_16x16x32_bf16 a[220:223], v[188:191], v[152:155], a[220:223]
  v_mfma_f32_16x16x32_bf16 a[224:227], v[160:163], v[156:159], a[224:227]
  s_add_u32 s62, s95, s97
  s_cmp_eq_u32 s97, 0x10000
  v_mfma_f32_16x16x32_bf16 a[228:231], v[164:167], v[156:159], a[228:231]
  s_cselect_b32 s63, 0xffff0000, s61
  s_add_u32 s97, s97, s63
  v_mfma_f32_16x16x32_bf16 a[232:235], v[168:171], v[156:159], a[232:235]
  v_add_u32 v6, s63, v6
  v_add_u32 v7, s63, v7
  v_mfma_f32_16x16x32_bf16 a[236:239], v[172:175], v[156:159], a[236:239]
  v_add_u32 v8, s63, v8
  v_add_u32 v9, s63, v9
  v_mfma_f32_16x16x32_bf16 a[240:243], v[176:179], v[156:159], a[240:243]
  v_add_u32 v10, s63, v10
  v_add_u32 v11, s63, v11
  v_mfma_f32_16x16x32_bf16 a[244:247], v[180:183], v[156:159], a[244:247]
  v_add_u32 v12, s63, v12
  v_add_u32 v13, s63, v13
  v_mfma_f32_16x16x32_bf16 a[248:251], v[184:187], v[156:159], a[248:251]
  v_mfma_f32_16x16x32_bf16 a[252:255], v[188:191], v[156:159], a[252:255]
  s_waitcnt vmcnt(8) lgkmcnt(0)
  s_barrier
  v_mfma_f32_16x16x32_bf16 a[0:3], v[224:227], v[192:195], a[0:3]
  ds_read_b128 v[128:131], v4 offset:0
  s_add_u32 m0, s95, 131072
  s_nop 0
  buffer_load_dwordx4 v2, s[8:11], s32 offen sc1 lds
  v_mfma_f32_16x16x32_bf16 a[4:7], v[228:231], v[192:195], a[4:7]
  v_mfma_f32_16x16x32_bf16 a[8:11], v[232:235], v[192:195], a[8:11]
  ds_read_b64_tr_b16 v[160:161], v6 offset:0
  v_mfma_f32_16x16x32_bf16 a[12:15], v[236:239], v[192:195], a[12:15]
  v_mfma_f32_16x16x32_bf16 a[16:19], v[240:243], v[192:195], a[16:19]
  ds_read_b64_tr_b16 v[162:163], v6 offset:1024
  v_mfma_f32_16x16x32_bf16 a[20:23], v[244:247], v[192:195], a[20:23]
  s_add_u32 m0, s95, 135168
  s_nop 0
  buffer_load_dwordx4 v2, s[8:11], s33 offen sc1 lds
  v_mfma_f32_16x16x32_bf16 a[24:27], v[248:251], v[192:195], a[24:27]
  ds_read_b128 v[132:135], v4 offset:2048
  v_mfma_f32_16x16x32_bf16 a[28:31], v[252:255], v[192:195], a[28:31]
  v_mfma_f32_16x16x32_bf16 a[32:35], v[224:227], v[196:199], a[32:35]
  ds_read_b64_tr_b16 v[164:165], v7 offset:0
  v_mfma_f32_16x16x32_bf16 a[36:39], v[228:231], v[196:199], a[36:39]
  v_mfma_f32_16x16x32_bf16 a[40:43], v[232:235], v[196:199], a[40:43]
  s_add_u32 m0, s95, 139264
  s_nop 0
  buffer_load_dwordx4 v2, s[8:11], s34 offen sc1 lds
  ds_read_b64_tr_b16 v[166:167], v7 offset:1024
  v_mfma_f32_16x16x32_bf16 a[44:47], v[236:239], v[196:199], a[44:47]
  v_mfma_f32_16x16x32_bf16 a[48:51], v[240:243], v[196:199], a[48:51]
  ds_read_b128 v[136:139], v4 offset:4096
  v_mfma_f32_16x16x32_bf16 a[52:55], v[244:247], v[196:199], a[52:55]
  v_mfma_f32_16x16x32_bf16 a[56:59], v[248:251], v[196:199], a[56:59]
  ds_read_b64_tr_b16 v[168:169], v8 offset:0
  s_add_u32 m0, s95, 143360
  s_nop 0
  buffer_load_dwordx4 v2, s[8:11], s35 offen sc1 lds
  v_mfma_f32_16x16x32_bf16 a[60:63], v[252:255], v[196:199], a[60:63]
  v_mfma_f32_16x16x32_bf16 a[64:67], v[224:227], v[200:203], a[64:67]
  ds_read_b64_tr_b16 v[170:171], v8 offset:1024
  v_mfma_f32_16x16x32_bf16 a[68:71], v[228:231], v[200:203], a[68:71]
  v_mfma_f32_16x16x32_bf16 a[72:75], v[232:235], v[200:203], a[72:75]
  ds_read_b128 v[140:143], v4 offset:6144
  v_mfma_f32_16x16x32_bf16 a[76:79], v[236:239], v[200:203], a[76:79]
  s_add_u32 m0, s95, 147456
  s_nop 0
  buffer_load_dwordx4 v2, s[8:11], s36 offen sc1 lds
  v_mfma_f32_16x16x32_bf16 a[80:83], v[240:243], v[200:203], a[80:83]
  ds_read_b64_tr_b16 v[172:173], v9 offset:0
  v_mfma_f32_16x16x32_bf16 a[84:87], v[244:247], v[200:203], a[84:87]
  v_mfma_f32_16x16x32_bf16 a[88:91], v[248:251], v[200:203], a[88:91]
  ds_read_b64_tr_b16 v[174:175], v9 offset:1024
  v_mfma_f32_16x16x32_bf16 a[92:95], v[252:255], v[200:203], a[92:95]
  v_mfma_f32_16x16x32_bf16 a[96:99], v[224:227], v[204:207], a[96:99]
  s_add_u32 m0, s95, 151552
  s_nop 0
  buffer_load_dwordx4 v2, s[8:11], s37 offen sc1 lds
  ds_read_b128 v[144:147], v4 offset:8192
  v_mfma_f32_16x16x32_bf16 a[100:103], v[228:231], v[204:207], a[100:103]
  v_mfma_f32_16x16x32_bf16 a[104:107], v[232:235], v[204:207], a[104:107]
  ds_read_b64_tr_b16 v[176:177], v10 offset:0
  v_mfma_f32_16x16x32_bf16 a[108:111], v[236:239], v[204:207], a[108:111]
  v_mfma_f32_16x16x32_bf16 a[112:115], v[240:243], v[204:207], a[112:115]
  ds_read_b64_tr_b16 v[178:179], v10 offset:1024
  s_add_u32 m0, s95, 155648
  s_nop 0
  buffer_load_dwordx4 v2, s[8:11], s38 offen sc1 lds
  v_mfma_f32_16x16x32_bf16 a[116:119], v[244:247], v[204:207], a[116:119]
  v_mfma_f32_16x16x32_bf16 a[120:123], v[248:251], v[204:207], a[120:123]
  ds_read_b128 v[148:151], v4 offset:10240
  v_mfma_f32_16x16x32_bf16 a[124:127], v[252:255], v[204:207], a[124:127]
  v_mfma_f32_16x16x32_bf16 a[128:131], v[224:227], v[208:211], a[128:131]
  ds_read_b64_tr_b16 v[180:181], v11 offset:0
  v_mfma_f32_16x16x32_bf16 a[132:135], v[228:231], v[208:211], a[132:135]
  s_add_u32 m0, s95, 159744
  s_nop 0
  buffer_load_dwordx4 v2, s[8:11], s39 offen sc1 lds
  v_add_u32 v2, s44, v2
  v_mfma_f32_16x16x32_bf16 a[136:139], v[232:235], v[208:211], a[136:139]
  ds_read_b64_tr_b16 v[182:183], v11 offset:1024
  v_mfma_f32_16x16x32_bf16 a[140:143], v[236:239], v[208:211], a[140:143]
  v_mfma_f32_16x16x32_bf16 a[144:147], v[240:243], v[208:211], a[144:147]
  ds_read_b128 v[152:155], v4 offset:12288
  v_mfma_f32_16x16x32_bf16 a[148:151], v[244:247], v[208:211], a[148:151]
  v_mfma_f32_16x16x32_bf16 a[152:155], v[248:251], v[208:211], a[152:155]
  ds_read_b64_tr_b16 v[184:185], v12 offset:0
  v_mfma_f32_16x16x32_bf16 a[156:159], v[252:255], v[208:211], a[156:159]
  v_mfma_f32_16x16x32_bf16 a[160:163], v[224:227], v[212:215], a[160:163]
  ds_read_b64_tr_b16 v[186:187], v12 offset:1024
  v_mfma_f32_16x16x32_bf16 a[164:167], v[228:231], v[212:215], a[164:167]
  v_mfma_f32_16x16x32_bf16 a[168:171], v[232:235], v[212:215], a[168:171]
  ds_read_b128 v[156:159], v4 offset:14336
  v_mfma_f32_16x16x32_bf16 a[172:175], v[236:239], v[212:215], a[172:175]
  v_mfma_f32_16x16x32_bf16 a[176:179], v[240:243], v[212:215], a[176:179]
  ds_read_b64_tr_b16 v[188:189], v13 offset:0
  v_mfma_f32_16x16x32_bf16 a[180:183], v[244:247], v[212:215], a[180:183]
  v_mfma_f32_16x16x32_bf16 a[184:187], v[248:251], v[212:215], a[184:187]
  ds_read_b64_tr_b16 v[190:191], v13 offset:1024
  v_mfma_f32_16x16x32_bf16 a[188:191], v[252:255], v[212:215], a[188:191]
  v_mfma_f32_16x16x32_bf16 a[192:195], v[224:227], v[216:219], a[192:195]
  v_mfma_f32_16x16x32_bf16 a[196:199], v[228:231], v[216:219], a[196:199]
  v_mfma_f32_16x16x32_bf16 a[200:203], v[232:235], v[216:219], a[200:203]
  v_mfma_f32_16x16x32_bf16 a[204:207], v[236:239], v[216:219], a[204:207]
  v_mfma_f32_16x16x32_bf16 a[208:211], v[240:243], v[216:219], a[208:211]
  v_mfma_f32_16x16x32_bf16 a[212:215], v[244:247], v[216:219], a[212:215]
  v_mfma_f32_16x16x32_bf16 a[216:219], v[248:251], v[216:219], a[216:219]
  v_mfma_f32_16x16x32_bf16 a[220:223], v[252:255], v[216:219], a[220:223]
  v_mfma_f32_16x16x32_bf16 a[224:227], v[224:227], v[220:223], a[224:227]
  v_mfma_f32_16x16x32_bf16 a[228:231], v[228:231], v[220:223], a[228:231]
  v_mfma_f32_16x16x32_bf16 a[232:235], v[232:235], v[220:223], a[232:235]
  v_mfma_f32_16x16x32_bf16 a[236:239], v[236:239], v[220:223], a[236:239]
  v_mfma_f32_16x16x32_bf16 a[240:243], v[240:243], v[220:223], a[240:243]
  v_mfma_f32_16x16x32_bf16 a[244:247], v[244:247], v[220:223], a[244:247]
  v_mfma_f32_16x16x32_bf16 a[248:251], v[248:251], v[220:223], a[248:251]
  v_mfma_f32_16x16x32_bf16 a[252:255], v[252:255], v[220:223], a[252:255]
  s_waitcnt lgkmcnt(0)
  s_sub_u32 s46, s46, 2
  s_cmp_lg_u32 s46, 0
  s_cbranch_scc1 G_l_bs_l
  v_mfma_f32_16x16x32_bf16 a[0:3], v[160:163], v[128:131], a[0:3]
  ds_read_b128 v[192:195], v5 offset:0
  v_mfma_f32_16x16x32_bf16 a[4:7], v[164:167], v[128:131], a[4:7]
  v_mfma_f32_16x16x32_bf16 a[8:11], v[168:171], v[128:131], a[8:11]
  ds_read_b64_tr_b16 v[224:225], v6 offset:8192
  v_mfma_f32_16x16x32_bf16 a[12:15], v[172:175], v[128:131], a[12:15]
  v_mfma_f32_16x16x32_bf16 a[16:19], v[176:179], v[128:131], a[16:19]
  ds_read_b64_tr_b16 v[226:227], v6 offset:9216
  v_mfma_f32_16x16x32_bf16 a[20:23], v[180:183], v[128:131], a[20:23]
  v_mfma_f32_16x16x32_bf16 a[24:27], v[184:187], v[128:131], a[24:27]
  ds_read_b128 v[196:199], v5 offset:2048
  v_mfma_f32_16x16x32_bf16 a[28:31], v[188:191], v[128:131], a[28:31]
  v_mfma_f32_16x16x32_bf16 a[32:35], v[160:163], v[132:135], a[32:35]
  ds_read_b64_tr_b16 v[228:229], v7 offset:8192
  v_mfma_f32_16x16x32_bf16 a[36:39], v[164:167], v[132:135], a[36:39]
  v_mfma_f32_16x16x32_bf16 a[40:43], v[168:171], v[132:135], a[40:43]
  ds_read_b64_tr_b16 v[230:231], v7 offset:9216
  v_mfma_f32_16x16x32_bf16 a[44:47], v[172:175], v[132:135], a[44:47]
  v_mfma_f32_16x16x32_bf16 a[48:51], v[176:179], v[132:135], a[48:51]
  ds_read_b128 v[200:203], v5 offset:4096
  v_mfma_f32_16x16x32_bf16 a[52:55], v[180:183], v[132:135], a[52:55]
  v_mfma_f32_16x16x32_bf16 a[56:59], v[184:187], v[132:135], a[56:59]
  ds_read_b64_tr_b16 v[232:233], v8 offset:8192
  v_mfma_f32_16x16x32_bf16 a[60:63], v[188:191], v[132:135], a[60:63]
  v_mfma_f32_16x16x32_bf16 a[64:67], v[160:163], v[136:139], a[64:67]
  ds_read_b64_tr_b16 v[234:235], v8 offset:9216
  v_mfma_f32_16x16x32_bf16 a[68:71], v[164:167], v[136:139], a[68:71]
  v_mfma_f32_16x16x32_bf16 a[72:75], v[168:171], v[136:139], a[72:75]
  ds_read_b128 v[204:207], v5 offset:6144
  v_mfma_f32_16x16x32_bf16 a[76:79], v[172:175], v[136:139], a[76:79]
  v_mfma_f32_16x16x32_bf16 a[80:83], v[176:179], v[136:139], a[80:83]
  ds_read_b64_tr_b16 v[236:237], v9 offset:8192
  v_mfma_f32_16x16x32_bf16 a[84:87], v[180:183], v[136:139], a[84:87]
  v_mfma_f32_16x16x32_bf16 a[88:91], v[184:187], v[136:139], a[88:91]
  ds_read_b64_tr_b16 v[238:239], v9 offset:9216
  v_mfma_f32_16x16x32_bf16 a[92:95], v[188:191], v[136:139], a[92:95]
  v_mfma_f32_16x16x32_bf16 a[96:99], v[160:163], v[140:143], a[96:99]
  ds_read_b128 v[208:211], v5 offset:8192
  v_mfma_f32_16x16x32_bf16 a[100:103], v[164:167], v[140:143], a[100:103]
  v_mfma_f32_16x16x32_bf16 a[104:107], v[168:171], v[140:143], a[104:107]
  ds_read_b64_tr_b16 v[240:241], v10 offset:8192
  v_mfma_f32_16x16x32_bf16 a[108:111], v[172:175], v[140:143], a[108:111]
  v_mfma_f32_16x16x32_bf16 a[112:115], v[176:179], v[140:143], a[112:115]
  ds_read_b64_tr_b16 v[242:243], v10 offset:9216
  v_mfma_f32_16x16x32_bf16 a[116:119], v[180:183], v[140:143], a[116:119]
  v_mfma_f32_16x16x32_bf16 a[120:123], v[184:187], v[140:143], a[120:123]
  ds_read_b128 v[212:215], v5 offset:10240
  v_mfma_f32_16x16x32_bf16 a[124:127], v[188:191], v[140:143], a[124:127]
  v_mfma_f32_16x16x32_bf16 a[128:131], v[160:163], v[144:147], a[128:131]
  ds_read_b64_tr_b16 v[244:245], v11 offset:8192
  v_mfma_f32_16x16x32_bf16 a[132:135], v[164:167], v[144:147], a[132:135]
  v_mfma_f32_16x16x32_bf16 a[136:139], v[168:171], v[144:147], a[136:139]
  ds_read_b64_tr_b16 v[246:247], v11 offset:9216
  v_mfma_f32_16x16x32_bf16 a[140:143], v[172:175], v[144:147], a[140:143]
  v_mfma_f32_16x16x32_bf16 a[144:147], v[176:179], v[144:147], a[144:147]
  ds_read_b128 v[216:219], v5 offset:12288
  v_mfma_f32_16x16x32_bf16 a[148:151], v[180:183], v[144:147], a[148:151]
  v_mfma_f32_16x16x32_bf16 a[152:155], v[184:187], v[144:147], a[152:155]
  ds_read_b64_tr_b16 v[248:249], v12 offset:8192
  v_mfma_f32_16x16x32_bf16 a[156:159], v[188:191], v[144:147], a[156:159]
  v_mfma_f32_16x16x32_bf16 a[160:163], v[160:163], v[148:151], a[160:163]
  ds_read_b64_tr_b16 v[250:251], v12 offset:9216
  v_mfma_f32_16x16x32_bf16 a[164:167], v[164:167], v[148:151], a[164:167]
  v_mfma_f32_16x16x32_bf16 a[168:171], v[168:171], v[148:151], a[168:171]
  ds_read_b128 v[220:223], v5 offset:14336
  v_mfma_f32_16x16x32_bf16 a[172:175], v[172:175], v[148:151], a[172:175]
  v_mfma_f32_16x16x32_bf16 a[176:179], v[176:179], v[148:151], a[176:179]
  ds_read_b64_tr_b16 v[252:253], v13 offset:8192
  v_mfma_f32_16x16x32_bf16 a[180:183], v[180:183], v[148:151], a[180:183]
  v_mfma_f32_16x16x32_bf16 a[184:187], v[184:187], v[148:151], a[184:187]
  ds_read_b64_tr_b16 v[254:255], v13 offset:9216
  v_mfma_f32_16x16x32_bf16 a[188:191], v[188:191], v[148:151], a[188:191]
  v_mfma_f32_16x16x32_bf16 a[192:195], v[160:163], v[152:155], a[192:195]
  v_mfma_f32_16x16x32_bf16 a[196:199], v[164:167], v[152:155], a[196:199]
  v_mfma_f32_16x16x32_bf16 a[200:203], v[168:171], v[152:155], a[200:203]
  v_mfma_f32_16x16x32_bf16 a[204:207], v[172:175], v[152:155], a[204:207]
  v_mfma_f32_16x16x32_bf16 a[208:211], v[176:179], v[152:155], a[208:211]
  v_mfma_f32_16x16x32_bf16 a[212:215], v[180:183], v[152:155], a[212:215]
  v_mfma_f32_16x16x32_bf16 a[216:219], v[184:187], v[152:155], a[216:219]
  v_mfma_f32_16x16x32_bf16 a[220:223], v[188:191], v[152:155], a[220:223]
  v_mfma_f32_16x16x32_bf16 a[224:227], v[160:163], v[156:159], a[224:227]
  s_add_u32 s62, s95, s97
  s_cmp_eq_u32 s97, 0x10000
  v_mfma_f32_16x16x32_bf16 a[228:231], v[164:167], v[156:159], a[228:231]
  s_cselect_b32 s63, 0xffff0000, s61
  s_add_u32 s97, s97, s63
  v_mfma_f32_16x16x32_bf16 a[232:235], v[168:171], v[156:159], a[232:235]
  v_add_u32 v6, s63, v6
  v_add_u32 v7, s63, v7
  v_mfma_f32_16x16x32_bf16 a[236:239], v[172:175], v[156:159], a[236:239]
  v_add_u32 v8, s63, v8
  v_add_u32 v9, s63, v9
  v_mfma_f32_16x16x32_bf16 a[240:243], v[176:179], v[156:159], a[240:243]
  v_add_u32 v10, s63, v10
  v_add_u32 v11, s63, v11
  v_mfma_f32_16x16x32_bf16 a[244:247], v[180:183], v[156:159], a[244:247]
  v_add_u32 v12, s63, v12
  v_add_u32 v13, s63, v13
  v_mfma_f32_16x16x32_bf16 a[248:251], v[184:187], v[156:159], a[248:251]
  v_mfma_f32_16x16x32_bf16 a[252:255], v[188:191], v[156:159], a[252:255]
  s_waitcnt vmcnt(0) lgkmcnt(0)
  s_barrier
  v_mfma_f32_16x16x32_bf16 a[0:3], v[224:227], v[192:195], a[0:3]
  ds_read_b128 v[128:131], v4 offset:32768
  v_mfma_f32_16x16x32_bf16 a[4:7], v[228:231], v[192:195], a[4:7]
  v_mfma_f32_16x16x32_bf16 a[8:11], v[232:235], v[192:195], a[8:11]
  ds_read_b64_tr_b16 v[160:161], v6 offset:0
  v_mfma_f32_16x16x32_bf16 a[12:15], v[236:239], v[192:195], a[12:15]
  v_mfma_f32_16x16x32_bf16 a[16:19], v[240:243], v[192:195], a[16:19]
  ds_read_b64_tr_b16 v[162:163], v6 offset:1024
  v_mfma_f32_16x16x32_bf16 a[20:23], v[244:247], v[192:195], a[20:23]
  v_mfma_f32_16x16x32_bf16 a[24:27], v[248:251], v[192:195], a[24:27]
  ds_read_b128 v[132:135], v4 offset:34816
  v_mfma_f32_16x16x32_bf16 a[28:31], v[252:255], v[192:195], a[28:31]
  v_mfma_f32_16x16x32_bf16 a[32:35], v[224:227], v[196:199], a[32:35]
  ds_read_b64_tr_b16 v[164:165], v7 offset:0
  v_mfma_f32_16x16x32_bf16 a[36:39], v[228:231], v[196:199], a[36:39]
  v_mfma_f32_16x16x32_bf16 a[40:43], v[232:235], v[196:199], a[40:43]
  ds_read_b64_tr_b16 v[166:167], v7 offset:1024
  v_mfma_f32_16x16x32_bf16 a[44:47], v[236:239], v[196:199], a[44:47]
  v_mfma_f32_16x16x32_bf16 a[48:51], v[240:243], v[196:199], a[48:51]
  ds_read_b128 v[136:139], v4 offset:36864
  v_mfma_f32_16x16x32_bf16 a[52:55], v[244:247], v[196:199], a[52:55]
  v_mfma_f32_16x16x32_bf16 a[56:59], v[248:251], v[196:199], a[56:59]
  ds_read_b64_tr_b16 v[168:169], v8 offset:0
  v_mfma_f32_16x16x32_bf16 a[60:63], v[252:255], v[196:199], a[60:63]
  v_mfma_f32_16x16x32_bf16 a[64:67], v[224:227], v[200:203], a[64:67]
  ds_read_b64_tr_b16 v[170:171], v8 offset:1024
  v_mfma_f32_16x16x32_bf16 a[68:71], v[228:231], v[200:203], a[68:71]
  v_mfma_f32_16x16x32_bf16 a[72:75], v[232:235], v[200:203], a[72:75]
  ds_read_b128 v[140:143], v4 offset:38912
  v_mfma_f32_16x16x32_bf16 a[76:79], v[236:239], v[200:203], a[76:79]
  v_mfma_f32_16x16x32_bf16 a[80:83], v[240:243], v[200:203], a[80:83]
  ds_read_b64_tr_b16 v[172:173], v9 offset:0
  v_mfma_f32_16x16x32_bf16 a[84:87], v[244:247], v[200:203], a[84:87]
  v_mfma_f32_16x16x32_bf16 a[88:91], v[248:251], v[200:203], a[88:91]
  ds_read_b64_tr_b16 v[174:175], v9 offset:1024
  v_mfma_f32_16x16x32_bf16 a[92:95], v[252:255], v[200:203], a[92:95]
  v_mfma_f32_16x16x32_bf16 a[96:99], v[224:227], v[204:207], a[96:99]
  ds_read_b128 v[144:147], v4 offset:40960
  v_mfma_f32_16x16x32_bf16 a[100:103], v[228:231], v[204:207], a[100:103]
  v_mfma_f32_16x16x32_bf16 a[104:107], v[232:235], v[204:207], a[104:107]
  ds_read_b64_tr_b16 v[176:177], v10 offset:0
  v_mfma_f32_16x16x32_bf16 a[108:111], v[236:239], v[204:207], a[108:111]
  v_mfma_f32_16x16x32_bf16 a[112:115], v[240:243], v[204:207], a[112:115]
  ds_read_b64_tr_b16 v[178:179], v10 offset:1024
  v_mfma_f32_16x16x32_bf16 a[116:119], v[244:247], v[204:207], a[116:119]
  v_mfma_f32_16x16x32_bf16 a[120:123], v[248:251], v[204:207], a[120:123]
  ds_read_b128 v[148:151], v4 offset:43008
  v_mfma_f32_16x16x32_bf16 a[124:127], v[252:255], v[204:207], a[124:127]
  v_mfma_f32_16x16x32_bf16 a[128:131], v[224:227], v[208:211], a[128:131]
  ds_read_b64_tr_b16 v[180:181], v11 offset:0
  v_mfma_f32_16x16x32_bf16 a[132:135], v[228:231], v[208:211], a[132:135]
  v_mfma_f32_16x16x32_bf16 a[136:139], v[232:235], v[208:211], a[136:139]
  ds_read_b64_tr_b16 v[182:183], v11 offset:1024
  v_mfma_f32_16x16x32_bf16 a[140:143], v[236:239], v[208:211], a[140:143]
  v_mfma_f32_16x16x32_bf16 a[144:147], v[240:243], v[208:211], a[144:147]
  ds_read_b128 v[152:155], v4 offset:45056
  v_mfma_f32_16x16x32_bf16 a[148:151], v[244:247], v[208:211], a[148:151]
  v_mfma_f32_16x16x32_bf16 a[152:155], v[248:251], v[208:211], a[152:155]
  ds_read_b64_tr_b16 v[184:185], v12 offset:0
  v_mfma_f32_16x16x32_bf16 a[156:159], v[252:255], v[208:211], a[156:159]
  v_mfma_f32_16x16x32_bf16 a[160:163], v[224:227], v[212:215], a[160:163]
  ds_read_b64_tr_b16 v[186:187], v12 offset:1024
  v_mfma_f32_16x16x32_bf16 a[164:167], v[228:231], v[212:215], a[164:167]
  v_mfma_f32_16x16x32_bf16 a[168:171], v[232:235], v[212:215], a[168:171]
  ds_read_b128 v[156:159], v4 offset:47104
  v_mfma_f32_16x16x32_bf16 a[172:175], v[236:239], v[212:215], a[172:175]
  v_mfma_f32_16x16x32_bf16 a[176:179], v[240:243], v[212:215], a[176:179]
  ds_read_b64_tr_b16 v[188:189], v13 offset:0
  v_mfma_f32_16x16x32_bf16 a[180:183], v[244:247], v[212:215], a[180:183]
  v_mfma_f32_16x16x32_bf16 a[184:187], v[248:251], v[212:215], a[184:187]
  ds_read_b64_tr_b16 v[190:191], v13 offset:1024
  v_mfma_f32_16x16x32_bf16 a[188:191], v[252:255], v[212:215], a[188:191]
  v_mfma_f32_16x16x32_bf16 a[192:195], v[224:227], v[216:219], a[192:195]
  v_mfma_f32_16x16x32_bf16 a[196:199], v[228:231], v[216:219], a[196:199]
  v_mfma_f32_16x16x32_bf16 a[200:203], v[232:235], v[216:219], a[200:203]
  v_mfma_f32_16x16x32_bf16 a[204:207], v[236:239], v[216:219], a[204:207]
  v_mfma_f32_16x16x32_bf16 a[208:211], v[240:243], v[216:219], a[208:211]
  v_mfma_f32_16x16x32_bf16 a[212:215], v[244:247], v[216:219], a[212:215]
  v_mfma_f32_16x16x32_bf16 a[216:219], v[248:251], v[216:219], a[216:219]
  v_mfma_f32_16x16x32_bf16 a[220:223], v[252:255], v[216:219], a[220:223]
  v_mfma_f32_16x16x32_bf16 a[224:227], v[224:227], v[220:223], a[224:227]
  v_mfma_f32_16x16x32_bf16 a[228:231], v[228:231], v[220:223], a[228:231]
  v_mfma_f32_16x16x32_bf16 a[232:235], v[232:235], v[220:223], a[232:235]
  v_mfma_f32_16x16x32_bf16 a[236:239], v[236:239], v[220:223], a[236:239]
  v_mfma_f32_16x16x32_bf16 a[240:243], v[240:243], v[220:223], a[240:243]
  v_mfma_f32_16x16x32_bf16 a[244:247], v[244:247], v[220:223], a[244:247]
  v_mfma_f32_16x16x32_bf16 a[248:251], v[248:251], v[220:223], a[248:251]
  v_mfma_f32_16x16x32_bf16 a[252:255], v[252:255], v[220:223], a[252:255]
  s_waitcnt lgkmcnt(0)
  v_mfma_f32_16x16x32_bf16 a[0:3], v[160:163], v[128:131], a[0:3]
  ds_read_b128 v[192:195], v5 offset:32768
  v_mfma_f32_16x16x32_bf16 a[4:7], v[164:167], v[128:131], a[4:7]
  v_mfma_f32_16x16x32_bf16 a[8:11], v[168:171], v[128:131], a[8:11]
  ds_read_b64_tr_b16 v[224:225], v6 offset:8192
  v_mfma_f32_16x16x32_bf16 a[12:15], v[172:175], v[128:131], a[12:15]
  v_mfma_f32_16x16x32_bf16 a[16:19], v[176:179], v[128:131], a[16:19]
  ds_read_b64_tr_b16 v[226:227], v6 offset:9216
  v_mfma_f32_16x16x32_bf16 a[20:23], v[180:183], v[128:131], a[20:23]
  v_mfma_f32_16x16x32_bf16 a[24:27], v[184:187], v[128:131], a[24:27]
  ds_read_b128 v[196:199], v5 offset:34816
  v_mfma_f32_16x16x32_bf16 a[28:31], v[188:191], v[128:131], a[28:31]
  v_mfma_f32_16x16x32_bf16 a[32:35], v[160:163], v[132:135], a[32:35]
  ds_read_b64_tr_b16 v[228:229], v7 offset:8192
  v_mfma_f32_16x16x32_bf16 a[36:39], v[164:167], v[132:135], a[36:39]
  v_mfma_f32_16x16x32_bf16 a[40:43], v[168:171], v[132:135], a[40:43]
  ds_read_b64_tr_b16 v[230:231], v7 offset:9216
  v_mfma_f32_16x16x32_bf16 a[44:47], v[172:175], v[132:135], a[44:47]
  v_mfma_f32_16x16x32_bf16 a[48:51], v[176:179], v[132:135], a[48:51]
  ds_read_b128 v[200:203], v5 offset:36864
  v_mfma_f32_16x16x32_bf16 a[52:55], v[180:183], v[132:135], a[52:55]
  v_mfma_f32_16x16x32_bf16 a[56:59], v[184:187], v[132:135], a[56:59]
  ds_read_b64_tr_b16 v[232:233], v8 offset:8192
  v_mfma_f32_16x16x32_bf16 a[60:63], v[188:191], v[132:135], a[60:63]
  v_mfma_f32_16x16x32_bf16 a[64:67], v[160:163], v[136:139], a[64:67]
  ds_read_b64_tr_b16 v[234:235], v8 offset:9216
  v_mfma_f32_16x16x32_bf16 a[68:71], v[164:167], v[136:139], a[68:71]
  v_mfma_f32_16x16x32_bf16 a[72:75], v[168:171], v[136:139], a[72:75]
  ds_read_b128 v[204:207], v5 offset:38912
  v_mfma_f32_16x16x32_bf16 a[76:79], v[172:175], v[136:139], a[76:79]
  v_mfma_f32_16x16x32_bf16 a[80:83], v[176:179], v[136:139], a[80:83]
  ds_read_b64_tr_b16 v[236:237], v9 offset:8192
  v_mfma_f32_16x16x32_bf16 a[84:87], v[180:183], v[136:139], a[84:87]
  v_mfma_f32_16x16x32_bf16 a[88:91], v[184:187], v[136:139], a[88:91]
  ds_read_b64_tr_b16 v[238:239], v9 offset:9216
  v_mfma_f32_16x16x32_bf16 a[92:95], v[188:191], v[136:139], a[92:95]
  v_mfma_f32_16x16x32_bf16 a[96:99], v[160:163], v[140:143], a[96:99]
  ds_read_b128 v[208:211], v5 offset:40960
  v_mfma_f32_16x16x32_bf16 a[100:103], v[164:167], v[140:143], a[100:103]
  v_mfma_f32_16x16x32_bf16 a[104:107], v[168:171], v[140:143], a[104:107]
  ds_read_b64_tr_b16 v[240:241], v10 offset:8192
  v_mfma_f32_16x16x32_bf16 a[108:111], v[172:175], v[140:143], a[108:111]
  v_mfma_f32_16x16x32_bf16 a[112:115], v[176:179], v[140:143], a[112:115]
  ds_read_b64_tr_b16 v[242:243], v10 offset:9216
  v_mfma_f32_16x16x32_bf16 a[116:119], v[180:183], v[140:143], a[116:119]
  v_mfma_f32_16x16x32_bf16 a[120:123], v[184:187], v[140:143], a[120:123]
  ds_read_b128 v[212:215], v5 offset:43008
  v_mfma_f32_16x16x32_bf16 a[124:127], v[188:191], v[140:143], a[124:127]
  v_mfma_f32_16x16x32_bf16 a[128:131], v[160:163], v[144:147], a[128:131]
  ds_read_b64_tr_b16 v[244:245], v11 offset:8192
  v_mfma_f32_16x16x32_bf16 a[132:135], v[164:167], v[144:147], a[132:135]
  v_mfma_f32_16x16x32_bf16 a[136:139], v[168:171], v[144:147], a[136:139]
  ds_read_b64_tr_b16 v[246:247], v11 offset:9216
  v_mfma_f32_16x16x32_bf16 a[140:143], v[172:175], v[144:147], a[140:143]
  v_mfma_f32_16x16x32_bf16 a[144:147], v[176:179], v[144:147], a[144:147]
  ds_read_b128 v[216:219], v5 offset:45056
  v_mfma_f32_16x16x32_bf16 a[148:151], v[180:183], v[144:147], a[148:151]
  v_mfma_f32_16x16x32_bf16 a[152:155], v[184:187], v[144:147], a[152:155]
  ds_read_b64_tr_b16 v[248:249], v12 offset:8192
  v_mfma_f32_16x16x32_bf16 a[156:159], v[188:191], v[144:147], a[156:159]
  v_mfma_f32_16x16x32_bf16 a[160:163], v[160:163], v[148:151], a[160:163]
  ds_read_b64_tr_b16 v[250:251], v12 offset:9216
  v_mfma_f32_16x16x32_bf16 a[164:167], v[164:167], v[148:151], a[164:167]
  v_mfma_f32_16x16x32_bf16 a[168:171], v[168:171], v[148:151], a[168:171]
  ds_read_b128 v[220:223], v5 offset:47104
  v_mfma_f32_16x16x32_bf16 a[172:175], v[172:175], v[148:151], a[172:175]
  v_mfma_f32_16x16x32_bf16 a[176:179], v[176:179], v[148:151], a[176:179]
  ds_read_b64_tr_b16 v[252:253], v13 offset:8192
  v_mfma_f32_16x16x32_bf16 a[180:183], v[180:183], v[148:151], a[180:183]
  v_mfma_f32_16x16x32_bf16 a[184:187], v[184:187], v[148:151], a[184:187]
  ds_read_b64_tr_b16 v[254:255], v13 offset:9216
  v_mfma_f32_16x16x32_bf16 a[188:191], v[188:191], v[148:151], a[188:191]
  v_mfma_f32_16x16x32_bf16 a[192:195], v[160:163], v[152:155], a[192:195]
  v_mfma_f32_16x16x32_bf16 a[196:199], v[164:167], v[152:155], a[196:199]
  v_mfma_f32_16x16x32_bf16 a[200:203], v[168:171], v[152:155], a[200:203]
  v_mfma_f32_16x16x32_bf16 a[204:207], v[172:175], v[152:155], a[204:207]
  v_mfma_f32_16x16x32_bf16 a[208:211], v[176:179], v[152:155], a[208:211]
  v_mfma_f32_16x16x32_bf16 a[212:215], v[180:183], v[152:155], a[212:215]
  v_mfma_f32_16x16x32_bf16 a[216:219], v[184:187], v[152:155], a[216:219]
  v_mfma_f32_16x16x32_bf16 a[220:223], v[188:191], v[152:155], a[220:223]
  v_mfma_f32_16x16x32_bf16 a[224:227], v[160:163], v[156:159], a[224:227]
  v_mfma_f32_16x16x32_bf16 a[228:231], v[164:167], v[156:159], a[228:231]
  v_mfma_f32_16x16x32_bf16 a[232:235], v[168:171], v[156:159], a[232:235]
  v_mfma_f32_16x16x32_bf16 a[236:239], v[172:175], v[156:159], a[236:239]
  v_mfma_f32_16x16x32_bf16 a[240:243], v[176:179], v[156:159], a[240:243]
  v_mfma_f32_16x16x32_bf16 a[244:247], v[180:183], v[156:159], a[244:247]
  v_mfma_f32_16x16x32_bf16 a[248:251], v[184:187], v[156:159], a[248:251]
  v_mfma_f32_16x16x32_bf16 a[252:255], v[188:191], v[156:159], a[252:255]
  s_waitcnt lgkmcnt(0)
  s_barrier
  v_mfma_f32_16x16x32_bf16 a[0:3], v[224:227], v[192:195], a[0:3]
  v_mfma_f32_16x16x32_bf16 a[4:7], v[228:231], v[192:195], a[4:7]
  v_mfma_f32_16x16x32_bf16 a[8:11], v[232:235], v[192:195], a[8:11]
  v_mfma_f32_16x16x32_bf16 a[12:15], v[236:239], v[192:195], a[12:15]
  v_mfma_f32_16x16x32_bf16 a[16:19], v[240:243], v[192:195], a[16:19]
  v_mfma_f32_16x16x32_bf16 a[20:23], v[244:247], v[192:195], a[20:23]
  v_mfma_f32_16x16x32_bf16 a[24:27], v[248:251], v[192:195], a[24:27]
  v_mfma_f32_16x16x32_bf16 a[28:31], v[252:255], v[192:195], a[28:31]
  v_mfma_f32_16x16x32_bf16 a[32:35], v[224:227], v[196:199], a[32:35]
  v_mfma_f32_16x16x32_bf16 a[36:39], v[228:231], v[196:199], a[36:39]
  v_mfma_f32_16x16x32_bf16 a[40:43], v[232:235], v[196:199], a[40:43]
  v_mfma_f32_16x16x32_bf16 a[44:47], v[236:239], v[196:199], a[44:47]
  v_mfma_f32_16x16x32_bf16 a[48:51], v[240:243], v[196:199], a[48:51]
  v_mfma_f32_16x16x32_bf16 a[52:55], v[244:247], v[196:199], a[52:55]
  v_mfma_f32_16x16x32_bf16 a[56:59], v[248:251], v[196:199], a[56:59]
  v_mfma_f32_16x16x32_bf16 a[60:63], v[252:255], v[196:199], a[60:63]
  v_mfma_f32_16x16x32_bf16 a[64:67], v[224:227], v[200:203], a[64:67]
  v_mfma_f32_16x16x32_bf16 a[68:71], v[228:231], v[200:203], a[68:71]
  v_mfma_f32_16x16x32_bf16 a[72:75], v[232:235], v[200:203], a[72:75]
  v_mfma_f32_16x16x32_bf16 a[76:79], v[236:239], v[200:203], a[76:79]
  v_mfma_f32_16x16x32_bf16 a[80:83], v[240:243], v[200:203], a[80:83]
  v_mfma_f32_16x16x32_bf16 a[84:87], v[244:247], v[200:203], a[84:87]
  v_mfma_f32_16x16x32_bf16 a[88:91], v[248:251], v[200:203], a[88:91]
  v_mfma_f32_16x16x32_bf16 a[92:95], v[252:255], v[200:203], a[92:95]
  v_mfma_f32_16x16x32_bf16 a[96:99], v[224:227], v[204:207], a[96:99]
  v_mfma_f32_16x16x32_bf16 a[100:103], v[228:231], v[204:207], a[100:103]
  v_mfma_f32_16x16x32_bf16 a[104:107], v[232:235], v[204:207], a[104:107]
  v_mfma_f32_16x16x32_bf16 a[108:111], v[236:239], v[204:207], a[108:111]
  v_mfma_f32_16x16x32_bf16 a[112:115], v[240:243], v[204:207], a[112:115]
  v_mfma_f32_16x16x32_bf16 a[116:119], v[244:247], v[204:207], a[116:119]
  v_mfma_f32_16x16x32_bf16 a[120:123], v[248:251], v[204:207], a[120:123]
  v_mfma_f32_16x16x32_bf16 a[124:127], v[252:255], v[204:207], a[124:127]
  v_mfma_f32_16x16x32_bf16 a[128:131], v[224:227], v[208:211], a[128:131]
  v_mfma_f32_16x16x32_bf16 a[132:135], v[228:231], v[208:211], a[132:135]
  v_mfma_f32_16x16x32_bf16 a[136:139], v[232:235], v[208:211], a[136:139]
  v_mfma_f32_16x16x32_bf16 a[140:143], v[236:239], v[208:211], a[140:143]
  v_mfma_f32_16x16x32_bf16 a[144:147], v[240:243], v[208:211], a[144:147]
  v_mfma_f32_16x16x32_bf16 a[148:151], v[244:247], v[208:211], a[148:151]
  v_mfma_f32_16x16x32_bf16 a[152:155], v[248:251], v[208:211], a[152:155]
  v_mfma_f32_16x16x32_bf16 a[156:159], v[252:255], v[208:211], a[156:159]
  v_mfma_f32_16x16x32_bf16 a[160:163], v[224:227], v[212:215], a[160:163]
  v_mfma_f32_16x16x32_bf16 a[164:167], v[228:231], v[212:215], a[164:167]
  v_mfma_f32_16x16x32_bf16 a[168:171], v[232:235], v[212:215], a[168:171]
  v_mfma_f32_16x16x32_bf16 a[172:175], v[236:239], v[212:215], a[172:175]
  v_mfma_f32_16x16x32_bf16 a[176:179], v[240:243], v[212:215], a[176:179]
  v_mfma_f32_16x16x32_bf16 a[180:183], v[244:247], v[212:215], a[180:183]
  v_mfma_f32_16x16x32_bf16 a[184:187], v[248:251], v[212:215], a[184:187]
  v_mfma_f32_16x16x32_bf16 a[188:191], v[252:255], v[212:215], a[188:191]
  v_mfma_f32_16x16x32_bf16 a[192:195], v[224:227], v[216:219], a[192:195]
  v_mfma_f32_16x16x32_bf16 a[196:199], v[228:231], v[216:219], a[196:199]
  v_mfma_f32_16x16x32_bf16 a[200:203], v[232:235], v[216:219], a[200:203]
  v_mfma_f32_16x16x32_bf16 a[204:207], v[236:239], v[216:219], a[204:207]
  v_mfma_f32_16x16x32_bf16 a[208:211], v[240:243], v[216:219], a[208:211]
  v_mfma_f32_16x16x32_bf16 a[212:215], v[244:247], v[216:219], a[212:215]
  v_mfma_f32_16x16x32_bf16 a[216:219], v[248:251], v[216:219], a[216:219]
  v_mfma_f32_16x16x32_bf16 a[220:223], v[252:255], v[216:219], a[220:223]
  v_mfma_f32_16x16x32_bf16 a[224:227], v[224:227], v[220:223], a[224:227]
  v_mfma_f32_16x16x32_bf16 a[228:231], v[228:231], v[220:223], a[228:231]
  v_mfma_f32_16x16x32_bf16 a[232:235], v[232:235], v[220:223], a[232:235]
  v_mfma_f32_16x16x32_bf16 a[236:239], v[236:239], v[220:223], a[236:239]
  v_mfma_f32_16x16x32_bf16 a[240:243], v[240:243], v[220:223], a[240:243]
  v_mfma_f32_16x16x32_bf16 a[244:247], v[244:247], v[220:223], a[244:247]
  v_mfma_f32_16x16x32_bf16 a[248:251], v[248:251], v[220:223], a[248:251]
  v_mfma_f32_16x16x32_bf16 a[252:255], v[252:255], v[220:223], a[252:255]
  s_branch G_next
G_l_bn:
  s_barrier
  ds_read_b128 v[128:131], v4 offset:0
  ds_read_b64_tr_b16 v[160:161], v6 offset:0
  ds_read_b64_tr_b16 v[162:163], v6 offset:1024
  ds_read_b128 v[132:135], v4 offset:2048
  ds_read_b64_tr_b16 v[164:165], v7 offset:0
  ds_read_b64_tr_b16 v[166:167], v7 offset:1024
  ds_read_b128 v[136:139], v4 offset:4096
  ds_read_b64_tr_b16 v[168:169], v8 offset:0
  ds_read_b64_tr_b16 v[170:171], v8 offset:1024
  ds_read_b128 v[140:143], v4 offset:6144
  ds_read_b64_tr_b16 v[172:173], v9 offset:0
  ds_read_b64_tr_b16 v[174:175], v9 offset:1024
  ds_read_b128 v[144:147], v4 offset:8192
  ds_read_b64_tr_b16 v[176:177], v10 offset:0
  ds_read_b64_tr_b16 v[178:179], v10 offset:1024
  ds_read_b128 v[148:151], v4 offset:10240
  ds_read_b64_tr_b16 v[180:181], v11 offset:0
  ds_read_b64_tr_b16 v[182:183], v11 offset:1024
  ds_read_b128 v[152:155], v4 offset:12288
  ds_read_b64_tr_b16 v[184:185], v12 offset:0
  ds_read_b64_tr_b16 v[186:187], v12 offset:1024
  ds_read_b128 v[156:159], v4 offset:14336
  ds_read_b64_tr_b16 v[188:189], v13 offset:0
  ds_read_b64_tr_b16 v[190:191], v13 offset:1024
  s_sub_u32 s46, s96, 4
  s_mov_b32 s97, 0
  s_add_u32 s62, s95, 0x10000
  s_mov_b32 s61, 0x8000
  s_waitcnt lgkmcnt(0)
  v_mfma_f32_16x16x32_bf16 a[0:3], v[128:131], v[160:163], 0
  ds_read_b128 v[192:195], v5 offset:0
  s_add_u32 m0, s62, 0
  s_nop 0
  buffer_load_dwordx4 v3, s[12:15], s40 offen  lds
  v_mfma_f32_16x16x32_bf16 a[4:7], v[128:131], v[164:167], 0
  v_mfma_f32_16x16x32_bf16 a[8:11], v[128:131], v[168:171], 0
  ds_read_b64_tr_b16 v[224:225], v6 offset:8192
  v_mfma_f32_16x16x32_bf16 a[12:15], v[128:131], v[172:175], 0
  v_mfma_f32_16x16x32_bf16 a[16:19], v[128:131], v[176:179], 0
  ds_read_b64_tr_b16 v[226:227], v6 offset:9216
  v_mfma_f32_16x16x32_bf16 a[20:23], v[128:131], v[180:183], 0
  v_mfma_f32_16x16x32_bf16 a[24:27], v[128:131], v[184:187], 0
  ds_read_b128 v[196:199], v5 offset:2048
  s_add_u32 m0, s62, 16384
  s_nop 0
  buffer_load_dwordx4 v24, s[16:19], s40 offen  lds
  v_mfma_f32_16x16x32_bf16 a[28:31], v[128:131], v[188:191], 0
  v_mfma_f32_16x16x32_bf16 a[32:35], v[132:135], v[160:163], 0
  ds_read_b64_tr_b16 v[228:229], v7 offset:8192
  v_mfma_f32_16x16x32_bf16 a[36:39], v[132:135], v[164:167], 0
  v_mfma_f32_16x16x32_bf16 a[40:43], v[132:135], v[168:171], 0
  ds_read_b64_tr_b16 v[230:231], v7 offset:9216
  v_mfma_f32_16x16x32_bf16 a[44:47], v[132:135], v[172:175], 0
  v_mfma_f32_16x16x32_bf16 a[48:51], v[132:135], v[176:179], 0
  ds_read_b128 v[200:203], v5 offset:4096
  s_add_u32 m0, s62, 4096
  s_nop 0
  buffer_load_dwordx4 v3, s[12:15], s41 offen  lds
  v_mfma_f32_16x16x32_bf16 a[52:55], v[132:135], v[180:183], 0
  v_mfma_f32_16x16x32_bf16 a[56:59], v[132:135], v[184:187], 0
  ds_read_b64_tr_b16 v[232:233], v8 offset:8192
  v_mfma_f32_16x16x32_bf16 a[60:63], v[132:135], v[188:191], 0
  v_mfma_f32_16x16x32_bf16 a[64:67], v[136:139], v[160:163], 0
  ds_read_b64_tr_b16 v[234:235], v8 offset:9216
  v_mfma_f32_16x16x32_bf16 a[68:71], v[136:139], v[164:167], 0
  v_mfma_f32_16x16x32_bf16 a[72:75], v[136:139], v[168:171], 0
  ds_read_b128 v[204:207], v5 offset:6144
  v_mfma_f32_16x16x32_bf16 a[76:79], v[136:139], v[172:175], 0
  s_add_u32 m0, s62, 20480
  s_nop 0
  buffer_load_dwordx4 v24, s[16:19], s41 offen  lds
  v_mfma_f32_16x16x32_bf16 a[80:83], v[136:139], v[176:179], 0
  ds_read_b64_tr_b16 v[236:237], v9 offset:8192
  v_mfma_f32_16x16x32_bf16 a[84:87], v[136:139], v[180:183], 0
  v_mfma_f32_16x16x32_bf16 a[88:91], v[136:139], v[184:187], 0
  ds_read_b64_tr_b16 v[238:239], v9 offset:9216
  v_mfma_f32_16x16x32_bf16 a[92:95], v[136:139], v[188:191], 0
  v_mfma_f32_16x16x32_bf16 a[96:99], v[140:143], v[160:163], 0
  ds_read_b128 v[208:211], v5 offset:8192
  v_mfma_f32_16x16x32_bf16 a[100:103], v[140:143], v[164:167], 0
  s_add_u32 m0, s62, 8192
  s_nop 0
  buffer_load_dwordx4 v3, s[12:15], s42 offen  lds
  v_mfma_f32_16x16x32_bf16 a[104:107], v[140:143], v[168:171], 0
  ds_read_b64_tr_b16 v[240:241], v10 offset:8192
  v_mfma_f32_16x16x32_bf16 a[108:111], v[140:143], v[172:175], 0
  v_mfma_f32_16x16x32_bf16 a[112:115], v[140:143], v[176:179], 0
  ds_read_b64_tr_b16 v[242:243], v10 offset:9216
  v_mfma_f32_16x16x32_bf16 a[116:119], v[140:143], v[180:183], 0
  v_mfma_f32_16x16x32_bf16 a[120:123], v[140:143], v[184:187], 0
  ds_read_b128 v[212:215], v5 offset:10240
  v_mfma_f32_16x16x32_bf16 a[124:127], v[140:143], v[188:191], 0
  s_add_u32 m0, s62, 24576
  s_nop 0
  buffer_load_dwordx4 v24, s[16:19], s42 offen  lds
  v_mfma_f32_16x16x32_bf16 a[128:131], v[144:147], v[160:163], 0
  ds_read_b64_tr_b16 v[244:245], v11 offset:8192
  v_mfma_f32_16x16x32_bf16 a[132:135], v[144:147], v[164:167], 0
  v_mfma_f32_16x16x32_bf16 a[136:139], v[144:147], v[168:171], 0
  ds_read_b64_tr_b16 v[246:247], v11 offset:9216
  v_mfma_f32_16x16x32_bf16 a[140:143], v[144:147], v[172:175], 0
  v_mfma_f32_16x16x32_bf16 a[144:147], v[144:147], v[176:179], 0
  ds_read_b128 v[216:219], v5 offset:12288
  v_mfma_f32_16x16x32_bf16 a[148:151], v[144:147], v[180:183], 0
  v_mfma_f32_16x16x32_bf16 a[152:155], v[144:147], v[184:187], 0
  s_add_u32 m0, s62, 12288
  s_nop 0
  buffer_load_dwordx4 v3, s[12:15], s43 offen  lds
  ds_read_b64_tr_b16 v[248:249], v12 offset:8192
  v_mfma_f32_16x16x32_bf16 a[156:159], v[144:147], v[188:191], 0
  v_mfma_f32_16x16x32_bf16 a[160:163], v[148:151], v[160:163], 0
  ds_read_b64_tr_b16 v[250:251], v12 offset:9216
  v_mfma_f32_16x16x32_bf16 a[164:167], v[148:151], v[164:167], 0
  v_mfma_f32_16x16x32_bf16 a[168:171], v[148:151], v[168:171], 0
  ds_read_b128 v[220:223], v5 offset:14336
  v_mfma_f32_16x16x32_bf16 a[172:175], v[148:151], v[172:175], 0
  v_mfma_f32_16x16x32_bf16 a[176:179], v[148:151], v[176:179], 0
  s_add_u32 m0, s62, 28672
  s_nop 0
  buffer_load_dwordx4 v24, s[16:19], s43 offen  lds
  v_add_u32 v3, s45, v3
  v_add_u32 v24, s45, v24
  ds_read_b64_tr_b16 v[252:253], v13 offset:8192
  v_mfma_f32_16x16x32_bf16 a[180:183], v[148:151], v[180:183], 0
  v_mfma_f32_16x16x32_bf16 a[184:187], v[148:151], v[184:187], 0
  ds_read_b64_tr_b16 v[254:255], v13 offset:9216
  v_mfma_f32_16x16x32_bf16 a[188:191], v[148:151], v[188:191], 0
  v_mfma_f32_16x16x32_bf16 a[192:195], v[152:155], v[160:163], 0
  v_mfma_f32_16x16x32_bf16 a[196:199], v[152:155], v[164:167], 0
  v_mfma_f32_16x16x32_bf16 a[200:203], v[152:155], v[168:171], 0
  v_mfma_f32_16x16x32_bf16 a[204:207], v[152:155], v[172:175], 0
  v_mfma_f32_16x16x32_bf16 a[208:211], v[152:155], v[176:179], 0
  v_mfma_f32_16x16x32_bf16 a[212:215], v[152:155], v[180:183], 0
  v_mfma_f32_16x16x32_bf16 a[216:219], v[152:155], v[184:187], 0
  v_mfma_f32_16x16x32_bf16 a[220:223], v[152:155], v[188:191], 0
  v_mfma_f32_16x16x32_bf16 a[224:227], v[156:159], v[160:163], 0
  s_add_u32 s62, s95, s97
  s_cmp_eq_u32 s97, 0x10000
  v_mfma_f32_16x16x32_bf16 a[228:231], v[156:159], v[164:167], 0
  s_cselect_b32 s63, 0xffff0000, s61
  s_add_u32 s97, s97, s63
  v_mfma_f32_16x16x32_bf16 a[232:235], v[156:159], v[168:171], 0
  v_add_u32 v6, s63, v6
  v_add_u32 v7, s63, v7
  v_mfma_f32_16x16x32_bf16 a[236:239], v[156:159], v[172:175], 0
  v_add_u32 v8, s63, v8
  v_add_u32 v9, s63, v9
  v_mfma_f32_16x16x32_bf16 a[240:243], v[156:159], v[176:179], 0
  v_add_u32 v10, s63, v10
  v_add_u32 v11, s63, v11
  v_mfma_f32_16x16x32_bf16 a[244:247], v[156:159], v[180:183], 0
  v_add_u32 v12, s63, v12
  v_add_u32 v13, s63, v13
  v_mfma_f32_16x16x32_bf16 a[248:251], v[156:159], v[184:187], 0
  v_mfma_f32_16x16x32_bf16 a[252:255], v[156:159], v[188:191], 0
  s_waitcnt lgkmcnt(0)
  s_barrier
  v_mfma_f32_16x16x32_bf16 a[0:3], v[192:195], v[224:227], a[0:3]
  ds_read_b128 v[128:131], v4 offset:32768
  s_add_u32 m0, s95, 98304
  s_nop 0
  buffer_load_dwordx4 v2, s[8:11], s32 offen sc1 lds
  v_mfma_f32_16x16x32_bf16 a[4:7], v[192:195], v[228:231], a[4:7]
  v_mfma_f32_16x16x32_bf16 a[8:11], v[192:195], v[232:235], a[8:11]
  ds_read_b64_tr_b16 v[160:161], v6 offset:0
  v_mfma_f32_16x16x32_bf16 a[12:15], v[192:195], v[236:239], a[12:15]
  v_mfma_f32_16x16x32_bf16 a[16:19], v[192:195], v[240:243], a[16:19]
  ds_read_b64_tr_b16 v[162:163], v6 offset:1024
  v_mfma_f32_16x16x32_bf16 a[20:23], v[192:195], v[244:247], a[20:23]
  s_add_u32 m0, s95, 102400
  s_nop 0
  buffer_load_dwordx4 v2, s[8:11], s33 offen sc1 lds
  v_mfma_f32_16x16x32_bf16 a[24:27], v[192:195], v[248:251], a[24:27]
  ds_read_b128 v[132:135], v4 offset:34816
  v_mfma_f32_16x16x32_bf16 a[28:31], v[192:195], v[252:255], a[28:31]
  v_mfma_f32_16x16x32_bf16 a[32:35], v[196:199], v[224:227], a[32:35]
  ds_read_b64_tr_b16 v[164:165], v7 offset:0
  v_mfma_f32_16x16x32_bf16 a[36:39], v[196:199], v[228:231], a[36:39]
  v_mfma_f32_16x16x32_bf16 a[40:43], v[196:199], v[232:235], a[40:43]
  s_add_u32 m0, s95, 106496
  s_nop 0
  buffer_load_dwordx4 v2, s[8:11], s34 offen sc1 lds
  ds_read_b64_tr_b16 v[166:167], v7 offset:1024
  v_mfma_f32_16x16x32_bf16 a[44:47], v[196:199], v[236:239], a[44:47]
  v_mfma_f32_16x16x32_bf16 a[48:51], v[196:199], v[240:243], a[48:51]
  ds_read_b128 v[136:139], v4 offset:36864
  v_mfma_f32_16x16x32_bf16 a[52:55], v[196:199], v[244:247], a[52:55]
  v_mfma_f32_16x16x32_bf16 a[56:59], v[196:199], v[248:251], a[56:59]
  ds_read_b64_tr_b16 v[168:169], v8 offset:0
  s_add_u32 m0, s95, 110592
  s_nop 0
  buffer_load_dwordx4 v2, s[8:11], s35 offen sc1 lds
  v_mfma_f32_16x16x32_bf16 a[60:63], v[196:199], v[252:255], a[60:63]
  v_mfma_f32_16x16x32_bf16 a[64:67], v[200:203], v[224:227], a[64:67]
  ds_read_b64_tr_b16 v[170:171], v8 offset:1024
  v_mfma_f32_16x16x32_bf16 a[68:71], v[200:203], v[228:231], a[68:71]
  v_mfma_f32_16x16x32_bf16 a[72:75], v[200:203], v[232:235], a[72:75]
  ds_read_b128 v[140:143], v4 offset:38912
  v_mfma_f32_16x16x32_bf16 a[76:79], v[200:203], v[236:239], a[76:79]
  s_add_u32 m0, s95, 114688
  s_nop 0
  buffer_load_dwordx4 v2, s[8:11], s36 offen sc1 lds
  v_mfma_f32_16x16x32_bf16 a[80:83], v[200:203], v[240:243], a[80:83]
  ds_read_b64_tr_b16 v[172:173], v9 offset:0
  v_mfma_f32_16x16x32_bf16 a[84:87], v[200:203], v[244:247], a[84:87]
  v_mfma_f32_16x16x32_bf16 a[88:91], v[200:203], v[248:251], a[88:91]
  ds_read_b64_tr_b16 v[174:175], v9 offset:1024
  v_mfma_f32_16x16x32_bf16 a[92:95], v[200:203], v[252:255], a[92:95]
  v_mfma_f32_16x16x32_bf16 a[96:99], v[204:207], v[224:227], a[96:99]
  s_add_u32 m0, s95, 118784
  s_nop 0
  buffer_load_dwordx4 v2, s[8:11], s37 offen sc1 lds
  ds_read_b128 v[144:147], v4 offset:40960
  v_mfma_f32_16x16x32_bf16 a[100:103], v[204:207], v[228:231], a[100:103]
  v_mfma_f32_16x16x32_bf16 a[104:107], v[204:207], v[232:235], a[104:107]
  ds_read_b64_tr_b16 v[176:177], v10 offset:0
  v_mfma_f32_16x16x32_bf16 a[108:111], v[204:207], v[236:239], a[108:111]
  v_mfma_f32_16x16x32_bf16 a[112:115], v[204:207], v[240:243], a[112:115]
  ds_read_b64_tr_b16 v[178:179], v10 offset:1024
  s_add_u32 m0, s95, 122880
  s_nop 0
  buffer_load_dwordx4 v2, s[8:11], s38 offen sc1 lds
  v_mfma_f32_16x16x32_bf16 a[116:119], v[204:207], v[244:247], a[116:119]
  v_mfma_f32_16x16x32_bf16 a[120:123], v[204:207], v[248:251], a[120:123]
  ds_read_b128 v[148:151], v4 offset:43008
  v_mfma_f32_16x16x32_bf16 a[124:127], v[204:207], v[252:255], a[124:127]
  v_mfma_f32_16x16x32_bf16 a[128:131], v[208:211], v[224:227], a[128:131]
  ds_read_b64_tr_b16 v[180:181], v11 offset:0
  v_mfma_f32_16x16x32_bf16 a[132:135], v[208:211], v[228:231], a[132:135]
  s_add_u32 m0, s95, 126976
  s_nop 0
  buffer_load_dwordx4 v2, s[8:11], s39 offen sc1 lds
  v_add_u32 v2, s44, v2
  v_mfma_f32_16x16x32_bf16 a[136:139], v[208:211], v[232:235], a[136:139]
  ds_read_b64_tr_b16 v[182:183], v11 offset:1024
  v_mfma_f32_16x16x32_bf16 a[140:143], v[208:211], v[236:239], a[140:143]
  v_mfma_f32_16x16x32_bf16 a[144:147], v[208:211], v[240:243], a[144:147]
  ds_read_b128 v[152:155], v4 offset:45056
  v_mfma_f32_16x16x32_bf16 a[148:151], v[208:211], v[244:247], a[148:151]
  v_mfma_f32_16x16x32_bf16 a[152:155], v[208:211], v[248:251], a[152:155]
  ds_read_b64_tr_b16 v[184:185], v12 offset:0
  v_mfma_f32_16x16x32_bf16 a[156:159], v[208:211], v[252:255], a[156:159]
  v_mfma_f32_16x16x32_bf16 a[160:163], v[212:215], v[224:227], a[160:163]
  ds_read_b64_tr_b16 v[186:187], v12 offset:1024
  v_mfma_f32_16x16x32_bf16 a[164:167], v[212:215], v[228:231], a[164:167]
  v_mfma_f32_16x16x32_bf16 a[168:171], v[212:215], v[232:235], a[168:171]
  ds_read_b128 v[156:159], v4 offset:47104
  v_mfma_f32_16x16x32_bf16 a[172:175], v[212:215], v[236:239], a[172:175]
  v_mfma_f32_16x16x32_bf16 a[176:179], v[212:215], v[240:243], a[176:179]
  ds_read_b64_tr_b16 v[188:189], v13 offset:0
  v_mfma_f32_16x16x32_bf16 a[180:183], v[212:215], v[244:247], a[180:183]
  v_mfma_f32_16x16x32_bf16 a[184:187], v[212:215], v[248:251], a[184:187]
  ds_read_b64_tr_b16 v[190:191], v13 offset:1024
  v_mfma_f32_16x16x32_bf16 a[188:191], v[212:215], v[252:255], a[188:191]
  v_mfma_f32_16x16x32_bf16 a[192:195], v[216:219], v[224:227], a[192:195]
  v_mfma_f32_16x16x32_bf16 a[196:199], v[216:219], v[228:231], a[196:199]
  v_mfma_f32_16x16x32_bf16 a[200:203], v[216:219], v[232:235], a[200:203]
  v_mfma_f32_16x16x32_bf16 a[204:207], v[216:219], v[236:239], a[204:207]
  v_mfma_f32_16x16x32_bf16 a[208:211], v[216:219], v[240:243], a[208:211]
  v_mfma_f32_16x16x32_bf16 a[212:215], v[216:219], v[244:247], a[212:215]
  v_mfma_f32_16x16x32_bf16 a[216:219], v[216:219], v[248:251], a[216:219]
  v_mfma_f32_16x16x32_bf16 a[220:223], v[216:219], v[252:255], a[220:223]
  v_mfma_f32_16x16x32_bf16 a[224:227], v[220:223], v[224:227], a[224:227]
  v_mfma_f32_16x16x32_bf16 a[228:231], v[220:223], v[228:231], a[228:231]
  v_mfma_f32_16x16x32_bf16 a[232:235], v[220:223], v[232:235], a[232:235]
  v_mfma_f32_16x16x32_bf16 a[236:239], v[220:223], v[236:239], a[236:239]
  v_mfma_f32_16x16x32_bf16 a[240:243], v[220:223], v[240:243], a[240:243]
  v_mfma_f32_16x16x32_bf16 a[244:247], v[220:223], v[244:247], a[244:247]
  v_mfma_f32_16x16x32_bf16 a[248:251], v[220:223], v[248:251], a[248:251]
  v_mfma_f32_16x16x32_bf16 a[252:255], v[220:223], v[252:255], a[252:255]
  s_waitcnt lgkmcnt(0)
  v_mfma_f32_16x16x32_bf16 a[0:3], v[128:131], v[160:163], a[0:3]
  ds_read_b128 v[192:195], v5 offset:32768
  s_add_u32 m0, s62, 0
  s_nop 0
  buffer_load_dwordx4 v3, s[12:15], s40 offen  lds
  v_mfma_f32_16x16x32_bf16 a[4:7], v[128:131], v[164:167], a[4:7]
  v_mfma_f32_16x16x32_bf16 a[8:11], v[128:131], v[168:171], a[8:11]
  ds_read_b64_tr_b16 v[224:225], v6 offset:8192
  v_mfma_f32_16x16x32_bf16 a[12:15], v[128:131], v[172:175], a[12:15]
  v_mfma_f32_16x16x32_bf16 a[16:19], v[128:131], v[176:179], a[16:19]
  ds_read_b64_tr_b16 v[226:227], v6 offset:9216
  v_mfma_f32_16x16x32_bf16 a[20:23], v[128:131], v[180:183], a[20:23]
  v_mfma_f32_16x16x32_bf16 a[24:27], v[128:131], v[184:187], a[24:27]
  ds_read_b128 v[196:199], v5 offset:34816
  s_add_u32 m0, s62, 16384
  s_nop 0
  buffer_load_dwordx4 v24, s[16:19], s40 offen  lds
  v_mfma_f32_16x16x32_bf16 a[28:31], v[128:131], v[188:191], a[28:31]
  v_mfma_f32_16x16x32_bf16 a[32:35], v[132:135], v[160:163], a[32:35]
  ds_read_b64_tr_b16 v[228:229], v7 offset:8192
  v_mfma_f32_16x16x32_bf16 a[36:39], v[132:135], v[164:167], a[36:39]
  v_mfma_f32_16x16x32_bf16 a[40:43], v[132:135], v[168:171], a[40:43]
  ds_read_b64_tr_b16 v[230:231], v7 offset:9216
  v_mfma_f32_16x16x32_bf16 a[44:47], v[132:135], v[172:175], a[44:47]
  v_mfma_f32_16x16x32_bf16 a[48:51], v[132:135], v[176:179], a[48:51]
  ds_read_b128 v[200:203], v5 offset:36864
  s_add_u32 m0, s62, 4096
  s_nop 0
  buffer_load_dwordx4 v3, s[12:15], s41 offen  lds
  v_mfma_f32_16x16x32_bf16 a[52:55], v[132:135], v[180:183], a[52:55]
  v_mfma_f32_16x16x32_bf16 a[56:59], v[132:135], v[184:187], a[56:59]
  ds_read_b64_tr_b16 v[232:233], v8 offset:8192
  v_mfma_f32_16x16x32_bf16 a[60:63], v[132:135], v[188:191], a[60:63]
  v_mfma_f32_16x16x32_bf16 a[64:67], v[136:139], v[160:163], a[64:67]
  ds_read_b64_tr_b16 v[234:235], v8 offset:9216
  v_mfma_f32_16x16x32_bf16 a[68:71], v[136:139], v[164:167], a[68:71]
  v_mfma_f32_16x16x32_bf16 a[72:75], v[136:139], v[168:171], a[72:75]
  ds_read_b128 v[204:207], v5 offset:38912
  v_mfma_f32_16x16x32_bf16 a[76:79], v[136:139], v[172:175], a[76:79]
  s_add_u32 m0, s62, 20480
  s_nop 0
  buffer_load_dwordx4 v24, s[16:19], s41 offen  lds
  v_mfma_f32_16x16x32_bf16 a[80:83], v[136:139], v[176:179], a[80:83]
  ds_read_b64_tr_b16 v[236:237], v9 offset:8192
  v_mfma_f32_16x16x32_bf16 a[84:87], v[136:139], v[180:183], a[84:87]
  v_mfma_f32_16x16x32_bf16 a[88:91], v[136:139], v[184:187], a[88:91]
  ds_read_b64_tr_b16 v[238:239], v9 offset:9216
  v_mfma_f32_16x16x32_bf16 a[92:95], v[136:139], v[188:191], a[92:95]
  v_mfma_f32_16x16x32_bf16 a[96:99], v[140:143], v[160:163], a[96:99]
  ds_read_b128 v[208:211], v5 offset:40960
  v_mfma_f32_16x16x32_bf16 a[100:103], v[140:143], v[164:167], a[100:103]
  s_add_u32 m0, s62, 8192
  s_nop 0
  buffer_load_dwordx4 v3, s[12:15], s42 offen  lds
  v_mfma_f32_16x16x32_bf16 a[104:107], v[140:143], v[168:171], a[104:107]
  ds_read_b64_tr_b16 v[240:241], v10 offset:8192
  v_mfma_f32_16x16x32_bf16 a[108:111], v[140:143], v[172:175], a[108:111]
  v_mfma_f32_16x16x32_bf16 a[112:115], v[140:143], v[176:179], a[112:115]
  ds_read_b64_tr_b16 v[242:243], v10 offset:9216
  v_mfma_f32_16x16x32_bf16 a[116:119], v[140:143], v[180:183], a[116:119]
  v_mfma_f32_16x16x32_bf16 a[120:123], v[140:143], v[184:187], a[120:123]
  ds_read_b128 v[212:215], v5 offset:43008
  v_mfma_f32_16x16x32_bf16 a[124:127], v[140:143], v[188:191], a[124:127]
  s_add_u32 m0, s62, 24576
  s_nop 0
  buffer_load_dwordx4 v24, s[16:19], s42 offen  lds
  v_mfma_f32_16x16x32_bf16 a[128:131], v[144:147], v[160:163], a[128:131]
  ds_read_b64_tr_b16 v[244:245], v11 offset:8192
  v_mfma_f32_16x16x32_bf16 a[132:135], v[144:147], v[164:167], a[132:135]
  v_mfma_f32_16x16x32_bf16 a[136:139], v[144:147], v[168:171], a[136:139]
  ds_read_b64_tr_b16 v[246:247], v11 offset:9216
  v_mfma_f32_16x16x32_bf16 a[140:143], v[144:147], v[172:175], a[140:143]
  v_mfma_f32_16x16x32_bf16 a[144:147], v[144:147], v[176:179], a[144:147]
  ds_read_b128 v[216:219], v5 offset:45056
  v_mfma_f32_16x16x32_bf16 a[148:151], v[144:147], v[180:183], a[148:151]
  v_mfma_f32_16x16x32_bf16 a[152:155], v[144:147], v[184:187], a[152:155]
  s_add_u32 m0, s62, 12288
  s_nop 0
  buffer_load_dwordx4 v3, s[12:15], s43 offen  lds
  ds_read_b64_tr_b16 v[248:249], v12 offset:8192
  v_mfma_f32_16x16x32_bf16 a[156:159], v[144:147], v[188:191], a[156:159]
  v_mfma_f32_16x16x32_bf16 a[160:163], v[148:151], v[160:163], a[160:163]
  ds_read_b64_tr_b16 v[250:251], v12 offset:9216
  v_mfma_f32_16x16x32_bf16 a[164:167], v[148:151], v[164:167], a[164:167]
  v_mfma_f32_16x16x32_bf16 a[168:171], v[148:151], v[168:171], a[168:171]
  ds_read_b128 v[220:223], v5 offset:47104
  v_mfma_f32_16x16x32_bf16 a[172:175], v[148:151], v[172:175], a[172:175]
  v_mfma_f32_16x16x32_bf16 a[176:179], v[148:151], v[176:179], a[176:179]
  s_add_u32 m0, s62, 28672
  s_nop 0
  buffer_load_dwordx4 v24, s[16:19], s43 offen  lds
  v_add_u32 v3, s45, v3
  v_add_u32 v24, s45, v24
  ds_read_b64_tr_b16 v[252:253], v13 offset:8192
  v_mfma_f32_16x16x32_bf16 a[180:183], v[148:151], v[180:183], a[180:183]
  v_mfma_f32_16x16x32_bf16 a[184:187], v[148:151], v[184:187], a[184:187]
  ds_read_b64_tr_b16 v[254:255], v13 offset:9216
  v_mfma_f32_16x16x32_bf16 a[188:191], v[148:151], v[188:191], a[188:191]
  v_mfma_f32_16x16x32_bf16 a[192:195], v[152:155], v[160:163], a[192:195]
  v_mfma_f32_16x16x32_bf16 a[196:199], v[152:155], v[164:167], a[196:199]
  v_mfma_f32_16x16x32_bf16 a[200:203], v[152:155], v[168:171], a[200:203]
  v_mfma_f32_16x16x32_bf16 a[204:207], v[152:155], v[172:175], a[204:207]
  v_mfma_f32_16x16x32_bf16 a[208:211], v[152:155], v[176:179], a[208:211]
  v_mfma_f32_16x16x32_bf16 a[212:215], v[152:155], v[180:183], a[212:215]
  v_mfma_f32_16x16x32_bf16 a[216:219], v[152:155], v[184:187], a[216:219]
  v_mfma_f32_16x16x32_bf16 a[220:223], v[152:155], v[188:191], a[220:223]
  v_mfma_f32_16x16x32_bf16 a[224:227], v[156:159], v[160:163], a[224:227]
  s_add_u32 s62, s95, s97
  s_cmp_eq_u32 s97, 0x10000
  v_mfma_f32_16x16x32_bf16 a[228:231], v[156:159], v[164:167], a[228:231]
  s_cselect_b32 s63, 0xffff0000, s61
  s_add_u32 s97, s97, s63
  v_mfma_f32_16x16x32_bf16 a[232:235], v[156:159], v[168:171], a[232:235]
  v_add_u32 v6, s63, v6
  v_add_u32 v7, s63, v7
  v_mfma_f32_16x16x32_bf16 a[236:239], v[156:159], v[172:175], a[236:239]
  v_add_u32 v8, s63, v8
  v_add_u32 v9, s63, v9
  v_mfma_f32_16x16x32_bf16 a[240:243], v[156:159], v[176:179], a[240:243]
  v_add_u32 v10, s63, v10
  v_add_u32 v11, s63, v11
  v_mfma_f32_16x16x32_bf16 a[244:247], v[156:159], v[180:183], a[244:247]
  v_add_u32 v12, s63, v12
  v_add_u32 v13, s63, v13
  v_mfma_f32_16x16x32_bf16 a[248:251], v[156:159], v[184:187], a[248:251]
  v_mfma_f32_16x16x32_bf16 a[252:255], v[156:159], v[188:191], a[252:255]
  s_waitcnt vmcnt(8) lgkmcnt(0)
  s_barrier
  s_cmp_eq_u32 s55, 0
  s_cbranch_scc1 nf_51
  v_mov_b32 v14, s55
  s_mov_b64 exec, 1
  buffer_atomic_add v15, v14, s[4:7], 0 offen
  s_mov_b64 exec, -1
  s_mov_b32 s55, 0
nf_51:
  v_mfma_f32_16x16x32_bf16 a[0:3], v[192:195], v[224:227], a[0:3]
  ds_read_b128 v[128:131], v4 offset:0
  s_add_u32 m0, s95, 131072
  s_nop 0
  buffer_load_dwordx4 v2, s[8:11], s32 offen sc1 lds
  v_mfma_f32_16x16x32_bf16 a[4:7], v[192:195], v[228:231], a[4:7]
  v_mfma_f32_16x16x32_bf16 a[8:11], v[192:195], v[232:235], a[8:11]
  ds_read_b64_tr_b16 v[160:161], v6 offset:0
  v_mfma_f32_16x16x32_bf16 a[12:15], v[192:195], v[236:239], a[12:15]
  v_mfma_f32_16x16x32_bf16 a[16:19], v[192:195], v[240:243], a[16:19]
  ds_read_b64_tr_b16 v[162:163], v6 offset:1024
  v_mfma_f32_16x16x32_bf16 a[20:23], v[192:195], v[244:247], a[20:23]
  s_add_u32 m0, s95, 135168
  s_nop 0
  buffer_load_dwordx4 v2, s[8:11], s33 offen sc1 lds
  v_mfma_f32_16x16x32_bf16 a[24:27], v[192:195], v[248:251], a[24:27]
  ds_read_b128 v[132:135], v4 offset:2048
  v_mfma_f32_16x16x32_bf16 a[28:31], v[192:195], v[252:255], a[28:31]
  v_mfma_f32_16x16x32_bf16 a[32:35], v[196:199], v[224:227], a[32:35]
  ds_read_b64_tr_b16 v[164:165], v7 offset:0
  v_mfma_f32_16x16x32_bf16 a[36:39], v[196:199], v[228:231], a[36:39]
  v_mfma_f32_16x16x32_bf16 a[40:43], v[196:199], v[232:235], a[40:43]
  s_add_u32 m0, s95, 139264
  s_nop 0
  buffer_load_dwordx4 v2, s[8:11], s34 offen sc1 lds
  ds_read_b64_tr_b16 v[166:167], v7 offset:1024
  v_mfma_f32_16x16x32_bf16 a[44:47], v[196:199], v[236:239], a[44:47]
  v_mfma_f32_16x16x32_bf16 a[48:51], v[196:199], v[240:243], a[48:51]
  ds_read_b128 v[136:139], v4 offset:4096
  v_mfma_f32_16x16x32_bf16 a[52:55], v[196:199], v[244:247], a[52:55]
  v_mfma_f32_16x16x32_bf16 a[56:59], v[196:199], v[248:251], a[56:59]
  ds_read_b64_tr_b16 v[168:169], v8 offset:0
  s_add_u32 m0, s95, 143360
  s_nop 0
  buffer_load_dwordx4 v2, s[8:11], s35 offen sc1 lds
  v_mfma_f32_16x16x32_bf16 a[60:63], v[196:199], v[252:255], a[60:63]
  v_mfma_f32_16x16x32_bf16 a[64:67], v[200:203], v[224:227], a[64:67]
  ds_read_b64_tr_b16 v[170:171], v8 offset:1024
  v_mfma_f32_16x16x32_bf16 a[68:71], v[200:203], v[228:231], a[68:71]
  v_mfma_f32_16x16x32_bf16 a[72:75], v[200:203], v[232:235], a[72:75]
  ds_read_b128 v[140:143], v4 offset:6144
  v_mfma_f32_16x16x32_bf16 a[76:79], v[200:203], v[236:239], a[76:79]
  s_add_u32 m0, s95, 147456
  s_nop 0
  buffer_load_dwordx4 v2, s[8:11], s36 offen sc1 lds
  v_mfma_f32_16x16x32_bf16 a[80:83], v[200:203], v[240:243], a[80:83]
  ds_read_b64_tr_b16 v[172:173], v9 offset:0
  v_mfma_f32_16x16x32_bf16 a[84:87], v[200:203], v[244:247], a[84:87]
  v_mfma_f32_16x16x32_bf16 a[88:91], v[200:203], v[248:251], a[88:91]
  ds_read_b64_tr_b16 v[174:175], v9 offset:1024
  v_mfma_f32_16x16x32_bf16 a[92:95], v[200:203], v[252:255], a[92:95]
  v_mfma_f32_16x16x32_bf16 a[96:99], v[204:207], v[224:227], a[96:99]
  s_add_u32 m0, s95, 151552
  s_nop 0
  buffer_load_dwordx4 v2, s[8:11], s37 offen sc1 lds
  ds_read_b128 v[144:147], v4 offset:8192
  v_mfma_f32_16x16x32_bf16 a[100:103], v[204:207], v[228:231], a[100:103]
  v_mfma_f32_16x16x32_bf16 a[104:107], v[204:207], v[232:235], a[104:107]
  ds_read_b64_tr_b16 v[176:177], v10 offset:0
  v_mfma_f32_16x16x32_bf16 a[108:111], v[204:207], v[236:239], a[108:111]
  v_mfma_f32_16x16x32_bf16 a[112:115], v[204:207], v[240:243], a[112:115]
  ds_read_b64_tr_b16 v[178:179], v10 offset:1024
  s_add_u32 m0, s95, 155648
  s_nop 0
  buffer_load_dwordx4 v2, s[8:11], s38 offen sc1 lds
  v_mfma_f32_16x16x32_bf16 a[116:119], v[204:207], v[244:247], a[116:119]
  v_mfma_f32_16x16x32_bf16 a[120:123], v[204:207], v[248:251], a[120:123]
  ds_read_b128 v[148:151], v4 offset:10240
  v_mfma_f32_16x16x32_bf16 a[124:127], v[204:207], v[252:255], a[124:127]
  v_mfma_f32_16x16x32_bf16 a[128:131], v[208:211], v[224:227], a[128:131]
  ds_read_b64_tr_b16 v[180:181], v11 offset:0
  v_mfma_f32_16x16x32_bf16 a[132:135], v[208:211], v[228:231], a[132:135]
  s_add_u32 m0, s95, 159744
  s_nop 0
  buffer_load_dwordx4 v2, s[8:11], s39 offen sc1 lds
  v_add_u32 v2, s44, v2
  v_mfma_f32_16x16x32_bf16 a[136:139], v[208:211], v[232:235], a[136:139]
  ds_read_b64_tr_b16 v[182:183], v11 offset:1024
  v_mfma_f32_16x16x32_bf16 a[140:143], v[208:211], v[236:239], a[140:143]
  v_mfma_f32_16x16x32_bf16 a[144:147], v[208:211], v[240:243], a[144:147]
  ds_read_b128 v[152:155], v4 offset:12288
  v_mfma_f32_16x16x32_bf16 a[148:151], v[208:211], v[244:247], a[148:151]
  v_mfma_f32_16x16x32_bf16 a[152:155], v[208:211], v[248:251], a[152:155]
  ds_read_b64_tr_b16 v[184:185], v12 offset:0
  v_mfma_f32_16x16x32_bf16 a[156:159], v[208:211], v[252:255], a[156:159]
  v_mfma_f32_16x16x32_bf16 a[160:163], v[212:215], v[224:227], a[160:163]
  ds_read_b64_tr_b16 v[186:187], v12 offset:1024
  v_mfma_f32_16x16x32_bf16 a[164:167], v[212:215], v[228:231], a[164:167]
  v_mfma_f32_16x16x32_bf16 a[168:171], v[212:215], v[232:235], a[168:171]
  ds_read_b128 v[156:159], v4 offset:14336
  v_mfma_f32_16x16x32_bf16 a[172:175], v[212:215], v[236:239], a[172:175]
  v_mfma_f32_16x16x32_bf16 a[176:179], v[212:215], v[240:243], a[176:179]
  ds_read_b64_tr_b16 v[188:189], v13 offset:0
  v_mfma_f32_16x16x32_bf16 a[180:183], v[212:215], v[244:247], a[180:183]
  v_mfma_f32_16x16x32_bf16 a[184:187], v[212:215], v[248:251], a[184:187]
  ds_read_b64_tr_b16 v[190:191], v13 offset:1024
  v_mfma_f32_16x16x32_bf16 a[188:191], v[212:215], v[252:255], a[188:191]
  v_mfma_f32_16x16x32_bf16 a[192:195], v[216:219], v[224:227], a[192:195]
  v_mfma_f32_16x16x32_bf16 a[196:199], v[216:219], v[228:231], a[196:199]
  v_mfma_f32_16x16x32_bf16 a[200:203], v[216:219], v[232:235], a[200:203]
  v_mfma_f32_16x16x32_bf16 a[204:207], v[216:219], v[236:239], a[204:207]
  v_mfma_f32_16x16x32_bf16 a[208:211], v[216:219], v[240:243], a[208:211]
  v_mfma_f32_16x16x32_bf16 a[212:215], v[216:219], v[244:247], a[212:215]
  v_mfma_f32_16x16x32_bf16 a[216:219], v[216:219], v[248:251], a[216:219]
  v_mfma_f32_16x16x32_bf16 a[220:223], v[216:219], v[252:255], a[220:223]
  v_mfma_f32_16x16x32_bf16 a[224:227], v[220:223], v[224:227], a[224:227]
  v_mfma_f32_16x16x32_bf16 a[228:231], v[220:223], v[228:231], a[228:231]
  v_mfma_f32_16x16x32_bf16 a[232:235], v[220:223], v[232:235], a[232:235]
  v_mfma_f32_16x16x32_bf16 a[236:239], v[220:223], v[236:239], a[236:239]
  v_mfma_f32_16x16x32_bf16 a[240:243], v[220:223], v[240:243], a[240:243]
  v_mfma_f32_16x16x32_bf16 a[244:247], v[220:223], v[244:247], a[244:247]
  v_mfma_f32_16x16x32_bf16 a[248:251], v[220:223], v[248:251], a[248:251]
  v_mfma_f32_16x16x32_bf16 a[252:255], v[220:223], v[252:255], a[252:255]
  s_waitcnt lgkmcnt(0)
G_l_bn_l:
  v_mfma_f32_16x16x32_bf16 a[0:3], v[128:131], v[160:163], a[0:3]
  ds_read_b128 v[192:195], v5 offset:0
  s_add_u32 m0, s62, 0
  s_nop 0
  buffer_load_dwordx4 v3, s[12:15], s40 offen  lds
  v_mfma_f32_16x16x32_bf16 a[4:7], v[128:131], v[164:167], a[4:7]
  v_mfma_f32_16x16x32_bf16 a[8:11], v[128:131], v[168:171], a[8:11]
  ds_read_b64_tr_b16 v[224:225], v6 offset:8192
  v_mfma_f32_16x16x32_bf16 a[12:15], v[128:131], v[172:175], a[12:15]
  v_mfma_f32_16x16x32_bf16 a[16:19], v[128:131], v[176:179], a[16:19]
  ds_read_b64_tr_b16 v[226:227], v6 offset:9216
  v_mfma_f32_16x16x32_bf16 a[20:23], v[128:131], v[180:183], a[20:23]
  v_mfma_f32_16x16x32_bf16 a[24:27], v[128:131], v[184:187], a[24:27]
  ds_read_b128 v[196:199], v5 offset:2048
  s_add_u32 m0, s62, 16384
  s_nop 0
  buffer_load_dwordx4 v24, s[16:19], s40 offen  lds
  v_mfma_f32_16x16x32_bf16 a[28:31], v[128:131], v[188:191], a[28:31]
  v_mfma_f32_16x16x32_bf16 a[32:35], v[132:135], v[160:163], a[32:35]
  ds_read_b64_tr_b16 v[228:229], v7 offset:8192
  v_mfma_f32_16x16x32_bf16 a[36:39], v[132:135], v[164:167], a[36:39]
  v_mfma_f32_16x16x32_bf16 a[40:43], v[132:135], v[168:171], a[40:43]
  ds_read_b64_tr_b16 v[230:231], v7 offset:9216
  v_mfma_f32_16x16x32_bf16 a[44:47], v[132:135], v[172:175], a[44:47]
  v_mfma_f32_16x16x32_bf16 a[48:51], v[132:135], v[176:179], a[48:51]
  ds_read_b128 v[200:203], v5 offset:4096
  s_add_u32 m0, s62, 4096
  s_nop 0
  buffer_load_dwordx4 v3, s[12:15], s41 offen  lds
  v_mfma_f32_16x16x32_bf16 a[52:55], v[132:135], v[180:183], a[52:55]
  v_mfma_f32_16x16x32_bf16 a[56:59], v[132:135], v[184:187], a[56:59]
  ds_read_b64_tr_b16 v[232:233], v8 offset:8192
  v_mfma_f32_16x16x32_bf16 a[60:63], v[132:135], v[188:191], a[60:63]
  v_mfma_f32_16x16x32_bf16 a[64:67], v[136:139], v[160:163], a[64:67]
  ds_read_b64_tr_b16 v[234:235], v8 offset:9216
  v_mfma_f32_16x16x32_bf16 a[68:71], v[136:139], v[164:167], a[68:71]
  v_mfma_f32_16x16x32_bf16 a[72:75], v[136:139], v[168:171], a[72:75]
  ds_read_b128 v[204:207], v5 offset:6144
  v_mfma_f32_16x16x32_bf16 a[76:79], v[136:139], v[172:175], a[76:79]
  s_add_u32 m0, s62, 20480
  s_nop 0
  buffer_load_dwordx4 v24, s[16:19], s41 offen  lds
  v_mfma_f32_16x16x32_bf16 a[80:83], v[136:139], v[176:179], a[80:83]
  ds_read_b64_tr_b16 v[236:237], v9 offset:8192
  v_mfma_f32_16x16x32_bf16 a[84:87], v[136:139], v[180:183], a[84:87]
  v_mfma_f32_16x16x32_bf16 a[88:91], v[136:139], v[184:187], a[88:91]
  ds_read_b64_tr_b16 v[238:239], v9 offset:9216
  v_mfma_f32_16x16x32_bf16 a[92:95], v[136:139], v[188:191], a[92:95]
  v_mfma_f32_16x16x32_bf16 a[96:99], v[140:143], v[160:163], a[96:99]
  ds_read_b128 v[208:211], v5 offset:8192
  v_mfma_f32_16x16x32_bf16 a[100:103], v[140:143], v[164:167], a[100:103]
  s_add_u32 m0, s62, 8192
  s_nop 0
  buffer_load_dwordx4 v3, s[12:15], s42 offen  lds
  v_mfma_f32_16x16x32_bf16 a[104:107], v[140:143], v[168:171], a[104:107]
  ds_read_b64_tr_b16 v[240:241], v10 offset:8192
  v_mfma_f32_16x16x32_bf16 a[108:111], v[140:143], v[172:175], a[108:111]
  v_mfma_f32_16x16x32_bf16 a[112:115], v[140:143], v[176:179], a[112:115]
  ds_read_b64_tr_b16 v[242:243], v10 offset:9216
  v_mfma_f32_16x16x32_bf16 a[116:119], v[140:143], v[180:183], a[116:119]
  v_mfma_f32_16x16x32_bf16 a[120:123], v[140:143], v[184:187], a[120:123]
  ds_read_b128 v[212:215], v5 offset:10240
  v_mfma_f32_16x16x32_bf16 a[124:127], v[140:143], v[188:191], a[124:127]
  s_add_u32 m0, s62, 24576
  s_nop 0
  buffer_load_dwordx4 v24, s[16:19], s42 offen  lds
  v_mfma_f32_16x16x32_bf16 a[128:131], v[144:147], v[160:163], a[128:131]
  ds_read_b64_tr_b16 v[244:245], v11 offset:8192
  v_mfma_f32_16x16x32_bf16 a[132:135], v[144:147], v[164:167], a[132:135]
  v_mfma_f32_16x16x32_bf16 a[136:139], v[144:147], v[168:171], a[136:139]
  ds_read_b64_tr_b16 v[246:247], v11 offset:9216
  v_mfma_f32_16x16x32_bf16 a[140:143], v[144:147], v[172:175], a[140:143]
  v_mfma_f32_16x16x32_bf16 a[144:147], v[144:147], v[176:179], a[144:147]
  ds_read_b128 v[216:219], v5 offset:12288
  v_mfma_f32_16x16x32_bf16 a[148:151], v[144:147], v[180:183], a[148:151]
  v_mfma_f32_16x16x32_bf16 a[152:155], v[144:147], v[184:187], a[152:155]
  s_add_u32 m0, s62, 12288
  s_nop 0
  buffer_load_dwordx4 v3, s[12:15], s43 offen  lds
  ds_read_b64_tr_b16 v[248:249], v12 offset:8192
  v_mfma_f32_16x16x32_bf16 a[156:159], v[144:147], v[188:191], a[156:159]
  v_mfma_f32_16x16x32_bf16 a[160:163], v[148:151], v[160:163], a[160:163]
  ds_read_b64_tr_b16 v[250:251], v12 offset:9216
  v_mfma_f32_16x16x32_bf16 a[164:167], v[148:151], v[164:167], a[164:167]
  v_mfma_f32_16x16x32_bf16 a[168:171], v[148:151], v[168:171], a[168:171]
  ds_read_b128 v[220:223], v5 offset:14336
  v_mfma_f32_16x16x32_bf16 a[172:175], v[148:151], v[172:175], a[172:175]
  v_mfma_f32_16x16x32_bf16 a[176:179], v[148:151], v[176:179], a[176:179]
  s_add_u32 m0, s62, 28672
  s_nop 0
  buffer_load_dwordx4 v24, s[16:19], s43 offen  lds
  v_add_u32 v3, s45, v3
  v_add_u32 v24, s45, v24
  ds_read_b64_tr_b16 v[252:253], v13 offset:8192
  v_mfma_f32_16x16x32_bf16 a[180:183], v[148:151], v[180:183], a[180:183]
  v_mfma_f32_16x16x32_bf16 a[184:187], v[148:151], v[184:187], a[184:187]
  ds_read_b64_tr_b16 v[254:255], v13 offset:9216
  v_mfma_f32_16x16x32_bf16 a[188:191], v[148:151], v[188:191], a[188:191]
  v_mfma_f32_16x16x32_bf16 a[192:195], v[152:155], v[160:163], a[192:195]
  v_mfma_f32_16x16x32_bf16 a[196:199], v[152:155], v[164:167], a[196:199]
  v_mfma_f32_16x16x32_bf16 a[200:203], v[152:155], v[168:171], a[200:203]
  v_mfma_f32_16x16x32_bf16 a[204:207], v[152:155], v[172:175], a[204:207]
  v_mfma_f32_16x16x32_bf16 a[208:211], v[152:155], v[176:179], a[208:211]
  v_mfma_f32_16x16x32_bf16 a[212:215], v[152:155], v[180:183], a[212:215]
  v_mfma_f32_16x16x32_bf16 a[216:219], v[152:155], v[184:187], a[216:219]
  v_mfma_f32_16x16x32_bf16 a[220:223], v[152:155], v[188:191], a[220:223]
  v_mfma_f32_16x16x32_bf16 a[224:227], v[156:159], v[160:163], a[224:227]
  s_add_u32 s62, s95, s97
  s_cmp_eq_u32 s97, 0x10000
  v_mfma_f32_16x16x32_bf16 a[228:231], v[156:159], v[164:167], a[228:231]
  s_cselect_b32 s63, 0xffff0000, s61
  s_add_u32 s97, s97, s63
  v_mfma_f32_16x16x32_bf16 a[232:235], v[156:159], v[168:171], a[232:235]
  v_add_u32 v6, s63, v6
  v_add_u32 v7, s63, v7
  v_mfma_f32_16x16x32_bf16 a[236:239], v[156:159], v[172:175], a[236:239]
  v_add_u32 v8, s63, v8
  v_add_u32 v9, s63, v9
  v_mfma_f32_16x16x32_bf16 a[240:243], v[156:159], v[176:179], a[240:243]
  v_add_u32 v10, s63, v10
  v_add_u32 v11, s63, v11
  v_mfma_f32_16x16x32_bf16 a[244:247], v[156:159], v[180:183], a[244:247]
  v_add_u32 v12, s63, v12
  v_add_u32 v13, s63, v13
  v_mfma_f32_16x16x32_bf16 a[248:251], v[156:159], v[184:187], a[248:251]
  v_mfma_f32_16x16x32_bf16 a[252:255], v[156:159], v[188:191], a[252:255]
  s_waitcnt vmcnt(8) lgkmcnt(0)
  s_barrier
  v_mfma_f32_16x16x32_bf16 a[0:3], v[192:195], v[224:227], a[0:3]
  ds_read_b128 v[128:131], v4 offset:32768
  s_add_u32 m0, s95, 98304
  s_nop 0
  buffer_load_dwordx4 v2, s[8:11], s32 offen sc1 lds
  v_mfma_f32_16x16x32_bf16 a[4:7], v[192:195], v[228:231], a[4:7]
  v_mfma_f32_16x16x32_bf16 a[8:11], v[192:195], v[232:235], a[8:11]
  ds_read_b64_tr_b16 v[160:161], v6 offset:0
  v_mfma_f32_16x16x32_bf16 a[12:15], v[192:195], v[236:239], a[12:15]
  v_mfma_f32_16x16x32_bf16 a[16:19], v[192:195], v[240:243], a[16:19]
  ds_read_b64_tr_b16 v[162:163], v6 offset:1024
  v_mfma_f32_16x16x32_bf16 a[20:23], v[192:195], v[244:247], a[20:23]
  s_add_u32 m0, s95, 102400
  s_nop 0
  buffer_load_dwordx4 v2, s[8:11], s33 offen sc1 lds
  v_mfma_f32_16x16x32_bf16 a[24:27], v[192:195], v[248:251], a[24:27]
  ds_read_b128 v[132:135], v4 offset:34816
  v_mfma_f32_16x16x32_bf16 a[28:31], v[192:195], v[252:255], a[28:31]
  v_mfma_f32_16x16x32_bf16 a[32:35], v[196:199], v[224:227], a[32:35]
  ds_read_b64_tr_b16 v[164:165], v7 offset:0
  v_mfma_f32_16x16x32_bf16 a[36:39], v[196:199], v[228:231], a[36:39]
  v_mfma_f32_16x16x32_bf16 a[40:43], v[196:199], v[232:235], a[40:43]
  s_add_u32 m0, s95, 106496
  s_nop 0
  buffer_load_dwordx4 v2, s[8:11], s34 offen sc1 lds
  ds_read_b64_tr_b16 v[166:167], v7 offset:1024
  v_mfma_f32_16x16x32_bf16 a[44:47], v[196:199], v[236:239], a[44:47]
  v_mfma_f32_16x16x32_bf16 a[48:51], v[196:199], v[240:243], a[48:51]
  ds_read_b128 v[136:139], v4 offset:36864
  v_mfma_f32_16x16x32_bf16 a[52:55], v[196:199], v[244:247], a[52:55]
  v_mfma_f32_16x16x32_bf16 a[56:59], v[196:199], v[248:251], a[56:59]
  ds_read_b64_tr_b16 v[168:169], v8 offset:0
  s_add_u32 m0, s95, 110592
  s_nop 0
  buffer_load_dwordx4 v2, s[8:11], s35 offen sc1 lds
  v_mfma_f32_16x16x32_bf16 a[60:63], v[196:199], v[252:255], a[60:63]
  v_mfma_f32_16x16x32_bf16 a[64:67], v[200:203], v[224:227], a[64:67]
  ds_read_b64_tr_b16 v[170:171], v8 offset:1024
  v_mfma_f32_16x16x32_bf16 a[68:71], v[200:203], v[228:231], a[68:71]
  v_mfma_f32_16x16x32_bf16 a[72:75], v[200:203], v[232:235], a[72:75]
  ds_read_b128 v[140:143], v4 offset:38912
  v_mfma_f32_16x16x32_bf16 a[76:79], v[200:203], v[236:239], a[76:79]
  s_add_u32 m0, s95, 114688
  s_nop 0
  buffer_load_dwordx4 v2, s[8:11], s36 offen sc1 lds
  v_mfma_f32_16x16x32_bf16 a[80:83], v[200:203], v[240:243], a[80:83]
  ds_read_b64_tr_b16 v[172:173], v9 offset:0
  v_mfma_f32_16x16x32_bf16 a[84:87], v[200:203], v[244:247], a[84:87]
  v_mfma_f32_16x16x32_bf16 a[88:91], v[200:203], v[248:251], a[88:91]
  ds_read_b64_tr_b16 v[174:175], v9 offset:1024
  v_mfma_f32_16x16x32_bf16 a[92:95], v[200:203], v[252:255], a[92:95]
  v_mfma_f32_16x16x32_bf16 a[96:99], v[204:207], v[224:227], a[96:99]
  s_add_u32 m0, s95, 118784
  s_nop 0
  buffer_load_dwordx4 v2, s[8:11], s37 offen sc1 lds
  ds_read_b128 v[144:147], v4 offset:40960
  v_mfma_f32_16x16x32_bf16 a[100:103], v[204:207], v[228:231], a[100:103]
  v_mfma_f32_16x16x32_bf16 a[104:107], v[204:207], v[232:235], a[104:107]
  ds_read_b64_tr_b16 v[176:177], v10 offset:0
  v_mfma_f32_16x16x32_bf16 a[108:111], v[204:207], v[236:239], a[108:111]
  v_mfma_f32_16x16x32_bf16 a[112:115], v[204:207], v[240:243], a[112:115]
  ds_read_b64_tr_b16 v[178:179], v10 offset:1024
  s_add_u32 m0, s95, 122880
  s_nop 0
  buffer_load_dwordx4 v2, s[8:11], s38 offen sc1 lds
  v_mfma_f32_16x16x32_bf16 a[116:119], v[204:207], v[244:247], a[116:119]
  v_mfma_f32_16x16x32_bf16 a[120:123], v[204:207], v[248:251], a[120:123]
  ds_read_b128 v[148:151], v4 offset:43008
  v_mfma_f32_16x16x32_bf16 a[124:127], v[204:207], v[252:255], a[124:127]
  v_mfma_f32_16x16x32_bf16 a[128:131], v[208:211], v[224:227], a[128:131]
  ds_read_b64_tr_b16 v[180:181], v11 offset:0
  v_mfma_f32_16x16x32_bf16 a[132:135], v[208:211], v[228:231], a[132:135]
  s_add_u32 m0, s95, 126976
  s_nop 0
  buffer_load_dwordx4 v2, s[8:11], s39 offen sc1 lds
  v_add_u32 v2, s44, v2
  v_mfma_f32_16x16x32_bf16 a[136:139], v[208:211], v[232:235], a[136:139]
  ds_read_b64_tr_b16 v[182:183], v11 offset:1024
  v_mfma_f32_16x16x32_bf16 a[140:143], v[208:211], v[236:239], a[140:143]
  v_mfma_f32_16x16x32_bf16 a[144:147], v[208:211], v[240:243], a[144:147]
  ds_read_b128 v[152:155], v4 offset:45056
  v_mfma_f32_16x16x32_bf16 a[148:151], v[208:211], v[244:247], a[148:151]
  v_mfma_f32_16x16x32_bf16 a[152:155], v[208:211], v[248:251], a[152:155]
  ds_read_b64_tr_b16 v[184:185], v12 offset:0
  v_mfma_f32_16x16x32_bf16 a[156:159], v[208:211], v[252:255], a[156:159]
  v_mfma_f32_16x16x32_bf16 a[160:163], v[212:215], v[224:227], a[160:163]
  ds_read_b64_tr_b16 v[186:187], v12 offset:1024
  v_mfma_f32_16x16x32_bf16 a[164:167], v[212:215], v[228:231], a[164:167]
  v_mfma_f32_16x16x32_bf16 a[168:171], v[212:215], v[232:235], a[168:171]
  ds_read_b128 v[156:159], v4 offset:47104
  v_mfma_f32_16x16x32_bf16 a[172:175], v[212:215], v[236:239], a[172:175]
  v_mfma_f32_16x16x32_bf16 a[176:179], v[212:215], v[240:243], a[176:179]
  ds_read_b64_tr_b16 v[188:189], v13 offset:0
  v_mfma_f32_16x16x32_bf16 a[180:183], v[212:215], v[244:247], a[180:183]
  v_mfma_f32_16x16x32_bf16 a[184:187], v[212:215], v[248:251], a[184:187]
  ds_read_b64_tr_b16 v[190:191], v13 offset:1024
  v_mfma_f32_16x16x32_bf16 a[188:191], v[212:215], v[252:255], a[188:191]
  v_mfma_f32_16x16x32_bf16 a[192:195], v[216:219], v[224:227], a[192:195]
  v_mfma_f32_16x16x32_bf16 a[196:199], v[216:219], v[228:231], a[196:199]
  v_mfma_f32_16x16x32_bf16 a[200:203], v[216:219], v[232:235], a[200:203]
  v_mfma_f32_16x16x32_bf16 a[204:207], v[216:219], v[236:239], a[204:207]
  v_mfma_f32_16x16x32_bf16 a[208:211], v[216:219], v[240:243], a[208:211]
  v_mfma_f32_16x16x32_bf16 a[212:215], v[216:219], v[244:247], a[212:215]
  v_mfma_f32_16x16x32_bf16 a[216:219], v[216:219], v[248:251], a[216:219]
  v_mfma_f32_16x16x32_bf16 a[220:223], v[216:219], v[252:255], a[220:223]
  v_mfma_f32_16x16x32_bf16 a[224:227], v[220:223], v[224:227], a[224:227]
  v_mfma_f32_16x16x32_bf16 a[228:231], v[220:223], v[228:231], a[228:231]
  v_mfma_f32_16x16x32_bf16 a[232:235], v[220:223], v[232:235], a[232:235]
  v_mfma_f32_16x16x32_bf16 a[236:239], v[220:223], v[236:239], a[236:239]
  v_mfma_f32_16x16x32_bf16 a[240:243], v[220:223], v[240:243], a[240:243]
  v_mfma_f32_16x16x32_bf16 a[244:247], v[220:223], v[244:247], a[244:247]
  v_mfma_f32_16x16x32_bf16 a[248:251], v[220:223], v[248:251], a[248:251]
  v_mfma_f32_16x16x32_bf16 a[252:255], v[220:223], v[252:255], a[252:255]
  s_waitcnt lgkmcnt(0)
  v_mfma_f32_16x16x32_bf16 a[0:3], v[128:131], v[160:163], a[0:3]
  ds_read_b128 v[192:195], v5 offset:32768
  s_add_u32 m0, s62, 0
  s_nop 0
  buffer_load_dwordx4 v3, s[12:15], s40 offen  lds
  v_mfma_f32_16x16x32_bf16 a[4:7], v[128:131], v[164:167], a[4:7]
  v_mfma_f32_16x16x32_bf16 a[8:11], v[128:131], v[168:171], a[8:11]
  ds_read_b64_tr_b16 v[224:225], v6 offset:8192
  v_mfma_f32_16x16x32_bf16 a[12:15], v[128:131], v[172:175], a[12:15]
  v_mfma_f32_16x16x32_bf16 a[16:19], v[128:131], v[176:179], a[16:19]
  ds_read_b64_tr_b16 v[226:227], v6 offset:9216
  v_mfma_f32_16x16x32_bf16 a[20:23], v[128:131], v[180:183], a[20:23]
  v_mfma_f32_16x16x32_bf16 a[24:27], v[128:131], v[184:187], a[24:27]
  ds_read_b128 v[196:199], v5 offset:34816
  s_add_u32 m0, s62, 16384
  s_nop 0
  buffer_load_dwordx4 v24, s[16:19], s40 offen  lds
  v_mfma_f32_16x16x32_bf16 a[28:31], v[128:131], v[188:191], a[28:31]
  v_mfma_f32_16x16x32_bf16 a[32:35], v[132:135], v[160:163], a[32:35]
  ds_read_b64_tr_b16 v[228:229], v7 offset:8192
  v_mfma_f32_16x16x32_bf16 a[36:39], v[132:135], v[164:167], a[36:39]
  v_mfma_f32_16x16x32_bf16 a[40:43], v[132:135], v[168:171], a[40:43]
  ds_read_b64_tr_b16 v[230:231], v7 offset:9216
  v_mfma_f32_16x16x32_bf16 a[44:47], v[132:135], v[172:175], a[44:47]
  v_mfma_f32_16x16x32_bf16 a[48:51], v[132:135], v[176:179], a[48:51]
  ds_read_b128 v[200:203], v5 offset:36864
  s_add_u32 m0, s62, 4096
  s_nop 0
  buffer_load_dwordx4 v3, s[12:15], s41 offen  lds
  v_mfma_f32_16x16x32_bf16 a[52:55], v[132:135], v[180:183], a[52:55]
  v_mfma_f32_16x16x32_bf16 a[56:59], v[132:135], v[184:187], a[56:59]
  ds_read_b64_tr_b16 v[232:233], v8 offset:8192
  v_mfma_f32_16x16x32_bf16 a[60:63], v[132:135], v[188:191], a[60:63]
  v_mfma_f32_16x16x32_bf16 a[64:67], v[136:139], v[160:163], a[64:67]
  ds_read_b64_tr_b16 v[234:235], v8 offset:9216
  v_mfma_f32_16x16x32_bf16 a[68:71], v[136:139], v[164:167], a[68:71]
  v_mfma_f32_16x16x32_bf16 a[72:75], v[136:139], v[168:171], a[72:75]
  ds_read_b128 v[204:207], v5 offset:38912
  v_mfma_f32_16x16x32_bf16 a[76:79], v[136:139], v[172:175], a[76:79]
  s_add_u32 m0, s62, 20480
  s_nop 0
  buffer_load_dwordx4 v24, s[16:19], s41 offen  lds
  v_mfma_f32_16x16x32_bf16 a[80:83], v[136:139], v[176:179], a[80:83]
  ds_read_b64_tr_b16 v[236:237], v9 offset:8192
  v_mfma_f32_16x16x32_bf16 a[84:87], v[136:139], v[180:183], a[84:87]
  v_mfma_f32_16x16x32_bf16 a[88:91], v[136:139], v[184:187], a[88:91]
  ds_read_b64_tr_b16 v[238:239], v9 offset:9216
  v_mfma_f32_16x16x32_bf16 a[92:95], v[136:139], v[188:191], a[92:95]
  v_mfma_f32_16x16x32_bf16 a[96:99], v[140:143], v[160:163], a[96:99]
  ds_read_b128 v[208:211], v5 offset:40960
  v_mfma_f32_16x16x32_bf16 a[100:103], v[140:143], v[164:167], a[100:103]
  s_add_u32 m0, s62, 8192
  s_nop 0
  buffer_load_dwordx4 v3, s[12:15], s42 offen  lds
  v_mfma_f32_16x16x32_bf16 a[104:107], v[140:143], v[168:171], a[104:107]
  ds_read_b64_tr_b16 v[240:241], v10 offset:8192
  v_mfma_f32_16x16x32_bf16 a[108:111], v[140:143], v[172:175], a[108:111]
  v_mfma_f32_16x16x32_bf16 a[112:115], v[140:143], v[176:179], a[112:115]
  ds_read_b64_tr_b16 v[242:243], v10 offset:9216
  v_mfma_f32_16x16x32_bf16 a[116:119], v[140:143], v[180:183], a[116:119]
  v_mfma_f32_16x16x32_bf16 a[120:123], v[140:143], v[184:187], a[120:123]
  ds_read_b128 v[212:215], v5 offset:43008
  v_mfma_f32_16x16x32_bf16 a[124:127], v[140:143], v[188:191], a[124:127]
  s_add_u32 m0, s62, 24576
  s_nop 0
  buffer_load_dwordx4 v24, s[16:19], s42 offen  lds
  v_mfma_f32_16x16x32_bf16 a[128:131], v[144:147], v[160:163], a[128:131]
  ds_read_b64_tr_b16 v[244:245], v11 offset:8192
  v_mfma_f32_16x16x32_bf16 a[132:135], v[144:147], v[164:167], a[132:135]
  v_mfma_f32_16x16x32_bf16 a[136:139], v[144:147], v[168:171], a[136:139]
  ds_read_b64_tr_b16 v[246:247], v11 offset:9216
  v_mfma_f32_16x16x32_bf16 a[140:143], v[144:147], v[172:175], a[140:143]
  v_mfma_f32_16x16x32_bf16 a[144:147], v[144:147], v[176:179], a[144:147]
  ds_read_b128 v[216:219], v5 offset:45056
  v_mfma_f32_16x16x32_bf16 a[148:151], v[144:147], v[180:183], a[148:151]
  v_mfma_f32_16x16x32_bf16 a[152:155], v[144:147], v[184:187], a[152:155]
  s_add_u32 m0, s62, 12288
  s_nop 0
  buffer_load_dwordx4 v3, s[12:15], s43 offen  lds
  ds_read_b64_tr_b16 v[248:249], v12 offset:8192
  v_mfma_f32_16x16x32_bf16 a[156:159], v[144:147], v[188:191], a[156:159]
  v_mfma_f32_16x16x32_bf16 a[160:163], v[148:151], v[160:163], a[160:163]
  ds_read_b64_tr_b16 v[250:251], v12 offset:9216
  v_mfma_f32_16x16x32_bf16 a[164:167], v[148:151], v[164:167], a[164:167]
  v_mfma_f32_16x16x32_bf16 a[168:171], v[148:151], v[168:171], a[168:171]
  ds_read_b128 v[220:223], v5 offset:47104
  v_mfma_f32_16x16x32_bf16 a[172:175], v[148:151], v[172:175], a[172:175]
  v_mfma_f32_16x16x32_bf16 a[176:179], v[148:151], v[176:179], a[176:179]
  s_add_u32 m0, s62, 28672
  s_nop 0
  buffer_load_dwordx4 v24, s[16:19], s43 offen  lds
  v_add_u32 v3, s45, v3
  v_add_u32 v24, s45, v24
  ds_read_b64_tr_b16 v[252:253], v13 offset:8192
  v_mfma_f32_16x16x32_bf16 a[180:183], v[148:151], v[180:183], a[180:183]
  v_mfma_f32_16x16x32_bf16 a[184:187], v[148:151], v[184:187], a[184:187]
  ds_read_b64_tr_b16 v[254:255], v13 offset:9216
  v_mfma_f32_16x16x32_bf16 a[188:191], v[148:151], v[188:191], a[188:191]
  v_mfma_f32_16x16x32_bf16 a[192:195], v[152:155], v[160:163], a[192:195]
  v_mfma_f32_16x16x32_bf16 a[196:199], v[152:155], v[164:167], a[196:199]
  v_mfma_f32_16x16x32_bf16 a[200:203], v[152:155], v[168:171], a[200:203]
  v_mfma_f32_16x16x32_bf16 a[204:207], v[152:155], v[172:175], a[204:207]
  v_mfma_f32_16x16x32_bf16 a[208:211], v[152:155], v[176:179], a[208:211]
  v_mfma_f32_16x16x32_bf16 a[212:215], v[152:155], v[180:183], a[212:215]
  v_mfma_f32_16x16x32_bf16 a[216:219], v[152:155], v[184:187], a[216:219]
  v_mfma_f32_16x16x32_bf16 a[220:223], v[152:155], v[188:191], a[220:223]
  v_mfma_f32_16x16x32_bf16 a[224:227], v[156:159], v[160:163], a[224:227]
  s_add_u32 s62, s95, s97
  s_cmp_eq_u32 s97, 0x10000
  v_mfma_f32_16x16x32_bf16 a[228:231], v[156:159], v[164:167], a[228:231]
  s_cselect_b32 s63, 0xffff0000, s61
  s_add_u32 s97, s97, s63
  v_mfma_f32_16x16x32_bf16 a[232:235], v[156:159], v[168:171], a[232:235]
  v_add_u32 v6, s63, v6
  v_add_u32 v7, s63, v7
  v_mfma_f32_16x16x32_bf16 a[236:239], v[156:159], v[172:175], a[236:239]
  v_add_u32 v8, s63, v8
  v_add_u32 v9, s63, v9
  v_mfma_f32_16x16x32_bf16 a[240:243], v[156:159], v[176:179], a[240:243]
  v_add_u32 v10, s63, v10
  v_add_u32 v11, s63, v11
  v_mfma_f32_16x16x32_bf16 a[244:247], v[156:159], v[180:183], a[244:247]
  v_add_u32 v12, s63, v12
  v_add_u32 v13, s63, v13
  v_mfma_f32_16x16x32_bf16 a[248:251], v[156:159], v[184:187], a[248:251]
  v_mfma_f32_16x16x32_bf16 a[252:255], v[156:159], v[188:191], a[252:255]
  s_waitcnt vmcnt(8) lgkmcnt(0)
  s_barrier
  v_mfma_f32_16x16x32_bf16 a[0:3], v[192:195], v[224:227], a[0:3]
  ds_read_b128 v[128:131], v4 offset:0
  s_add_u32 m0, s95, 131072
  s_nop 0
  buffer_load_dwordx4 v2, s[8:11], s32 offen sc1 lds
  v_mfma_f32_16x16x32_bf16 a[4:7], v[192:195], v[228:231], a[4:7]
  v_mfma_f32_16x16x32_bf16 a[8:11], v[192:195], v[232:235], a[8:11]
  ds_read_b64_tr_b16 v[160:161], v6 offset:0
  v_mfma_f32_16x16x32_bf16 a[12:15], v[192:195], v[236:239], a[12:15]
  v_mfma_f32_16x16x32_bf16 a[16:19], v[192:195], v[240:243], a[16:19]
  ds_read_b64_tr_b16 v[162:163], v6 offset:1024
  v_mfma_f32_16x16x32_bf16 a[20:23], v[192:195], v[244:247], a[20:23]
  s_add_u32 m0, s95, 135168
  s_nop 0
  buffer_load_dwordx4 v2, s[8:11], s33 offen sc1 lds
  v_mfma_f32_16x16x32_bf16 a[24:27], v[192:195], v[248:251], a[24:27]
  ds_read_b128 v[132:135], v4 offset:2048
  v_mfma_f32_16x16x32_bf16 a[28:31], v[192:195], v[252:255], a[28:31]
  v_mfma_f32_16x16x32_bf16 a[32:35], v[196:199], v[224:227], a[32:35]
  ds_read_b64_tr_b16 v[164:165], v7 offset:0
  v_mfma_f32_16x16x32_bf16 a[36:39], v[196:199], v[228:231], a[36:39]
  v_mfma_f32_16x16x32_bf16 a[40:43], v[196:199], v[232:235], a[40:43]
  s_add_u32 m0, s95, 139264
  s_nop 0
  buffer_load_dwordx4 v2, s[8:11], s34 offen sc1 lds
  ds_read_b64_tr_b16 v[166:167], v7 offset:1024
  v_mfma_f32_16x16x32_bf16 a[44:47], v[196:199], v[236:239], a[44:47]
  v_mfma_f32_16x16x32_bf16 a[48:51], v[196:199], v[240:243], a[48:51]
  ds_read_b128 v[136:139], v4 offset:4096
  v_mfma_f32_16x16x32_bf16 a[52:55], v[196:199], v[244:247], a[52:55]
  v_mfma_f32_16x16x32_bf16 a[56:59], v[196:199], v[248:251], a[56:59]
  ds_read_b64_tr_b16 v[168:169], v8 offset:0
  s_add_u32 m0, s95, 143360
  s_nop 0
  buffer_load_dwordx4 v2, s[8:11], s35 offen sc1 lds
  v_mfma_f32_16x16x32_bf16 a[60:63], v[196:199], v[252:255], a[60:63]
  v_mfma_f32_16x16x32_bf16 a[64:67], v[200:203], v[224:227], a[64:67]
  ds_read_b64_tr_b16 v[170:171], v8 offset:1024
  v_mfma_f32_16x16x32_bf16 a[68:71], v[200:203], v[228:231], a[68:71]
  v_mfma_f32_16x16x32_bf16 a[72:75], v[200:203], v[232:235], a[72:75]
  ds_read_b128 v[140:143], v4 offset:6144
  v_mfma_f32_16x16x32_bf16 a[76:79], v[200:203], v[236:239], a[76:79]
  s_add_u32 m0, s95, 147456
  s_nop 0
  buffer_load_dwordx4 v2, s[8:11], s36 offen sc1 lds
  v_mfma_f32_16x16x32_bf16 a[80:83], v[200:203], v[240:243], a[80:83]
  ds_read_b64_tr_b16 v[172:173], v9 offset:0
  v_mfma_f32_16x16x32_bf16 a[84:87], v[200:203], v[244:247], a[84:87]
  v_mfma_f32_16x16x32_bf16 a[88:91], v[200:203], v[248:251], a[88:91]
  ds_read_b64_tr_b16 v[174:175], v9 offset:1024
  v_mfma_f32_16x16x32_bf16 a[92:95], v[200:203], v[252:255], a[92:95]
  v_mfma_f32_16x16x32_bf16 a[96:99], v[204:207], v[224:227], a[96:99]
  s_add_u32 m0, s95, 151552
  s_nop 0
  buffer_load_dwordx4 v2, s[8:11], s37 offen sc1 lds
  ds_read_b128 v[144:147], v4 offset:8192
  v_mfma_f32_16x16x32_bf16 a[100:103], v[204:207], v[228:231], a[100:103]
  v_mfma_f32_16x16x32_bf16 a[104:107], v[204:207], v[232:235], a[104:107]
  ds_read_b64_tr_b16 v[176:177], v10 offset:0
  v_mfma_f32_16x16x32_bf16 a[108:111], v[204:207], v[236:239], a[108:111]
  v_mfma_f32_16x16x32_bf16 a[112:115], v[204:207], v[240:243], a[112:115]
  ds_read_b64_tr_b16 v[178:179], v10 offset:1024
  s_add_u32 m0, s95, 155648
  s_nop 0
  buffer_load_dwordx4 v2, s[8:11], s38 offen sc1 lds
  v_mfma_f32_16x16x32_bf16 a[116:119], v[204:207], v[244:247], a[116:119]
  v_mfma_f32_16x16x32_bf16 a[120:123], v[204:207], v[248:251], a[120:123]
  ds_read_b128 v[148:151], v4 offset:10240
  v_mfma_f32_16x16x32_bf16 a[124:127], v[204:207], v[252:255], a[124:127]
  v_mfma_f32_16x16x32_bf16 a[128:131], v[208:211], v[224:227], a[128:131]
  ds_read_b64_tr_b16 v[180:181], v11 offset:0
  v_mfma_f32_16x16x32_bf16 a[132:135], v[208:211], v[228:231], a[132:135]
  s_add_u32 m0, s95, 159744
  s_nop 0
  buffer_load_dwordx4 v2, s[8:11], s39 offen sc1 lds
  v_add_u32 v2, s44, v2
  v_mfma_f32_16x16x32_bf16 a[136:139], v[208:211], v[232:235], a[136:139]
  ds_read_b64_tr_b16 v[182:183], v11 offset:1024
  v_mfma_f32_16x16x32_bf16 a[140:143], v[208:211], v[236:239], a[140:143]
  v_mfma_f32_16x16x32_bf16 a[144:147], v[208:211], v[240:243], a[144:147]
  ds_read_b128 v[152:155], v4 offset:12288
  v_mfma_f32_16x16x32_bf16 a[148:151], v[208:211], v[244:247], a[148:151]
  v_mfma_f32_16x16x32_bf16 a[152:155], v[208:211], v[248:251], a[152:155]
  ds_read_b64_tr_b16 v[184:185], v12 offset:0
  v_mfma_f32_16x16x32_bf16 a[156:159], v[208:211], v[252:255], a[156:159]
  v_mfma_f32_16x16x32_bf16 a[160:163], v[212:215], v[224:227], a[160:163]
  ds_read_b64_tr_b16 v[186:187], v12 offset:1024
  v_mfma_f32_16x16x32_bf16 a[164:167], v[212:215], v[228:231], a[164:167]
  v_mfma_f32_16x16x32_bf16 a[168:171], v[212:215], v[232:235], a[168:171]
  ds_read_b128 v[156:159], v4 offset:14336
  v_mfma_f32_16x16x32_bf16 a[172:175], v[212:215], v[236:239], a[172:175]
  v_mfma_f32_16x16x32_bf16 a[176:179], v[212:215], v[240:243], a[176:179]
  ds_read_b64_tr_b16 v[188:189], v13 offset:0
  v_mfma_f32_16x16x32_bf16 a[180:183], v[212:215], v[244:247], a[180:183]
  v_mfma_f32_16x16x32_bf16 a[184:187], v[212:215], v[248:251], a[184:187]
  ds_read_b64_tr_b16 v[190:191], v13 offset:1024
  v_mfma_f32_16x16x32_bf16 a[188:191], v[212:215], v[252:255], a[188:191]
  v_mfma_f32_16x16x32_bf16 a[192:195], v[216:219], v[224:227], a[192:195]
  v_mfma_f32_16x16x32_bf16 a[196:199], v[216:219], v[228:231], a[196:199]
  v_mfma_f32_16x16x32_bf16 a[200:203], v[216:219], v[232:235], a[200:203]
  v_mfma_f32_16x16x32_bf16 a[204:207], v[216:219], v[236:239], a[204:207]
  v_mfma_f32_16x16x32_bf16 a[208:211], v[216:219], v[240:243], a[208:211]
  v_mfma_f32_16x16x32_bf16 a[212:215], v[216:219], v[244:247], a[212:215]
  v_mfma_f32_16x16x32_bf16 a[216:219], v[216:219], v[248:251], a[216:219]
  v_mfma_f32_16x16x32_bf16 a[220:223], v[216:219], v[252:255], a[220:223]
  v_mfma_f32_16x16x32_bf16 a[224:227], v[220:223], v[224:227], a[224:227]
  v_mfma_f32_16x16x32_bf16 a[228:231], v[220:223], v[228:231], a[228:231]
  v_mfma_f32_16x16x32_bf16 a[232:235], v[220:223], v[232:235], a[232:235]
  v_mfma_f32_16x16x32_bf16 a[236:239], v[220:223], v[236:239], a[236:239]
  v_mfma_f32_16x16x32_bf16 a[240:243], v[220:223], v[240:243], a[240:243]
  v_mfma_f32_16x16x32_bf16 a[244:247], v[220:223], v[244:247], a[244:247]
  v_mfma_f32_16x16x32_bf16 a[248:251], v[220:223], v[248:251], a[248:251]
  v_mfma_f32_16x16x32_bf16 a[252:255], v[220:223], v[252:255], a[252:255]
  s_waitcnt lgkmcnt(0)
  s_sub_u32 s46, s46, 2
  s_cmp_lg_u32 s46, 0
  s_cbranch_scc1 G_l_bn_l
  v_mfma_f32_16x16x32_bf16 a[0:3], v[128:131], v[160:163], a[0:3]
  ds_read_b128 v[192:195], v5 offset:0
  v_mfma_f32_16x16x32_bf16 a[4:7], v[128:131], v[164:167], a[4:7]
  v_mfma_f32_16x16x32_bf16 a[8:11], v[128:131], v[168:171], a[8:11]
  ds_read_b64_tr_b16 v[224:225], v6 offset:8192
  v_mfma_f32_16x16x32_bf16 a[12:15], v[128:131], v[172:175], a[12:15]
  v_mfma_f32_16x16x32_bf16 a[16:19], v[128:131], v[176:179], a[16:19]
  ds_read_b64_tr_b16 v[226:227], v6 offset:9216
  v_mfma_f32_16x16x32_bf16 a[20:23], v[128:131], v[180:183], a[20:23]
  v_mfma_f32_16x16x32_bf16 a[24:27], v[128:131], v[184:187], a[24:27]
  ds_read_b128 v[196:199], v5 offset:2048
  v_mfma_f32_16x16x32_bf16 a[28:31], v[128:131], v[188:191], a[28:31]
  v_mfma_f32_16x16x32_bf16 a[32:35], v[132:135], v[160:163], a[32:35]
  ds_read_b64_tr_b16 v[228:229], v7 offset:8192
  v_mfma_f32_16x16x32_bf16 a[36:39], v[132:135], v[164:167], a[36:39]
  v_mfma_f32_16x16x32_bf16 a[40:43], v[132:135], v[168:171], a[40:43]
  ds_read_b64_tr_b16 v[230:231], v7 offset:9216
  v_mfma_f32_16x16x32_bf16 a[44:47], v[132:135], v[172:175], a[44:47]
  v_mfma_f32_16x16x32_bf16 a[48:51], v[132:135], v[176:179], a[48:51]
  ds_read_b128 v[200:203], v5 offset:4096
  v_mfma_f32_16x16x32_bf16 a[52:55], v[132:135], v[180:183], a[52:55]
  v_mfma_f32_16x16x32_bf16 a[56:59], v[132:135], v[184:187], a[56:59]
  ds_read_b64_tr_b16 v[232:233], v8 offset:8192
  v_mfma_f32_16x16x32_bf16 a[60:63], v[132:135], v[188:191], a[60:63]
  v_mfma_f32_16x16x32_bf16 a[64:67], v[136:139], v[160:163], a[64:67]
  ds_read_b64_tr_b16 v[234:235], v8 offset:9216
  v_mfma_f32_16x16x32_bf16 a[68:71], v[136:139], v[164:167], a[68:71]
  v_mfma_f32_16x16x32_bf16 a[72:75], v[136:139], v[168:171], a[72:75]
  ds_read_b128 v[204:207], v5 offset:6144
  v_mfma_f32_16x16x32_bf16 a[76:79], v[136:139], v[172:175], a[76:79]
  v_mfma_f32_16x16x32_bf16 a[80:83], v[136:139], v[176:179], a[80:83]
  ds_read_b64_tr_b16 v[236:237], v9 offset:8192
  v_mfma_f32_16x16x32_bf16 a[84:87], v[136:139], v[180:183], a[84:87]
  v_mfma_f32_16x16x32_bf16 a[88:91], v[136:139], v[184:187], a[88:91]
  ds_read_b64_tr_b16 v[238:239], v9 offset:9216
  v_mfma_f32_16x16x32_bf16 a[92:95], v[136:139], v[188:191], a[92:95]
  v_mfma_f32_16x16x32_bf16 a[96:99], v[140:143], v[160:163], a[96:99]
  ds_read_b128 v[208:211], v5 offset:8192
  v_mfma_f32_16x16x32_bf16 a[100:103], v[140:143], v[164:167], a[100:103]
  v_mfma_f32_16x16x32_bf16 a[104:107], v[140:143], v[168:171], a[104:107]
  ds_read_b64_tr_b16 v[240:241], v10 offset:8192
  v_mfma_f32_16x16x32_bf16 a[108:111], v[140:143], v[172:175], a[108:111]
  v_mfma_f32_16x16x32_bf16 a[112:115], v[140:143], v[176:179], a[112:115]
  ds_read_b64_tr_b16 v[242:243], v10 offset:9216
  v_mfma_f32_16x16x32_bf16 a[116:119], v[140:143], v[180:183], a[116:119]
  v_mfma_f32_16x16x32_bf16 a[120:123], v[140:143], v[184:187], a[120:123]
  ds_read_b128 v[212:215], v5 offset:10240
  v_mfma_f32_16x16x32_bf16 a[124:127], v[140:143], v[188:191], a[124:127]
  v_mfma_f32_16x16x32_bf16 a[128:131], v[144:147], v[160:163], a[128:131]
  ds_read_b64_tr_b16 v[244:245], v11 offset:8192
  v_mfma_f32_16x16x32_bf16 a[132:135], v[144:147], v[164:167], a[132:135]
  v_mfma_f32_16x16x32_bf16 a[136:139], v[144:147], v[168:171], a[136:139]
  ds_read_b64_tr_b16 v[246:247], v11 offset:9216
  v_mfma_f32_16x16x32_bf16 a[140:143], v[144:147], v[172:175], a[140:143]
  v_mfma_f32_16x16x32_bf16 a[144:147], v[144:147], v[176:179], a[144:147]
  ds_read_b128 v[216:219], v5 offset:12288
  v_mfma_f32_16x16x32_bf16 a[148:151], v[144:147], v[180:183], a[148:151]
  v_mfma_f32_16x16x32_bf16 a[152:155], v[144:147], v[184:187], a[152:155]
  ds_read_b64_tr_b16 v[248:249], v12 offset:8192
  v_mfma_f32_16x16x32_bf16 a[156:159], v[144:147], v[188:191], a[156:159]
  v_mfma_f32_16x16x32_bf16 a[160:163], v[148:151], v[160:163], a[160:163]
  ds_read_b64_tr_b16 v[250:251], v12 offset:9216
  v_mfma_f32_16x16x32_bf16 a[164:167], v[148:151], v[164:167], a[164:167]
  v_mfma_f32_16x16x32_bf16 a[168:171], v[148:151], v[168:171], a[168:171]
  ds_read_b128 v[220:223], v5 offset:14336
  v_mfma_f32_16x16x32_bf16 a[172:175], v[148:151], v[172:175], a[172:175]
  v_mfma_f32_16x16x32_bf16 a[176:179], v[148:151], v[176:179], a[176:179]
  ds_read_b64_tr_b16 v[252:253], v13 offset:8192
  v_mfma_f32_16x16x32_bf16 a[180:183], v[148:151], v[180:183], a[180:183]
  v_mfma_f32_16x16x32_bf16 a[184:187], v[148:151], v[184:187], a[184:187]
  ds_read_b64_tr_b16 v[254:255], v13 offset:9216
  v_mfma_f32_16x16x32_bf16 a[188:191], v[148:151], v[188:191], a[188:191]
  v_mfma_f32_16x16x32_bf16 a[192:195], v[152:155], v[160:163], a[192:195]
  v_mfma_f32_16x16x32_bf16 a[196:199], v[152:155], v[164:167], a[196:199]
  v_mfma_f32_16x16x32_bf16 a[200:203], v[152:155], v[168:171], a[200:203]
  v_mfma_f32_16x16x32_bf16 a[204:207], v[152:155], v[172:175], a[204:207]
  v_mfma_f32_16x16x32_bf16 a[208:211], v[152:155], v[176:179], a[208:211]
  v_mfma_f32_16x16x32_bf16 a[212:215], v[152:155], v[180:183], a[212:215]
  v_mfma_f32_16x16x32_bf16 a[216:219], v[152:155], v[184:187], a[216:219]
  v_mfma_f32_16x16x32_bf16 a[220:223], v[152:155], v[188:191], a[220:223]
  v_mfma_f32_16x16x32_bf16 a[224:227], v[156:159], v[160:163], a[224:227]
  s_add_u32 s62, s95, s97
  s_cmp_eq_u32 s97, 0x10000
  v_mfma_f32_16x16x32_bf16 a[228:231], v[156:159], v[164:167], a[228:231]
  s_cselect_b32 s63, 0xffff0000, s61
  s_add_u32 s97, s97, s63
  v_mfma_f32_16x16x32_bf16 a[232:235], v[156:159], v[168:171], a[232:235]
  v_add_u32 v6, s63, v6
  v_add_u32 v7, s63, v7
  v_mfma_f32_16x16x32_bf16 a[236:239], v[156:159], v[172:175], a[236:239]
  v_add_u32 v8, s63, v8
  v_add_u32 v9, s63, v9
  v_mfma_f32_16x16x32_bf16 a[240:243], v[156:159], v[176:179], a[240:243]
  v_add_u32 v10, s63, v10
  v_add_u32 v11, s63, v11
  v_mfma_f32_16x16x32_bf16 a[244:247], v[156:159], v[180:183], a[244:247]
  v_add_u32 v12, s63, v12
  v_add_u32 v13, s63, v13
  v_mfma_f32_16x16x32_bf16 a[248:251], v[156:159], v[184:187], a[248:251]
  v_mfma_f32_16x16x32_bf16 a[252:255], v[156:159], v[188:191], a[252:255]
  s_waitcnt vmcnt(0) lgkmcnt(0)
  s_barrier
  v_mfma_f32_16x16x32_bf16 a[0:3], v[192:195], v[224:227], a[0:3]
  ds_read_b128 v[128:131], v4 offset:32768
  v_mfma_f32_16x16x32_bf16 a[4:7], v[192:195], v[228:231], a[4:7]
  v_mfma_f32_16x16x32_bf16 a[8:11], v[192:195], v[232:235], a[8:11]
  ds_read_b64_tr_b16 v[160:161], v6 offset:0
  v_mfma_f32_16x16x32_bf16 a[12:15], v[192:195], v[236:239], a[12:15]
  v_mfma_f32_16x16x32_bf16 a[16:19], v[192:195], v[240:243], a[16:19]
  ds_read_b64_tr_b16 v[162:163], v6 offset:1024
  v_mfma_f32_16x16x32_bf16 a[20:23], v[192:195], v[244:247], a[20:23]
  v_mfma_f32_16x16x32_bf16 a[24:27], v[192:195], v[248:251], a[24:27]
  ds_read_b128 v[132:135], v4 offset:34816
  v_mfma_f32_16x16x32_bf16 a[28:31], v[192:195], v[252:255], a[28:31]
  v_mfma_f32_16x16x32_bf16 a[32:35], v[196:199], v[224:227], a[32:35]
  ds_read_b64_tr_b16 v[164:165], v7 offset:0
  v_mfma_f32_16x16x32_bf16 a[36:39], v[196:199], v[228:231], a[36:39]
  v_mfma_f32_16x16x32_bf16 a[40:43], v[196:199], v[232:235], a[40:43]
  ds_read_b64_tr_b16 v[166:167], v7 offset:1024
  v_mfma_f32_16x16x32_bf16 a[44:47], v[196:199], v[236:239], a[44:47]
  v_mfma_f32_16x16x32_bf16 a[48:51], v[196:199], v[240:243], a[48:51]
  ds_read_b128 v[136:139], v4 offset:36864
  v_mfma_f32_16x16x32_bf16 a[52:55], v[196:199], v[244:247], a[52:55]
  v_mfma_f32_16x16x32_bf16 a[56:59], v[196:199], v[248:251], a[56:59]
  ds_read_b64_tr_b16 v[168:169], v8 offset:0
  v_mfma_f32_16x16x32_bf16 a[60:63], v[196:199], v[252:255], a[60:63]
  v_mfma_f32_16x16x32_bf16 a[64:67], v[200:203], v[224:227], a[64:67]
  ds_read_b64_tr_b16 v[170:171], v8 offset:1024
  v_mfma_f32_16x16x32_bf16 a[68:71], v[200:203], v[228:231], a[68:71]
  v_mfma_f32_16x16x32_bf16 a[72:75], v[200:203], v[232:235], a[72:75]
  ds_read_b128 v[140:143], v4 offset:38912
  v_mfma_f32_16x16x32_bf16 a[76:79], v[200:203], v[236:239], a[76:79]
  v_mfma_f32_16x16x32_bf16 a[80:83], v[200:203], v[240:243], a[80:83]
  ds_read_b64_tr_b16 v[172:173], v9 offset:0
  v_mfma_f32_16x16x32_bf16 a[84:87], v[200:203], v[244:247], a[84:87]
  v_mfma_f32_16x16x32_bf16 a[88:91], v[200:203], v[248:251], a[88:91]
  ds_read_b64_tr_b16 v[174:175], v9 offset:1024
  v_mfma_f32_16x16x32_bf16 a[92:95], v[200:203], v[252:255], a[92:95]
  v_mfma_f32_16x16x32_bf16 a[96:99], v[204:207], v[224:227], a[96:99]
  ds_read_b128 v[144:147], v4 offset:40960
  v_mfma_f32_16x16x32_bf16 a[100:103], v[204:207], v[228:231], a[100:103]
  v_mfma_f32_16x16x32_bf16 a[104:107], v[204:207], v[232:235], a[104:107]
  ds_read_b64_tr_b16 v[176:177], v10 offset:0
  v_mfma_f32_16x16x32_bf16 a[108:111], v[204:207], v[236:239], a[108:111]
  v_mfma_f32_16x16x32_bf16 a[112:115], v[204:207], v[240:243], a[112:115]
  ds_read_b64_tr_b16 v[178:179], v10 offset:1024
  v_mfma_f32_16x16x32_bf16 a[116:119], v[204:207], v[244:247], a[116:119]
  v_mfma_f32_16x16x32_bf16 a[120:123], v[204:207], v[248:251], a[120:123]
  ds_read_b128 v[148:151], v4 offset:43008
  v_mfma_f32_16x16x32_bf16 a[124:127], v[204:207], v[252:255], a[124:127]
  v_mfma_f32_16x16x32_bf16 a[128:131], v[208:211], v[224:227], a[128:131]
  ds_read_b64_tr_b16 v[180:181], v11 offset:0
  v_mfma_f32_16x16x32_bf16 a[132:135], v[208:211], v[228:231], a[132:135]
  v_mfma_f32_16x16x32_bf16 a[136:139], v[208:211], v[232:235], a[136:139]
  ds_read_b64_tr_b16 v[182:183], v11 offset:1024
  v_mfma_f32_16x16x32_bf16 a[140:143], v[208:211], v[236:239], a[140:143]
  v_mfma_f32_16x16x32_bf16 a[144:147], v[208:211], v[240:243], a[144:147]
  ds_read_b128 v[152:155], v4 offset:45056
  v_mfma_f32_16x16x32_bf16 a[148:151], v[208:211], v[244:247], a[148:151]
  v_mfma_f32_16x16x32_bf16 a[152:155], v[208:211], v[248:251], a[152:155]
  ds_read_b64_tr_b16 v[184:185], v12 offset:0
  v_mfma_f32_16x16x32_bf16 a[156:159], v[208:211], v[252:255], a[156:159]
  v_mfma_f32_16x16x32_bf16 a[160:163], v[212:215], v[224:227], a[160:163]
  ds_read_b64_tr_b16 v[186:187], v12 offset:1024
  v_mfma_f32_16x16x32_bf16 a[164:167], v[212:215], v[228:231], a[164:167]
  v_mfma_f32_16x16x32_bf16 a[168:171], v[212:215], v[232:235], a[168:171]
  ds_read_b128 v[156:159], v4 offset:47104
  v_mfma_f32_16x16x32_bf16 a[172:175], v[212:215], v[236:239], a[172:175]
  v_mfma_f32_16x16x32_bf16 a[176:179], v[212:215], v[240:243], a[176:179]
  ds_read_b64_tr_b16 v[188:189], v13 offset:0
  v_mfma_f32_16x16x32_bf16 a[180:183], v[212:215], v[244:247], a[180:183]
  v_mfma_f32_16x16x32_bf16 a[184:187], v[212:215], v[248:251], a[184:187]
  ds_read_b64_tr_b16 v[190:191], v13 offset:1024
  v_mfma_f32_16x16x32_bf16 a[188:191], v[212:215], v[252:255], a[188:191]
  v_mfma_f32_16x16x32_bf16 a[192:195], v[216:219], v[224:227], a[192:195]
  v_mfma_f32_16x16x32_bf16 a[196:199], v[216:219], v[228:231], a[196:199]
  v_mfma_f32_16x16x32_bf16 a[200:203], v[216:219], v[232:235], a[200:203]
  v_mfma_f32_16x16x32_bf16 a[204:207], v[216:219], v[236:239], a[204:207]
  v_mfma_f32_16x16x32_bf16 a[208:211], v[216:219], v[240:243], a[208:211]
  v_mfma_f32_16x16x32_bf16 a[212:215], v[216:219], v[244:247], a[212:215]
  v_mfma_f32_16x16x32_bf16 a[216:219], v[216:219], v[248:251], a[216:219]
  v_mfma_f32_16x16x32_bf16 a[220:223], v[216:219], v[252:255], a[220:223]
  v_mfma_f32_16x16x32_bf16 a[224:227], v[220:223], v[224:227], a[224:227]
  v_mfma_f32_16x16x32_bf16 a[228:231], v[220:223], v[228:231], a[228:231]
  v_mfma_f32_16x16x32_bf16 a[232:235], v[220:223], v[232:235], a[232:235]
  v_mfma_f32_16x16x32_bf16 a[236:239], v[220:223], v[236:239], a[236:239]
  v_mfma_f32_16x16x32_bf16 a[240:243], v[220:223], v[240:243], a[240:243]
  v_mfma_f32_16x16x32_bf16 a[244:247], v[220:223], v[244:247], a[244:247]
  v_mfma_f32_16x16x32_bf16 a[248:251], v[220:223], v[248:251], a[248:251]
  v_mfma_f32_16x16x32_bf16 a[252:255], v[220:223], v[252:255], a[252:255]
  s_waitcnt lgkmcnt(0)
  v_mfma_f32_16x16x32_bf16 a[0:3], v[128:131], v[160:163], a[0:3]
  ds_read_b128 v[192:195], v5 offset:32768
  v_mfma_f32_16x16x32_bf16 a[4:7], v[128:131], v[164:167], a[4:7]
  v_mfma_f32_16x16x32_bf16 a[8:11], v[128:131], v[168:171], a[8:11]
  ds_read_b64_tr_b16 v[224:225], v6 offset:8192
  v_mfma_f32_16x16x32_bf16 a[12:15], v[128:131], v[172:175], a[12:15]
  v_mfma_f32_16x16x32_bf16 a[16:19], v[128:131], v[176:179], a[16:19]
  ds_read_b64_tr_b16 v[226:227], v6 offset:9216
  v_mfma_f32_16x16x32_bf16 a[20:23], v[128:131], v[180:183], a[20:23]
  v_mfma_f32_16x16x32_bf16 a[24:27], v[128:131], v[184:187], a[24:27]
  ds_read_b128 v[196:199], v5 offset:34816
  v_mfma_f32_16x16x32_bf16 a[28:31], v[128:131], v[188:191], a[28:31]
  v_mfma_f32_16x16x32_bf16 a[32:35], v[132:135], v[160:163], a[32:35]
  ds_read_b64_tr_b16 v[228:229], v7 offset:8192
  v_mfma_f32_16x16x32_bf16 a[36:39], v[132:135], v[164:167], a[36:39]
  v_mfma_f32_16x16x32_bf16 a[40:43], v[132:135], v[168:171], a[40:43]
  ds_read_b64_tr_b16 v[230:231], v7 offset:9216
  v_mfma_f32_16x16x32_bf16 a[44:47], v[132:135], v[172:175], a[44:47]
  v_mfma_f32_16x16x32_bf16 a[48:51], v[132:135], v[176:179], a[48:51]
  ds_read_b128 v[200:203], v5 offset:36864
  v_mfma_f32_16x16x32_bf16 a[52:55], v[132:135], v[180:183], a[52:55]
  v_mfma_f32_16x16x32_bf16 a[56:59], v[132:135], v[184:187], a[56:59]
  ds_read_b64_tr_b16 v[232:233], v8 offset:8192
  v_mfma_f32_16x16x32_bf16 a[60:63], v[132:135], v[188:191], a[60:63]
  v_mfma_f32_16x16x32_bf16 a[64:67], v[136:139], v[160:163], a[64:67]
  ds_read_b64_tr_b16 v[234:235], v8 offset:9216
  v_mfma_f32_16x16x32_bf16 a[68:71], v[136:139], v[164:167], a[68:71]
  v_mfma_f32_16x16x32_bf16 a[72:75], v[136:139], v[168:171], a[72:75]
  ds_read_b128 v[204:207], v5 offset:38912
  v_mfma_f32_16x16x32_bf16 a[76:79], v[136:139], v[172:175], a[76:79]
  v_mfma_f32_16x16x32_bf16 a[80:83], v[136:139], v[176:179], a[80:83]
  ds_read_b64_tr_b16 v[236:237], v9 offset:8192
  v_mfma_f32_16x16x32_bf16 a[84:87], v[136:139], v[180:183], a[84:87]
  v_mfma_f32_16x16x32_bf16 a[88:91], v[136:139], v[184:187], a[88:91]
  ds_read_b64_tr_b16 v[238:239], v9 offset:9216
  v_mfma_f32_16x16x32_bf16 a[92:95], v[136:139], v[188:191], a[92:95]
  v_mfma_f32_16x16x32_bf16 a[96:99], v[140:143], v[160:163], a[96:99]
  ds_read_b128 v[208:211], v5 offset:40960
  v_mfma_f32_16x16x32_bf16 a[100:103], v[140:143], v[164:167], a[100:103]
  v_mfma_f32_16x16x32_bf16 a[104:107], v[140:143], v[168:171], a[104:107]
  ds_read_b64_tr_b16 v[240:241], v10 offset:8192
  v_mfma_f32_16x16x32_bf16 a[108:111], v[140:143], v[172:175], a[108:111]
  v_mfma_f32_16x16x32_bf16 a[112:115], v[140:143], v[176:179], a[112:115]
  ds_read_b64_tr_b16 v[242:243], v10 offset:9216
  v_mfma_f32_16x16x32_bf16 a[116:119], v[140:143], v[180:183], a[116:119]
  v_mfma_f32_16x16x32_bf16 a[120:123], v[140:143], v[184:187], a[120:123]
  ds_read_b128 v[212:215], v5 offset:43008
  v_mfma_f32_16x16x32_bf16 a[124:127], v[140:143], v[188:191], a[124:127]
  v_mfma_f32_16x16x32_bf16 a[128:131], v[144:147], v[160:163], a[128:131]
  ds_read_b64_tr_b16 v[244:245], v11 offset:8192
  v_mfma_f32_16x16x32_bf16 a[132:135], v[144:147], v[164:167], a[132:135]
  v_mfma_f32_16x16x32_bf16 a[136:139], v[144:147], v[168:171], a[136:139]
  ds_read_b64_tr_b16 v[246:247], v11 offset:9216
  v_mfma_f32_16x16x32_bf16 a[140:143], v[144:147], v[172:175], a[140:143]
  v_mfma_f32_16x16x32_bf16 a[144:147], v[144:147], v[176:179], a[144:147]
  ds_read_b128 v[216:219], v5 offset:45056
  v_mfma_f32_16x16x32_bf16 a[148:151], v[144:147], v[180:183], a[148:151]
  v_mfma_f32_16x16x32_bf16 a[152:155], v[144:147], v[184:187], a[152:155]
  ds_read_b64_tr_b16 v[248:249], v12 offset:8192
  v_mfma_f32_16x16x32_bf16 a[156:159], v[144:147], v[188:191], a[156:159]
  v_mfma_f32_16x16x32_bf16 a[160:163], v[148:151], v[160:163], a[160:163]
  ds_read_b64_tr_b16 v[250:251], v12 offset:9216
  v_mfma_f32_16x16x32_bf16 a[164:167], v[148:151], v[164:167], a[164:167]
  v_mfma_f32_16x16x32_bf16 a[168:171], v[148:151], v[168:171], a[168:171]
  ds_read_b128 v[220:223], v5 offset:47104
  v_mfma_f32_16x16x32_bf16 a[172:175], v[148:151], v[172:175], a[172:175]
  v_mfma_f32_16x16x32_bf16 a[176:179], v[148:151], v[176:179], a[176:179]
  ds_read_b64_tr_b16 v[252:253], v13 offset:8192
  v_mfma_f32_16x16x32_bf16 a[180:183], v[148:151], v[180:183], a[180:183]
  v_mfma_f32_16x16x32_bf16 a[184:187], v[148:151], v[184:187], a[184:187]
  ds_read_b64_tr_b16 v[254:255], v13 offset:9216
  v_mfma_f32_16x16x32_bf16 a[188:191], v[148:151], v[188:191], a[188:191]
  v_mfma_f32_16x16x32_bf16 a[192:195], v[152:155], v[160:163], a[192:195]
  v_mfma_f32_16x16x32_bf16 a[196:199], v[152:155], v[164:167], a[196:199]
  v_mfma_f32_16x16x32_bf16 a[200:203], v[152:155], v[168:171], a[200:203]
  v_mfma_f32_16x16x32_bf16 a[204:207], v[152:155], v[172:175], a[204:207]
  v_mfma_f32_16x16x32_bf16 a[208:211], v[152:155], v[176:179], a[208:211]
  v_mfma_f32_16x16x32_bf16 a[212:215], v[152:155], v[180:183], a[212:215]
  v_mfma_f32_16x16x32_bf16 a[216:219], v[152:155], v[184:187], a[216:219]
  v_mfma_f32_16x16x32_bf16 a[220:223], v[152:155], v[188:191], a[220:223]
  v_mfma_f32_16x16x32_bf16 a[224:227], v[156:159], v[160:163], a[224:227]
  v_mfma_f32_16x16x32_bf16 a[228:231], v[156:159], v[164:167], a[228:231]
  v_mfma_f32_16x16x32_bf16 a[232:235], v[156:159], v[168:171], a[232:235]
  v_mfma_f32_16x16x32_bf16 a[236:239], v[156:159], v[172:175], a[236:239]
  v_mfma_f32_16x16x32_bf16 a[240:243], v[156:159], v[176:179], a[240:243]
  v_mfma_f32_16x16x32_bf16 a[244:247], v[156:159], v[180:183], a[244:247]
  v_mfma_f32_16x16x32_bf16 a[248:251], v[156:159], v[184:187], a[248:251]
  v_mfma_f32_16x16x32_bf16 a[252:255], v[156:159], v[188:191], a[252:255]
  s_waitcnt lgkmcnt(0)
  s_barrier
  v_mfma_f32_16x16x32_bf16 a[0:3], v[192:195], v[224:227], a[0:3]
  v_mfma_f32_16x16x32_bf16 a[4:7], v[192:195], v[228:231], a[4:7]
  v_mfma_f32_16x16x32_bf16 a[8:11], v[192:195], v[232:235], a[8:11]
  v_mfma_f32_16x16x32_bf16 a[12:15], v[192:195], v[236:239], a[12:15]
  v_mfma_f32_16x16x32_bf16 a[16:19], v[192:195], v[240:243], a[16:19]
  v_mfma_f32_16x16x32_bf16 a[20:23], v[192:195], v[244:247], a[20:23]
  v_mfma_f32_16x16x32_bf16 a[24:27], v[192:195], v[248:251], a[24:27]
  v_mfma_f32_16x16x32_bf16 a[28:31], v[192:195], v[252:255], a[28:31]
  v_mfma_f32_16x16x32_bf16 a[32:35], v[196:199], v[224:227], a[32:35]
  v_mfma_f32_16x16x32_bf16 a[36:39], v[196:199], v[228:231], a[36:39]
  v_mfma_f32_16x16x32_bf16 a[40:43], v[196:199], v[232:235], a[40:43]
  v_mfma_f32_16x16x32_bf16 a[44:47], v[196:199], v[236:239], a[44:47]
  v_mfma_f32_16x16x32_bf16 a[48:51], v[196:199], v[240:243], a[48:51]
  v_mfma_f32_16x16x32_bf16 a[52:55], v[196:199], v[244:247], a[52:55]
  v_mfma_f32_16x16x32_bf16 a[56:59], v[196:199], v[248:251], a[56:59]
  v_mfma_f32_16x16x32_bf16 a[60:63], v[196:199], v[252:255], a[60:63]
  v_mfma_f32_16x16x32_bf16 a[64:67], v[200:203], v[224:227], a[64:67]
  v_mfma_f32_16x16x32_bf16 a[68:71], v[200:203], v[228:231], a[68:71]
  v_mfma_f32_16x16x32_bf16 a[72:75], v[200:203], v[232:235], a[72:75]
  v_mfma_f32_16x16x32_bf16 a[76:79], v[200:203], v[236:239], a[76:79]
  v_mfma_f32_16x16x32_bf16 a[80:83], v[200:203], v[240:243], a[80:83]
  v_mfma_f32_16x16x32_bf16 a[84:87], v[200:203], v[244:247], a[84:87]
  v_mfma_f32_16x16x32_bf16 a[88:91], v[200:203], v[248:251], a[88:91]
  v_mfma_f32_16x16x32_bf16 a[92:95], v[200:203], v[252:255], a[92:95]
  v_mfma_f32_16x16x32_bf16 a[96:99], v[204:207], v[224:227], a[96:99]
  v_mfma_f32_16x16x32_bf16 a[100:103], v[204:207], v[228:231], a[100:103]
  v_mfma_f32_16x16x32_bf16 a[104:107], v[204:207], v[232:235], a[104:107]
  v_mfma_f32_16x16x32_bf16 a[108:111], v[204:207], v[236:239], a[108:111]
  v_mfma_f32_16x16x32_bf16 a[112:115], v[204:207], v[240:243], a[112:115]
  v_mfma_f32_16x16x32_bf16 a[116:119], v[204:207], v[244:247], a[116:119]
  v_mfma_f32_16x16x32_bf16 a[120:123], v[204:207], v[248:251], a[120:123]
  v_mfma_f32_16x16x32_bf16 a[124:127], v[204:207], v[252:255], a[124:127]
  v_mfma_f32_16x16x32_bf16 a[128:131], v[208:211], v[224:227], a[128:131]
  v_mfma_f32_16x16x32_bf16 a[132:135], v[208:211], v[228:231], a[132:135]
  v_mfma_f32_16x16x32_bf16 a[136:139], v[208:211], v[232:235], a[136:139]
  v_mfma_f32_16x16x32_bf16 a[140:143], v[208:211], v[236:239], a[140:143]
  v_mfma_f32_16x16x32_bf16 a[144:147], v[208:211], v[240:243], a[144:147]
  v_mfma_f32_16x16x32_bf16 a[148:151], v[208:211], v[244:247], a[148:151]
  v_mfma_f32_16x16x32_bf16 a[152:155], v[208:211], v[248:251], a[152:155]
  v_mfma_f32_16x16x32_bf16 a[156:159], v[208:211], v[252:255], a[156:159]
  v_mfma_f32_16x16x32_bf16 a[160:163], v[212:215], v[224:227], a[160:163]
  v_mfma_f32_16x16x32_bf16 a[164:167], v[212:215], v[228:231], a[164:167]
  v_mfma_f32_16x16x32_bf16 a[168:171], v[212:215], v[232:235], a[168:171]
  v_mfma_f32_16x16x32_bf16 a[172:175], v[212:215], v[236:239], a[172:175]
  v_mfma_f32_16x16x32_bf16 a[176:179], v[212:215], v[240:243], a[176:179]
  v_mfma_f32_16x16x32_bf16 a[180:183], v[212:215], v[244:247], a[180:183]
  v_mfma_f32_16x16x32_bf16 a[184:187], v[212:215], v[248:251], a[184:187]
  v_mfma_f32_16x16x32_bf16 a[188:191], v[212:215], v[252:255], a[188:191]
  v_mfma_f32_16x16x32_bf16 a[192:195], v[216:219], v[224:227], a[192:195]
  v_mfma_f32_16x16x32_bf16 a[196:199], v[216:219], v[228:231], a[196:199]
  v_mfma_f32_16x16x32_bf16 a[200:203], v[216:219], v[232:235], a[200:203]
  v_mfma_f32_16x16x32_bf16 a[204:207], v[216:219], v[236:239], a[204:207]
  v_mfma_f32_16x16x32_bf16 a[208:211], v[216:219], v[240:243], a[208:211]
  v_mfma_f32_16x16x32_bf16 a[212:215], v[216:219], v[244:247], a[212:215]
  v_mfma_f32_16x16x32_bf16 a[216:219], v[216:219], v[248:251], a[216:219]
  v_mfma_f32_16x16x32_bf16 a[220:223], v[216:219], v[252:255], a[220:223]
  v_mfma_f32_16x16x32_bf16 a[224:227], v[220:223], v[224:227], a[224:227]
  v_mfma_f32_16x16x32_bf16 a[228:231], v[220:223], v[228:231], a[228:231]
  v_mfma_f32_16x16x32_bf16 a[232:235], v[220:223], v[232:235], a[232:235]
  v_mfma_f32_16x16x32_bf16 a[236:239], v[220:223], v[236:239], a[236:239]
  v_mfma_f32_16x16x32_bf16 a[240:243], v[220:223], v[240:243], a[240:243]
  v_mfma_f32_16x16x32_bf16 a[244:247], v[220:223], v[244:247], a[244:247]
  v_mfma_f32_16x16x32_bf16 a[248:251], v[220:223], v[248:251], a[248:251]
  v_mfma_f32_16x16x32_bf16 a[252:255], v[220:223], v[252:255], a[252:255]
  s_branch G_next
G_l_us:
  s_barrier
  ds_read_b128 v[128:131], v4 offset:0
  ds_read_b64_tr_b16 v[160:161], v6 offset:0
  ds_read_b64_tr_b16 v[162:163], v6 offset:1024
  ds_read_b128 v[132:135], v4 offset:2048
  ds_read_b64_tr_b16 v[164:165], v7 offset:0
  ds_read_b64_tr_b16 v[166:167], v7 offset:1024
  ds_read_b128 v[136:139], v4 offset:4096
  ds_read_b64_tr_b16 v[168:169], v8 offset:0
  ds_read_b64_tr_b16 v[170:171], v8 offset:1024
  ds_read_b128 v[140:143], v4 offset:6144
  ds_read_b64_tr_b16 v[172:173], v9 offset:0
  ds_read_b64_tr_b16 v[174:175], v9 offset:1024
  ds_read_b128 v[144:147], v4 offset:8192
  ds_read_b64_tr_b16 v[176:177], v10 offset:0
  ds_read_b64_tr_b16 v[178:179], v10 offset:1024
  ds_read_b128 v[148:151], v4 offset:10240
  ds_read_b64_tr_b16 v[180:181], v11 offset:0
  ds_read_b64_tr_b16 v[182:183], v11 offset:1024
  ds_read_b128 v[152:155], v4 offset:12288
  ds_read_b64_tr_b16 v[184:185], v12 offset:0
  ds_read_b64_tr_b16 v[186:187], v12 offset:1024
  ds_read_b128 v[156:159], v4 offset:14336
  ds_read_b64_tr_b16 v[188:189], v13 offset:0
  ds_read_b64_tr_b16 v[190:191], v13 offset:1024
  s_sub_u32 s46, s96, 4
  s_mov_b32 s97, 0
  s_add_u32 s62, s95, 0x10000
  s_mov_b32 s61, 0x8000
  s_waitcnt lgkmcnt(0)
  v_mfma_f32_16x16x32_bf16 a[0:3], v[160:163], v[128:131], 0
  ds_read_b128 v[192:195], v5 offset:0
  s_add_u32 m0, s62, 0
  s_nop 0
  buffer_load_dwordx4 v3, s[12:15], s40 offen nt lds
  v_mfma_f32_16x16x32_bf16 a[4:7], v[164:167], v[128:131], 0
  v_mfma_f32_16x16x32_bf16 a[8:11], v[168:171], v[128:131], 0
  ds_read_b64_tr_b16 v[224:225], v6 offset:8192
  v_mfma_f32_16x16x32_bf16 a[12:15], v[172:175], v[128:131], 0
  v_mfma_f32_16x16x32_bf16 a[16:19], v[176:179], v[128:131], 0
  ds_read_b64_tr_b16 v[226:227], v6 offset:9216
  v_mfma_f32_16x16x32_bf16 a[20:23], v[180:183], v[128:131], 0
  v_mfma_f32_16x16x32_bf16 a[24:27], v[184:187], v[128:131], 0
  ds_read_b128 v[196:199], v5 offset:2048
  s_add_u32 m0, s62, 16384
  s_nop 0
  buffer_load_dwordx4 v24, s[16:19], s40 offen nt lds
  v_mfma_f32_16x16x32_bf16 a[28:31], v[188:191], v[128:131], 0
  v_mfma_f32_16x16x32_bf16 a[32:35], v[160:163], v[132:135], 0
  ds_read_b64_tr_b16 v[228:229], v7 offset:8192
  v_mfma_f32_16x16x32_bf16 a[36:39], v[164:167], v[132:135], 0
  v_mfma_f32_16x16x32_bf16 a[40:43], v[168:171], v[132:135], 0
  ds_read_b64_tr_b16 v[230:231], v7 offset:9216
  v_mfma_f32_16x16x32_bf16 a[44:47], v[172:175], v[132:135], 0
  v_mfma_f32_16x16x32_bf16 a[48:51], v[176:179], v[132:135], 0
  ds_read_b128 v[200:203], v5 offset:4096
  s_add_u32 m0, s62, 4096
  s_nop 0
  buffer_load_dwordx4 v3, s[12:15], s41 offen nt lds
  v_mfma_f32_16x16x32_bf16 a[52:55], v[180:183], v[132:135], 0
  v_mfma_f32_16x16x32_bf16 a[56:59], v[184:187], v[132:135], 0
  ds_read_b64_tr_b16 v[232:233], v8 offset:8192
  v_mfma_f32_16x16x32_bf16 a[60:63], v[188:191], v[132:135], 0
  v_mfma_f32_16x16x32_bf16 a[64:67], v[160:163], v[136:139], 0
  ds_read_b64_tr_b16 v[234:235], v8 offset:9216
  v_mfma_f32_16x16x32_bf16 a[68:71], v[164:167], v[136:139], 0
  v_mfma_f32_16x16x32_bf16 a[72:75], v[168:171], v[136:139], 0
  ds_read_b128 v[204:207], v5 offset:6144
  v_mfma_f32_16x16x32_bf16 a[76:79], v[172:175], v[136:139], 0
  s_add_u32 m0, s62, 20480
  s_nop 0
  buffer_load_dwordx4 v24, s[16:19], s41 offen nt lds
  v_mfma_f32_16x16x32_bf16 a[80:83], v[176:179], v[136:139], 0
  ds_read_b64_tr_b16 v[236:237], v9 offset:8192
  v_mfma_f32_16x16x32_bf16 a[84:87], v[180:183], v[136:139], 0
  v_mfma_f32_16x16x32_bf16 a[88:91], v[184:187], v[136:139], 0
  ds_read_b64_tr_b16 v[238:239], v9 offset:9216
  v_mfma_f32_16x16x32_bf16 a[92:95], v[188:191], v[136:139], 0
  v_mfma_f32_16x16x32_bf16 a[96:99], v[160:163], v[140:143], 0
  ds_read_b128 v[208:211], v5 offset:8192
  v_mfma_f32_16x16x32_bf16 a[100:103], v[164:167], v[140:143], 0
  s_add_u32 m0, s62, 8192
  s_nop 0
  buffer_load_dwordx4 v3, s[12:15], s42 offen nt lds
  v_mfma_f32_16x16x32_bf16 a[104:107], v[168:171], v[140:143], 0
  ds_read_b64_tr_b16 v[240:241], v10 offset:8192
  v_mfma_f32_16x16x32_bf16 a[108:111], v[172:175], v[140:143], 0
  v_mfma_f32_16x16x32_bf16 a[112:115], v[176:179], v[140:143], 0
  ds_read_b64_tr_b16 v[242:243], v10 offset:9216
  v_mfma_f32_16x16x32_bf16 a[116:119], v[180:183], v[140:143], 0
  v_mfma_f32_16x16x32_bf16 a[120:123], v[184:187], v[140:143], 0
  ds_read_b128 v[212:215], v5 offset:10240
  v_mfma_f32_16x16x32_bf16 a[124:127], v[188:191], v[140:143], 0
  s_add_u32 m0, s62, 24576
  s_nop 0
  buffer_load_dwordx4 v24, s[16:19], s42 offen nt lds
  v_mfma_f32_16x16x32_bf16 a[128:131], v[160:163], v[144:147], 0
  ds_read_b64_tr_b16 v[244:245], v11 offset:8192
  v_mfma_f32_16x16x32_bf16 a[132:135], v[164:167], v[144:147], 0
  v_mfma_f32_16x16x32_bf16 a[136:139], v[168:171], v[144:147], 0
  ds_read_b64_tr_b16 v[246:247], v11 offset:9216
  v_mfma_f32_16x16x32_bf16 a[140:143], v[172:175], v[144:147], 0
  v_mfma_f32_16x16x32_bf16 a[144:147], v[176:179], v[144:147], 0
  ds_read_b128 v[216:219], v5 offset:12288
  v_mfma_f32_16x16x32_bf16 a[148:151], v[180:183], v[144:147], 0
  v_mfma_f32_16x16x32_bf16 a[152:155], v[184:187], v[144:147], 0
  s_add_u32 m0, s62, 12288
  s_nop 0
  buffer_load_dwordx4 v3, s[12:15], s43 offen nt lds
  ds_read_b64_tr_b16 v[248:249], v12 offset:8192
  v_mfma_f32_16x16x32_bf16 a[156:159], v[188:191], v[144:147], 0
  v_mfma_f32_16x16x32_bf16 a[160:163], v[160:163], v[148:151], 0
  ds_read_b64_tr_b16 v[250:251], v12 offset:9216
  v_mfma_f32_16x16x32_bf16 a[164:167], v[164:167], v[148:151], 0
  v_mfma_f32_16x16x32_bf16 a[168:171], v[168:171], v[148:151], 0
  ds_read_b128 v[220:223], v5 offset:14336
  v_mfma_f32_16x16x32_bf16 a[172:175], v[172:175], v[148:151], 0
  v_mfma_f32_16x16x32_bf16 a[176:179], v[176:179], v[148:151], 0
  s_add_u32 m0, s62, 28672
  s_nop 0
  buffer_load_dwordx4 v24, s[16:19], s43 offen nt lds
  v_add_u32 v3, s45, v3
  v_add_u32 v24, s45, v24
  ds_read_b64_tr_b16 v[252:253], v13 offset:8192
  v_mfma_f32_16x16x32_bf16 a[180:183], v[180:183], v[148:151], 0
  v_mfma_f32_16x16x32_bf16 a[184:187], v[184:187], v[148:151], 0
  ds_read_b64_tr_b16 v[254:255], v13 offset:9216
  v_mfma_f32_16x16x32_bf16 a[188:191], v[188:191], v[148:151], 0
  v_mfma_f32_16x16x32_bf16 a[192:195], v[160:163], v[152:155], 0
  v_mfma_f32_16x16x32_bf16 a[196:199], v[164:167], v[152:155], 0
  v_mfma_f32_16x16x32_bf16 a[200:203], v[168:171], v[152:155], 0
  v_mfma_f32_16x16x32_bf16 a[204:207], v[172:175], v[152:155], 0
  v_mfma_f32_16x16x32_bf16 a[208:211], v[176:179], v[152:155], 0
  v_mfma_f32_16x16x32_bf16 a[212:215], v[180:183], v[152:155], 0
  v_mfma_f32_16x16x32_bf16 a[216:219], v[184:187], v[152:155], 0
  v_mfma_f32_16x16x32_bf16 a[220:223], v[188:191], v[152:155], 0
  v_mfma_f32_16x16x32_bf16 a[224:227], v[160:163], v[156:159], 0
  s_add_u32 s62, s95, s97
  s_cmp_eq_u32 s97, 0x10000
  v_mfma_f32_16x16x32_bf16 a[228:231], v[164:167], v[156:159], 0
  s_cselect_b32 s63, 0xffff0000, s61
  s_add_u32 s97, s97, s63
  v_mfma_f32_16x16x32_bf16 a[232:235], v[168:171], v[156:159], 0
  v_add_u32 v6, s63, v6
  v_add_u32 v7, s63, v7
  v_mfma_f32_16x16x32_bf16 a[236:239], v[172:175], v[156:159], 0
  v_add_u32 v8, s63, v8
  v_add_u32 v9, s63, v9
  v_mfma_f32_16x16x32_bf16 a[240:243], v[176:179], v[156:159], 0
  v_add_u32 v10, s63, v10
  v_add_u32 v11, s63, v11
  v_mfma_f32_16x16x32_bf16 a[244:247], v[180:183], v[156:159], 0
  v_add_u32 v12, s63, v12
  v_add_u32 v13, s63, v13
  v_mfma_f32_16x16x32_bf16 a[248:251], v[184:187], v[156:159], 0
  v_mfma_f32_16x16x32_bf16 a[252:255], v[188:191], v[156:159], 0
  s_waitcnt lgkmcnt(0)
  s_barrier
  v_mfma_f32_16x16x32_bf16 a[0:3], v[224:227], v[192:195], a[0:3]
  ds_read_b128 v[128:131], v4 offset:32768
  s_add_u32 m0, s95, 98304
  s_nop 0
  buffer_load_dwordx4 v2, s[8:11], s32 offen sc1 lds
  v_mfma_f32_16x16x32_bf16 a[4:7], v[228:231], v[192:195], a[4:7]
  v_mfma_f32_16x16x32_bf16 a[8:11], v[232:235], v[192:195], a[8:11]
  ds_read_b64_tr_b16 v[160:161], v6 offset:0
  v_mfma_f32_16x16x32_bf16 a[12:15], v[236:239], v[192:195], a[12:15]
  v_mfma_f32_16x16x32_bf16 a[16:19], v[240:243], v[192:195], a[16:19]
  ds_read_b64_tr_b16 v[162:163], v6 offset:1024
  v_mfma_f32_16x16x32_bf16 a[20:23], v[244:247], v[192:195], a[20:23]
  s_add_u32 m0, s95, 102400
  s_nop 0
  buffer_load_dwordx4 v2, s[8:11], s33 offen sc1 lds
  v_mfma_f32_16x16x32_bf16 a[24:27], v[248:251], v[192:195], a[24:27]
  ds_read_b128 v[132:135], v4 offset:34816
  v_mfma_f32_16x16x32_bf16 a[28:31], v[252:255], v[192:195], a[28:31]
  v_mfma_f32_16x16x32_bf16 a[32:35], v[224:227], v[196:199], a[32:35]
  ds_read_b64_tr_b16 v[164:165], v7 offset:0
  v_mfma_f32_16x16x32_bf16 a[36:39], v[228:231], v[196:199], a[36:39]
  v_mfma_f32_16x16x32_bf16 a[40:43], v[232:235], v[196:199], a[40:43]
  s_add_u32 m0, s95, 106496
  s_nop 0
  buffer_load_dwordx4 v2, s[8:11], s34 offen sc1 lds
  ds_read_b64_tr_b16 v[166:167], v7 offset:1024
  v_mfma_f32_16x16x32_bf16 a[44:47], v[236:239], v[196:199], a[44:47]
  v_mfma_f32_16x16x32_bf16 a[48:51], v[240:243], v[196:199], a[48:51]
  ds_read_b128 v[136:139], v4 offset:36864
  v_mfma_f32_16x16x32_bf16 a[52:55], v[244:247], v[196:199], a[52:55]
  v_mfma_f32_16x16x32_bf16 a[56:59], v[248:251], v[196:199], a[56:59]
  ds_read_b64_tr_b16 v[168:169], v8 offset:0
  s_add_u32 m0, s95, 110592
  s_nop 0
  buffer_load_dwordx4 v2, s[8:11], s35 offen sc1 lds
  v_mfma_f32_16x16x32_bf16 a[60:63], v[252:255], v[196:199], a[60:63]
  v_mfma_f32_16x16x32_bf16 a[64:67], v[224:227], v[200:203], a[64:67]
  ds_read_b64_tr_b16 v[170:171], v8 offset:1024
  v_mfma_f32_16x16x32_bf16 a[68:71], v[228:231], v[200:203], a[68:71]
  v_mfma_f32_16x16x32_bf16 a[72:75], v[232:235], v[200:203], a[72:75]
  ds_read_b128 v[140:143], v4 offset:38912
  v_mfma_f32_16x16x32_bf16 a[76:79], v[236:239], v[200:203], a[76:79]
  s_add_u32 m0, s95, 114688
  s_nop 0
  buffer_load_dwordx4 v2, s[8:11], s36 offen sc1 lds
  v_mfma_f32_16x16x32_bf16 a[80:83], v[240:243], v[200:203], a[80:83]
  ds_read_b64_tr_b16 v[172:173], v9 offset:0
  v_mfma_f32_16x16x32_bf16 a[84:87], v[244:247], v[200:203], a[84:87]
  v_mfma_f32_16x16x32_bf16 a[88:91], v[248:251], v[200:203], a[88:91]
  ds_read_b64_tr_b16 v[174:175], v9 offset:1024
  v_mfma_f32_16x16x32_bf16 a[92:95], v[252:255], v[200:203], a[92:95]
  v_mfma_f32_16x16x32_bf16 a[96:99], v[224:227], v[204:207], a[96:99]
  s_add_u32 m0, s95, 118784
  s_nop 0
  buffer_load_dwordx4 v2, s[8:11], s37 offen sc1 lds
  ds_read_b128 v[144:147], v4 offset:40960
  v_mfma_f32_16x16x32_bf16 a[100:103], v[228:231], v[204:207], a[100:103]
  v_mfma_f32_16x16x32_bf16 a[104:107], v[232:235], v[204:207], a[104:107]
  ds_read_b64_tr_b16 v[176:177], v10 offset:0
  v_mfma_f32_16x16x32_bf16 a[108:111], v[236:239], v[204:207], a[108:111]
  v_mfma_f32_16x16x32_bf16 a[112:115], v[240:243], v[204:207], a[112:115]
  ds_read_b64_tr_b16 v[178:179], v10 offset:1024
  s_add_u32 m0, s95, 122880
  s_nop 0
  buffer_load_dwordx4 v2, s[8:11], s38 offen sc1 lds
  v_mfma_f32_16x16x32_bf16 a[116:119], v[244:247], v[204:207], a[116:119]
  v_mfma_f32_16x16x32_bf16 a[120:123], v[248:251], v[204:207], a[120:123]
  ds_read_b128 v[148:151], v4 offset:43008
  v_mfma_f32_16x16x32_bf16 a[124:127], v[252:255], v[204:207], a[124:127]
  v_mfma_f32_16x16x32_bf16 a[128:131], v[224:227], v[208:211], a[128:131]
  ds_read_b64_tr_b16 v[180:181], v11 offset:0
  v_mfma_f32_16x16x32_bf16 a[132:135], v[228:231], v[208:211], a[132:135]
  s_add_u32 m0, s95, 126976
  s_nop 0
  buffer_load_dwordx4 v2, s[8:11], s39 offen sc1 lds
  v_add_u32 v2, s44, v2
  v_mfma_f32_16x16x32_bf16 a[136:139], v[232:235], v[208:211], a[136:139]
  ds_read_b64_tr_b16 v[182:183], v11 offset:1024
  v_mfma_f32_16x16x32_bf16 a[140:143], v[236:239], v[208:211], a[140:143]
  v_mfma_f32_16x16x32_bf16 a[144:147], v[240:243], v[208:211], a[144:147]
  ds_read_b128 v[152:155], v4 offset:45056
  v_mfma_f32_16x16x32_bf16 a[148:151], v[244:247], v[208:211], a[148:151]
  v_mfma_f32_16x16x32_bf16 a[152:155], v[248:251], v[208:211], a[152:155]
  ds_read_b64_tr_b16 v[184:185], v12 offset:0
  v_mfma_f32_16x16x32_bf16 a[156:159], v[252:255], v[208:211], a[156:159]
  v_mfma_f32_16x16x32_bf16 a[160:163], v[224:227], v[212:215], a[160:163]
  ds_read_b64_tr_b16 v[186:187], v12 offset:1024
  v_mfma_f32_16x16x32_bf16 a[164:167], v[228:231], v[212:215], a[164:167]
  v_mfma_f32_16x16x32_bf16 a[168:171], v[232:235], v[212:215], a[168:171]
  ds_read_b128 v[156:159], v4 offset:47104
  v_mfma_f32_16x16x32_bf16 a[172:175], v[236:239], v[212:215], a[172:175]
  v_mfma_f32_16x16x32_bf16 a[176:179], v[240:243], v[212:215], a[176:179]
  ds_read_b64_tr_b16 v[188:189], v13 offset:0
  v_mfma_f32_16x16x32_bf16 a[180:183], v[244:247], v[212:215], a[180:183]
  v_mfma_f32_16x16x32_bf16 a[184:187], v[248:251], v[212:215], a[184:187]
  ds_read_b64_tr_b16 v[190:191], v13 offset:1024
  v_mfma_f32_16x16x32_bf16 a[188:191], v[252:255], v[212:215], a[188:191]
  v_mfma_f32_16x16x32_bf16 a[192:195], v[224:227], v[216:219], a[192:195]
  v_mfma_f32_16x16x32_bf16 a[196:199], v[228:231], v[216:219], a[196:199]
  v_mfma_f32_16x16x32_bf16 a[200:203], v[232:235], v[216:219], a[200:203]
  v_mfma_f32_16x16x32_bf16 a[204:207], v[236:239], v[216:219], a[204:207]
  v_mfma_f32_16x16x32_bf16 a[208:211], v[240:243], v[216:219], a[208:211]
  v_mfma_f32_16x16x32_bf16 a[212:215], v[244:247], v[216:219], a[212:215]
  v_mfma_f32_16x16x32_bf16 a[216:219], v[248:251], v[216:219], a[216:219]
  v_mfma_f32_16x16x32_bf16 a[220:223], v[252:255], v[216:219], a[220:223]
  v_mfma_f32_16x16x32_bf16 a[224:227], v[224:227], v[220:223], a[224:227]
  v_mfma_f32_16x16x32_bf16 a[228:231], v[228:231], v[220:223], a[228:231]
  v_mfma_f32_16x16x32_bf16 a[232:235], v[232:235], v[220:223], a[232:235]
  v_mfma_f32_16x16x32_bf16 a[236:239], v[236:239], v[220:223], a[236:239]
  v_mfma_f32_16x16x32_bf16 a[240:243], v[240:243], v[220:223], a[240:243]
  v_mfma_f32_16x16x32_bf16 a[244:247], v[244:247], v[220:223], a[244:247]
  v_mfma_f32_16x16x32_bf16 a[248:251], v[248:251], v[220:223], a[248:251]
  v_mfma_f32_16x16x32_bf16 a[252:255], v[252:255], v[220:223], a[252:255]
  s_waitcnt lgkmcnt(0)
  v_mfma_f32_16x16x32_bf16 a[0:3], v[160:163], v[128:131], a[0:3]
  ds_read_b128 v[192:195], v5 offset:32768
  s_add_u32 m0, s62, 0
  s_nop 0
  buffer_load_dwordx4 v3, s[12:15], s40 offen nt lds
  v_mfma_f32_16x16x32_bf16 a[4:7], v[164:167], v[128:131], a[4:7]
  v_mfma_f32_16x16x32_bf16 a[8:11], v[168:171], v[128:131], a[8:11]
  ds_read_b64_tr_b16 v[224:225], v6 offset:8192
  v_mfma_f32_16x16x32_bf16 a[12:15], v[172:175], v[128:131], a[12:15]
  v_mfma_f32_16x16x32_bf16 a[16:19], v[176:179], v[128:131], a[16:19]
  ds_read_b64_tr_b16 v[226:227], v6 offset:9216
  v_mfma_f32_16x16x32_bf16 a[20:23], v[180:183], v[128:131], a[20:23]
  v_mfma_f32_16x16x32_bf16 a[24:27], v[184:187], v[128:131], a[24:27]
  ds_read_b128 v[196:199], v5 offset:34816
  s_add_u32 m0, s62, 16384
  s_nop 0
  buffer_load_dwordx4 v24, s[16:19], s40 offen nt lds
  v_mfma_f32_16x16x32_bf16 a[28:31], v[188:191], v[128:131], a[28:31]
  v_mfma_f32_16x16x32_bf16 a[32:35], v[160:163], v[132:135], a[32:35]
  ds_read_b64_tr_b16 v[228:229], v7 offset:8192
  v_mfma_f32_16x16x32_bf16 a[36:39], v[164:167], v[132:135], a[36:39]
  v_mfma_f32_16x16x32_bf16 a[40:43], v[168:171], v[132:135], a[40:43]
  ds_read_b64_tr_b16 v[230:231], v7 offset:9216
  v_mfma_f32_16x16x32_bf16 a[44:47], v[172:175], v[132:135], a[44:47]
  v_mfma_f32_16x16x32_bf16 a[48:51], v[176:179], v[132:135], a[48:51]
  ds_read_b128 v[200:203], v5 offset:36864
  s_add_u32 m0, s62, 4096
  s_nop 0
  buffer_load_dwordx4 v3, s[12:15], s41 offen nt lds
  v_mfma_f32_16x16x32_bf16 a[52:55], v[180:183], v[132:135], a[52:55]
  v_mfma_f32_16x16x32_bf16 a[56:59], v[184:187], v[132:135], a[56:59]
  ds_read_b64_tr_b16 v[232:233], v8 offset:8192
  v_mfma_f32_16x16x32_bf16 a[60:63], v[188:191], v[132:135], a[60:63]
  v_mfma_f32_16x16x32_bf16 a[64:67], v[160:163], v[136:139], a[64:67]
  ds_read_b64_tr_b16 v[234:235], v8 offset:9216
  v_mfma_f32_16x16x32_bf16 a[68:71], v[164:167], v[136:139], a[68:71]
  v_mfma_f32_16x16x32_bf16 a[72:75], v[168:171], v[136:139], a[72:75]
  ds_read_b128 v[204:207], v5 offset:38912
  v_mfma_f32_16x16x32_bf16 a[76:79], v[172:175], v[136:139], a[76:79]
  s_add_u32 m0, s62, 20480
  s_nop 0
  buffer_load_dwordx4 v24, s[16:19], s41 offen nt lds
  v_mfma_f32_16x16x32_bf16 a[80:83], v[176:179], v[136:139], a[80:83]
  ds_read_b64_tr_b16 v[236:237], v9 offset:8192
  v_mfma_f32_16x16x32_bf16 a[84:87], v[180:183], v[136:139], a[84:87]
  v_mfma_f32_16x16x32_bf16 a[88:91], v[184:187], v[136:139], a[88:91]
  ds_read_b64_tr_b16 v[238:239], v9 offset:9216
  v_mfma_f32_16x16x32_bf16 a[92:95], v[188:191], v[136:139], a[92:95]
  v_mfma_f32_16x16x32_bf16 a[96:99], v[160:163], v[140:143], a[96:99]
  ds_read_b128 v[208:211], v5 offset:40960
  v_mfma_f32_16x16x32_bf16 a[100:103], v[164:167], v[140:143], a[100:103]
  s_add_u32 m0, s62, 8192
  s_nop 0
  buffer_load_dwordx4 v3, s[12:15], s42 offen nt lds
  v_mfma_f32_16x16x32_bf16 a[104:107], v[168:171], v[140:143], a[104:107]
  ds_read_b64_tr_b16 v[240:241], v10 offset:8192
  v_mfma_f32_16x16x32_bf16 a[108:111], v[172:175], v[140:143], a[108:111]
  v_mfma_f32_16x16x32_bf16 a[112:115], v[176:179], v[140:143], a[112:115]
  ds_read_b64_tr_b16 v[242:243], v10 offset:9216
  v_mfma_f32_16x16x32_bf16 a[116:119], v[180:183], v[140:143], a[116:119]
  v_mfma_f32_16x16x32_bf16 a[120:123], v[184:187], v[140:143], a[120:123]
  ds_read_b128 v[212:215], v5 offset:43008
  v_mfma_f32_16x16x32_bf16 a[124:127], v[188:191], v[140:143], a[124:127]
  s_add_u32 m0, s62, 24576
  s_nop 0
  buffer_load_dwordx4 v24, s[16:19], s42 offen nt lds
  v_mfma_f32_16x16x32_bf16 a[128:131], v[160:163], v[144:147], a[128:131]
  ds_read_b64_tr_b16 v[244:245], v11 offset:8192
  v_mfma_f32_16x16x32_bf16 a[132:135], v[164:167], v[144:147], a[132:135]
  v_mfma_f32_16x16x32_bf16 a[136:139], v[168:171], v[144:147], a[136:139]
  ds_read_b64_tr_b16 v[246:247], v11 offset:9216
  v_mfma_f32_16x16x32_bf16 a[140:143], v[172:175], v[144:147], a[140:143]
  v_mfma_f32_16x16x32_bf16 a[144:147], v[176:179], v[144:147], a[144:147]
  ds_read_b128 v[216:219], v5 offset:45056
  v_mfma_f32_16x16x32_bf16 a[148:151], v[180:183], v[144:147], a[148:151]
  v_mfma_f32_16x16x32_bf16 a[152:155], v[184:187], v[144:147], a[152:155]
  s_add_u32 m0, s62, 12288
  s_nop 0
  buffer_load_dwordx4 v3, s[12:15], s43 offen nt lds
  ds_read_b64_tr_b16 v[248:249], v12 offset:8192
  v_mfma_f32_16x16x32_bf16 a[156:159], v[188:191], v[144:147], a[156:159]
  v_mfma_f32_16x16x32_bf16 a[160:163], v[160:163], v[148:151], a[160:163]
  ds_read_b64_tr_b16 v[250:251], v12 offset:9216
  v_mfma_f32_16x16x32_bf16 a[164:167], v[164:167], v[148:151], a[164:167]
  v_mfma_f32_16x16x32_bf16 a[168:171], v[168:171], v[148:151], a[168:171]
  ds_read_b128 v[220:223], v5 offset:47104
  v_mfma_f32_16x16x32_bf16 a[172:175], v[172:175], v[148:151], a[172:175]
  v_mfma_f32_16x16x32_bf16 a[176:179], v[176:179], v[148:151], a[176:179]
  s_add_u32 m0, s62, 28672
  s_nop 0
  buffer_load_dwordx4 v24, s[16:19], s43 offen nt lds
  v_add_u32 v3, s45, v3
  v_add_u32 v24, s45, v24
  ds_read_b64_tr_b16 v[252:253], v13 offset:8192
  v_mfma_f32_16x16x32_bf16 a[180:183], v[180:183], v[148:151], a[180:183]
  v_mfma_f32_16x16x32_bf16 a[184:187], v[184:187], v[148:151], a[184:187]
  ds_read_b64_tr_b16 v[254:255], v13 offset:9216
  v_mfma_f32_16x16x32_bf16 a[188:191], v[188:191], v[148:151], a[188:191]
  v_mfma_f32_16x16x32_bf16 a[192:195], v[160:163], v[152:155], a[192:195]
  v_mfma_f32_16x16x32_bf16 a[196:199], v[164:167], v[152:155], a[196:199]
  v_mfma_f32_16x16x32_bf16 a[200:203], v[168:171], v[152:155], a[200:203]
  v_mfma_f32_16x16x32_bf16 a[204:207], v[172:175], v[152:155], a[204:207]
  v_mfma_f32_16x16x32_bf16 a[208:211], v[176:179], v[152:155], a[208:211]
  v_mfma_f32_16x16x32_bf16 a[212:215], v[180:183], v[152:155], a[212:215]
  v_mfma_f32_16x16x32_bf16 a[216:219], v[184:187], v[152:155], a[216:219]
  v_mfma_f32_16x16x32_bf16 a[220:223], v[188:191], v[152:155], a[220:223]
  v_mfma_f32_16x16x32_bf16 a[224:227], v[160:163], v[156:159], a[224:227]
  s_add_u32 s62, s95, s97
  s_cmp_eq_u32 s97, 0x10000
  v_mfma_f32_16x16x32_bf16 a[228:231], v[164:167], v[156:159], a[228:231]
  s_cselect_b32 s63, 0xffff0000, s61
  s_add_u32 s97, s97, s63
  v_mfma_f32_16x16x32_bf16 a[232:235], v[168:171], v[156:159], a[232:235]
  v_add_u32 v6, s63, v6
  v_add_u32 v7, s63, v7
  v_mfma_f32_16x16x32_bf16 a[236:239], v[172:175], v[156:159], a[236:239]
  v_add_u32 v8, s63, v8
  v_add_u32 v9, s63, v9
  v_mfma_f32_16x16x32_bf16 a[240:243], v[176:179], v[156:159], a[240:243]
  v_add_u32 v10, s63, v10
  v_add_u32 v11, s63, v11
  v_mfma_f32_16x16x32_bf16 a[244:247], v[180:183], v[156:159], a[244:247]
  v_add_u32 v12, s63, v12
  v_add_u32 v13, s63, v13
  v_mfma_f32_16x16x32_bf16 a[248:251], v[184:187], v[156:159], a[248:251]
  v_mfma_f32_16x16x32_bf16 a[252:255], v[188:191], v[156:159], a[252:255]
  s_waitcnt vmcnt(8) lgkmcnt(0)
  s_barrier
  s_cmp_eq_u32 s55, 0
  s_cbranch_scc1 nf_52
  v_mov_b32 v14, s55
  s_mov_b64 exec, 1
  buffer_atomic_add v15, v14, s[4:7], 0 offen
  s_mov_b64 exec, -1
  s_mov_b32 s55, 0
nf_52:
  v_mfma_f32_16x16x32_bf16 a[0:3], v[224:227], v[192:195], a[0:3]
  ds_read_b128 v[128:131], v4 offset:0
  s_add_u32 m0, s95, 131072
  s_nop 0
  buffer_load_dwordx4 v2, s[8:11], s32 offen sc1 lds
  v_mfma_f32_16x16x32_bf16 a[4:7], v[228:231], v[192:195], a[4:7]
  v_mfma_f32_16x16x32_bf16 a[8:11], v[232:235], v[192:195], a[8:11]
  ds_read_b64_tr_b16 v[160:161], v6 offset:0
  v_mfma_f32_16x16x32_bf16 a[12:15], v[236:239], v[192:195], a[12:15]
  v_mfma_f32_16x16x32_bf16 a[16:19], v[240:243], v[192:195], a[16:19]
  ds_read_b64_tr_b16 v[162:163], v6 offset:1024
  v_mfma_f32_16x16x32_bf16 a[20:23], v[244:247], v[192:195], a[20:23]
  s_add_u32 m0, s95, 135168
  s_nop 0
  buffer_load_dwordx4 v2, s[8:11], s33 offen sc1 lds
  v_mfma_f32_16x16x32_bf16 a[24:27], v[248:251], v[192:195], a[24:27]
  ds_read_b128 v[132:135], v4 offset:2048
  v_mfma_f32_16x16x32_bf16 a[28:31], v[252:255], v[192:195], a[28:31]
  v_mfma_f32_16x16x32_bf16 a[32:35], v[224:227], v[196:199], a[32:35]
  ds_read_b64_tr_b16 v[164:165], v7 offset:0
  v_mfma_f32_16x16x32_bf16 a[36:39], v[228:231], v[196:199], a[36:39]
  v_mfma_f32_16x16x32_bf16 a[40:43], v[232:235], v[196:199], a[40:43]
  s_add_u32 m0, s95, 139264
  s_nop 0
  buffer_load_dwordx4 v2, s[8:11], s34 offen sc1 lds
  ds_read_b64_tr_b16 v[166:167], v7 offset:1024
  v_mfma_f32_16x16x32_bf16 a[44:47], v[236:239], v[196:199], a[44:47]
  v_mfma_f32_16x16x32_bf16 a[48:51], v[240:243], v[196:199], a[48:51]
  ds_read_b128 v[136:139], v4 offset:4096
  v_mfma_f32_16x16x32_bf16 a[52:55], v[244:247], v[196:199], a[52:55]
  v_mfma_f32_16x16x32_bf16 a[56:59], v[248:251], v[196:199], a[56:59]
  ds_read_b64_tr_b16 v[168:169], v8 offset:0
  s_add_u32 m0, s95, 143360
  s_nop 0
  buffer_load_dwordx4 v2, s[8:11], s35 offen sc1 lds
  v_mfma_f32_16x16x32_bf16 a[60:63], v[252:255], v[196:199], a[60:63]
  v_mfma_f32_16x16x32_bf16 a[64:67], v[224:227], v[200:203], a[64:67]
  ds_read_b64_tr_b16 v[170:171], v8 offset:1024
  v_mfma_f32_16x16x32_bf16 a[68:71], v[228:231], v[200:203], a[68:71]
  v_mfma_f32_16x16x32_bf16 a[72:75], v[232:235], v[200:203], a[72:75]
  ds_read_b128 v[140:143], v4 offset:6144
  v_mfma_f32_16x16x32_bf16 a[76:79], v[236:239], v[200:203], a[76:79]
  s_add_u32 m0, s95, 147456
  s_nop 0
  buffer_load_dwordx4 v2, s[8:11], s36 offen sc1 lds
  v_mfma_f32_16x16x32_bf16 a[80:83], v[240:243], v[200:203], a[80:83]
  ds_read_b64_tr_b16 v[172:173], v9 offset:0
  v_mfma_f32_16x16x32_bf16 a[84:87], v[244:247], v[200:203], a[84:87]
  v_mfma_f32_16x16x32_bf16 a[88:91], v[248:251], v[200:203], a[88:91]
  ds_read_b64_tr_b16 v[174:175], v9 offset:1024
  v_mfma_f32_16x16x32_bf16 a[92:95], v[252:255], v[200:203], a[92:95]
  v_mfma_f32_16x16x32_bf16 a[96:99], v[224:227], v[204:207], a[96:99]
  s_add_u32 m0, s95, 151552
  s_nop 0
  buffer_load_dwordx4 v2, s[8:11], s37 offen sc1 lds
  ds_read_b128 v[144:147], v4 offset:8192
  v_mfma_f32_16x16x32_bf16 a[100:103], v[228:231], v[204:207], a[100:103]
  v_mfma_f32_16x16x32_bf16 a[104:107], v[232:235], v[204:207], a[104:107]
  ds_read_b64_tr_b16 v[176:177], v10 offset:0
  v_mfma_f32_16x16x32_bf16 a[108:111], v[236:239], v[204:207], a[108:111]
  v_mfma_f32_16x16x32_bf16 a[112:115], v[240:243], v[204:207], a[112:115]
  ds_read_b64_tr_b16 v[178:179], v10 offset:1024
  s_add_u32 m0, s95, 155648
  s_nop 0
  buffer_load_dwordx4 v2, s[8:11], s38 offen sc1 lds
  v_mfma_f32_16x16x32_bf16 a[116:119], v[244:247], v[204:207], a[116:119]
  v_mfma_f32_16x16x32_bf16 a[120:123], v[248:251], v[204:207], a[120:123]
  ds_read_b128 v[148:151], v4 offset:10240
  v_mfma_f32_16x16x32_bf16 a[124:127], v[252:255], v[204:207], a[124:127]
  v_mfma_f32_16x16x32_bf16 a[128:131], v[224:227], v[208:211], a[128:131]
  ds_read_b64_tr_b16 v[180:181], v11 offset:0
  v_mfma_f32_16x16x32_bf16 a[132:135], v[228:231], v[208:211], a[132:135]
  s_add_u32 m0, s95, 159744
  s_nop 0
  buffer_load_dwordx4 v2, s[8:11], s39 offen sc1 lds
  v_add_u32 v2, s44, v2
  v_mfma_f32_16x16x32_bf16 a[136:139], v[232:235], v[208:211], a[136:139]
  ds_read_b64_tr_b16 v[182:183], v11 offset:1024
  v_mfma_f32_16x16x32_bf16 a[140:143], v[236:239], v[208:211], a[140:143]
  v_mfma_f32_16x16x32_bf16 a[144:147], v[240:243], v[208:211], a[144:147]
  ds_read_b128 v[152:155], v4 offset:12288
  v_mfma_f32_16x16x32_bf16 a[148:151], v[244:247], v[208:211], a[148:151]
  v_mfma_f32_16x16x32_bf16 a[152:155], v[248:251], v[208:211], a[152:155]
  ds_read_b64_tr_b16 v[184:185], v12 offset:0
  v_mfma_f32_16x16x32_bf16 a[156:159], v[252:255], v[208:211], a[156:159]
  v_mfma_f32_16x16x32_bf16 a[160:163], v[224:227], v[212:215], a[160:163]
  ds_read_b64_tr_b16 v[186:187], v12 offset:1024
  v_mfma_f32_16x16x32_bf16 a[164:167], v[228:231], v[212:215], a[164:167]
  v_mfma_f32_16x16x32_bf16 a[168:171], v[232:235], v[212:215], a[168:171]
  ds_read_b128 v[156:159], v4 offset:14336
  v_mfma_f32_16x16x32_bf16 a[172:175], v[236:239], v[212:215], a[172:175]
  v_mfma_f32_16x16x32_bf16 a[176:179], v[240:243], v[212:215], a[176:179]
  ds_read_b64_tr_b16 v[188:189], v13 offset:0
  v_mfma_f32_16x16x32_bf16 a[180:183], v[244:247], v[212:215], a[180:183]
  v_mfma_f32_16x16x32_bf16 a[184:187], v[248:251], v[212:215], a[184:187]
  ds_read_b64_tr_b16 v[190:191], v13 offset:1024
  v_mfma_f32_16x16x32_bf16 a[188:191], v[252:255], v[212:215], a[188:191]
  v_mfma_f32_16x16x32_bf16 a[192:195], v[224:227], v[216:219], a[192:195]
  v_mfma_f32_16x16x32_bf16 a[196:199], v[228:231], v[216:219], a[196:199]
  v_mfma_f32_16x16x32_bf16 a[200:203], v[232:235], v[216:219], a[200:203]
  v_mfma_f32_16x16x32_bf16 a[204:207], v[236:239], v[216:219], a[204:207]
  v_mfma_f32_16x16x32_bf16 a[208:211], v[240:243], v[216:219], a[208:211]
  v_mfma_f32_16x16x32_bf16 a[212:215], v[244:247], v[216:219], a[212:215]
  v_mfma_f32_16x16x32_bf16 a[216:219], v[248:251], v[216:219], a[216:219]
  v_mfma_f32_16x16x32_bf16 a[220:223], v[252:255], v[216:219], a[220:223]
  v_mfma_f32_16x16x32_bf16 a[224:227], v[224:227], v[220:223], a[224:227]
  v_mfma_f32_16x16x32_bf16 a[228:231], v[228:231], v[220:223], a[228:231]
  v_mfma_f32_16x16x32_bf16 a[232:235], v[232:235], v[220:223], a[232:235]
  v_mfma_f32_16x16x32_bf16 a[236:239], v[236:239], v[220:223], a[236:239]
  v_mfma_f32_16x16x32_bf16 a[240:243], v[240:243], v[220:223], a[240:243]
  v_mfma_f32_16x16x32_bf16 a[244:247], v[244:247], v[220:223], a[244:247]
  v_mfma_f32_16x16x32_bf16 a[248:251], v[248:251], v[220:223], a[248:251]
  v_mfma_f32_16x16x32_bf16 a[252:255], v[252:255], v[220:223], a[252:255]
  s_waitcnt lgkmcnt(0)
G_l_us_l:
  v_mfma_f32_16x16x32_bf16 a[0:3], v[160:163], v[128:131], a[0:3]
  ds_read_b128 v[192:195], v5 offset:0
  s_add_u32 m0, s62, 0
  s_nop 0
  buffer_load_dwordx4 v3, s[12:15], s40 offen nt lds
  v_mfma_f32_16x16x32_bf16 a[4:7], v[164:167], v[128:131], a[4:7]
  v_mfma_f32_16x16x32_bf16 a[8:11], v[168:171], v[128:131], a[8:11]
  ds_read_b64_tr_b16 v[224:225], v6 offset:8192
  v_mfma_f32_16x16x32_bf16 a[12:15], v[172:175], v[128:131], a[12:15]
  v_mfma_f32_16x16x32_bf16 a[16:19], v[176:179], v[128:131], a[16:19]
  ds_read_b64_tr_b16 v[226:227], v6 offset:9216
  v_mfma_f32_16x16x32_bf16 a[20:23], v[180:183], v[128:131], a[20:23]
  v_mfma_f32_16x16x32_bf16 a[24:27], v[184:187], v[128:131], a[24:27]
  ds_read_b128 v[196:199], v5 offset:2048
  s_add_u32 m0, s62, 16384
  s_nop 0
  buffer_load_dwordx4 v24, s[16:19], s40 offen nt lds
  v_mfma_f32_16x16x32_bf16 a[28:31], v[188:191], v[128:131], a[28:31]
  v_mfma_f32_16x16x32_bf16 a[32:35], v[160:163], v[132:135], a[32:35]
  ds_read_b64_tr_b16 v[228:229], v7 offset:8192
  v_mfma_f32_16x16x32_bf16 a[36:39], v[164:167], v[132:135], a[36:39]
  v_mfma_f32_16x16x32_bf16 a[40:43], v[168:171], v[132:135], a[40:43]
  ds_read_b64_tr_b16 v[230:231], v7 offset:9216
  v_mfma_f32_16x16x32_bf16 a[44:47], v[172:175], v[132:135], a[44:47]
  v_mfma_f32_16x16x32_bf16 a[48:51], v[176:179], v[132:135], a[48:51]
  ds_read_b128 v[200:203], v5 offset:4096
  s_add_u32 m0, s62, 4096
  s_nop 0
  buffer_load_dwordx4 v3, s[12:15], s41 offen nt lds
  v_mfma_f32_16x16x32_bf16 a[52:55], v[180:183], v[132:135], a[52:55]
  v_mfma_f32_16x16x32_bf16 a[56:59], v[184:187], v[132:135], a[56:59]
  ds_read_b64_tr_b16 v[232:233], v8 offset:8192
  v_mfma_f32_16x16x32_bf16 a[60:63], v[188:191], v[132:135], a[60:63]
  v_mfma_f32_16x16x32_bf16 a[64:67], v[160:163], v[136:139], a[64:67]
  ds_read_b64_tr_b16 v[234:235], v8 offset:9216
  v_mfma_f32_16x16x32_bf16 a[68:71], v[164:167], v[136:139], a[68:71]
  v_mfma_f32_16x16x32_bf16 a[72:75], v[168:171], v[136:139], a[72:75]
  ds_read_b128 v[204:207], v5 offset:6144
  v_mfma_f32_16x16x32_bf16 a[76:79], v[172:175], v[136:139], a[76:79]
  s_add_u32 m0, s62, 20480
  s_nop 0
  buffer_load_dwordx4 v24, s[16:19], s41 offen nt lds
  v_mfma_f32_16x16x32_bf16 a[80:83], v[176:179], v[136:139], a[80:83]
  ds_read_b64_tr_b16 v[236:237], v9 offset:8192
  v_mfma_f32_16x16x32_bf16 a[84:87], v[180:183], v[136:139], a[84:87]
  v_mfma_f32_16x16x32_bf16 a[88:91], v[184:187], v[136:139], a[88:91]
  ds_read_b64_tr_b16 v[238:239], v9 offset:9216
  v_mfma_f32_16x16x32_bf16 a[92:95], v[188:191], v[136:139], a[92:95]
  v_mfma_f32_16x16x32_bf16 a[96:99], v[160:163], v[140:143], a[96:99]
  ds_read_b128 v[208:211], v5 offset:8192
  v_mfma_f32_16x16x32_bf16 a[100:103], v[164:167], v[140:143], a[100:103]
  s_add_u32 m0, s62, 8192
  s_nop 0
  buffer_load_dwordx4 v3, s[12:15], s42 offen nt lds
  v_mfma_f32_16x16x32_bf16 a[104:107], v[168:171], v[140:143], a[104:107]
  ds_read_b64_tr_b16 v[240:241], v10 offset:8192
  v_mfma_f32_16x16x32_bf16 a[108:111], v[172:175], v[140:143], a[108:111]
  v_mfma_f32_16x16x32_bf16 a[112:115], v[176:179], v[140:143], a[112:115]
  ds_read_b64_tr_b16 v[242:243], v10 offset:9216
  v_mfma_f32_16x16x32_bf16 a[116:119], v[180:183], v[140:143], a[116:119]
  v_mfma_f32_16x16x32_bf16 a[120:123], v[184:187], v[140:143], a[120:123]
  ds_read_b128 v[212:215], v5 offset:10240
  v_mfma_f32_16x16x32_bf16 a[124:127], v[188:191], v[140:143], a[124:127]
  s_add_u32 m0, s62, 24576
  s_nop 0
  buffer_load_dwordx4 v24, s[16:19], s42 offen nt lds
  v_mfma_f32_16x16x32_bf16 a[128:131], v[160:163], v[144:147], a[128:131]
  ds_read_b64_tr_b16 v[244:245], v11 offset:8192
  v_mfma_f32_16x16x32_bf16 a[132:135], v[164:167], v[144:147], a[132:135]
  v_mfma_f32_16x16x32_bf16 a[136:139], v[168:171], v[144:147], a[136:139]
  ds_read_b64_tr_b16 v[246:247], v11 offset:9216
  v_mfma_f32_16x16x32_bf16 a[140:143], v[172:175], v[144:147], a[140:143]
  v_mfma_f32_16x16x32_bf16 a[144:147], v[176:179], v[144:147], a[144:147]
  ds_read_b128 v[216:219], v5 offset:12288
  v_mfma_f32_16x16x32_bf16 a[148:151], v[180:183], v[144:147], a[148:151]
  v_mfma_f32_16x16x32_bf16 a[152:155], v[184:187], v[144:147], a[152:155]
  s_add_u32 m0, s62, 12288
  s_nop 0
  buffer_load_dwordx4 v3, s[12:15], s43 offen nt lds
  ds_read_b64_tr_b16 v[248:249], v12 offset:8192
  v_mfma_f32_16x16x32_bf16 a[156:159], v[188:191], v[144:147], a[156:159]
  v_mfma_f32_16x16x32_bf16 a[160:163], v[160:163], v[148:151], a[160:163]
  ds_read_b64_tr_b16 v[250:251], v12 offset:9216
  v_mfma_f32_16x16x32_bf16 a[164:167], v[164:167], v[148:151], a[164:167]
  v_mfma_f32_16x16x32_bf16 a[168:171], v[168:171], v[148:151], a[168:171]
  ds_read_b128 v[220:223], v5 offset:14336
  v_mfma_f32_16x16x32_bf16 a[172:175], v[172:175], v[148:151], a[172:175]
  v_mfma_f32_16x16x32_bf16 a[176:179], v[176:179], v[148:151], a[176:179]
  s_add_u32 m0, s62, 28672
  s_nop 0
  buffer_load_dwordx4 v24, s[16:19], s43 offen nt lds
  v_add_u32 v3, s45, v3
  v_add_u32 v24, s45, v24
  ds_read_b64_tr_b16 v[252:253], v13 offset:8192
  v_mfma_f32_16x16x32_bf16 a[180:183], v[180:183], v[148:151], a[180:183]
  v_mfma_f32_16x16x32_bf16 a[184:187], v[184:187], v[148:151], a[184:187]
  ds_read_b64_tr_b16 v[254:255], v13 offset:9216
  v_mfma_f32_16x16x32_bf16 a[188:191], v[188:191], v[148:151], a[188:191]
  v_mfma_f32_16x16x32_bf16 a[192:195], v[160:163], v[152:155], a[192:195]
  v_mfma_f32_16x16x32_bf16 a[196:199], v[164:167], v[152:155], a[196:199]
  v_mfma_f32_16x16x32_bf16 a[200:203], v[168:171], v[152:155], a[200:203]
  v_mfma_f32_16x16x32_bf16 a[204:207], v[172:175], v[152:155], a[204:207]
  v_mfma_f32_16x16x32_bf16 a[208:211], v[176:179], v[152:155], a[208:211]
  v_mfma_f32_16x16x32_bf16 a[212:215], v[180:183], v[152:155], a[212:215]
  v_mfma_f32_16x16x32_bf16 a[216:219], v[184:187], v[152:155], a[216:219]
  v_mfma_f32_16x16x32_bf16 a[220:223], v[188:191], v[152:155], a[220:223]
  v_mfma_f32_16x16x32_bf16 a[224:227], v[160:163], v[156:159], a[224:227]
  s_add_u32 s62, s95, s97
  s_cmp_eq_u32 s97, 0x10000
  v_mfma_f32_16x16x32_bf16 a[228:231], v[164:167], v[156:159], a[228:231]
  s_cselect_b32 s63, 0xffff0000, s61
  s_add_u32 s97, s97, s63
  v_mfma_f32_16x16x32_bf16 a[232:235], v[168:171], v[156:159], a[232:235]
  v_add_u32 v6, s63, v6
  v_add_u32 v7, s63, v7
  v_mfma_f32_16x16x32_bf16 a[236:239], v[172:175], v[156:159], a[236:239]
  v_add_u32 v8, s63, v8
  v_add_u32 v9, s63, v9
  v_mfma_f32_16x16x32_bf16 a[240:243], v[176:179], v[156:159], a[240:243]
  v_add_u32 v10, s63, v10
  v_add_u32 v11, s63, v11
  v_mfma_f32_16x16x32_bf16 a[244:247], v[180:183], v[156:159], a[244:247]
  v_add_u32 v12, s63, v12
  v_add_u32 v13, s63, v13
  v_mfma_f32_16x16x32_bf16 a[248:251], v[184:187], v[156:159], a[248:251]
  v_mfma_f32_16x16x32_bf16 a[252:255], v[188:191], v[156:159], a[252:255]
  s_waitcnt vmcnt(8) lgkmcnt(0)
  s_barrier
  v_mfma_f32_16x16x32_bf16 a[0:3], v[224:227], v[192:195], a[0:3]
  ds_read_b128 v[128:131], v4 offset:32768
  s_add_u32 m0, s95, 98304
  s_nop 0
  buffer_load_dwordx4 v2, s[8:11], s32 offen sc1 lds
  v_mfma_f32_16x16x32_bf16 a[4:7], v[228:231], v[192:195], a[4:7]
  v_mfma_f32_16x16x32_bf16 a[8:11], v[232:235], v[192:195], a[8:11]
  ds_read_b64_tr_b16 v[160:161], v6 offset:0
  v_mfma_f32_16x16x32_bf16 a[12:15], v[236:239], v[192:195], a[12:15]
  v_mfma_f32_16x16x32_bf16 a[16:19], v[240:243], v[192:195], a[16:19]
  ds_read_b64_tr_b16 v[162:163], v6 offset:1024
  v_mfma_f32_16x16x32_bf16 a[20:23], v[244:247], v[192:195], a[20:23]
  s_add_u32 m0, s95, 102400
  s_nop 0
  buffer_load_dwordx4 v2, s[8:11], s33 offen sc1 lds
  v_mfma_f32_16x16x32_bf16 a[24:27], v[248:251], v[192:195], a[24:27]
  ds_read_b128 v[132:135], v4 offset:34816
  v_mfma_f32_16x16x32_bf16 a[28:31], v[252:255], v[192:195], a[28:31]
  v_mfma_f32_16x16x32_bf16 a[32:35], v[224:227], v[196:199], a[32:35]
  ds_read_b64_tr_b16 v[164:165], v7 offset:0
  v_mfma_f32_16x16x32_bf16 a[36:39], v[228:231], v[196:199], a[36:39]
  v_mfma_f32_16x16x32_bf16 a[40:43], v[232:235], v[196:199], a[40:43]
  s_add_u32 m0, s95, 106496
  s_nop 0
  buffer_load_dwordx4 v2, s[8:11], s34 offen sc1 lds
  ds_read_b64_tr_b16 v[166:167], v7 offset:1024
  v_mfma_f32_16x16x32_bf16 a[44:47], v[236:239], v[196:199], a[44:47]
  v_mfma_f32_16x16x32_bf16 a[48:51], v[240:243], v[196:199], a[48:51]
  ds_read_b128 v[136:139], v4 offset:36864
  v_mfma_f32_16x16x32_bf16 a[52:55], v[244:247], v[196:199], a[52:55]
  v_mfma_f32_16x16x32_bf16 a[56:59], v[248:251], v[196:199], a[56:59]
  ds_read_b64_tr_b16 v[168:169], v8 offset:0
  s_add_u32 m0, s95, 110592
  s_nop 0
  buffer_load_dwordx4 v2, s[8:11], s35 offen sc1 lds
  v_mfma_f32_16x16x32_bf16 a[60:63], v[252:255], v[196:199], a[60:63]
  v_mfma_f32_16x16x32_bf16 a[64:67], v[224:227], v[200:203], a[64:67]
  ds_read_b64_tr_b16 v[170:171], v8 offset:1024
  v_mfma_f32_16x16x32_bf16 a[68:71], v[228:231], v[200:203], a[68:71]
  v_mfma_f32_16x16x32_bf16 a[72:75], v[232:235], v[200:203], a[72:75]
  ds_read_b128 v[140:143], v4 offset:38912
  v_mfma_f32_16x16x32_bf16 a[76:79], v[236:239], v[200:203], a[76:79]
  s_add_u32 m0, s95, 114688
  s_nop 0
  buffer_load_dwordx4 v2, s[8:11], s36 offen sc1 lds
  v_mfma_f32_16x16x32_bf16 a[80:83], v[240:243], v[200:203], a[80:83]
  ds_read_b64_tr_b16 v[172:173], v9 offset:0
  v_mfma_f32_16x16x32_bf16 a[84:87], v[244:247], v[200:203], a[84:87]
  v_mfma_f32_16x16x32_bf16 a[88:91], v[248:251], v[200:203], a[88:91]
  ds_read_b64_tr_b16 v[174:175], v9 offset:1024
  v_mfma_f32_16x16x32_bf16 a[92:95], v[252:255], v[200:203], a[92:95]
  v_mfma_f32_16x16x32_bf16 a[96:99], v[224:227], v[204:207], a[96:99]
  s_add_u32 m0, s95, 118784
  s_nop 0
  buffer_load_dwordx4 v2, s[8:11], s37 offen sc1 lds
  ds_read_b128 v[144:147], v4 offset:40960
  v_mfma_f32_16x16x32_bf16 a[100:103], v[228:231], v[204:207], a[100:103]
  v_mfma_f32_16x16x32_bf16 a[104:107], v[232:235], v[204:207], a[104:107]
  ds_read_b64_tr_b16 v[176:177], v10 offset:0
  v_mfma_f32_16x16x32_bf16 a[108:111], v[236:239], v[204:207], a[108:111]
  v_mfma_f32_16x16x32_bf16 a[112:115], v[240:243], v[204:207], a[112:115]
  ds_read_b64_tr_b16 v[178:179], v10 offset:1024
  s_add_u32 m0, s95, 122880
  s_nop 0
  buffer_load_dwordx4 v2, s[8:11], s38 offen sc1 lds
  v_mfma_f32_16x16x32_bf16 a[116:119], v[244:247], v[204:207], a[116:119]
  v_mfma_f32_16x16x32_bf16 a[120:123], v[248:251], v[204:207], a[120:123]
  ds_read_b128 v[148:151], v4 offset:43008
  v_mfma_f32_16x16x32_bf16 a[124:127], v[252:255], v[204:207], a[124:127]
  v_mfma_f32_16x16x32_bf16 a[128:131], v[224:227], v[208:211], a[128:131]
  ds_read_b64_tr_b16 v[180:181], v11 offset:0
  v_mfma_f32_16x16x32_bf16 a[132:135], v[228:231], v[208:211], a[132:135]
  s_add_u32 m0, s95, 126976
  s_nop 0
  buffer_load_dwordx4 v2, s[8:11], s39 offen sc1 lds
  v_add_u32 v2, s44, v2
  v_mfma_f32_16x16x32_bf16 a[136:139], v[232:235], v[208:211], a[136:139]
  ds_read_b64_tr_b16 v[182:183], v11 offset:1024
  v_mfma_f32_16x16x32_bf16 a[140:143], v[236:239], v[208:211], a[140:143]
  v_mfma_f32_16x16x32_bf16 a[144:147], v[240:243], v[208:211], a[144:147]
  ds_read_b128 v[152:155], v4 offset:45056
  v_mfma_f32_16x16x32_bf16 a[148:151], v[244:247], v[208:211], a[148:151]
  v_mfma_f32_16x16x32_bf16 a[152:155], v[248:251], v[208:211], a[152:155]
  ds_read_b64_tr_b16 v[184:185], v12 offset:0
  v_mfma_f32_16x16x32_bf16 a[156:159], v[252:255], v[208:211], a[156:159]
  v_mfma_f32_16x16x32_bf16 a[160:163], v[224:227], v[212:215], a[160:163]
  ds_read_b64_tr_b16 v[186:187], v12 offset:1024
  v_mfma_f32_16x16x32_bf16 a[164:167], v[228:231], v[212:215], a[164:167]
  v_mfma_f32_16x16x32_bf16 a[168:171], v[232:235], v[212:215], a[168:171]
  ds_read_b128 v[156:159], v4 offset:47104
  v_mfma_f32_16x16x32_bf16 a[172:175], v[236:239], v[212:215], a[172:175]
  v_mfma_f32_16x16x32_bf16 a[176:179], v[240:243], v[212:215], a[176:179]
  ds_read_b64_tr_b16 v[188:189], v13 offset:0
  v_mfma_f32_16x16x32_bf16 a[180:183], v[244:247], v[212:215], a[180:183]
  v_mfma_f32_16x16x32_bf16 a[184:187], v[248:251], v[212:215], a[184:187]
  ds_read_b64_tr_b16 v[190:191], v13 offset:1024
  v_mfma_f32_16x16x32_bf16 a[188:191], v[252:255], v[212:215], a[188:191]
  v_mfma_f32_16x16x32_bf16 a[192:195], v[224:227], v[216:219], a[192:195]
  v_mfma_f32_16x16x32_bf16 a[196:199], v[228:231], v[216:219], a[196:199]
  v_mfma_f32_16x16x32_bf16 a[200:203], v[232:235], v[216:219], a[200:203]
  v_mfma_f32_16x16x32_bf16 a[204:207], v[236:239], v[216:219], a[204:207]
  v_mfma_f32_16x16x32_bf16 a[208:211], v[240:243], v[216:219], a[208:211]
  v_mfma_f32_16x16x32_bf16 a[212:215], v[244:247], v[216:219], a[212:215]
  v_mfma_f32_16x16x32_bf16 a[216:219], v[248:251], v[216:219], a[216:219]
  v_mfma_f32_16x16x32_bf16 a[220:223], v[252:255], v[216:219], a[220:223]
  v_mfma_f32_16x16x32_bf16 a[224:227], v[224:227], v[220:223], a[224:227]
  v_mfma_f32_16x16x32_bf16 a[228:231], v[228:231], v[220:223], a[228:231]
  v_mfma_f32_16x16x32_bf16 a[232:235], v[232:235], v[220:223], a[232:235]
  v_mfma_f32_16x16x32_bf16 a[236:239], v[236:239], v[220:223], a[236:239]
  v_mfma_f32_16x16x32_bf16 a[240:243], v[240:243], v[220:223], a[240:243]
  v_mfma_f32_16x16x32_bf16 a[244:247], v[244:247], v[220:223], a[244:247]
  v_mfma_f32_16x16x32_bf16 a[248:251], v[248:251], v[220:223], a[248:251]
  v_mfma_f32_16x16x32_bf16 a[252:255], v[252:255], v[220:223], a[252:255]
  s_waitcnt lgkmcnt(0)
  v_mfma_f32_16x16x32_bf16 a[0:3], v[160:163], v[128:131], a[0:3]
  ds_read_b128 v[192:195], v5 offset:32768
  s_add_u32 m0, s62, 0
  s_nop 0
  buffer_load_dwordx4 v3, s[12:15], s40 offen nt lds
  v_mfma_f32_16x16x32_bf16 a[4:7], v[164:167], v[128:131], a[4:7]
  v_mfma_f32_16x16x32_bf16 a[8:11], v[168:171], v[128:131], a[8:11]
  ds_read_b64_tr_b16 v[224:225], v6 offset:8192
  v_mfma_f32_16x16x32_bf16 a[12:15], v[172:175], v[128:131], a[12:15]
  v_mfma_f32_16x16x32_bf16 a[16:19], v[176:179], v[128:131], a[16:19]
  ds_read_b64_tr_b16 v[226:227], v6 offset:9216
  v_mfma_f32_16x16x32_bf16 a[20:23], v[180:183], v[128:131], a[20:23]
  v_mfma_f32_16x16x32_bf16 a[24:27], v[184:187], v[128:131], a[24:27]
  ds_read_b128 v[196:199], v5 offset:34816
  s_add_u32 m0, s62, 16384
  s_nop 0
  buffer_load_dwordx4 v24, s[16:19], s40 offen nt lds
  v_mfma_f32_16x16x32_bf16 a[28:31], v[188:191], v[128:131], a[28:31]
  v_mfma_f32_16x16x32_bf16 a[32:35], v[160:163], v[132:135], a[32:35]
  ds_read_b64_tr_b16 v[228:229], v7 offset:8192
  v_mfma_f32_16x16x32_bf16 a[36:39], v[164:167], v[132:135], a[36:39]
  v_mfma_f32_16x16x32_bf16 a[40:43], v[168:171], v[132:135], a[40:43]
  ds_read_b64_tr_b16 v[230:231], v7 offset:9216
  v_mfma_f32_16x16x32_bf16 a[44:47], v[172:175], v[132:135], a[44:47]
  v_mfma_f32_16x16x32_bf16 a[48:51], v[176:179], v[132:135], a[48:51]
  ds_read_b128 v[200:203], v5 offset:36864
  s_add_u32 m0, s62, 4096
  s_nop 0
  buffer_load_dwordx4 v3, s[12:15], s41 offen nt lds
  v_mfma_f32_16x16x32_bf16 a[52:55], v[180:183], v[132:135], a[52:55]
  v_mfma_f32_16x16x32_bf16 a[56:59], v[184:187], v[132:135], a[56:59]
  ds_read_b64_tr_b16 v[232:233], v8 offset:8192
  v_mfma_f32_16x16x32_bf16 a[60:63], v[188:191], v[132:135], a[60:63]
  v_mfma_f32_16x16x32_bf16 a[64:67], v[160:163], v[136:139], a[64:67]
  ds_read_b64_tr_b16 v[234:235], v8 offset:9216
  v_mfma_f32_16x16x32_bf16 a[68:71], v[164:167], v[136:139], a[68:71]
  v_mfma_f32_16x16x32_bf16 a[72:75], v[168:171], v[136:139], a[72:75]
  ds_read_b128 v[204:207], v5 offset:38912
  v_mfma_f32_16x16x32_bf16 a[76:79], v[172:175], v[136:139], a[76:79]
  s_add_u32 m0, s62, 20480
  s_nop 0
  buffer_load_dwordx4 v24, s[16:19], s41 offen nt lds
  v_mfma_f32_16x16x32_bf16 a[80:83], v[176:179], v[136:139], a[80:83]
  ds_read_b64_tr_b16 v[236:237], v9 offset:8192
  v_mfma_f32_16x16x32_bf16 a[84:87], v[180:183], v[136:139], a[84:87]
  v_mfma_f32_16x16x32_bf16 a[88:91], v[184:187], v[136:139], a[88:91]
  ds_read_b64_tr_b16 v[238:239], v9 offset:9216
  v_mfma_f32_16x16x32_bf16 a[92:95], v[188:191], v[136:139], a[92:95]
  v_mfma_f32_16x16x32_bf16 a[96:99], v[160:163], v[140:143], a[96:99]
  ds_read_b128 v[208:211], v5 offset:40960
  v_mfma_f32_16x16x32_bf16 a[100:103], v[164:167], v[140:143], a[100:103]
  s_add_u32 m0, s62, 8192
  s_nop 0
  buffer_load_dwordx4 v3, s[12:15], s42 offen nt lds
  v_mfma_f32_16x16x32_bf16 a[104:107], v[168:171], v[140:143], a[104:107]
  ds_read_b64_tr_b16 v[240:241], v10 offset:8192
  v_mfma_f32_16x16x32_bf16 a[108:111], v[172:175], v[140:143], a[108:111]
  v_mfma_f32_16x16x32_bf16 a[112:115], v[176:179], v[140:143], a[112:115]
  ds_read_b64_tr_b16 v[242:243], v10 offset:9216
  v_mfma_f32_16x16x32_bf16 a[116:119], v[180:183], v[140:143], a[116:119]
  v_mfma_f32_16x16x32_bf16 a[120:123], v[184:187], v[140:143], a[120:123]
  ds_read_b128 v[212:215], v5 offset:43008
  v_mfma_f32_16x16x32_bf16 a[124:127], v[188:191], v[140:143], a[124:127]
  s_add_u32 m0, s62, 24576
  s_nop 0
  buffer_load_dwordx4 v24, s[16:19], s42 offen nt lds
  v_mfma_f32_16x16x32_bf16 a[128:131], v[160:163], v[144:147], a[128:131]
  ds_read_b64_tr_b16 v[244:245], v11 offset:8192
  v_mfma_f32_16x16x32_bf16 a[132:135], v[164:167], v[144:147], a[132:135]
  v_mfma_f32_16x16x32_bf16 a[136:139], v[168:171], v[144:147], a[136:139]
  ds_read_b64_tr_b16 v[246:247], v11 offset:9216
  v_mfma_f32_16x16x32_bf16 a[140:143], v[172:175], v[144:147], a[140:143]
  v_mfma_f32_16x16x32_bf16 a[144:147], v[176:179], v[144:147], a[144:147]
  ds_read_b128 v[216:219], v5 offset:45056
  v_mfma_f32_16x16x32_bf16 a[148:151], v[180:183], v[144:147], a[148:151]
  v_mfma_f32_16x16x32_bf16 a[152:155], v[184:187], v[144:147], a[152:155]
  s_add_u32 m0, s62, 12288
  s_nop 0
  buffer_load_dwordx4 v3, s[12:15], s43 offen nt lds
  ds_read_b64_tr_b16 v[248:249], v12 offset:8192
  v_mfma_f32_16x16x32_bf16 a[156:159], v[188:191], v[144:147], a[156:159]
  v_mfma_f32_16x16x32_bf16 a[160:163], v[160:163], v[148:151], a[160:163]
  ds_read_b64_tr_b16 v[250:251], v12 offset:9216
  v_mfma_f32_16x16x32_bf16 a[164:167], v[164:167], v[148:151], a[164:167]
  v_mfma_f32_16x16x32_bf16 a[168:171], v[168:171], v[148:151], a[168:171]
  ds_read_b128 v[220:223], v5 offset:47104
  v_mfma_f32_16x16x32_bf16 a[172:175], v[172:175], v[148:151], a[172:175]
  v_mfma_f32_16x16x32_bf16 a[176:179], v[176:179], v[148:151], a[176:179]
  s_add_u32 m0, s62, 28672
  s_nop 0
  buffer_load_dwordx4 v24, s[16:19], s43 offen nt lds
  v_add_u32 v3, s45, v3
  v_add_u32 v24, s45, v24
  ds_read_b64_tr_b16 v[252:253], v13 offset:8192
  v_mfma_f32_16x16x32_bf16 a[180:183], v[180:183], v[148:151], a[180:183]
  v_mfma_f32_16x16x32_bf16 a[184:187], v[184:187], v[148:151], a[184:187]
  ds_read_b64_tr_b16 v[254:255], v13 offset:9216
  v_mfma_f32_16x16x32_bf16 a[188:191], v[188:191], v[148:151], a[188:191]
  v_mfma_f32_16x16x32_bf16 a[192:195], v[160:163], v[152:155], a[192:195]
  v_mfma_f32_16x16x32_bf16 a[196:199], v[164:167], v[152:155], a[196:199]
  v_mfma_f32_16x16x32_bf16 a[200:203], v[168:171], v[152:155], a[200:203]
  v_mfma_f32_16x16x32_bf16 a[204:207], v[172:175], v[152:155], a[204:207]
  v_mfma_f32_16x16x32_bf16 a[208:211], v[176:179], v[152:155], a[208:211]
  v_mfma_f32_16x16x32_bf16 a[212:215], v[180:183], v[152:155], a[212:215]
  v_mfma_f32_16x16x32_bf16 a[216:219], v[184:187], v[152:155], a[216:219]
  v_mfma_f32_16x16x32_bf16 a[220:223], v[188:191], v[152:155], a[220:223]
  v_mfma_f32_16x16x32_bf16 a[224:227], v[160:163], v[156:159], a[224:227]
  s_add_u32 s62, s95, s97
  s_cmp_eq_u32 s97, 0x10000
  v_mfma_f32_16x16x32_bf16 a[228:231], v[164:167], v[156:159], a[228:231]
  s_cselect_b32 s63, 0xffff0000, s61
  s_add_u32 s97, s97, s63
  v_mfma_f32_16x16x32_bf16 a[232:235], v[168:171], v[156:159], a[232:235]
  v_add_u32 v6, s63, v6
  v_add_u32 v7, s63, v7
  v_mfma_f32_16x16x32_bf16 a[236:239], v[172:175], v[156:159], a[236:239]
  v_add_u32 v8, s63, v8
  v_add_u32 v9, s63, v9
  v_mfma_f32_16x16x32_bf16 a[240:243], v[176:179], v[156:159], a[240:243]
  v_add_u32 v10, s63, v10
  v_add_u32 v11, s63, v11
  v_mfma_f32_16x16x32_bf16 a[244:247], v[180:183], v[156:159], a[244:247]
  v_add_u32 v12, s63, v12
  v_add_u32 v13, s63, v13
  v_mfma_f32_16x16x32_bf16 a[248:251], v[184:187], v[156:159], a[248:251]
  v_mfma_f32_16x16x32_bf16 a[252:255], v[188:191], v[156:159], a[252:255]
  s_waitcnt vmcnt(8) lgkmcnt(0)
  s_barrier
  v_mfma_f32_16x16x32_bf16 a[0:3], v[224:227], v[192:195], a[0:3]
  ds_read_b128 v[128:131], v4 offset:0
  s_add_u32 m0, s95, 131072
  s_nop 0
  buffer_load_dwordx4 v2, s[8:11], s32 offen sc1 lds
  v_mfma_f32_16x16x32_bf16 a[4:7], v[228:231], v[192:195], a[4:7]
  v_mfma_f32_16x16x32_bf16 a[8:11], v[232:235], v[192:195], a[8:11]
  ds_read_b64_tr_b16 v[160:161], v6 offset:0
  v_mfma_f32_16x16x32_bf16 a[12:15], v[236:239], v[192:195], a[12:15]
  v_mfma_f32_16x16x32_bf16 a[16:19], v[240:243], v[192:195], a[16:19]
  ds_read_b64_tr_b16 v[162:163], v6 offset:1024
  v_mfma_f32_16x16x32_bf16 a[20:23], v[244:247], v[192:195], a[20:23]
  s_add_u32 m0, s95, 135168
  s_nop 0
  buffer_load_dwordx4 v2, s[8:11], s33 offen sc1 lds
  v_mfma_f32_16x16x32_bf16 a[24:27], v[248:251], v[192:195], a[24:27]
  ds_read_b128 v[132:135], v4 offset:2048
  v_mfma_f32_16x16x32_bf16 a[28:31], v[252:255], v[192:195], a[28:31]
  v_mfma_f32_16x16x32_bf16 a[32:35], v[224:227], v[196:199], a[32:35]
  ds_read_b64_tr_b16 v[164:165], v7 offset:0
  v_mfma_f32_16x16x32_bf16 a[36:39], v[228:231], v[196:199], a[36:39]
  v_mfma_f32_16x16x32_bf16 a[40:43], v[232:235], v[196:199], a[40:43]
  s_add_u32 m0, s95, 139264
  s_nop 0
  buffer_load_dwordx4 v2, s[8:11], s34 offen sc1 lds
  ds_read_b64_tr_b16 v[166:167], v7 offset:1024
  v_mfma_f32_16x16x32_bf16 a[44:47], v[236:239], v[196:199], a[44:47]
  v_mfma_f32_16x16x32_bf16 a[48:51], v[240:243], v[196:199], a[48:51]
  ds_read_b128 v[136:139], v4 offset:4096
  v_mfma_f32_16x16x32_bf16 a[52:55], v[244:247], v[196:199], a[52:55]
  v_mfma_f32_16x16x32_bf16 a[56:59], v[248:251], v[196:199], a[56:59]
  ds_read_b64_tr_b16 v[168:169], v8 offset:0
  s_add_u32 m0, s95, 143360
  s_nop 0
  buffer_load_dwordx4 v2, s[8:11], s35 offen sc1 lds
  v_mfma_f32_16x16x32_bf16 a[60:63], v[252:255], v[196:199], a[60:63]
  v_mfma_f32_16x16x32_bf16 a[64:67], v[224:227], v[200:203], a[64:67]
  ds_read_b64_tr_b16 v[170:171], v8 offset:1024
  v_mfma_f32_16x16x32_bf16 a[68:71], v[228:231], v[200:203], a[68:71]
  v_mfma_f32_16x16x32_bf16 a[72:75], v[232:235], v[200:203], a[72:75]
  ds_read_b128 v[140:143], v4 offset:6144
  v_mfma_f32_16x16x32_bf16 a[76:79], v[236:239], v[200:203], a[76:79]
  s_add_u32 m0, s95, 147456
  s_nop 0
  buffer_load_dwordx4 v2, s[8:11], s36 offen sc1 lds
  v_mfma_f32_16x16x32_bf16 a[80:83], v[240:243], v[200:203], a[80:83]
  ds_read_b64_tr_b16 v[172:173], v9 offset:0
  v_mfma_f32_16x16x32_bf16 a[84:87], v[244:247], v[200:203], a[84:87]
  v_mfma_f32_16x16x32_bf16 a[88:91], v[248:251], v[200:203], a[88:91]
  ds_read_b64_tr_b16 v[174:175], v9 offset:1024
  v_mfma_f32_16x16x32_bf16 a[92:95], v[252:255], v[200:203], a[92:95]
  v_mfma_f32_16x16x32_bf16 a[96:99], v[224:227], v[204:207], a[96:99]
  s_add_u32 m0, s95, 151552
  s_nop 0
  buffer_load_dwordx4 v2, s[8:11], s37 offen sc1 lds
  ds_read_b128 v[144:147], v4 offset:8192
  v_mfma_f32_16x16x32_bf16 a[100:103], v[228:231], v[204:207], a[100:103]
  v_mfma_f32_16x16x32_bf16 a[104:107], v[232:235], v[204:207], a[104:107]
  ds_read_b64_tr_b16 v[176:177], v10 offset:0
  v_mfma_f32_16x16x32_bf16 a[108:111], v[236:239], v[204:207], a[108:111]
  v_mfma_f32_16x16x32_bf16 a[112:115], v[240:243], v[204:207], a[112:115]
  ds_read_b64_tr_b16 v[178:179], v10 offset:1024
  s_add_u32 m0, s95, 155648
  s_nop 0
  buffer_load_dwordx4 v2, s[8:11], s38 offen sc1 lds
  v_mfma_f32_16x16x32_bf16 a[116:119], v[244:247], v[204:207], a[116:119]
  v_mfma_f32_16x16x32_bf16 a[120:123], v[248:251], v[204:207], a[120:123]
  ds_read_b128 v[148:151], v4 offset:10240
  v_mfma_f32_16x16x32_bf16 a[124:127], v[252:255], v[204:207], a[124:127]
  v_mfma_f32_16x16x32_bf16 a[128:131], v[224:227], v[208:211], a[128:131]
  ds_read_b64_tr_b16 v[180:181], v11 offset:0
  v_mfma_f32_16x16x32_bf16 a[132:135], v[228:231], v[208:211], a[132:135]
  s_add_u32 m0, s95, 159744
  s_nop 0
  buffer_load_dwordx4 v2, s[8:11], s39 offen sc1 lds
  v_add_u32 v2, s44, v2
  v_mfma_f32_16x16x32_bf16 a[136:139], v[232:235], v[208:211], a[136:139]
  ds_read_b64_tr_b16 v[182:183], v11 offset:1024
  v_mfma_f32_16x16x32_bf16 a[140:143], v[236:239], v[208:211], a[140:143]
  v_mfma_f32_16x16x32_bf16 a[144:147], v[240:243], v[208:211], a[144:147]
  ds_read_b128 v[152:155], v4 offset:12288
  v_mfma_f32_16x16x32_bf16 a[148:151], v[244:247], v[208:211], a[148:151]
  v_mfma_f32_16x16x32_bf16 a[152:155], v[248:251], v[208:211], a[152:155]
  ds_read_b64_tr_b16 v[184:185], v12 offset:0
  v_mfma_f32_16x16x32_bf16 a[156:159], v[252:255], v[208:211], a[156:159]
  v_mfma_f32_16x16x32_bf16 a[160:163], v[224:227], v[212:215], a[160:163]
  ds_read_b64_tr_b16 v[186:187], v12 offset:1024
  v_mfma_f32_16x16x32_bf16 a[164:167], v[228:231], v[212:215], a[164:167]
  v_mfma_f32_16x16x32_bf16 a[168:171], v[232:235], v[212:215], a[168:171]
  ds_read_b128 v[156:159], v4 offset:14336
  v_mfma_f32_16x16x32_bf16 a[172:175], v[236:239], v[212:215], a[172:175]
  v_mfma_f32_16x16x32_bf16 a[176:179], v[240:243], v[212:215], a[176:179]
  ds_read_b64_tr_b16 v[188:189], v13 offset:0
  v_mfma_f32_16x16x32_bf16 a[180:183], v[244:247], v[212:215], a[180:183]
  v_mfma_f32_16x16x32_bf16 a[184:187], v[248:251], v[212:215], a[184:187]
  ds_read_b64_tr_b16 v[190:191], v13 offset:1024
  v_mfma_f32_16x16x32_bf16 a[188:191], v[252:255], v[212:215], a[188:191]
  v_mfma_f32_16x16x32_bf16 a[192:195], v[224:227], v[216:219], a[192:195]
  v_mfma_f32_16x16x32_bf16 a[196:199], v[228:231], v[216:219], a[196:199]
  v_mfma_f32_16x16x32_bf16 a[200:203], v[232:235], v[216:219], a[200:203]
  v_mfma_f32_16x16x32_bf16 a[204:207], v[236:239], v[216:219], a[204:207]
  v_mfma_f32_16x16x32_bf16 a[208:211], v[240:243], v[216:219], a[208:211]
  v_mfma_f32_16x16x32_bf16 a[212:215], v[244:247], v[216:219], a[212:215]
  v_mfma_f32_16x16x32_bf16 a[216:219], v[248:251], v[216:219], a[216:219]
  v_mfma_f32_16x16x32_bf16 a[220:223], v[252:255], v[216:219], a[220:223]
  v_mfma_f32_16x16x32_bf16 a[224:227], v[224:227], v[220:223], a[224:227]
  v_mfma_f32_16x16x32_bf16 a[228:231], v[228:231], v[220:223], a[228:231]
  v_mfma_f32_16x16x32_bf16 a[232:235], v[232:235], v[220:223], a[232:235]
  v_mfma_f32_16x16x32_bf16 a[236:239], v[236:239], v[220:223], a[236:239]
  v_mfma_f32_16x16x32_bf16 a[240:243], v[240:243], v[220:223], a[240:243]
  v_mfma_f32_16x16x32_bf16 a[244:247], v[244:247], v[220:223], a[244:247]
  v_mfma_f32_16x16x32_bf16 a[248:251], v[248:251], v[220:223], a[248:251]
  v_mfma_f32_16x16x32_bf16 a[252:255], v[252:255], v[220:223], a[252:255]
  s_waitcnt lgkmcnt(0)
  s_sub_u32 s46, s46, 2
  s_cmp_lg_u32 s46, 0
  s_cbranch_scc1 G_l_us_l
  v_mfma_f32_16x16x32_bf16 a[0:3], v[160:163], v[128:131], a[0:3]
  ds_read_b128 v[192:195], v5 offset:0
  v_mfma_f32_16x16x32_bf16 a[4:7], v[164:167], v[128:131], a[4:7]
  v_mfma_f32_16x16x32_bf16 a[8:11], v[168:171], v[128:131], a[8:11]
  ds_read_b64_tr_b16 v[224:225], v6 offset:8192
  v_mfma_f32_16x16x32_bf16 a[12:15], v[172:175], v[128:131], a[12:15]
  v_mfma_f32_16x16x32_bf16 a[16:19], v[176:179], v[128:131], a[16:19]
  ds_read_b64_tr_b16 v[226:227], v6 offset:9216
  v_mfma_f32_16x16x32_bf16 a[20:23], v[180:183], v[128:131], a[20:23]
  v_mfma_f32_16x16x32_bf16 a[24:27], v[184:187], v[128:131], a[24:27]
  ds_read_b128 v[196:199], v5 offset:2048
  v_mfma_f32_16x16x32_bf16 a[28:31], v[188:191], v[128:131], a[28:31]
  v_mfma_f32_16x16x32_bf16 a[32:35], v[160:163], v[132:135], a[32:35]
  ds_read_b64_tr_b16 v[228:229], v7 offset:8192
  v_mfma_f32_16x16x32_bf16 a[36:39], v[164:167], v[132:135], a[36:39]
  v_mfma_f32_16x16x32_bf16 a[40:43], v[168:171], v[132:135], a[40:43]
  ds_read_b64_tr_b16 v[230:231], v7 offset:9216
  v_mfma_f32_16x16x32_bf16 a[44:47], v[172:175], v[132:135], a[44:47]
  v_mfma_f32_16x16x32_bf16 a[48:51], v[176:179], v[132:135], a[48:51]
  ds_read_b128 v[200:203], v5 offset:4096
  v_mfma_f32_16x16x32_bf16 a[52:55], v[180:183], v[132:135], a[52:55]
  v_mfma_f32_16x16x32_bf16 a[56:59], v[184:187], v[132:135], a[56:59]
  ds_read_b64_tr_b16 v[232:233], v8 offset:8192
  v_mfma_f32_16x16x32_bf16 a[60:63], v[188:191], v[132:135], a[60:63]
  v_mfma_f32_16x16x32_bf16 a[64:67], v[160:163], v[136:139], a[64:67]
  ds_read_b64_tr_b16 v[234:235], v8 offset:9216
  v_mfma_f32_16x16x32_bf16 a[68:71], v[164:167], v[136:139], a[68:71]
  v_mfma_f32_16x16x32_bf16 a[72:75], v[168:171], v[136:139], a[72:75]
  ds_read_b128 v[204:207], v5 offset:6144
  v_mfma_f32_16x16x32_bf16 a[76:79], v[172:175], v[136:139], a[76:79]
  v_mfma_f32_16x16x32_bf16 a[80:83], v[176:179], v[136:139], a[80:83]
  ds_read_b64_tr_b16 v[236:237], v9 offset:8192
  v_mfma_f32_16x16x32_bf16 a[84:87], v[180:183], v[136:139], a[84:87]
  v_mfma_f32_16x16x32_bf16 a[88:91], v[184:187], v[136:139], a[88:91]
  ds_read_b64_tr_b16 v[238:239], v9 offset:9216
  v_mfma_f32_16x16x32_bf16 a[92:95], v[188:191], v[136:139], a[92:95]
  v_mfma_f32_16x16x32_bf16 a[96:99], v[160:163], v[140:143], a[96:99]
  ds_read_b128 v[208:211], v5 offset:8192
  v_mfma_f32_16x16x32_bf16 a[100:103], v[164:167], v[140:143], a[100:103]
  v_mfma_f32_16x16x32_bf16 a[104:107], v[168:171], v[140:143], a[104:107]
  ds_read_b64_tr_b16 v[240:241], v10 offset:8192
  v_mfma_f32_16x16x32_bf16 a[108:111], v[172:175], v[140:143], a[108:111]
  v_mfma_f32_16x16x32_bf16 a[112:115], v[176:179], v[140:143], a[112:115]
  ds_read_b64_tr_b16 v[242:243], v10 offset:9216
  v_mfma_f32_16x16x32_bf16 a[116:119], v[180:183], v[140:143], a[116:119]
  v_mfma_f32_16x16x32_bf16 a[120:123], v[184:187], v[140:143], a[120:123]
  ds_read_b128 v[212:215], v5 offset:10240
  v_mfma_f32_16x16x32_bf16 a[124:127], v[188:191], v[140:143], a[124:127]
  v_mfma_f32_16x16x32_bf16 a[128:131], v[160:163], v[144:147], a[128:131]
  ds_read_b64_tr_b16 v[244:245], v11 offset:8192
  v_mfma_f32_16x16x32_bf16 a[132:135], v[164:167], v[144:147], a[132:135]
  v_mfma_f32_16x16x32_bf16 a[136:139], v[168:171], v[144:147], a[136:139]
  ds_read_b64_tr_b16 v[246:247], v11 offset:9216
  v_mfma_f32_16x16x32_bf16 a[140:143], v[172:175], v[144:147], a[140:143]
  v_mfma_f32_16x16x32_bf16 a[144:147], v[176:179], v[144:147], a[144:147]
  ds_read_b128 v[216:219], v5 offset:12288
  v_mfma_f32_16x16x32_bf16 a[148:151], v[180:183], v[144:147], a[148:151]
  v_mfma_f32_16x16x32_bf16 a[152:155], v[184:187], v[144:147], a[152:155]
  ds_read_b64_tr_b16 v[248:249], v12 offset:8192
  v_mfma_f32_16x16x32_bf16 a[156:159], v[188:191], v[144:147], a[156:159]
  v_mfma_f32_16x16x32_bf16 a[160:163], v[160:163], v[148:151], a[160:163]
  ds_read_b64_tr_b16 v[250:251], v12 offset:9216
  v_mfma_f32_16x16x32_bf16 a[164:167], v[164:167], v[148:151], a[164:167]
  v_mfma_f32_16x16x32_bf16 a[168:171], v[168:171], v[148:151], a[168:171]
  ds_read_b128 v[220:223], v5 offset:14336
  v_mfma_f32_16x16x32_bf16 a[172:175], v[172:175], v[148:151], a[172:175]
  v_mfma_f32_16x16x32_bf16 a[176:179], v[176:179], v[148:151], a[176:179]
  ds_read_b64_tr_b16 v[252:253], v13 offset:8192
  v_mfma_f32_16x16x32_bf16 a[180:183], v[180:183], v[148:151], a[180:183]
  v_mfma_f32_16x16x32_bf16 a[184:187], v[184:187], v[148:151], a[184:187]
  ds_read_b64_tr_b16 v[254:255], v13 offset:9216
  v_mfma_f32_16x16x32_bf16 a[188:191], v[188:191], v[148:151], a[188:191]
  v_mfma_f32_16x16x32_bf16 a[192:195], v[160:163], v[152:155], a[192:195]
  v_mfma_f32_16x16x32_bf16 a[196:199], v[164:167], v[152:155], a[196:199]
  v_mfma_f32_16x16x32_bf16 a[200:203], v[168:171], v[152:155], a[200:203]
  v_mfma_f32_16x16x32_bf16 a[204:207], v[172:175], v[152:155], a[204:207]
  v_mfma_f32_16x16x32_bf16 a[208:211], v[176:179], v[152:155], a[208:211]
  v_mfma_f32_16x16x32_bf16 a[212:215], v[180:183], v[152:155], a[212:215]
  v_mfma_f32_16x16x32_bf16 a[216:219], v[184:187], v[152:155], a[216:219]
  v_mfma_f32_16x16x32_bf16 a[220:223], v[188:191], v[152:155], a[220:223]
  v_mfma_f32_16x16x32_bf16 a[224:227], v[160:163], v[156:159], a[224:227]
  s_add_u32 s62, s95, s97
  s_cmp_eq_u32 s97, 0x10000
  v_mfma_f32_16x16x32_bf16 a[228:231], v[164:167], v[156:159], a[228:231]
  s_cselect_b32 s63, 0xffff0000, s61
  s_add_u32 s97, s97, s63
  v_mfma_f32_16x16x32_bf16 a[232:235], v[168:171], v[156:159], a[232:235]
  v_add_u32 v6, s63, v6
  v_add_u32 v7, s63, v7
  v_mfma_f32_16x16x32_bf16 a[236:239], v[172:175], v[156:159], a[236:239]
  v_add_u32 v8, s63, v8
  v_add_u32 v9, s63, v9
  v_mfma_f32_16x16x32_bf16 a[240:243], v[176:179], v[156:159], a[240:243]
  v_add_u32 v10, s63, v10
  v_add_u32 v11, s63, v11
  v_mfma_f32_16x16x32_bf16 a[244:247], v[180:183], v[156:159], a[244:247]
  v_add_u32 v12, s63, v12
  v_add_u32 v13, s63, v13
  v_mfma_f32_16x16x32_bf16 a[248:251], v[184:187], v[156:159], a[248:251]
  v_mfma_f32_16x16x32_bf16 a[252:255], v[188:191], v[156:159], a[252:255]
  s_waitcnt vmcnt(0) lgkmcnt(0)
  s_barrier
  v_mfma_f32_16x16x32_bf16 a[0:3], v[224:227], v[192:195], a[0:3]
  ds_read_b128 v[128:131], v4 offset:32768
  v_mfma_f32_16x16x32_bf16 a[4:7], v[228:231], v[192:195], a[4:7]
  v_mfma_f32_16x16x32_bf16 a[8:11], v[232:235], v[192:195], a[8:11]
  ds_read_b64_tr_b16 v[160:161], v6 offset:0
  v_mfma_f32_16x16x32_bf16 a[12:15], v[236:239], v[192:195], a[12:15]
  v_mfma_f32_16x16x32_bf16 a[16:19], v[240:243], v[192:195], a[16:19]
  ds_read_b64_tr_b16 v[162:163], v6 offset:1024
  v_mfma_f32_16x16x32_bf16 a[20:23], v[244:247], v[192:195], a[20:23]
  v_mfma_f32_16x16x32_bf16 a[24:27], v[248:251], v[192:195], a[24:27]
  ds_read_b128 v[132:135], v4 offset:34816
  v_mfma_f32_16x16x32_bf16 a[28:31], v[252:255], v[192:195], a[28:31]
  v_mfma_f32_16x16x32_bf16 a[32:35], v[224:227], v[196:199], a[32:35]
  ds_read_b64_tr_b16 v[164:165], v7 offset:0
  v_mfma_f32_16x16x32_bf16 a[36:39], v[228:231], v[196:199], a[36:39]
  v_mfma_f32_16x16x32_bf16 a[40:43], v[232:235], v[196:199], a[40:43]
  ds_read_b64_tr_b16 v[166:167], v7 offset:1024
  v_mfma_f32_16x16x32_bf16 a[44:47], v[236:239], v[196:199], a[44:47]
  v_mfma_f32_16x16x32_bf16 a[48:51], v[240:243], v[196:199], a[48:51]
  ds_read_b128 v[136:139], v4 offset:36864
  v_mfma_f32_16x16x32_bf16 a[52:55], v[244:247], v[196:199], a[52:55]
  v_mfma_f32_16x16x32_bf16 a[56:59], v[248:251], v[196:199], a[56:59]
  ds_read_b64_tr_b16 v[168:169], v8 offset:0
  v_mfma_f32_16x16x32_bf16 a[60:63], v[252:255], v[196:199], a[60:63]
  v_mfma_f32_16x16x32_bf16 a[64:67], v[224:227], v[200:203], a[64:67]
  ds_read_b64_tr_b16 v[170:171], v8 offset:1024
  v_mfma_f32_16x16x32_bf16 a[68:71], v[228:231], v[200:203], a[68:71]
  v_mfma_f32_16x16x32_bf16 a[72:75], v[232:235], v[200:203], a[72:75]
  ds_read_b128 v[140:143], v4 offset:38912
  v_mfma_f32_16x16x32_bf16 a[76:79], v[236:239], v[200:203], a[76:79]
  v_mfma_f32_16x16x32_bf16 a[80:83], v[240:243], v[200:203], a[80:83]
  ds_read_b64_tr_b16 v[172:173], v9 offset:0
  v_mfma_f32_16x16x32_bf16 a[84:87], v[244:247], v[200:203], a[84:87]
  v_mfma_f32_16x16x32_bf16 a[88:91], v[248:251], v[200:203], a[88:91]
  ds_read_b64_tr_b16 v[174:175], v9 offset:1024
  v_mfma_f32_16x16x32_bf16 a[92:95], v[252:255], v[200:203], a[92:95]
  v_mfma_f32_16x16x32_bf16 a[96:99], v[224:227], v[204:207], a[96:99]
  ds_read_b128 v[144:147], v4 offset:40960
  v_mfma_f32_16x16x32_bf16 a[100:103], v[228:231], v[204:207], a[100:103]
  v_mfma_f32_16x16x32_bf16 a[104:107], v[232:235], v[204:207], a[104:107]
  ds_read_b64_tr_b16 v[176:177], v10 offset:0
  v_mfma_f32_16x16x32_bf16 a[108:111], v[236:239], v[204:207], a[108:111]
  v_mfma_f32_16x16x32_bf16 a[112:115], v[240:243], v[204:207], a[112:115]
  ds_read_b64_tr_b16 v[178:179], v10 offset:1024
  v_mfma_f32_16x16x32_bf16 a[116:119], v[244:247], v[204:207], a[116:119]
  v_mfma_f32_16x16x32_bf16 a[120:123], v[248:251], v[204:207], a[120:123]
  ds_read_b128 v[148:151], v4 offset:43008
  v_mfma_f32_16x16x32_bf16 a[124:127], v[252:255], v[204:207], a[124:127]
  v_mfma_f32_16x16x32_bf16 a[128:131], v[224:227], v[208:211], a[128:131]
  ds_read_b64_tr_b16 v[180:181], v11 offset:0
  v_mfma_f32_16x16x32_bf16 a[132:135], v[228:231], v[208:211], a[132:135]
  v_mfma_f32_16x16x32_bf16 a[136:139], v[232:235], v[208:211], a[136:139]
  ds_read_b64_tr_b16 v[182:183], v11 offset:1024
  v_mfma_f32_16x16x32_bf16 a[140:143], v[236:239], v[208:211], a[140:143]
  v_mfma_f32_16x16x32_bf16 a[144:147], v[240:243], v[208:211], a[144:147]
  ds_read_b128 v[152:155], v4 offset:45056
  v_mfma_f32_16x16x32_bf16 a[148:151], v[244:247], v[208:211], a[148:151]
  v_mfma_f32_16x16x32_bf16 a[152:155], v[248:251], v[208:211], a[152:155]
  ds_read_b64_tr_b16 v[184:185], v12 offset:0
  v_mfma_f32_16x16x32_bf16 a[156:159], v[252:255], v[208:211], a[156:159]
  v_mfma_f32_16x16x32_bf16 a[160:163], v[224:227], v[212:215], a[160:163]
  ds_read_b64_tr_b16 v[186:187], v12 offset:1024
  v_mfma_f32_16x16x32_bf16 a[164:167], v[228:231], v[212:215], a[164:167]
  v_mfma_f32_16x16x32_bf16 a[168:171], v[232:235], v[212:215], a[168:171]
  ds_read_b128 v[156:159], v4 offset:47104
  v_mfma_f32_16x16x32_bf16 a[172:175], v[236:239], v[212:215], a[172:175]
  v_mfma_f32_16x16x32_bf16 a[176:179], v[240:243], v[212:215], a[176:179]
  ds_read_b64_tr_b16 v[188:189], v13 offset:0
  v_mfma_f32_16x16x32_bf16 a[180:183], v[244:247], v[212:215], a[180:183]
  v_mfma_f32_16x16x32_bf16 a[184:187], v[248:251], v[212:215], a[184:187]
  ds_read_b64_tr_b16 v[190:191], v13 offset:1024
  v_mfma_f32_16x16x32_bf16 a[188:191], v[252:255], v[212:215], a[188:191]
  v_mfma_f32_16x16x32_bf16 a[192:195], v[224:227], v[216:219], a[192:195]
  v_mfma_f32_16x16x32_bf16 a[196:199], v[228:231], v[216:219], a[196:199]
  v_mfma_f32_16x16x32_bf16 a[200:203], v[232:235], v[216:219], a[200:203]
  v_mfma_f32_16x16x32_bf16 a[204:207], v[236:239], v[216:219], a[204:207]
  v_mfma_f32_16x16x32_bf16 a[208:211], v[240:243], v[216:219], a[208:211]
  v_mfma_f32_16x16x32_bf16 a[212:215], v[244:247], v[216:219], a[212:215]
  v_mfma_f32_16x16x32_bf16 a[216:219], v[248:251], v[216:219], a[216:219]
  v_mfma_f32_16x16x32_bf16 a[220:223], v[252:255], v[216:219], a[220:223]
  v_mfma_f32_16x16x32_bf16 a[224:227], v[224:227], v[220:223], a[224:227]
  v_mfma_f32_16x16x32_bf16 a[228:231], v[228:231], v[220:223], a[228:231]
  v_mfma_f32_16x16x32_bf16 a[232:235], v[232:235], v[220:223], a[232:235]
  v_mfma_f32_16x16x32_bf16 a[236:239], v[236:239], v[220:223], a[236:239]
  v_mfma_f32_16x16x32_bf16 a[240:243], v[240:243], v[220:223], a[240:243]
  v_mfma_f32_16x16x32_bf16 a[244:247], v[244:247], v[220:223], a[244:247]
  v_mfma_f32_16x16x32_bf16 a[248:251], v[248:251], v[220:223], a[248:251]
  v_mfma_f32_16x16x32_bf16 a[252:255], v[252:255], v[220:223], a[252:255]
  s_waitcnt lgkmcnt(0)
  v_mfma_f32_16x16x32_bf16 a[0:3], v[160:163], v[128:131], a[0:3]
  ds_read_b128 v[192:195], v5 offset:32768
  v_mfma_f32_16x16x32_bf16 a[4:7], v[164:167], v[128:131], a[4:7]
  v_mfma_f32_16x16x32_bf16 a[8:11], v[168:171], v[128:131], a[8:11]
  ds_read_b64_tr_b16 v[224:225], v6 offset:8192
  v_mfma_f32_16x16x32_bf16 a[12:15], v[172:175], v[128:131], a[12:15]
  v_mfma_f32_16x16x32_bf16 a[16:19], v[176:179], v[128:131], a[16:19]
  ds_read_b64_tr_b16 v[226:227], v6 offset:9216
  v_mfma_f32_16x16x32_bf16 a[20:23], v[180:183], v[128:131], a[20:23]
  v_mfma_f32_16x16x32_bf16 a[24:27], v[184:187], v[128:131], a[24:27]
  ds_read_b128 v[196:199], v5 offset:34816
  v_mfma_f32_16x16x32_bf16 a[28:31], v[188:191], v[128:131], a[28:31]
  v_mfma_f32_16x16x32_bf16 a[32:35], v[160:163], v[132:135], a[32:35]
  ds_read_b64_tr_b16 v[228:229], v7 offset:8192
  v_mfma_f32_16x16x32_bf16 a[36:39], v[164:167], v[132:135], a[36:39]
  v_mfma_f32_16x16x32_bf16 a[40:43], v[168:171], v[132:135], a[40:43]
  ds_read_b64_tr_b16 v[230:231], v7 offset:9216
  v_mfma_f32_16x16x32_bf16 a[44:47], v[172:175], v[132:135], a[44:47]
  v_mfma_f32_16x16x32_bf16 a[48:51], v[176:179], v[132:135], a[48:51]
  ds_read_b128 v[200:203], v5 offset:36864
  v_mfma_f32_16x16x32_bf16 a[52:55], v[180:183], v[132:135], a[52:55]
  v_mfma_f32_16x16x32_bf16 a[56:59], v[184:187], v[132:135], a[56:59]
  ds_read_b64_tr_b16 v[232:233], v8 offset:8192
  v_mfma_f32_16x16x32_bf16 a[60:63], v[188:191], v[132:135], a[60:63]
  v_mfma_f32_16x16x32_bf16 a[64:67], v[160:163], v[136:139], a[64:67]
  ds_read_b64_tr_b16 v[234:235], v8 offset:9216
  v_mfma_f32_16x16x32_bf16 a[68:71], v[164:167], v[136:139], a[68:71]
  v_mfma_f32_16x16x32_bf16 a[72:75], v[168:171], v[136:139], a[72:75]
  ds_read_b128 v[204:207], v5 offset:38912
  v_mfma_f32_16x16x32_bf16 a[76:79], v[172:175], v[136:139], a[76:79]
  v_mfma_f32_16x16x32_bf16 a[80:83], v[176:179], v[136:139], a[80:83]
  ds_read_b64_tr_b16 v[236:237], v9 offset:8192
  v_mfma_f32_16x16x32_bf16 a[84:87], v[180:183], v[136:139], a[84:87]
  v_mfma_f32_16x16x32_bf16 a[88:91], v[184:187], v[136:139], a[88:91]
  ds_read_b64_tr_b16 v[238:239], v9 offset:9216
  v_mfma_f32_16x16x32_bf16 a[92:95], v[188:191], v[136:139], a[92:95]
  v_mfma_f32_16x16x32_bf16 a[96:99], v[160:163], v[140:143], a[96:99]
  ds_read_b128 v[208:211], v5 offset:40960
  v_mfma_f32_16x16x32_bf16 a[100:103], v[164:167], v[140:143], a[100:103]
  v_mfma_f32_16x16x32_bf16 a[104:107], v[168:171], v[140:143], a[104:107]
  ds_read_b64_tr_b16 v[240:241], v10 offset:8192
  v_mfma_f32_16x16x32_bf16 a[108:111], v[172:175], v[140:143], a[108:111]
  v_mfma_f32_16x16x32_bf16 a[112:115], v[176:179], v[140:143], a[112:115]
  ds_read_b64_tr_b16 v[242:243], v10 offset:9216
  v_mfma_f32_16x16x32_bf16 a[116:119], v[180:183], v[140:143], a[116:119]
  v_mfma_f32_16x16x32_bf16 a[120:123], v[184:187], v[140:143], a[120:123]
  ds_read_b128 v[212:215], v5 offset:43008
  v_mfma_f32_16x16x32_bf16 a[124:127], v[188:191], v[140:143], a[124:127]
  v_mfma_f32_16x16x32_bf16 a[128:131], v[160:163], v[144:147], a[128:131]
  ds_read_b64_tr_b16 v[244:245], v11 offset:8192
  v_mfma_f32_16x16x32_bf16 a[132:135], v[164:167], v[144:147], a[132:135]
  v_mfma_f32_16x16x32_bf16 a[136:139], v[168:171], v[144:147], a[136:139]
  ds_read_b64_tr_b16 v[246:247], v11 offset:9216
  v_mfma_f32_16x16x32_bf16 a[140:143], v[172:175], v[144:147], a[140:143]
  v_mfma_f32_16x16x32_bf16 a[144:147], v[176:179], v[144:147], a[144:147]
  ds_read_b128 v[216:219], v5 offset:45056
  v_mfma_f32_16x16x32_bf16 a[148:151], v[180:183], v[144:147], a[148:151]
  v_mfma_f32_16x16x32_bf16 a[152:155], v[184:187], v[144:147], a[152:155]
  ds_read_b64_tr_b16 v[248:249], v12 offset:8192
  v_mfma_f32_16x16x32_bf16 a[156:159], v[188:191], v[144:147], a[156:159]
  v_mfma_f32_16x16x32_bf16 a[160:163], v[160:163], v[148:151], a[160:163]
  ds_read_b64_tr_b16 v[250:251], v12 offset:9216
  v_mfma_f32_16x16x32_bf16 a[164:167], v[164:167], v[148:151], a[164:167]
  v_mfma_f32_16x16x32_bf16 a[168:171], v[168:171], v[148:151], a[168:171]
  ds_read_b128 v[220:223], v5 offset:47104
  v_mfma_f32_16x16x32_bf16 a[172:175], v[172:175], v[148:151], a[172:175]
  v_mfma_f32_16x16x32_bf16 a[176:179], v[176:179], v[148:151], a[176:179]
  ds_read_b64_tr_b16 v[252:253], v13 offset:8192
  v_mfma_f32_16x16x32_bf16 a[180:183], v[180:183], v[148:151], a[180:183]
  v_mfma_f32_16x16x32_bf16 a[184:187], v[184:187], v[148:151], a[184:187]
  ds_read_b64_tr_b16 v[254:255], v13 offset:9216
  v_mfma_f32_16x16x32_bf16 a[188:191], v[188:191], v[148:151], a[188:191]
  v_mfma_f32_16x16x32_bf16 a[192:195], v[160:163], v[152:155], a[192:195]
  v_mfma_f32_16x16x32_bf16 a[196:199], v[164:167], v[152:155], a[196:199]
  v_mfma_f32_16x16x32_bf16 a[200:203], v[168:171], v[152:155], a[200:203]
  v_mfma_f32_16x16x32_bf16 a[204:207], v[172:175], v[152:155], a[204:207]
  v_mfma_f32_16x16x32_bf16 a[208:211], v[176:179], v[152:155], a[208:211]
  v_mfma_f32_16x16x32_bf16 a[212:215], v[180:183], v[152:155], a[212:215]
  v_mfma_f32_16x16x32_bf16 a[216:219], v[184:187], v[152:155], a[216:219]
  v_mfma_f32_16x16x32_bf16 a[220:223], v[188:191], v[152:155], a[220:223]
  v_mfma_f32_16x16x32_bf16 a[224:227], v[160:163], v[156:159], a[224:227]
  v_mfma_f32_16x16x32_bf16 a[228:231], v[164:167], v[156:159], a[228:231]
  v_mfma_f32_16x16x32_bf16 a[232:235], v[168:171], v[156:159], a[232:235]
  v_mfma_f32_16x16x32_bf16 a[236:239], v[172:175], v[156:159], a[236:239]
  v_mfma_f32_16x16x32_bf16 a[240:243], v[176:179], v[156:159], a[240:243]
  v_mfma_f32_16x16x32_bf16 a[244:247], v[180:183], v[156:159], a[244:247]
  v_mfma_f32_16x16x32_bf16 a[248:251], v[184:187], v[156:159], a[248:251]
  v_mfma_f32_16x16x32_bf16 a[252:255], v[188:191], v[156:159], a[252:255]
  s_waitcnt lgkmcnt(0)
  s_barrier
  v_mfma_f32_16x16x32_bf16 a[0:3], v[224:227], v[192:195], a[0:3]
  v_mfma_f32_16x16x32_bf16 a[4:7], v[228:231], v[192:195], a[4:7]
  v_mfma_f32_16x16x32_bf16 a[8:11], v[232:235], v[192:195], a[8:11]
  v_mfma_f32_16x16x32_bf16 a[12:15], v[236:239], v[192:195], a[12:15]
  v_mfma_f32_16x16x32_bf16 a[16:19], v[240:243], v[192:195], a[16:19]
  v_mfma_f32_16x16x32_bf16 a[20:23], v[244:247], v[192:195], a[20:23]
  v_mfma_f32_16x16x32_bf16 a[24:27], v[248:251], v[192:195], a[24:27]
  v_mfma_f32_16x16x32_bf16 a[28:31], v[252:255], v[192:195], a[28:31]
  v_mfma_f32_16x16x32_bf16 a[32:35], v[224:227], v[196:199], a[32:35]
  v_mfma_f32_16x16x32_bf16 a[36:39], v[228:231], v[196:199], a[36:39]
  v_mfma_f32_16x16x32_bf16 a[40:43], v[232:235], v[196:199], a[40:43]
  v_mfma_f32_16x16x32_bf16 a[44:47], v[236:239], v[196:199], a[44:47]
  v_mfma_f32_16x16x32_bf16 a[48:51], v[240:243], v[196:199], a[48:51]
  v_mfma_f32_16x16x32_bf16 a[52:55], v[244:247], v[196:199], a[52:55]
  v_mfma_f32_16x16x32_bf16 a[56:59], v[248:251], v[196:199], a[56:59]
  v_mfma_f32_16x16x32_bf16 a[60:63], v[252:255], v[196:199], a[60:63]
  v_mfma_f32_16x16x32_bf16 a[64:67], v[224:227], v[200:203], a[64:67]
  v_mfma_f32_16x16x32_bf16 a[68:71], v[228:231], v[200:203], a[68:71]
  v_mfma_f32_16x16x32_bf16 a[72:75], v[232:235], v[200:203], a[72:75]
  v_mfma_f32_16x16x32_bf16 a[76:79], v[236:239], v[200:203], a[76:79]
  v_mfma_f32_16x16x32_bf16 a[80:83], v[240:243], v[200:203], a[80:83]
  v_mfma_f32_16x16x32_bf16 a[84:87], v[244:247], v[200:203], a[84:87]
  v_mfma_f32_16x16x32_bf16 a[88:91], v[248:251], v[200:203], a[88:91]
  v_mfma_f32_16x16x32_bf16 a[92:95], v[252:255], v[200:203], a[92:95]
  v_mfma_f32_16x16x32_bf16 a[96:99], v[224:227], v[204:207], a[96:99]
  v_mfma_f32_16x16x32_bf16 a[100:103], v[228:231], v[204:207], a[100:103]
  v_mfma_f32_16x16x32_bf16 a[104:107], v[232:235], v[204:207], a[104:107]
  v_mfma_f32_16x16x32_bf16 a[108:111], v[236:239], v[204:207], a[108:111]
  v_mfma_f32_16x16x32_bf16 a[112:115], v[240:243], v[204:207], a[112:115]
  v_mfma_f32_16x16x32_bf16 a[116:119], v[244:247], v[204:207], a[116:119]
  v_mfma_f32_16x16x32_bf16 a[120:123], v[248:251], v[204:207], a[120:123]
  v_mfma_f32_16x16x32_bf16 a[124:127], v[252:255], v[204:207], a[124:127]
  v_mfma_f32_16x16x32_bf16 a[128:131], v[224:227], v[208:211], a[128:131]
  v_mfma_f32_16x16x32_bf16 a[132:135], v[228:231], v[208:211], a[132:135]
  v_mfma_f32_16x16x32_bf16 a[136:139], v[232:235], v[208:211], a[136:139]
  v_mfma_f32_16x16x32_bf16 a[140:143], v[236:239], v[208:211], a[140:143]
  v_mfma_f32_16x16x32_bf16 a[144:147], v[240:243], v[208:211], a[144:147]
  v_mfma_f32_16x16x32_bf16 a[148:151], v[244:247], v[208:211], a[148:151]
  v_mfma_f32_16x16x32_bf16 a[152:155], v[248:251], v[208:211], a[152:155]
  v_mfma_f32_16x16x32_bf16 a[156:159], v[252:255], v[208:211], a[156:159]
  v_mfma_f32_16x16x32_bf16 a[160:163], v[224:227], v[212:215], a[160:163]
  v_mfma_f32_16x16x32_bf16 a[164:167], v[228:231], v[212:215], a[164:167]
  v_mfma_f32_16x16x32_bf16 a[168:171], v[232:235], v[212:215], a[168:171]
  v_mfma_f32_16x16x32_bf16 a[172:175], v[236:239], v[212:215], a[172:175]
  v_mfma_f32_16x16x32_bf16 a[176:179], v[240:243], v[212:215], a[176:179]
  v_mfma_f32_16x16x32_bf16 a[180:183], v[244:247], v[212:215], a[180:183]
  v_mfma_f32_16x16x32_bf16 a[184:187], v[248:251], v[212:215], a[184:187]
  v_mfma_f32_16x16x32_bf16 a[188:191], v[252:255], v[212:215], a[188:191]
  v_mfma_f32_16x16x32_bf16 a[192:195], v[224:227], v[216:219], a[192:195]
  v_mfma_f32_16x16x32_bf16 a[196:199], v[228:231], v[216:219], a[196:199]
  v_mfma_f32_16x16x32_bf16 a[200:203], v[232:235], v[216:219], a[200:203]
  v_mfma_f32_16x16x32_bf16 a[204:207], v[236:239], v[216:219], a[204:207]
  v_mfma_f32_16x16x32_bf16 a[208:211], v[240:243], v[216:219], a[208:211]
  v_mfma_f32_16x16x32_bf16 a[212:215], v[244:247], v[216:219], a[212:215]
  v_mfma_f32_16x16x32_bf16 a[216:219], v[248:251], v[216:219], a[216:219]
  v_mfma_f32_16x16x32_bf16 a[220:223], v[252:255], v[216:219], a[220:223]
  v_mfma_f32_16x16x32_bf16 a[224:227], v[224:227], v[220:223], a[224:227]
  v_mfma_f32_16x16x32_bf16 a[228:231], v[228:231], v[220:223], a[228:231]
  v_mfma_f32_16x16x32_bf16 a[232:235], v[232:235], v[220:223], a[232:235]
  v_mfma_f32_16x16x32_bf16 a[236:239], v[236:239], v[220:223], a[236:239]
  v_mfma_f32_16x16x32_bf16 a[240:243], v[240:243], v[220:223], a[240:243]
  v_mfma_f32_16x16x32_bf16 a[244:247], v[244:247], v[220:223], a[244:247]
  v_mfma_f32_16x16x32_bf16 a[248:251], v[248:251], v[220:223], a[248:251]
  v_mfma_f32_16x16x32_bf16 a[252:255], v[252:255], v[220:223], a[252:255]
  s_branch G_next
G_l_ss:
  v_accvgpr_write_b32 a0, 0
  v_accvgpr_write_b32 a1, 0
  v_accvgpr_write_b32 a2, 0
  v_accvgpr_write_b32 a3, 0
  v_accvgpr_write_b32 a4, 0
  v_accvgpr_write_b32 a5, 0
  v_accvgpr_write_b32 a6, 0
  v_accvgpr_write_b32 a7, 0
  v_accvgpr_write_b32 a8, 0
  v_accvgpr_write_b32 a9, 0
  v_accvgpr_write_b32 a10, 0
  v_accvgpr_write_b32 a11, 0
  v_accvgpr_write_b32 a12, 0
  v_accvgpr_write_b32 a13, 0
  v_accvgpr_write_b32 a14, 0
  v_accvgpr_write_b32 a15, 0
  v_accvgpr_write_b32 a16, 0
  v_accvgpr_write_b32 a17, 0
  v_accvgpr_write_b32 a18, 0
  v_accvgpr_write_b32 a19, 0
  v_accvgpr_write_b32 a20, 0
  v_accvgpr_write_b32 a21, 0
  v_accvgpr_write_b32 a22, 0
  v_accvgpr_write_b32 a23, 0
  v_accvgpr_write_b32 a24, 0
  v_accvgpr_write_b32 a25, 0
  v_accvgpr_write_b32 a26, 0
  v_accvgpr_write_b32 a27, 0
  v_accvgpr_write_b32 a28, 0
  v_accvgpr_write_b32 a29, 0
  v_accvgpr_write_b32 a30, 0
  v_accvgpr_write_b32 a31, 0
  v_accvgpr_write_b32 a32, 0
  v_accvgpr_write_b32 a33, 0
  v_accvgpr_write_b32 a34, 0
  v_accvgpr_write_b32 a35, 0
  v_accvgpr_write_b32 a36, 0
  v_accvgpr_write_b32 a37, 0
  v_accvgpr_write_b32 a38, 0
  v_accvgpr_write_b32 a39, 0
  v_accvgpr_write_b32 a40, 0
  v_accvgpr_write_b32 a41, 0
  v_accvgpr_write_b32 a42, 0
  v_accvgpr_write_b32 a43, 0
  v_accvgpr_write_b32 a44, 0
  v_accvgpr_write_b32 a45, 0
  v_accvgpr_write_b32 a46, 0
  v_accvgpr_write_b32 a47, 0
  v_accvgpr_write_b32 a48, 0
  v_accvgpr_write_b32 a49, 0
  v_accvgpr_write_b32 a50, 0
  v_accvgpr_write_b32 a51, 0
  v_accvgpr_write_b32 a52, 0
  v_accvgpr_write_b32 a53, 0
  v_accvgpr_write_b32 a54, 0
  v_accvgpr_write_b32 a55, 0
  v_accvgpr_write_b32 a56, 0
  v_accvgpr_write_b32 a57, 0
  v_accvgpr_write_b32 a58, 0
  v_accvgpr_write_b32 a59, 0
  v_accvgpr_write_b32 a60, 0
  v_accvgpr_write_b32 a61, 0
  v_accvgpr_write_b32 a62, 0
  v_accvgpr_write_b32 a63, 0
  s_mov_b32 s46, 3
  s_waitcnt vmcnt(24)
  s_barrier
  ds_read_b128 v[128:131], v4 offset:0
  ds_read_b64_tr_b16 v[160:161], v6 offset:0
  ds_read_b64_tr_b16 v[162:163], v6 offset:1024
  ds_read_b128 v[132:135], v4 offset:2048
  ds_read_b64_tr_b16 v[164:165], v7 offset:0
  ds_read_b64_tr_b16 v[166:167], v7 offset:1024
  ds_read_b128 v[136:139], v4 offset:4096
  ds_read_b64_tr_b16 v[168:169], v8 offset:0
  ds_read_b64_tr_b16 v[170:171], v8 offset:1024
  ds_read_b128 v[140:143], v4 offset:6144
  ds_read_b64_tr_b16 v[172:173], v9 offset:0
  ds_read_b64_tr_b16 v[174:175], v9 offset:1024
  s_waitcnt lgkmcnt(0)
G_l_ss_l:
  s_cmp_eq_u32 s46, 0
  s_cselect_b32 s10, 0, s10
  s_cselect_b32 s14, 0, s14
  v_mfma_f32_16x16x32_bf16 a[0:3], v[160:163], v[128:131], a[0:3]
  ds_read_b128 v[192:195], v5 offset:0
  v_mfma_f32_16x16x32_bf16 a[4:7], v[164:167], v[128:131], a[4:7]
  ds_read_b64_tr_b16 v[224:225], v6 offset:8192
  v_mfma_f32_16x16x32_bf16 a[8:11], v[168:171], v[128:131], a[8:11]
  ds_read_b64_tr_b16 v[226:227], v6 offset:9216
  v_mfma_f32_16x16x32_bf16 a[12:15], v[172:175], v[128:131], a[12:15]
  ds_read_b128 v[196:199], v5 offset:2048
  v_mfma_f32_16x16x32_bf16 a[16:19], v[160:163], v[132:135], a[16:19]
  ds_read_b64_tr_b16 v[228:229], v7 offset:8192
  v_mfma_f32_16x16x32_bf16 a[20:23], v[164:167], v[132:135], a[20:23]
  ds_read_b64_tr_b16 v[230:231], v7 offset:9216
  v_mfma_f32_16x16x32_bf16 a[24:27], v[168:171], v[132:135], a[24:27]
  ds_read_b128 v[200:203], v5 offset:4096
  v_mfma_f32_16x16x32_bf16 a[28:31], v[172:175], v[132:135], a[28:31]
  ds_read_b64_tr_b16 v[232:233], v8 offset:8192
  v_mfma_f32_16x16x32_bf16 a[32:35], v[160:163], v[136:139], a[32:35]
  ds_read_b64_tr_b16 v[234:235], v8 offset:9216
  v_mfma_f32_16x16x32_bf16 a[36:39], v[164:167], v[136:139], a[36:39]
  ds_read_b128 v[204:207], v5 offset:6144
  v_mfma_f32_16x16x32_bf16 a[40:43], v[168:171], v[136:139], a[40:43]
  ds_read_b64_tr_b16 v[236:237], v9 offset:8192
  v_mfma_f32_16x16x32_bf16 a[44:47], v[172:175], v[136:139], a[44:47]
  ds_read_b64_tr_b16 v[238:239], v9 offset:9216
  v_mfma_f32_16x16x32_bf16 a[48:51], v[160:163], v[140:143], a[48:51]
  v_mfma_f32_16x16x32_bf16 a[52:55], v[164:167], v[140:143], a[52:55]
  v_mfma_f32_16x16x32_bf16 a[56:59], v[168:171], v[140:143], a[56:59]
  v_mfma_f32_16x16x32_bf16 a[60:63], v[172:175], v[140:143], a[60:63]
  s_waitcnt vmcnt(16) lgkmcnt(0)
  s_barrier
  v_mfma_f32_16x16x32_bf16 a[0:3], v[224:227], v[192:195], a[0:3]
  ds_read_b128 v[128:131], v4 offset:16384
  s_add_u32 m0, s95, 0
  s_nop 0
  buffer_load_dwordx4 v3, s[12:15], s40 offen  lds
  v_mfma_f32_16x16x32_bf16 a[4:7], v[228:231], v[192:195], a[4:7]
  ds_read_b64_tr_b16 v[160:161], v6 offset:16384
  v_mfma_f32_16x16x32_bf16 a[8:11], v[232:235], v[192:195], a[8:11]
  s_add_u32 m0, s95, 98304
  s_nop 0
  buffer_load_dwordx4 v2, s[8:11], s32 offen sc1 lds
  ds_read_b64_tr_b16 v[162:163], v6 offset:17408
  v_mfma_f32_16x16x32_bf16 a[12:15], v[236:239], v[192:195], a[12:15]
  ds_read_b128 v[132:135], v4 offset:18432
  s_add_u32 m0, s95, 4096
  s_nop 0
  buffer_load_dwordx4 v3, s[12:15], s41 offen  lds
  v_mfma_f32_16x16x32_bf16 a[16:19], v[224:227], v[196:199], a[16:19]
  ds_read_b64_tr_b16 v[164:165], v7 offset:16384
  v_mfma_f32_16x16x32_bf16 a[20:23], v[228:231], v[196:199], a[20:23]
  s_add_u32 m0, s95, 102400
  s_nop 0
  buffer_load_dwordx4 v2, s[8:11], s33 offen sc1 lds
  ds_read_b64_tr_b16 v[166:167], v7 offset:17408
  v_mfma_f32_16x16x32_bf16 a[24:27], v[232:235], v[196:199], a[24:27]
  ds_read_b128 v[136:139], v4 offset:20480
  s_add_u32 m0, s95, 8192
  s_nop 0
  buffer_load_dwordx4 v3, s[12:15], s42 offen  lds
  v_mfma_f32_16x16x32_bf16 a[28:31], v[236:239], v[196:199], a[28:31]
  ds_read_b64_tr_b16 v[168:169], v8 offset:16384
  v_mfma_f32_16x16x32_bf16 a[32:35], v[224:227], v[200:203], a[32:35]
  s_add_u32 m0, s95, 106496
  s_nop 0
  buffer_load_dwordx4 v2, s[8:11], s34 offen sc1 lds
  ds_read_b64_tr_b16 v[170:171], v8 offset:17408
  v_mfma_f32_16x16x32_bf16 a[36:39], v[228:231], v[200:203], a[36:39]
  ds_read_b128 v[140:143], v4 offset:22528
  s_add_u32 m0, s95, 12288
  s_nop 0
  buffer_load_dwordx4 v3, s[12:15], s43 offen  lds
  v_mfma_f32_16x16x32_bf16 a[40:43], v[232:235], v[200:203], a[40:43]
  ds_read_b64_tr_b16 v[172:173], v9 offset:16384
  v_mfma_f32_16x16x32_bf16 a[44:47], v[236:239], v[200:203], a[44:47]
  s_add_u32 m0, s95, 110592
  s_nop 0
  buffer_load_dwordx4 v2, s[8:11], s35 offen sc1 lds
  v_add_u32 v2, s44, v2
  v_add_u32 v3, s45, v3
  ds_read_b64_tr_b16 v[174:175], v9 offset:17408
  v_mfma_f32_16x16x32_bf16 a[48:51], v[224:227], v[204:207], a[48:51]
  v_mfma_f32_16x16x32_bf16 a[52:55], v[228:231], v[204:207], a[52:55]
  v_mfma_f32_16x16x32_bf16 a[56:59], v[232:235], v[204:207], a[56:59]
  v_mfma_f32_16x16x32_bf16 a[60:63], v[236:239], v[204:207], a[60:63]
  s_waitcnt lgkmcnt(0)
  v_mfma_f32_16x16x32_bf16 a[0:3], v[160:163], v[128:131], a[0:3]
  ds_read_b128 v[192:195], v5 offset:16384
  v_mfma_f32_16x16x32_bf16 a[4:7], v[164:167], v[128:131], a[4:7]
  ds_read_b64_tr_b16 v[224:225], v6 offset:24576
  v_mfma_f32_16x16x32_bf16 a[8:11], v[168:171], v[128:131], a[8:11]
  ds_read_b64_tr_b16 v[226:227], v6 offset:25600
  v_mfma_f32_16x16x32_bf16 a[12:15], v[172:175], v[128:131], a[12:15]
  ds_read_b128 v[196:199], v5 offset:18432
  v_mfma_f32_16x16x32_bf16 a[16:19], v[160:163], v[132:135], a[16:19]
  ds_read_b64_tr_b16 v[228:229], v7 offset:24576
  v_mfma_f32_16x16x32_bf16 a[20:23], v[164:167], v[132:135], a[20:23]
  ds_read_b64_tr_b16 v[230:231], v7 offset:25600
  v_mfma_f32_16x16x32_bf16 a[24:27], v[168:171], v[132:135], a[24:27]
  ds_read_b128 v[200:203], v5 offset:20480
  v_mfma_f32_16x16x32_bf16 a[28:31], v[172:175], v[132:135], a[28:31]
  ds_read_b64_tr_b16 v[232:233], v8 offset:24576
  v_mfma_f32_16x16x32_bf16 a[32:35], v[160:163], v[136:139], a[32:35]
  ds_read_b64_tr_b16 v[234:235], v8 offset:25600
  v_mfma_f32_16x16x32_bf16 a[36:39], v[164:167], v[136:139], a[36:39]
  ds_read_b128 v[204:207], v5 offset:22528
  v_mfma_f32_16x16x32_bf16 a[40:43], v[168:171], v[136:139], a[40:43]
  ds_read_b64_tr_b16 v[236:237], v9 offset:24576
  v_mfma_f32_16x16x32_bf16 a[44:47], v[172:175], v[136:139], a[44:47]
  ds_read_b64_tr_b16 v[238:239], v9 offset:25600
  v_mfma_f32_16x16x32_bf16 a[48:51], v[160:163], v[140:143], a[48:51]
  v_mfma_f32_16x16x32_bf16 a[52:55], v[164:167], v[140:143], a[52:55]
  v_mfma_f32_16x16x32_bf16 a[56:59], v[168:171], v[140:143], a[56:59]
  v_mfma_f32_16x16x32_bf16 a[60:63], v[172:175], v[140:143], a[60:63]
  s_waitcnt vmcnt(16) lgkmcnt(0)
  s_barrier
  v_mfma_f32_16x16x32_bf16 a[0:3], v[224:227], v[192:195], a[0:3]
  ds_read_b128 v[128:131], v4 offset:32768
  s_add_u32 m0, s95, 16384
  s_nop 0
  buffer_load_dwordx4 v3, s[12:15], s40 offen  lds
  v_mfma_f32_16x16x32_bf16 a[4:7], v[228:231], v[192:195], a[4:7]
  ds_read_b64_tr_b16 v[160:161], v6 offset:32768
  v_mfma_f32_16x16x32_bf16 a[8:11], v[232:235], v[192:195], a[8:11]
  s_add_u32 m0, s95, 114688
  s_nop 0
  buffer_load_dwordx4 v2, s[8:11], s32 offen sc1 lds
  ds_read_b64_tr_b16 v[162:163], v6 offset:33792
  v_mfma_f32_16x16x32_bf16 a[12:15], v[236:239], v[192:195], a[12:15]
  ds_read_b128 v[132:135], v4 offset:34816
  s_add_u32 m0, s95, 20480
  s_nop 0
  buffer_load_dwordx4 v3, s[12:15], s41 offen  lds
  v_mfma_f32_16x16x32_bf16 a[16:19], v[224:227], v[196:199], a[16:19]
  ds_read_b64_tr_b16 v[164:165], v7 offset:32768
  v_mfma_f32_16x16x32_bf16 a[20:23], v[228:231], v[196:199], a[20:23]
  s_add_u32 m0, s95, 118784
  s_nop 0
  buffer_load_dwordx4 v2, s[8:11], s33 offen sc1 lds
  ds_read_b64_tr_b16 v[166:167], v7 offset:33792
  v_mfma_f32_16x16x32_bf16 a[24:27], v[232:235], v[196:199], a[24:27]
  ds_read_b128 v[136:139], v4 offset:36864
  s_add_u32 m0, s95, 24576
  s_nop 0
  buffer_load_dwordx4 v3, s[12:15], s42 offen  lds
  v_mfma_f32_16x16x32_bf16 a[28:31], v[236:239], v[196:199], a[28:31]
  ds_read_b64_tr_b16 v[168:169], v8 offset:32768
  v_mfma_f32_16x16x32_bf16 a[32:35], v[224:227], v[200:203], a[32:35]
  s_add_u32 m0, s95, 122880
  s_nop 0
  buffer_load_dwordx4 v2, s[8:11], s34 offen sc1 lds
  ds_read_b64_tr_b16 v[170:171], v8 offset:33792
  v_mfma_f32_16x16x32_bf16 a[36:39], v[228:231], v[200:203], a[36:39]
  ds_read_b128 v[140:143], v4 offset:38912
  s_add_u32 m0, s95, 28672
  s_nop 0
  buffer_load_dwordx4 v3, s[12:15], s43 offen  lds
  v_mfma_f32_16x16x32_bf16 a[40:43], v[232:235], v[200:203], a[40:43]
  ds_read_b64_tr_b16 v[172:173], v9 offset:32768
  v_mfma_f32_16x16x32_bf16 a[44:47], v[236:239], v[200:203], a[44:47]
  s_add_u32 m0, s95, 126976
  s_nop 0
  buffer_load_dwordx4 v2, s[8:11], s35 offen sc1 lds
  v_add_u32 v2, s44, v2
  v_add_u32 v3, s45, v3
  ds_read_b64_tr_b16 v[174:175], v9 offset:33792
  v_mfma_f32_16x16x32_bf16 a[48:51], v[224:227], v[204:207], a[48:51]
  v_mfma_f32_16x16x32_bf16 a[52:55], v[228:231], v[204:207], a[52:55]
  v_mfma_f32_16x16x32_bf16 a[56:59], v[232:235], v[204:207], a[56:59]
  v_mfma_f32_16x16x32_bf16 a[60:63], v[236:239], v[204:207], a[60:63]
  s_waitcnt lgkmcnt(0)
  v_mfma_f32_16x16x32_bf16 a[0:3], v[160:163], v[128:131], a[0:3]
  ds_read_b128 v[192:195], v5 offset:32768
  v_mfma_f32_16x16x32_bf16 a[4:7], v[164:167], v[128:131], a[4:7]
  ds_read_b64_tr_b16 v[224:225], v6 offset:40960
  v_mfma_f32_16x16x32_bf16 a[8:11], v[168:171], v[128:131], a[8:11]
  ds_read_b64_tr_b16 v[226:227], v6 offset:41984
  v_mfma_f32_16x16x32_bf16 a[12:15], v[172:175], v[128:131], a[12:15]
  ds_read_b128 v[196:199], v5 offset:34816
  v_mfma_f32_16x16x32_bf16 a[16:19], v[160:163], v[132:135], a[16:19]
  ds_read_b64_tr_b16 v[228:229], v7 offset:40960
  v_mfma_f32_16x16x32_bf16 a[20:23], v[164:167], v[132:135], a[20:23]
  ds_read_b64_tr_b16 v[230:231], v7 offset:41984
  v_mfma_f32_16x16x32_bf16 a[24:27], v[168:171], v[132:135], a[24:27]
  ds_read_b128 v[200:203], v5 offset:36864
  v_mfma_f32_16x16x32_bf16 a[28:31], v[172:175], v[132:135], a[28:31]
  ds_read_b64_tr_b16 v[232:233], v8 offset:40960
  v_mfma_f32_16x16x32_bf16 a[32:35], v[160:163], v[136:139], a[32:35]
  ds_read_b64_tr_b16 v[234:235], v8 offset:41984
  v_mfma_f32_16x16x32_bf16 a[36:39], v[164:167], v[136:139], a[36:39]
  ds_read_b128 v[204:207], v5 offset:38912
  v_mfma_f32_16x16x32_bf16 a[40:43], v[168:171], v[136:139], a[40:43]
  ds_read_b64_tr_b16 v[236:237], v9 offset:40960
  v_mfma_f32_16x16x32_bf16 a[44:47], v[172:175], v[136:139], a[44:47]
  ds_read_b64_tr_b16 v[238:239], v9 offset:41984
  v_mfma_f32_16x16x32_bf16 a[48:51], v[160:163], v[140:143], a[48:51]
  v_mfma_f32_16x16x32_bf16 a[52:55], v[164:167], v[140:143], a[52:55]
  v_mfma_f32_16x16x32_bf16 a[56:59], v[168:171], v[140:143], a[56:59]
  v_mfma_f32_16x16x32_bf16 a[60:63], v[172:175], v[140:143], a[60:63]
  s_waitcnt vmcnt(16) lgkmcnt(0)
  s_barrier
  v_mfma_f32_16x16x32_bf16 a[0:3], v[224:227], v[192:195], a[0:3]
  ds_read_b128 v[128:131], v4 offset:49152
  s_add_u32 m0, s95, 32768
  s_nop 0
  buffer_load_dwordx4 v3, s[12:15], s40 offen  lds
  v_mfma_f32_16x16x32_bf16 a[4:7], v[228:231], v[192:195], a[4:7]
  ds_read_b64_tr_b16 v[160:161], v6 offset:49152
  v_mfma_f32_16x16x32_bf16 a[8:11], v[232:235], v[192:195], a[8:11]
  s_add_u32 m0, s95, 131072
  s_nop 0
  buffer_load_dwordx4 v2, s[8:11], s32 offen sc1 lds
  ds_read_b64_tr_b16 v[162:163], v6 offset:50176
  v_mfma_f32_16x16x32_bf16 a[12:15], v[236:239], v[192:195], a[12:15]
  ds_read_b128 v[132:135], v4 offset:51200
  s_add_u32 m0, s95, 36864
  s_nop 0
  buffer_load_dwordx4 v3, s[12:15], s41 offen  lds
  v_mfma_f32_16x16x32_bf16 a[16:19], v[224:227], v[196:199], a[16:19]
  ds_read_b64_tr_b16 v[164:165], v7 offset:49152
  v_mfma_f32_16x16x32_bf16 a[20:23], v[228:231], v[196:199], a[20:23]
  s_add_u32 m0, s95, 135168
  s_nop 0
  buffer_load_dwordx4 v2, s[8:11], s33 offen sc1 lds
  ds_read_b64_tr_b16 v[166:167], v7 offset:50176
  v_mfma_f32_16x16x32_bf16 a[24:27], v[232:235], v[196:199], a[24:27]
  ds_read_b128 v[136:139], v4 offset:53248
  s_add_u32 m0, s95, 40960
  s_nop 0
  buffer_load_dwordx4 v3, s[12:15], s42 offen  lds
  v_mfma_f32_16x16x32_bf16 a[28:31], v[236:239], v[196:199], a[28:31]
  ds_read_b64_tr_b16 v[168:169], v8 offset:49152
  v_mfma_f32_16x16x32_bf16 a[32:35], v[224:227], v[200:203], a[32:35]
  s_add_u32 m0, s95, 139264
  s_nop 0
  buffer_load_dwordx4 v2, s[8:11], s34 offen sc1 lds
  ds_read_b64_tr_b16 v[170:171], v8 offset:50176
  v_mfma_f32_16x16x32_bf16 a[36:39], v[228:231], v[200:203], a[36:39]
  ds_read_b128 v[140:143], v4 offset:55296
  s_add_u32 m0, s95, 45056
  s_nop 0
  buffer_load_dwordx4 v3, s[12:15], s43 offen  lds
  v_mfma_f32_16x16x32_bf16 a[40:43], v[232:235], v[200:203], a[40:43]
  ds_read_b64_tr_b16 v[172:173], v9 offset:49152
  v_mfma_f32_16x16x32_bf16 a[44:47], v[236:239], v[200:203], a[44:47]
  s_add_u32 m0, s95, 143360
  s_nop 0
  buffer_load_dwordx4 v2, s[8:11], s35 offen sc1 lds
  v_add_u32 v2, s44, v2
  v_add_u32 v3, s45, v3
  ds_read_b64_tr_b16 v[174:175], v9 offset:50176
  v_mfma_f32_16x16x32_bf16 a[48:51], v[224:227], v[204:207], a[48:51]
  v_mfma_f32_16x16x32_bf16 a[52:55], v[228:231], v[204:207], a[52:55]
  v_mfma_f32_16x16x32_bf16 a[56:59], v[232:235], v[204:207], a[56:59]
  v_mfma_f32_16x16x32_bf16 a[60:63], v[236:239], v[204:207], a[60:63]
  s_waitcnt lgkmcnt(0)
  v_mfma_f32_16x16x32_bf16 a[0:3], v[160:163], v[128:131], a[0:3]
  ds_read_b128 v[192:195], v5 offset:49152
  v_mfma_f32_16x16x32_bf16 a[4:7], v[164:167], v[128:131], a[4:7]
  ds_read_b64_tr_b16 v[224:225], v6 offset:57344
  v_mfma_f32_16x16x32_bf16 a[8:11], v[168:171], v[128:131], a[8:11]
  ds_read_b64_tr_b16 v[226:227], v6 offset:58368
  v_mfma_f32_16x16x32_bf16 a[12:15], v[172:175], v[128:131], a[12:15]
  ds_read_b128 v[196:199], v5 offset:51200
  v_mfma_f32_16x16x32_bf16 a[16:19], v[160:163], v[132:135], a[16:19]
  ds_read_b64_tr_b16 v[228:229], v7 offset:57344
  v_mfma_f32_16x16x32_bf16 a[20:23], v[164:167], v[132:135], a[20:23]
  ds_read_b64_tr_b16 v[230:231], v7 offset:58368
  v_mfma_f32_16x16x32_bf16 a[24:27], v[168:171], v[132:135], a[24:27]
  ds_read_b128 v[200:203], v5 offset:53248
  v_mfma_f32_16x16x32_bf16 a[28:31], v[172:175], v[132:135], a[28:31]
  ds_read_b64_tr_b16 v[232:233], v8 offset:57344
  v_mfma_f32_16x16x32_bf16 a[32:35], v[160:163], v[136:139], a[32:35]
  ds_read_b64_tr_b16 v[234:235], v8 offset:58368
  v_mfma_f32_16x16x32_bf16 a[36:39], v[164:167], v[136:139], a[36:39]
  ds_read_b128 v[204:207], v5 offset:55296
  v_mfma_f32_16x16x32_bf16 a[40:43], v[168:171], v[136:139], a[40:43]
  ds_read_b64_tr_b16 v[236:237], v9 offset:57344
  v_mfma_f32_16x16x32_bf16 a[44:47], v[172:175], v[136:139], a[44:47]
  ds_read_b64_tr_b16 v[238:239], v9 offset:58368
  v_mfma_f32_16x16x32_bf16 a[48:51], v[160:163], v[140:143], a[48:51]
  v_mfma_f32_16x16x32_bf16 a[52:55], v[164:167], v[140:143], a[52:55]
  v_mfma_f32_16x16x32_bf16 a[56:59], v[168:171], v[140:143], a[56:59]
  v_mfma_f32_16x16x32_bf16 a[60:63], v[172:175], v[140:143], a[60:63]
  s_waitcnt vmcnt(16) lgkmcnt(0)
  s_barrier
  v_mfma_f32_16x16x32_bf16 a[0:3], v[224:227], v[192:195], a[0:3]
  ds_read_b128 v[128:131], v4 offset:0
  s_add_u32 m0, s95, 49152
  s_nop 0
  buffer_load_dwordx4 v3, s[12:15], s40 offen  lds
  v_mfma_f32_16x16x32_bf16 a[4:7], v[228:231], v[192:195], a[4:7]
  ds_read_b64_tr_b16 v[160:161], v6 offset:0
  v_mfma_f32_16x16x32_bf16 a[8:11], v[232:235], v[192:195], a[8:11]
  s_add_u32 m0, s95, 147456
  s_nop 0
  buffer_load_dwordx4 v2, s[8:11], s32 offen sc1 lds
  ds_read_b64_tr_b16 v[162:163], v6 offset:1024
  v_mfma_f32_16x16x32_bf16 a[12:15], v[236:239], v[192:195], a[12:15]
  ds_read_b128 v[132:135], v4 offset:2048
  s_add_u32 m0, s95, 53248
  s_nop 0
  buffer_load_dwordx4 v3, s[12:15], s41 offen  lds
  v_mfma_f32_16x16x32_bf16 a[16:19], v[224:227], v[196:199], a[16:19]
  ds_read_b64_tr_b16 v[164:165], v7 offset:0
  v_mfma_f32_16x16x32_bf16 a[20:23], v[228:231], v[196:199], a[20:23]
  s_add_u32 m0, s95, 151552
  s_nop 0
  buffer_load_dwordx4 v2, s[8:11], s33 offen sc1 lds
  ds_read_b64_tr_b16 v[166:167], v7 offset:1024
  v_mfma_f32_16x16x32_bf16 a[24:27], v[232:235], v[196:199], a[24:27]
  ds_read_b128 v[136:139], v4 offset:4096
  s_add_u32 m0, s95, 57344
  s_nop 0
  buffer_load_dwordx4 v3, s[12:15], s42 offen  lds
  v_mfma_f32_16x16x32_bf16 a[28:31], v[236:239], v[196:199], a[28:31]
  ds_read_b64_tr_b16 v[168:169], v8 offset:0
  v_mfma_f32_16x16x32_bf16 a[32:35], v[224:227], v[200:203], a[32:35]
  s_add_u32 m0, s95, 155648
  s_nop 0
  buffer_load_dwordx4 v2, s[8:11], s34 offen sc1 lds
  ds_read_b64_tr_b16 v[170:171], v8 offset:1024
  v_mfma_f32_16x16x32_bf16 a[36:39], v[228:231], v[200:203], a[36:39]
  ds_read_b128 v[140:143], v4 offset:6144
  s_add_u32 m0, s95, 61440
  s_nop 0
  buffer_load_dwordx4 v3, s[12:15], s43 offen  lds
  v_mfma_f32_16x16x32_bf16 a[40:43], v[232:235], v[200:203], a[40:43]
  ds_read_b64_tr_b16 v[172:173], v9 offset:0
  v_mfma_f32_16x16x32_bf16 a[44:47], v[236:239], v[200:203], a[44:47]
  s_add_u32 m0, s95, 159744
  s_nop 0
  buffer_load_dwordx4 v2, s[8:11], s35 offen sc1 lds
  v_add_u32 v2, s44, v2
  v_add_u32 v3, s45, v3
  ds_read_b64_tr_b16 v[174:175], v9 offset:1024
  v_mfma_f32_16x16x32_bf16 a[48:51], v[224:227], v[204:207], a[48:51]
  v_mfma_f32_16x16x32_bf16 a[52:55], v[228:231], v[204:207], a[52:55]
  v_mfma_f32_16x16x32_bf16 a[56:59], v[232:235], v[204:207], a[56:59]
  v_mfma_f32_16x16x32_bf16 a[60:63], v[236:239], v[204:207], a[60:63]
  s_waitcnt lgkmcnt(0)
  s_sub_u32 s46, s46, 1
  s_cbranch_scc0 G_l_ss_l
  s_branch G_next
G_l_sn:
  v_accvgpr_write_b32 a0, 0
  v_accvgpr_write_b32 a1, 0
  v_accvgpr_write_b32 a2, 0
  v_accvgpr_write_b32 a3, 0
  v_accvgpr_write_b32 a4, 0
  v_accvgpr_write_b32 a5, 0
  v_accvgpr_write_b32 a6, 0
  v_accvgpr_write_b32 a7, 0
  v_accvgpr_write_b32 a8, 0
  v_accvgpr_write_b32 a9, 0
  v_accvgpr_write_b32 a10, 0
  v_accvgpr_write_b32 a11, 0
  v_accvgpr_write_b32 a12, 0
  v_accvgpr_write_b32 a13, 0
  v_accvgpr_write_b32 a14, 0
  v_accvgpr_write_b32 a15, 0
  v_accvgpr_write_b32 a16, 0
  v_accvgpr_write_b32 a17, 0
  v_accvgpr_write_b32 a18, 0
  v_accvgpr_write_b32 a19, 0
  v_accvgpr_write_b32 a20, 0
  v_accvgpr_write_b32 a21, 0
  v_accvgpr_write_b32 a22, 0
  v_accvgpr_write_b32 a23, 0
  v_accvgpr_write_b32 a24, 0
  v_accvgpr_write_b32 a25, 0
  v_accvgpr_write_b32 a26, 0
  v_accvgpr_write_b32 a27, 0
  v_accvgpr_write_b32 a28, 0
  v_accvgpr_write_b32 a29, 0
  v_accvgpr_write_b32 a30, 0
  v_accvgpr_write_b32 a31, 0
  v_accvgpr_write_b32 a32, 0
  v_accvgpr_write_b32 a33, 0
  v_accvgpr_write_b32 a34, 0
  v_accvgpr_write_b32 a35, 0
  v_accvgpr_write_b32 a36, 0
  v_accvgpr_write_b32 a37, 0
  v_accvgpr_write_b32 a38, 0
  v_accvgpr_write_b32 a39, 0
  v_accvgpr_write_b32 a40, 0
  v_accvgpr_write_b32 a41, 0
  v_accvgpr_write_b32 a42, 0
  v_accvgpr_write_b32 a43, 0
  v_accvgpr_write_b32 a44, 0
  v_accvgpr_write_b32 a45, 0
  v_accvgpr_write_b32 a46, 0
  v_accvgpr_write_b32 a47, 0
  v_accvgpr_write_b32 a48, 0
  v_accvgpr_write_b32 a49, 0
  v_accvgpr_write_b32 a50, 0
  v_accvgpr_write_b32 a51, 0
  v_accvgpr_write_b32 a52, 0
  v_accvgpr_write_b32 a53, 0
  v_accvgpr_write_b32 a54, 0
  v_accvgpr_write_b32 a55, 0
  v_accvgpr_write_b32 a56, 0
  v_accvgpr_write_b32 a57, 0
  v_accvgpr_write_b32 a58, 0
  v_accvgpr_write_b32 a59, 0
  v_accvgpr_write_b32 a60, 0
  v_accvgpr_write_b32 a61, 0
  v_accvgpr_write_b32 a62, 0
  v_accvgpr_write_b32 a63, 0
  s_mov_b32 s46, 3
  s_waitcnt vmcnt(24)
  s_barrier
  ds_read_b128 v[128:131], v4 offset:0
  ds_read_b64_tr_b16 v[160:161], v6 offset:0
  ds_read_b64_tr_b16 v[162:163], v6 offset:1024
  ds_read_b128 v[132:135], v4 offset:2048
  ds_read_b64_tr_b16 v[164:165], v7 offset:0
  ds_read_b64_tr_b16 v[166:167], v7 offset:1024
  ds_read_b128 v[136:139], v4 offset:4096
  ds_read_b64_tr_b16 v[168:169], v8 offset:0
  ds_read_b64_tr_b16 v[170:171], v8 offset:1024
  ds_read_b128 v[140:143], v4 offset:6144
  ds_read_b64_tr_b16 v[172:173], v9 offset:0
  ds_read_b64_tr_b16 v[174:175], v9 offset:1024
  s_waitcnt lgkmcnt(0)
G_l_sn_l:
  s_cmp_eq_u32 s46, 0
  s_cselect_b32 s10, 0, s10
  s_cselect_b32 s14, 0, s14
  v_mfma_f32_16x16x32_bf16 a[0:3], v[128:131], v[160:163], a[0:3]
  ds_read_b128 v[192:195], v5 offset:0
  v_mfma_f32_16x16x32_bf16 a[4:7], v[128:131], v[164:167], a[4:7]
  ds_read_b64_tr_b16 v[224:225], v6 offset:8192
  v_mfma_f32_16x16x32_bf16 a[8:11], v[128:131], v[168:171], a[8:11]
  ds_read_b64_tr_b16 v[226:227], v6 offset:9216
  v_mfma_f32_16x16x32_bf16 a[12:15], v[128:131], v[172:175], a[12:15]
  ds_read_b128 v[196:199], v5 offset:2048
  v_mfma_f32_16x16x32_bf16 a[16:19], v[132:135], v[160:163], a[16:19]
  ds_read_b64_tr_b16 v[228:229], v7 offset:8192
  v_mfma_f32_16x16x32_bf16 a[20:23], v[132:135], v[164:167], a[20:23]
  ds_read_b64_tr_b16 v[230:231], v7 offset:9216
  v_mfma_f32_16x16x32_bf16 a[24:27], v[132:135], v[168:171], a[24:27]
  ds_read_b128 v[200:203], v5 offset:4096
  v_mfma_f32_16x16x32_bf16 a[28:31], v[132:135], v[172:175], a[28:31]
  ds_read_b64_tr_b16 v[232:233], v8 offset:8192
  v_mfma_f32_16x16x32_bf16 a[32:35], v[136:139], v[160:163], a[32:35]
  ds_read_b64_tr_b16 v[234:235], v8 offset:9216
  v_mfma_f32_16x16x32_bf16 a[36:39], v[136:139], v[164:167], a[36:39]
  ds_read_b128 v[204:207], v5 offset:6144
  v_mfma_f32_16x16x32_bf16 a[40:43], v[136:139], v[168:171], a[40:43]
  ds_read_b64_tr_b16 v[236:237], v9 offset:8192
  v_mfma_f32_16x16x32_bf16 a[44:47], v[136:139], v[172:175], a[44:47]
  ds_read_b64_tr_b16 v[238:239], v9 offset:9216
  v_mfma_f32_16x16x32_bf16 a[48:51], v[140:143], v[160:163], a[48:51]
  v_mfma_f32_16x16x32_bf16 a[52:55], v[140:143], v[164:167], a[52:55]
  v_mfma_f32_16x16x32_bf16 a[56:59], v[140:143], v[168:171], a[56:59]
  v_mfma_f32_16x16x32_bf16 a[60:63], v[140:143], v[172:175], a[60:63]
  s_waitcnt vmcnt(16) lgkmcnt(0)
  s_barrier
  v_mfma_f32_16x16x32_bf16 a[0:3], v[192:195], v[224:227], a[0:3]
  ds_read_b128 v[128:131], v4 offset:16384
  s_add_u32 m0, s95, 0
  s_nop 0
  buffer_load_dwordx4 v3, s[12:15], s40 offen  lds
  v_mfma_f32_16x16x32_bf16 a[4:7], v[192:195], v[228:231], a[4:7]
  ds_read_b64_tr_b16 v[160:161], v6 offset:16384
  v_mfma_f32_16x16x32_bf16 a[8:11], v[192:195], v[232:235], a[8:11]
  s_add_u32 m0, s95, 98304
  s_nop 0
  buffer_load_dwordx4 v2, s[8:11], s32 offen sc1 lds
  ds_read_b64_tr_b16 v[162:163], v6 offset:17408
  v_mfma_f32_16x16x32_bf16 a[12:15], v[192:195], v[236:239], a[12:15]
  ds_read_b128 v[132:135], v4 offset:18432
  s_add_u32 m0, s95, 4096
  s_nop 0
  buffer_load_dwordx4 v3, s[12:15], s41 offen  lds
  v_mfma_f32_16x16x32_bf16 a[16:19], v[196:199], v[224:227], a[16:19]
  ds_read_b64_tr_b16 v[164:165], v7 offset:16384
  v_mfma_f32_16x16x32_bf16 a[20:23], v[196:199], v[228:231], a[20:23]
  s_add_u32 m0, s95, 102400
  s_nop 0
  buffer_load_dwordx4 v2, s[8:11], s33 offen sc1 lds
  ds_read_b64_tr_b16 v[166:167], v7 offset:17408
  v_mfma_f32_16x16x32_bf16 a[24:27], v[196:199], v[232:235], a[24:27]
  ds_read_b128 v[136:139], v4 offset:20480
  s_add_u32 m0, s95, 8192
  s_nop 0
  buffer_load_dwordx4 v3, s[12:15], s42 offen  lds
  v_mfma_f32_16x16x32_bf16 a[28:31], v[196:199], v[236:239], a[28:31]
  ds_read_b64_tr_b16 v[168:169], v8 offset:16384
  v_mfma_f32_16x16x32_bf16 a[32:35], v[200:203], v[224:227], a[32:35]
  s_add_u32 m0, s95, 106496
  s_nop 0
  buffer_load_dwordx4 v2, s[8:11], s34 offen sc1 lds
  ds_read_b64_tr_b16 v[170:171], v8 offset:17408
  v_mfma_f32_16x16x32_bf16 a[36:39], v[200:203], v[228:231], a[36:39]
  ds_read_b128 v[140:143], v4 offset:22528
  s_add_u32 m0, s95, 12288
  s_nop 0
  buffer_load_dwordx4 v3, s[12:15], s43 offen  lds
  v_mfma_f32_16x16x32_bf16 a[40:43], v[200:203], v[232:235], a[40:43]
  ds_read_b64_tr_b16 v[172:173], v9 offset:16384
  v_mfma_f32_16x16x32_bf16 a[44:47], v[200:203], v[236:239], a[44:47]
  s_add_u32 m0, s95, 110592
  s_nop 0
  buffer_load_dwordx4 v2, s[8:11], s35 offen sc1 lds
  v_add_u32 v2, s44, v2
  v_add_u32 v3, s45, v3
  ds_read_b64_tr_b16 v[174:175], v9 offset:17408
  v_mfma_f32_16x16x32_bf16 a[48:51], v[204:207], v[224:227], a[48:51]
  v_mfma_f32_16x16x32_bf16 a[52:55], v[204:207], v[228:231], a[52:55]
  v_mfma_f32_16x16x32_bf16 a[56:59], v[204:207], v[232:235], a[56:59]
  v_mfma_f32_16x16x32_bf16 a[60:63], v[204:207], v[236:239], a[60:63]
  s_waitcnt lgkmcnt(0)
  v_mfma_f32_16x16x32_bf16 a[0:3], v[128:131], v[160:163], a[0:3]
  ds_read_b128 v[192:195], v5 offset:16384
  v_mfma_f32_16x16x32_bf16 a[4:7], v[128:131], v[164:167], a[4:7]
  ds_read_b64_tr_b16 v[224:225], v6 offset:24576
  v_mfma_f32_16x16x32_bf16 a[8:11], v[128:131], v[168:171], a[8:11]
  ds_read_b64_tr_b16 v[226:227], v6 offset:25600
  v_mfma_f32_16x16x32_bf16 a[12:15], v[128:131], v[172:175], a[12:15]
  ds_read_b128 v[196:199], v5 offset:18432
  v_mfma_f32_16x16x32_bf16 a[16:19], v[132:135], v[160:163], a[16:19]
  ds_read_b64_tr_b16 v[228:229], v7 offset:24576
  v_mfma_f32_16x16x32_bf16 a[20:23], v[132:135], v[164:167], a[20:23]
  ds_read_b64_tr_b16 v[230:231], v7 offset:25600
  v_mfma_f32_16x16x32_bf16 a[24:27], v[132:135], v[168:171], a[24:27]
  ds_read_b128 v[200:203], v5 offset:20480
  v_mfma_f32_16x16x32_bf16 a[28:31], v[132:135], v[172:175], a[28:31]
  ds_read_b64_tr_b16 v[232:233], v8 offset:24576
  v_mfma_f32_16x16x32_bf16 a[32:35], v[136:139], v[160:163], a[32:35]
  ds_read_b64_tr_b16 v[234:235], v8 offset:25600
  v_mfma_f32_16x16x32_bf16 a[36:39], v[136:139], v[164:167], a[36:39]
  ds_read_b128 v[204:207], v5 offset:22528
  v_mfma_f32_16x16x32_bf16 a[40:43], v[136:139], v[168:171], a[40:43]
  ds_read_b64_tr_b16 v[236:237], v9 offset:24576
  v_mfma_f32_16x16x32_bf16 a[44:47], v[136:139], v[172:175], a[44:47]
  ds_read_b64_tr_b16 v[238:239], v9 offset:25600
  v_mfma_f32_16x16x32_bf16 a[48:51], v[140:143], v[160:163], a[48:51]
  v_mfma_f32_16x16x32_bf16 a[52:55], v[140:143], v[164:167], a[52:55]
  v_mfma_f32_16x16x32_bf16 a[56:59], v[140:143], v[168:171], a[56:59]
  v_mfma_f32_16x16x32_bf16 a[60:63], v[140:143], v[172:175], a[60:63]
  s_waitcnt vmcnt(16) lgkmcnt(0)
  s_barrier
  v_mfma_f32_16x16x32_bf16 a[0:3], v[192:195], v[224:227], a[0:3]
  ds_read_b128 v[128:131], v4 offset:32768
  s_add_u32 m0, s95, 16384
  s_nop 0
  buffer_load_dwordx4 v3, s[12:15], s40 offen  lds
  v_mfma_f32_16x16x32_bf16 a[4:7], v[192:195], v[228:231], a[4:7]
  ds_read_b64_tr_b16 v[160:161], v6 offset:32768
  v_mfma_f32_16x16x32_bf16 a[8:11], v[192:195], v[232:235], a[8:11]
  s_add_u32 m0, s95, 114688
  s_nop 0
  buffer_load_dwordx4 v2, s[8:11], s32 offen sc1 lds
  ds_read_b64_tr_b16 v[162:163], v6 offset:33792
  v_mfma_f32_16x16x32_bf16 a[12:15], v[192:195], v[236:239], a[12:15]
  ds_read_b128 v[132:135], v4 offset:34816
  s_add_u32 m0, s95, 20480
  s_nop 0
  buffer_load_dwordx4 v3, s[12:15], s41 offen  lds
  v_mfma_f32_16x16x32_bf16 a[16:19], v[196:199], v[224:227], a[16:19]
  ds_read_b64_tr_b16 v[164:165], v7 offset:32768
  v_mfma_f32_16x16x32_bf16 a[20:23], v[196:199], v[228:231], a[20:23]
  s_add_u32 m0, s95, 118784
  s_nop 0
  buffer_load_dwordx4 v2, s[8:11], s33 offen sc1 lds
  ds_read_b64_tr_b16 v[166:167], v7 offset:33792
  v_mfma_f32_16x16x32_bf16 a[24:27], v[196:199], v[232:235], a[24:27]
  ds_read_b128 v[136:139], v4 offset:36864
  s_add_u32 m0, s95, 24576
  s_nop 0
  buffer_load_dwordx4 v3, s[12:15], s42 offen  lds
  v_mfma_f32_16x16x32_bf16 a[28:31], v[196:199], v[236:239], a[28:31]
  ds_read_b64_tr_b16 v[168:169], v8 offset:32768
  v_mfma_f32_16x16x32_bf16 a[32:35], v[200:203], v[224:227], a[32:35]
  s_add_u32 m0, s95, 122880
  s_nop 0
  buffer_load_dwordx4 v2, s[8:11], s34 offen sc1 lds
  ds_read_b64_tr_b16 v[170:171], v8 offset:33792
  v_mfma_f32_16x16x32_bf16 a[36:39], v[200:203], v[228:231], a[36:39]
  ds_read_b128 v[140:143], v4 offset:38912
  s_add_u32 m0, s95, 28672
  s_nop 0
  buffer_load_dwordx4 v3, s[12:15], s43 offen  lds
  v_mfma_f32_16x16x32_bf16 a[40:43], v[200:203], v[232:235], a[40:43]
  ds_read_b64_tr_b16 v[172:173], v9 offset:32768
  v_mfma_f32_16x16x32_bf16 a[44:47], v[200:203], v[236:239], a[44:47]
  s_add_u32 m0, s95, 126976
  s_nop 0
  buffer_load_dwordx4 v2, s[8:11], s35 offen sc1 lds
  v_add_u32 v2, s44, v2
  v_add_u32 v3, s45, v3
  ds_read_b64_tr_b16 v[174:175], v9 offset:33792
  v_mfma_f32_16x16x32_bf16 a[48:51], v[204:207], v[224:227], a[48:51]
  v_mfma_f32_16x16x32_bf16 a[52:55], v[204:207], v[228:231], a[52:55]
  v_mfma_f32_16x16x32_bf16 a[56:59], v[204:207], v[232:235], a[56:59]
  v_mfma_f32_16x16x32_bf16 a[60:63], v[204:207], v[236:239], a[60:63]
  s_waitcnt lgkmcnt(0)
  v_mfma_f32_16x16x32_bf16 a[0:3], v[128:131], v[160:163], a[0:3]
  ds_read_b128 v[192:195], v5 offset:32768
  v_mfma_f32_16x16x32_bf16 a[4:7], v[128:131], v[164:167], a[4:7]
  ds_read_b64_tr_b16 v[224:225], v6 offset:40960
  v_mfma_f32_16x16x32_bf16 a[8:11], v[128:131], v[168:171], a[8:11]
  ds_read_b64_tr_b16 v[226:227], v6 offset:41984
  v_mfma_f32_16x16x32_bf16 a[12:15], v[128:131], v[172:175], a[12:15]
  ds_read_b128 v[196:199], v5 offset:34816
  v_mfma_f32_16x16x32_bf16 a[16:19], v[132:135], v[160:163], a[16:19]
  ds_read_b64_tr_b16 v[228:229], v7 offset:40960
  v_mfma_f32_16x16x32_bf16 a[20:23], v[132:135], v[164:167], a[20:23]
  ds_read_b64_tr_b16 v[230:231], v7 offset:41984
  v_mfma_f32_16x16x32_bf16 a[24:27], v[132:135], v[168:171], a[24:27]
  ds_read_b128 v[200:203], v5 offset:36864
  v_mfma_f32_16x16x32_bf16 a[28:31], v[132:135], v[172:175], a[28:31]
  ds_read_b64_tr_b16 v[232:233], v8 offset:40960
  v_mfma_f32_16x16x32_bf16 a[32:35], v[136:139], v[160:163], a[32:35]
  ds_read_b64_tr_b16 v[234:235], v8 offset:41984
  v_mfma_f32_16x16x32_bf16 a[36:39], v[136:139], v[164:167], a[36:39]
  ds_read_b128 v[204:207], v5 offset:38912
  v_mfma_f32_16x16x32_bf16 a[40:43], v[136:139], v[168:171], a[40:43]
  ds_read_b64_tr_b16 v[236:237], v9 offset:40960
  v_mfma_f32_16x16x32_bf16 a[44:47], v[136:139], v[172:175], a[44:47]
  ds_read_b64_tr_b16 v[238:239], v9 offset:41984
  v_mfma_f32_16x16x32_bf16 a[48:51], v[140:143], v[160:163], a[48:51]
  v_mfma_f32_16x16x32_bf16 a[52:55], v[140:143], v[164:167], a[52:55]
  v_mfma_f32_16x16x32_bf16 a[56:59], v[140:143], v[168:171], a[56:59]
  v_mfma_f32_16x16x32_bf16 a[60:63], v[140:143], v[172:175], a[60:63]
  s_waitcnt vmcnt(16) lgkmcnt(0)
  s_barrier
  v_mfma_f32_16x16x32_bf16 a[0:3], v[192:195], v[224:227], a[0:3]
  ds_read_b128 v[128:131], v4 offset:49152
  s_add_u32 m0, s95, 32768
  s_nop 0
  buffer_load_dwordx4 v3, s[12:15], s40 offen  lds
  v_mfma_f32_16x16x32_bf16 a[4:7], v[192:195], v[228:231], a[4:7]
  ds_read_b64_tr_b16 v[160:161], v6 offset:49152
  v_mfma_f32_16x16x32_bf16 a[8:11], v[192:195], v[232:235], a[8:11]
  s_add_u32 m0, s95, 131072
  s_nop 0
  buffer_load_dwordx4 v2, s[8:11], s32 offen sc1 lds
  ds_read_b64_tr_b16 v[162:163], v6 offset:50176
  v_mfma_f32_16x16x32_bf16 a[12:15], v[192:195], v[236:239], a[12:15]
  ds_read_b128 v[132:135], v4 offset:51200
  s_add_u32 m0, s95, 36864
  s_nop 0
  buffer_load_dwordx4 v3, s[12:15], s41 offen  lds
  v_mfma_f32_16x16x32_bf16 a[16:19], v[196:199], v[224:227], a[16:19]
  ds_read_b64_tr_b16 v[164:165], v7 offset:49152
  v_mfma_f32_16x16x32_bf16 a[20:23], v[196:199], v[228:231], a[20:23]
  s_add_u32 m0, s95, 135168
  s_nop 0
  buffer_load_dwordx4 v2, s[8:11], s33 offen sc1 lds
  ds_read_b64_tr_b16 v[166:167], v7 offset:50176
  v_mfma_f32_16x16x32_bf16 a[24:27], v[196:199], v[232:235], a[24:27]
  ds_read_b128 v[136:139], v4 offset:53248
  s_add_u32 m0, s95, 40960
  s_nop 0
  buffer_load_dwordx4 v3, s[12:15], s42 offen  lds
  v_mfma_f32_16x16x32_bf16 a[28:31], v[196:199], v[236:239], a[28:31]
  ds_read_b64_tr_b16 v[168:169], v8 offset:49152
  v_mfma_f32_16x16x32_bf16 a[32:35], v[200:203], v[224:227], a[32:35]
  s_add_u32 m0, s95, 139264
  s_nop 0
  buffer_load_dwordx4 v2, s[8:11], s34 offen sc1 lds
  ds_read_b64_tr_b16 v[170:171], v8 offset:50176
  v_mfma_f32_16x16x32_bf16 a[36:39], v[200:203], v[228:231], a[36:39]
  ds_read_b128 v[140:143], v4 offset:55296
  s_add_u32 m0, s95, 45056
  s_nop 0
  buffer_load_dwordx4 v3, s[12:15], s43 offen  lds
  v_mfma_f32_16x16x32_bf16 a[40:43], v[200:203], v[232:235], a[40:43]
  ds_read_b64_tr_b16 v[172:173], v9 offset:49152
  v_mfma_f32_16x16x32_bf16 a[44:47], v[200:203], v[236:239], a[44:47]
  s_add_u32 m0, s95, 143360
  s_nop 0
  buffer_load_dwordx4 v2, s[8:11], s35 offen sc1 lds
  v_add_u32 v2, s44, v2
  v_add_u32 v3, s45, v3
  ds_read_b64_tr_b16 v[174:175], v9 offset:50176
  v_mfma_f32_16x16x32_bf16 a[48:51], v[204:207], v[224:227], a[48:51]
  v_mfma_f32_16x16x32_bf16 a[52:55], v[204:207], v[228:231], a[52:55]
  v_mfma_f32_16x16x32_bf16 a[56:59], v[204:207], v[232:235], a[56:59]
  v_mfma_f32_16x16x32_bf16 a[60:63], v[204:207], v[236:239], a[60:63]
  s_waitcnt lgkmcnt(0)
  v_mfma_f32_16x16x32_bf16 a[0:3], v[128:131], v[160:163], a[0:3]
  ds_read_b128 v[192:195], v5 offset:49152
  v_mfma_f32_16x16x32_bf16 a[4:7], v[128:131], v[164:167], a[4:7]
  ds_read_b64_tr_b16 v[224:225], v6 offset:57344
  v_mfma_f32_16x16x32_bf16 a[8:11], v[128:131], v[168:171], a[8:11]
  ds_read_b64_tr_b16 v[226:227], v6 offset:58368
  v_mfma_f32_16x16x32_bf16 a[12:15], v[128:131], v[172:175], a[12:15]
  ds_read_b128 v[196:199], v5 offset:51200
  v_mfma_f32_16x16x32_bf16 a[16:19], v[132:135], v[160:163], a[16:19]
  ds_read_b64_tr_b16 v[228:229], v7 offset:57344
  v_mfma_f32_16x16x32_bf16 a[20:23], v[132:135], v[164:167], a[20:23]
  ds_read_b64_tr_b16 v[230:231], v7 offset:58368
  v_mfma_f32_16x16x32_bf16 a[24:27], v[132:135], v[168:171], a[24:27]
  ds_read_b128 v[200:203], v5 offset:53248
  v_mfma_f32_16x16x32_bf16 a[28:31], v[132:135], v[172:175], a[28:31]
  ds_read_b64_tr_b16 v[232:233], v8 offset:57344
  v_mfma_f32_16x16x32_bf16 a[32:35], v[136:139], v[160:163], a[32:35]
  ds_read_b64_tr_b16 v[234:235], v8 offset:58368
  v_mfma_f32_16x16x32_bf16 a[36:39], v[136:139], v[164:167], a[36:39]
  ds_read_b128 v[204:207], v5 offset:55296
  v_mfma_f32_16x16x32_bf16 a[40:43], v[136:139], v[168:171], a[40:43]
  ds_read_b64_tr_b16 v[236:237], v9 offset:57344
  v_mfma_f32_16x16x32_bf16 a[44:47], v[136:139], v[172:175], a[44:47]
  ds_read_b64_tr_b16 v[238:239], v9 offset:58368
  v_mfma_f32_16x16x32_bf16 a[48:51], v[140:143], v[160:163], a[48:51]
  v_mfma_f32_16x16x32_bf16 a[52:55], v[140:143], v[164:167], a[52:55]
  v_mfma_f32_16x16x32_bf16 a[56:59], v[140:143], v[168:171], a[56:59]
  v_mfma_f32_16x16x32_bf16 a[60:63], v[140:143], v[172:175], a[60:63]
  s_waitcnt vmcnt(16) lgkmcnt(0)
  s_barrier
  v_mfma_f32_16x16x32_bf16 a[0:3], v[192:195], v[224:227], a[0:3]
  ds_read_b128 v[128:131], v4 offset:0
  s_add_u32 m0, s95, 49152
  s_nop 0
  buffer_load_dwordx4 v3, s[12:15], s40 offen  lds
  v_mfma_f32_16x16x32_bf16 a[4:7], v[192:195], v[228:231], a[4:7]
  ds_read_b64_tr_b16 v[160:161], v6 offset:0
  v_mfma_f32_16x16x32_bf16 a[8:11], v[192:195], v[232:235], a[8:11]
  s_add_u32 m0, s95, 147456
  s_nop 0
  buffer_load_dwordx4 v2, s[8:11], s32 offen sc1 lds
  ds_read_b64_tr_b16 v[162:163], v6 offset:1024
  v_mfma_f32_16x16x32_bf16 a[12:15], v[192:195], v[236:239], a[12:15]
  ds_read_b128 v[132:135], v4 offset:2048
  s_add_u32 m0, s95, 53248
  s_nop 0
  buffer_load_dwordx4 v3, s[12:15], s41 offen  lds
  v_mfma_f32_16x16x32_bf16 a[16:19], v[196:199], v[224:227], a[16:19]
  ds_read_b64_tr_b16 v[164:165], v7 offset:0
  v_mfma_f32_16x16x32_bf16 a[20:23], v[196:199], v[228:231], a[20:23]
  s_add_u32 m0, s95, 151552
  s_nop 0
  buffer_load_dwordx4 v2, s[8:11], s33 offen sc1 lds
  ds_read_b64_tr_b16 v[166:167], v7 offset:1024
  v_mfma_f32_16x16x32_bf16 a[24:27], v[196:199], v[232:235], a[24:27]
  ds_read_b128 v[136:139], v4 offset:4096
  s_add_u32 m0, s95, 57344
  s_nop 0
  buffer_load_dwordx4 v3, s[12:15], s42 offen  lds
  v_mfma_f32_16x16x32_bf16 a[28:31], v[196:199], v[236:239], a[28:31]
  ds_read_b64_tr_b16 v[168:169], v8 offset:0
  v_mfma_f32_16x16x32_bf16 a[32:35], v[200:203], v[224:227], a[32:35]
  s_add_u32 m0, s95, 155648
  s_nop 0
  buffer_load_dwordx4 v2, s[8:11], s34 offen sc1 lds
  ds_read_b64_tr_b16 v[170:171], v8 offset:1024
  v_mfma_f32_16x16x32_bf16 a[36:39], v[200:203], v[228:231], a[36:39]
  ds_read_b128 v[140:143], v4 offset:6144
  s_add_u32 m0, s95, 61440
  s_nop 0
  buffer_load_dwordx4 v3, s[12:15], s43 offen  lds
  v_mfma_f32_16x16x32_bf16 a[40:43], v[200:203], v[232:235], a[40:43]
  ds_read_b64_tr_b16 v[172:173], v9 offset:0
  v_mfma_f32_16x16x32_bf16 a[44:47], v[200:203], v[236:239], a[44:47]
  s_add_u32 m0, s95, 159744
  s_nop 0
  buffer_load_dwordx4 v2, s[8:11], s35 offen sc1 lds
  v_add_u32 v2, s44, v2
  v_add_u32 v3, s45, v3
  ds_read_b64_tr_b16 v[174:175], v9 offset:1024
  v_mfma_f32_16x16x32_bf16 a[48:51], v[204:207], v[224:227], a[48:51]
  v_mfma_f32_16x16x32_bf16 a[52:55], v[204:207], v[228:231], a[52:55]
  v_mfma_f32_16x16x32_bf16 a[56:59], v[204:207], v[232:235], a[56:59]
  v_mfma_f32_16x16x32_bf16 a[60:63], v[204:207], v[236:239], a[60:63]
  s_waitcnt lgkmcnt(0)
  s_sub_u32 s46, s46, 1
  s_cbranch_scc0 G_l_sn_l
  s_branch G_next
T_start:
  v_mov_b32 v61, 64
  s_cmp_lg_u32 s31, 0
  s_cbranch_scc1 sl_53
  v_writelane_b32 v61, 1, 0
  v_writelane_b32 v61, 3, 1
  v_writelane_b32 v61, 5, 2
  v_writelane_b32 v61, 7, 3
  v_writelane_b32 v61, 9, 4
  v_writelane_b32 v61, 11, 5
  v_writelane_b32 v61, 14, 6
  v_writelane_b32 v61, 17, 7
  v_writelane_b32 v61, 21, 8
  v_writelane_b32 v61, 26, 9
  v_writelane_b32 v61, 32, 10
  v_writelane_b32 v61, 38, 11
  v_writelane_b32 v61, 44, 12
  v_writelane_b32 v61, 50, 13
  v_writelane_b32 v61, 56, 14
  v_writelane_b32 v61, 59, 15
sl_53:
  s_cmp_lg_u32 s31, 1
  s_cbranch_scc1 sl_54
  v_writelane_b32 v61, 0, 0
  v_writelane_b32 v61, 2, 1
  v_writelane_b32 v61, 4, 2
  v_writelane_b32 v61, 6, 3
  v_writelane_b32 v61, 8, 4
  v_writelane_b32 v61, 10, 5
  v_writelane_b32 v61, 12, 6
  v_writelane_b32 v61, 15, 7
  v_writelane_b32 v61, 19, 8
  v_writelane_b32 v61, 23, 9
  v_writelane_b32 v61, 28, 10
  v_writelane_b32 v61, 34, 11
  v_writelane_b32 v61, 40, 12
  v_writelane_b32 v61, 46, 13
  v_writelane_b32 v61, 52, 14
  v_writelane_b32 v61, 62, 15
sl_54:
  s_cmp_lg_u32 s31, 2
  s_cbranch_scc1 sl_55
  v_writelane_b32 v61, 29, 0
  v_writelane_b32 v61, 35, 1
  v_writelane_b32 v61, 41, 2
  v_writelane_b32 v61, 47, 3
  v_writelane_b32 v61, 53, 4
  v_writelane_b32 v61, 58, 5
sl_55:
  s_cmp_lg_u32 s31, 3
  s_cbranch_scc1 sl_56
  v_writelane_b32 v61, 25, 0
  v_writelane_b32 v61, 31, 1
  v_writelane_b32 v61, 37, 2
  v_writelane_b32 v61, 43, 3
  v_writelane_b32 v61, 49, 4
  v_writelane_b32 v61, 55, 5
  v_writelane_b32 v61, 60, 6
sl_56:
  s_cmp_lg_u32 s31, 4
  s_cbranch_scc1 sl_57
  v_writelane_b32 v61, 13, 0
  v_writelane_b32 v61, 16, 1
  v_writelane_b32 v61, 20, 2
  v_writelane_b32 v61, 24, 3
  v_writelane_b32 v61, 30, 4
  v_writelane_b32 v61, 36, 5
  v_writelane_b32 v61, 42, 6
  v_writelane_b32 v61, 48, 7
  v_writelane_b32 v61, 54, 8
  v_writelane_b32 v61, 61, 9
sl_57:
  s_cmp_lg_u32 s31, 5
  s_cbranch_scc1 sl_58
  v_writelane_b32 v61, 18, 0
  v_writelane_b32 v61, 22, 1
  v_writelane_b32 v61, 27, 2
  v_writelane_b32 v61, 33, 3
  v_writelane_b32 v61, 39, 4
  v_writelane_b32 v61, 45, 5
  v_writelane_b32 v61, 51, 6
  v_writelane_b32 v61, 57, 7
  v_writelane_b32 v61, 63, 8
sl_58:
  s_mov_b32 s12, s74
  s_mov_b32 s13, s75
  s_mov_b32 s14, 0x800000
  s_mov_b32 s15, 0x20000
  s_mov_b32 s16, s86
  s_mov_b32 s17, s87
  s_mov_b32 s18, 0x800
  s_mov_b32 s19, 0x20000
  s_mov_b32 s8, s64
  s_mov_b32 s9, s65
  s_mov_b32 s10, 0x400000
  s_mov_b32 s11, 0x20000
  v_lshrrev_b32 v66, 2, v0
  v_lshlrev_b32 v66, 11, v66
  v_and_b32 v67, 3, v0
  v_lshl_add_u32 v66, v67, 4, v66
  s_lshr_b32 s59, s29, 3
  s_lshl_b32 s56, s59, 21
  s_and_b32 s60, s29, 7
  s_lshl_b32 s60, s60, 2
  s_add_u32 s60, s60, s30
  s_lshl_b32 s57, s60, 6
  s_add_u32 s56, s56, s57
  s_lshl_b32 s57, s29, 6
  s_lshl_b32 s52, s59, 16
  s_lshl_b32 s60, s60, 11
  s_add_u32 s52, s52, s60
  s_add_u32 s52, s52, 33554432
  s_lshl_b32 s51, s30, 12
  s_lshl_b32 s53, s59, 15
  s_add_u32 s53, s53, s51
  s_lshl_b32 s53, s53, 1
  s_add_u32 s53, s53, 67108864
  v_add_u32 v66, s56, v66
  s_lshl_b32 s58, s30, 15
  v_lshrrev_b32 v68, 2, v0
  v_lshlrev_b32 v68, 6, v68
  v_lshl_add_u32 v68, v67, 3, v68
  v_add_u32 v68, s58, v68
  v_lshlrev_b32 v8, 5, v0
  buffer_load_dwordx4 v[44:47], v8, s[16:19], 0 offen
  buffer_load_dwordx4 v[48:51], v8, s[16:19], 0 offen offset:16
  s_lshl_b32 s56, s28, 4
  buffer_load_dword v62, off, s[20:23], s56 sc1
  s_add_u32 m0, s58, 0
  s_mov_b32 s56, 0
  buffer_load_dwordx4 v66, s[12:15], s56 offen lds
  s_add_u32 m0, s58, 1024
  s_mov_b32 s56, 32768
  buffer_load_dwordx4 v66, s[12:15], s56 offen lds
  s_add_u32 m0, s58, 2048
  s_mov_b32 s56, 65536
  buffer_load_dwordx4 v66, s[12:15], s56 offen lds
  s_add_u32 m0, s58, 3072
  s_mov_b32 s56, 98304
  buffer_load_dwordx4 v66, s[12:15], s56 offen lds
  s_add_u32 m0, s58, 4096
  s_mov_b32 s56, 131072
  buffer_load_dwordx4 v66, s[12:15], s56 offen lds
  s_add_u32 m0, s58, 5120
  s_mov_b32 s56, 163840
  buffer_load_dwordx4 v66, s[12:15], s56 offen lds
  s_add_u32 m0, s58, 6144
  s_mov_b32 s56, 196608
  buffer_load_dwordx4 v66, s[12:15], s56 offen lds
  s_add_u32 m0, s58, 7168
  s_mov_b32 s56, 229376
  buffer_load_dwordx4 v66, s[12:15], s56 offen lds
  s_add_u32 m0, s58, 8192
  s_mov_b32 s56, 262144
  buffer_load_dwordx4 v66, s[12:15], s56 offen lds
  s_add_u32 m0, s58, 9216
  s_mov_b32 s56, 294912
  buffer_load_dwordx4 v66, s[12:15], s56 offen lds
  s_add_u32 m0, s58, 10240
  s_mov_b32 s56, 327680
  buffer_load_dwordx4 v66, s[12:15], s56 offen lds
  s_add_u32 m0, s58, 11264
  s_mov_b32 s56, 360448
  buffer_load_dwordx4 v66, s[12:15], s56 offen lds
  s_add_u32 m0, s58, 12288
  s_mov_b32 s56, 393216
  buffer_load_dwordx4 v66, s[12:15], s56 offen lds
  s_add_u32 m0, s58, 13312
  s_mov_b32 s56, 425984
  buffer_load_dwordx4 v66, s[12:15], s56 offen lds
  s_add_u32 m0, s58, 14336
  s_mov_b32 s56, 458752
  buffer_load_dwordx4 v66, s[12:15], s56 offen lds
  s_add_u32 m0, s58, 15360
  s_mov_b32 s56, 491520
  buffer_load_dwordx4 v66, s[12:15], s56 offen lds
  s_add_u32 m0, s58, 16384
  s_mov_b32 s56, 524288
  buffer_load_dwordx4 v66, s[12:15], s56 offen lds
  s_add_u32 m0, s58, 17408
  s_mov_b32 s56, 557056
  buffer_load_dwordx4 v66, s[12:15], s56 offen lds
  s_add_u32 m0, s58, 18432
  s_mov_b32 s56, 589824
  buffer_load_dwordx4 v66, s[12:15], s56 offen lds
  s_add_u32 m0, s58, 19456
  s_mov_b32 s56, 622592
  buffer_load_dwordx4 v66, s[12:15], s56 offen lds
  s_add_u32 m0, s58, 20480
  s_mov_b32 s56, 655360
  buffer_load_dwordx4 v66, s[12:15], s56 offen lds
  s_add_u32 m0, s58, 21504
  s_mov_b32 s56, 688128
  buffer_load_dwordx4 v66, s[12:15], s56 offen lds
  s_add_u32 m0, s58, 22528
  s_mov_b32 s56, 720896
  buffer_load_dwordx4 v66, s[12:15], s56 offen lds
  s_add_u32 m0, s58, 23552
  s_mov_b32 s56, 753664
  buffer_load_dwordx4 v66, s[12:15], s56 offen lds
  s_add_u32 m0, s58, 24576
  s_mov_b32 s56, 786432
  buffer_load_dwordx4 v66, s[12:15], s56 offen lds
  s_add_u32 m0, s58, 25600
  s_mov_b32 s56, 819200
  buffer_load_dwordx4 v66, s[12:15], s56 offen lds
  s_add_u32 m0, s58, 26624
  s_mov_b32 s56, 851968
  buffer_load_dwordx4 v66, s[12:15], s56 offen lds
  s_add_u32 m0, s58, 27648
  s_mov_b32 s56, 884736
  buffer_load_dwordx4 v66, s[12:15], s56 offen lds
  s_add_u32 m0, s58, 28672
  s_mov_b32 s56, 917504
  buffer_load_dwordx4 v66, s[12:15], s56 offen lds
  s_add_u32 m0, s58, 29696
  s_mov_b32 s56, 950272
  buffer_load_dwordx4 v66, s[12:15], s56 offen lds
  s_add_u32 m0, s58, 30720
  s_mov_b32 s56, 983040
  buffer_load_dwordx4 v66, s[12:15], s56 offen lds
  s_add_u32 m0, s58, 31744
  s_mov_b32 s56, 1015808
  buffer_load_dwordx4 v66, s[12:15], s56 offen lds
  s_mov_b32 s33, 0x3e0293ee
  s_mov_b32 s34, 0xffff0000
  s_lshr_b32 s35, s30, 1
  s_and_b32 s36, s30, 1
  v_mov_b32 v9, 1
  v_lshlrev_b32 v2, 3, v0
  v_and_b32 v64, 15, v0
  v_lshrrev_b32 v65, 4, v0
  s_lshl_b32 s56, s35, 4
  v_add_u32 v69, s56, v64
  v_lshlrev_b32 v6, 2, v69
  v_add_u32 v6, 7340032, v6
  v_lshlrev_b32 v3, 11, v69
  v_lshl_add_u32 v3, v65, 3, v3
  s_lshl_b32 s56, s36, 5
  s_add_u32 s56, s56, s57
  v_add_u32 v3, s56, v3
  s_lshl_b32 s56, s29, 11
  s_lshl_b32 s57, s35, 10
  s_add_u32 s56, s56, s57
  s_lshl_b32 s57, s36, 3
  s_add_u32 s56, s56, s57
  v_add_u32 v7, s56, v1
  v_mov_b32 v5, v1
  v_lshlrev_b32 v70, 2, v65
  v_sub_u32 v69, v69, v70
  v_mov_b32 v70, 0xf149f2ca
  v_cmp_gt_i32 vcc, 0, v69
  s_nop 1
  v_cndmask_b32 v12, 0, v70, vcc
  v_cmp_gt_i32 vcc, 1, v69
  s_nop 1
  v_cndmask_b32 v13, 0, v70, vcc
  v_cmp_gt_i32 vcc, 2, v69
  s_nop 1
  v_cndmask_b32 v14, 0, v70, vcc
  v_cmp_gt_i32 vcc, 3, v69
  s_nop 1
  v_cndmask_b32 v15, 0, v70, vcc
  v_cmp_gt_i32 vcc, 16, v69
  s_nop 1
  v_cndmask_b32 v16, 0, v70, vcc
  v_cmp_gt_i32 vcc, 17, v69
  s_nop 1
  v_cndmask_b32 v17, 0, v70, vcc
  v_cmp_gt_i32 vcc, 18, v69
  s_nop 1
  v_cndmask_b32 v18, 0, v70, vcc
  v_cmp_gt_i32 vcc, 19, v69
  s_nop 1
  v_cndmask_b32 v19, 0, v70, vcc
  v_mov_b32 v24, 0x3f803f80
  v_mov_b32 v25, 0x3f803f80
  v_mov_b32 v26, 0x3f803f80
  v_mov_b32 v27, 0x3f803f80
  v_lshrrev_b32 v69, 2, v64
  v_xor_b32 v69, v69, v65
  v_lshlrev_b32 v69, 3, v69
  v_lshl_add_u32 v69, v64, 5, v69
  s_lshl_b32 s56, s30, 10
  s_add_u32 s56, s56, 147456
  v_add_u32 v20, s56, v69
  v_xor_b32 v69, v67, v65
  v_lshlrev_b32 v69, 3, v69
  v_lshrrev_b32 v70, 2, v0
  v_lshl_add_u32 v69, v70, 5, v69
  v_add_u32 v21, 147456, v69
  s_mov_b32 s56, 0x10000000
  s_cmp_eq_u32 s30, 0
  s_cselect_b32 s38, 7340032, s56
  s_cselect_b32 s39, 2637824, s56
  s_lshl_b32 s56, s31, 5
  s_add_u32 s56, s56, s29
  s_lshl_b32 s56, s56, 7
  s_add_u32 s39, s39, s56
  s_add_u32 s54, s39, 24576
  s_lshl_b32 s40, s35, 12
  s_lshl_b32 s56, s29, 13
  s_add_u32 s40, s40, s56
  s_lshl_b32 s56, s36, 11
  s_add_u32 s40, s40, s56
  s_add_u32 s40, s40, 67108864
  s_waitcnt vmcnt(32)
  v_lshlrev_b32 v28, 16, v44
  v_and_b32 v29, s34, v44
  v_lshlrev_b32 v30, 16, v45
  v_and_b32 v31, s34, v45
  v_lshlrev_b32 v32, 16, v46
  v_and_b32 v33, s34, v46
  v_lshlrev_b32 v34, 16, v47
  v_and_b32 v35, s34, v47
  v_lshlrev_b32 v36, 16, v48
  v_and_b32 v37, s34, v48
  v_lshlrev_b32 v38, 16, v49
  v_and_b32 v39, s34, v49
  v_lshlrev_b32 v40, 16, v50
  v_and_b32 v41, s34, v50
  v_lshlrev_b32 v42, 16, v51
  v_and_b32 v43, s34, v51
  s_waitcnt vmcnt(24)
  ds_read_b64_tr_b16 a[0:1], v68 offset:0
  ds_read_b64_tr_b16 a[2:3], v68 offset:1024
  ds_read_b64_tr_b16 a[4:5], v68 offset:32
  ds_read_b64_tr_b16 a[6:7], v68 offset:1056
  ds_read_b64_tr_b16 a[8:9], v68 offset:2048
  ds_read_b64_tr_b16 a[10:11], v68 offset:3072
  ds_read_b64_tr_b16 a[12:13], v68 offset:2080
  ds_read_b64_tr_b16 a[14:15], v68 offset:3104
  ds_read_b64_tr_b16 a[16:17], v68 offset:4096
  ds_read_b64_tr_b16 a[18:19], v68 offset:5120
  ds_read_b64_tr_b16 a[20:21], v68 offset:4128
  ds_read_b64_tr_b16 a[22:23], v68 offset:5152
  ds_read_b64_tr_b16 a[24:25], v68 offset:6144
  ds_read_b64_tr_b16 a[26:27], v68 offset:7168
  ds_read_b64_tr_b16 a[28:29], v68 offset:6176
  ds_read_b64_tr_b16 a[30:31], v68 offset:7200
  s_waitcnt lgkmcnt(0)
  s_add_u32 m0, s58, 0
  s_mov_b32 s56, 1048576
  buffer_load_dwordx4 v66, s[12:15], s56 offen lds
  s_add_u32 m0, s58, 1024
  s_mov_b32 s56, 1081344
  buffer_load_dwordx4 v66, s[12:15], s56 offen lds
  s_add_u32 m0, s58, 2048
  s_mov_b32 s56, 1114112
  buffer_load_dwordx4 v66, s[12:15], s56 offen lds
  s_add_u32 m0, s58, 3072
  s_mov_b32 s56, 1146880
  buffer_load_dwordx4 v66, s[12:15], s56 offen lds
  s_add_u32 m0, s58, 4096
  s_mov_b32 s56, 1179648
  buffer_load_dwordx4 v66, s[12:15], s56 offen lds
  s_add_u32 m0, s58, 5120
  s_mov_b32 s56, 1212416
  buffer_load_dwordx4 v66, s[12:15], s56 offen lds
  s_add_u32 m0, s58, 6144
  s_mov_b32 s56, 1245184
  buffer_load_dwordx4 v66, s[12:15], s56 offen lds
  s_add_u32 m0, s58, 7168
  s_mov_b32 s56, 1277952
  buffer_load_dwordx4 v66, s[12:15], s56 offen lds
  s_waitcnt vmcnt(24)
  ds_read_b64_tr_b16 a[32:33], v68 offset:8192
  ds_read_b64_tr_b16 a[34:35], v68 offset:9216
  ds_read_b64_tr_b16 a[36:37], v68 offset:8224
  ds_read_b64_tr_b16 a[38:39], v68 offset:9248
  ds_read_b64_tr_b16 a[40:41], v68 offset:10240
  ds_read_b64_tr_b16 a[42:43], v68 offset:11264
  ds_read_b64_tr_b16 a[44:45], v68 offset:10272
  ds_read_b64_tr_b16 a[46:47], v68 offset:11296
  ds_read_b64_tr_b16 a[48:49], v68 offset:12288
  ds_read_b64_tr_b16 a[50:51], v68 offset:13312
  ds_read_b64_tr_b16 a[52:53], v68 offset:12320
  ds_read_b64_tr_b16 a[54:55], v68 offset:13344
  ds_read_b64_tr_b16 a[56:57], v68 offset:14336
  ds_read_b64_tr_b16 a[58:59], v68 offset:15360
  ds_read_b64_tr_b16 a[60:61], v68 offset:14368
  ds_read_b64_tr_b16 a[62:63], v68 offset:15392
  s_waitcnt lgkmcnt(0)
  s_add_u32 m0, s58, 8192
  s_mov_b32 s56, 1310720
  buffer_load_dwordx4 v66, s[12:15], s56 offen lds
  s_add_u32 m0, s58, 9216
  s_mov_b32 s56, 1343488
  buffer_load_dwordx4 v66, s[12:15], s56 offen lds
  s_add_u32 m0, s58, 10240
  s_mov_b32 s56, 1376256
  buffer_load_dwordx4 v66, s[12:15], s56 offen lds
  s_add_u32 m0, s58, 11264
  s_mov_b32 s56, 1409024
  buffer_load_dwordx4 v66, s[12:15], s56 offen lds
  s_add_u32 m0, s58, 12288
  s_mov_b32 s56, 1441792
  buffer_load_dwordx4 v66, s[12:15], s56 offen lds
  s_add_u32 m0, s58, 13312
  s_mov_b32 s56, 1474560
  buffer_load_dwordx4 v66, s[12:15], s56 offen lds
  s_add_u32 m0, s58, 14336
  s_mov_b32 s56, 1507328
  buffer_load_dwordx4 v66, s[12:15], s56 offen lds
  s_add_u32 m0, s58, 15360
  s_mov_b32 s56, 1540096
  buffer_load_dwordx4 v66, s[12:15], s56 offen lds
  s_waitcnt vmcnt(24)
  ds_read_b64_tr_b16 a[64:65], v68 offset:16384
  ds_read_b64_tr_b16 a[66:67], v68 offset:17408
  ds_read_b64_tr_b16 a[68:69], v68 offset:16416
  ds_read_b64_tr_b16 a[70:71], v68 offset:17440
  ds_read_b64_tr_b16 a[72:73], v68 offset:18432
  ds_read_b64_tr_b16 a[74:75], v68 offset:19456
  ds_read_b64_tr_b16 a[76:77], v68 offset:18464
  ds_read_b64_tr_b16 a[78:79], v68 offset:19488
  ds_read_b64_tr_b16 a[80:81], v68 offset:20480
  ds_read_b64_tr_b16 a[82:83], v68 offset:21504
  ds_read_b64_tr_b16 a[84:85], v68 offset:20512
  ds_read_b64_tr_b16 a[86:87], v68 offset:21536
  ds_read_b64_tr_b16 a[88:89], v68 offset:22528
  ds_read_b64_tr_b16 a[90:91], v68 offset:23552
  ds_read_b64_tr_b16 a[92:93], v68 offset:22560
  ds_read_b64_tr_b16 a[94:95], v68 offset:23584
  s_waitcnt lgkmcnt(0)
  s_add_u32 m0, s58, 16384
  s_mov_b32 s56, 1572864
  buffer_load_dwordx4 v66, s[12:15], s56 offen lds
  s_add_u32 m0, s58, 17408
  s_mov_b32 s56, 1605632
  buffer_load_dwordx4 v66, s[12:15], s56 offen lds
  s_add_u32 m0, s58, 18432
  s_mov_b32 s56, 1638400
  buffer_load_dwordx4 v66, s[12:15], s56 offen lds
  s_add_u32 m0, s58, 19456
  s_mov_b32 s56, 1671168
  buffer_load_dwordx4 v66, s[12:15], s56 offen lds
  s_add_u32 m0, s58, 20480
  s_mov_b32 s56, 1703936
  buffer_load_dwordx4 v66, s[12:15], s56 offen lds
  s_add_u32 m0, s58, 21504
  s_mov_b32 s56, 1736704
  buffer_load_dwordx4 v66, s[12:15], s56 offen lds
  s_add_u32 m0, s58, 22528
  s_mov_b32 s56, 1769472
  buffer_load_dwordx4 v66, s[12:15], s56 offen lds
  s_add_u32 m0, s58, 23552
  s_mov_b32 s56, 1802240
  buffer_load_dwordx4 v66, s[12:15], s56 offen lds
  s_waitcnt vmcnt(24)
  ds_read_b64_tr_b16 a[96:97], v68 offset:24576
  ds_read_b64_tr_b16 a[98:99], v68 offset:25600
  ds_read_b64_tr_b16 a[100:101], v68 offset:24608
  ds_read_b64_tr_b16 a[102:103], v68 offset:25632
  ds_read_b64_tr_b16 a[104:105], v68 offset:26624
  ds_read_b64_tr_b16 a[106:107], v68 offset:27648
  ds_read_b64_tr_b16 a[108:109], v68 offset:26656
  ds_read_b64_tr_b16 a[110:111], v68 offset:27680
  ds_read_b64_tr_b16 a[112:113], v68 offset:28672
  ds_read_b64_tr_b16 a[114:115], v68 offset:29696
  ds_read_b64_tr_b16 a[116:117], v68 offset:28704
  ds_read_b64_tr_b16 a[118:119], v68 offset:29728
  ds_read_b64_tr_b16 a[120:121], v68 offset:30720
  ds_read_b64_tr_b16 a[122:123], v68 offset:31744
  ds_read_b64_tr_b16 a[124:125], v68 offset:30752
  ds_read_b64_tr_b16 a[126:127], v68 offset:31776
  s_waitcnt lgkmcnt(0)
  s_add_u32 m0, s58, 24576
  s_mov_b32 s56, 1835008
  buffer_load_dwordx4 v66, s[12:15], s56 offen lds
  s_add_u32 m0, s58, 25600
  s_mov_b32 s56, 1867776
  buffer_load_dwordx4 v66, s[12:15], s56 offen lds
  s_add_u32 m0, s58, 26624
  s_mov_b32 s56, 1900544
  buffer_load_dwordx4 v66, s[12:15], s56 offen lds
  s_add_u32 m0, s58, 27648
  s_mov_b32 s56, 1933312
  buffer_load_dwordx4 v66, s[12:15], s56 offen lds
  s_add_u32 m0, s58, 28672
  s_mov_b32 s56, 1966080
  buffer_load_dwordx4 v66, s[12:15], s56 offen lds
  s_add_u32 m0, s58, 29696
  s_mov_b32 s56, 1998848
  buffer_load_dwordx4 v66, s[12:15], s56 offen lds
  s_add_u32 m0, s58, 30720
  s_mov_b32 s56, 2031616
  buffer_load_dwordx4 v66, s[12:15], s56 offen lds
  s_add_u32 m0, s58, 31744
  s_mov_b32 s56, 2064384
  buffer_load_dwordx4 v66, s[12:15], s56 offen lds
  s_waitcnt vmcnt(24)
  ds_read_b64_tr_b16 a[128:129], v68 offset:0
  ds_read_b64_tr_b16 a[130:131], v68 offset:1024
  ds_read_b64_tr_b16 a[132:133], v68 offset:32
  ds_read_b64_tr_b16 a[134:135], v68 offset:1056
  ds_read_b64_tr_b16 a[136:137], v68 offset:2048
  ds_read_b64_tr_b16 a[138:139], v68 offset:3072
  ds_read_b64_tr_b16 a[140:141], v68 offset:2080
  ds_read_b64_tr_b16 a[142:143], v68 offset:3104
  ds_read_b64_tr_b16 a[144:145], v68 offset:4096
  ds_read_b64_tr_b16 a[146:147], v68 offset:5120
  ds_read_b64_tr_b16 a[148:149], v68 offset:4128
  ds_read_b64_tr_b16 a[150:151], v68 offset:5152
  ds_read_b64_tr_b16 a[152:153], v68 offset:6144
  ds_read_b64_tr_b16 a[154:155], v68 offset:7168
  ds_read_b64_tr_b16 a[156:157], v68 offset:6176
  ds_read_b64_tr_b16 a[158:159], v68 offset:7200
  s_waitcnt vmcnt(16)
  ds_read_b64_tr_b16 a[160:161], v68 offset:8192
  ds_read_b64_tr_b16 a[162:163], v68 offset:9216
  ds_read_b64_tr_b16 a[164:165], v68 offset:8224
  ds_read_b64_tr_b16 a[166:167], v68 offset:9248
  ds_read_b64_tr_b16 a[168:169], v68 offset:10240
  ds_read_b64_tr_b16 a[170:171], v68 offset:11264
  ds_read_b64_tr_b16 a[172:173], v68 offset:10272
  ds_read_b64_tr_b16 a[174:175], v68 offset:11296
  ds_read_b64_tr_b16 a[176:177], v68 offset:12288
  ds_read_b64_tr_b16 a[178:179], v68 offset:13312
  ds_read_b64_tr_b16 a[180:181], v68 offset:12320
  ds_read_b64_tr_b16 a[182:183], v68 offset:13344
  ds_read_b64_tr_b16 a[184:185], v68 offset:14336
  ds_read_b64_tr_b16 a[186:187], v68 offset:15360
  ds_read_b64_tr_b16 a[188:189], v68 offset:14368
  ds_read_b64_tr_b16 a[190:191], v68 offset:15392
  s_waitcnt vmcnt(8)
  ds_read_b64_tr_b16 a[192:193], v68 offset:16384
  ds_read_b64_tr_b16 a[194:195], v68 offset:17408
  ds_read_b64_tr_b16 a[196:197], v68 offset:16416
  ds_read_b64_tr_b16 a[198:199], v68 offset:17440
  ds_read_b64_tr_b16 a[200:201], v68 offset:18432
  ds_read_b64_tr_b16 a[202:203], v68 offset:19456
  ds_read_b64_tr_b16 a[204:205], v68 offset:18464
  ds_read_b64_tr_b16 a[206:207], v68 offset:19488
  ds_read_b64_tr_b16 a[208:209], v68 offset:20480
  ds_read_b64_tr_b16 a[210:211], v68 offset:21504
  ds_read_b64_tr_b16 a[212:213], v68 offset:20512
  ds_read_b64_tr_b16 a[214:215], v68 offset:21536
  ds_read_b64_tr_b16 a[216:217], v68 offset:22528
  ds_read_b64_tr_b16 a[218:219], v68 offset:23552
  ds_read_b64_tr_b16 a[220:221], v68 offset:22560
  ds_read_b64_tr_b16 a[222:223], v68 offset:23584
  s_waitcnt vmcnt(0)
  ds_read_b64_tr_b16 a[224:225], v68 offset:24576
  ds_read_b64_tr_b16 a[226:227], v68 offset:25600
  ds_read_b64_tr_b16 a[228:229], v68 offset:24608
  ds_read_b64_tr_b16 a[230:231], v68 offset:25632
  ds_read_b64_tr_b16 a[232:233], v68 offset:26624
  ds_read_b64_tr_b16 a[234:235], v68 offset:27648
  ds_read_b64_tr_b16 a[236:237], v68 offset:26656
  ds_read_b64_tr_b16 a[238:239], v68 offset:27680
  ds_read_b64_tr_b16 a[240:241], v68 offset:28672
  ds_read_b64_tr_b16 a[242:243], v68 offset:29696
  ds_read_b64_tr_b16 a[244:245], v68 offset:28704
  ds_read_b64_tr_b16 a[246:247], v68 offset:29728
  ds_read_b64_tr_b16 a[248:249], v68 offset:30720
  ds_read_b64_tr_b16 a[250:251], v68 offset:31744
  ds_read_b64_tr_b16 a[252:253], v68 offset:30752
  ds_read_b64_tr_b16 a[254:255], v68 offset:31776
  s_waitcnt lgkmcnt(0)
  v_readlane_b32 s32, v61, 0
  s_mov_b32 s48, 0x10000000
  s_mov_b32 s43, s48
  s_mov_b32 s49, s48
  s_mov_b32 s50, 0x1000
  s_mov_b32 s47, 0
  s_mov_b32 s44, 0
  s_mov_b32 s45, 0
  s_mov_b32 s46, 3
  s_mov_b32 s42, 0
  s_mov_b32 s37, s32
  s_mov_b32 s41, s32
  s_lshl_b32 s56, s29, 8
  s_add_u32 s56, s56, 2629632
  v_mov_b32 v22, s56
  s_add_u32 s56, s56, 128
  v_writelane_b32 v22, s56, 1
  v_mov_b32 v23, 0
  v_mov_b32 v60, 0
  v_writelane_b32 v23, 16, 2
  s_lshl_b32 s56, s31, 5
  s_and_b32 s57, s29, 24
  s_add_u32 s57, s57, s56
  s_lshl_b32 s57, s57, 7
  s_add_u32 s57, s57, 2636800
  s_mov_b64 exec, 65280
  v_lshl_add_u32 v22, v0, 7, s57
  s_lshr_b32 s57, s29, 2
  s_add_u32 s57, s57, s56
  s_lshl_b32 s57, s57, 7
  s_add_u32 s57, s57, 2646016
  s_mov_b64 exec, 0xf0000
  v_lshl_add_u32 v22, v0, 10, s57
  s_mov_b64 exec, -1
  s_add_u32 s56, s37, 1
  s_min_u32 s56, s56, 63
  v_writelane_b32 v23, s56, 0
  v_writelane_b32 v23, s56, 1
  s_or_b32 s42, s42, 3
  s_lshr_b32 s56, s41, 3
  s_lshl_b32 s57, s56, 7
  s_add_u32 s57, s57, 2623488
  s_add_u32 s56, s56, 1
  s_lshr_b32 s58, s41, 2
  s_cmp_lt_u32 s41, 8
  s_cselect_b32 s56, s58, s56
  s_cselect_b32 s58, 64, 32
  s_lshl_b32 s56, s56, 7
  s_add_u32 s56, s56, 2621440
  v_writelane_b32 v22, s57, 2
  v_writelane_b32 v22, s56, 3
  v_writelane_b32 v23, s58, 3
  s_or_b32 s42, s42, 12
  s_mov_b64 exec, 65280
  v_add_u32 v23, 1, v23
  s_mov_b64 exec, -1
  s_or_b32 s42, s42, 65280
  v_readfirstlane_b32 s56, v62
  s_nop 0
  s_cmp_lt_u32 s56, 32
  s_cbranch_scc1 ST_pre
T_pre:
  s_and_b32 s62, s42, 12
  s_cbranch_scc0 fe_60
fw_59:
  s_mov_b64 exec, 0xc
  buffer_load_dword v60, v22, s[4:7], 0 offen sc1
  s_mov_b64 exec, -1
  s_andn2_b32 s42, s42, 12
  s_waitcnt vmcnt(0)
  v_cmp_lt_u32 vcc, v60, v23
  s_nop 0
  s_and_b32 s62, vcc_lo, 12
  s_cbranch_scc0 fd_61
  s_sleep 1
  s_sub_u32 s94, s94, 1
  s_cbranch_scc0 fw_59
  s_mov_b32 s94, 0
fd_61:
fe_60:
  s_lshl_b32 s56, s41, 5
  s_add_u32 s56, s56, s29
  s_lshl_b32 s57, s56, 13
  s_lshl_b32 s58, s35, 12
  s_add_u32 s58, s58, s57
  s_add_u32 s58, s58, 67108864
  buffer_load_dwordx4 v[64:67], v1, s[4:7], s58 offen offset:0
  buffer_load_dwordx4 v[68:71], v1, s[4:7], s58 offen offset:1024
  buffer_load_dwordx4 v[72:75], v1, s[4:7], s58 offen offset:2048
  buffer_load_dwordx4 v[76:79], v1, s[4:7], s58 offen offset:3072
  s_add_u32 s58, s57, 33554432
  s_add_u32 s59, s58, 4096
  buffer_load_dwordx4 v[80:83], v1, s[4:7], s58 offen offset:0
  buffer_load_dwordx4 v[96:99], v1, s[4:7], s59 offen offset:0
  buffer_load_dwordx4 v[84:87], v1, s[4:7], s58 offen offset:1024
  buffer_load_dwordx4 v[100:103], v1, s[4:7], s59 offen offset:1024
  buffer_load_dwordx4 v[88:91], v1, s[4:7], s58 offen offset:2048
  buffer_load_dwordx4 v[104:107], v1, s[4:7], s59 offen offset:2048
  buffer_load_dwordx4 v[92:95], v1, s[4:7], s58 offen offset:3072
  buffer_load_dwordx4 v[108:111], v1, s[4:7], s59 offen offset:3072
  s_lshl_b32 s58, s36, 12
  s_add_u32 s58, s58, s57
  s_add_u32 s58, s58, 50331648
  buffer_load_dwordx4 v[112:115], v1, s[4:7], s58 offen offset:0
  buffer_load_dwordx4 v[116:119], v1, s[4:7], s58 offen offset:1024
  buffer_load_dwordx4 v[120:123], v1, s[4:7], s58 offen offset:2048
  buffer_load_dwordx4 v[124:127], v1, s[4:7], s58 offen offset:3072
  s_lshl_b32 s56, s56, 11
  buffer_load_dwordx4 v[188:191], v8, s[8:11], s56 offen
  buffer_load_dwordx4 v[192:195], v8, s[8:11], s56 offen offset:16
  s_add_u32 s56, s44, 1
  v_readlane_b32 s41, v61, s56
  s_nop 0
  s_lshr_b32 s56, s41, 3
  s_lshl_b32 s57, s56, 7
  s_add_u32 s57, s57, 2623488
  s_add_u32 s56, s56, 1
  s_lshr_b32 s58, s41, 2
  s_cmp_lt_u32 s41, 8
  s_cselect_b32 s56, s58, s56
  s_cselect_b32 s58, 64, 32
  s_lshl_b32 s56, s56, 7
  s_add_u32 s56, s56, 2621440
  v_writelane_b32 v22, s57, 2
  v_writelane_b32 v22, s56, 3
  v_writelane_b32 v23, s58, 3
  s_or_b32 s42, s42, 12
  s_cmp_eq_u32 s47, 2
  s_cbranch_scc1 T_g
  s_waitcnt vmcnt(0)
  s_cmp_eq_u32 s47, 0
  s_cbranch_scc1 T_att
  s_mov_b32 s47, 2
T_loop:
  s_and_b32 s62, s42, 65280
  s_cbranch_scc0 fe_63
fw_62:
  s_mov_b64 exec, 0xff00
  buffer_load_dword v60, v22, s[4:7], 0 offen sc1
  s_mov_b64 exec, -1
  s_andn2_b32 s42, s42, 65280
  s_waitcnt vmcnt(0)
  v_cmp_lt_u32 vcc, v60, v23
  s_nop 0
  s_and_b32 s62, vcc_lo, 65280
  s_cbranch_scc0 fd_64
  s_sleep 1
  s_sub_u32 s94, s94, 1
  s_cbranch_scc0 fw_62
  s_mov_b32 s94, 0
fd_64:
fe_63:
  s_xor_b32 s51, s51, 0x10000
  v_xor_b32 v5, 0x10000, v5
  s_lshl_b32 s56, s32, 18
  s_add_u32 s56, s56, s53
  s_add_u32 m0, s51, 0
  s_add_u32 s57, s56, 0
  buffer_load_dwordx4 v1, s[4:7], s57 offen offset:0 sc1 lds
  buffer_load_dwordx4 v1, s[4:7], s57 offen offset:1024 sc1 lds
  buffer_load_dwordx4 v1, s[4:7], s57 offen offset:2048 sc1 lds
  buffer_load_dwordx4 v1, s[4:7], s57 offen offset:3072 sc1 lds
  s_add_u32 m0, s51, 16384
  s_add_u32 s57, s56, 32768
  buffer_load_dwordx4 v1, s[4:7], s57 offen offset:0 sc1 lds
  buffer_load_dwordx4 v1, s[4:7], s57 offen offset:1024 sc1 lds
  buffer_load_dwordx4 v1, s[4:7], s57 offen offset:2048 sc1 lds
  buffer_load_dwordx4 v1, s[4:7], s57 offen offset:3072 sc1 lds
  s_add_u32 m0, s51, 32768
  s_add_u32 s57, s56, 4096
  buffer_load_dwordx4 v1, s[4:7], s57 offen offset:0 sc1 lds
  buffer_load_dwordx4 v1, s[4:7], s57 offen offset:1024 sc1 lds
  buffer_load_dwordx4 v1, s[4:7], s57 offen offset:2048 sc1 lds
  buffer_load_dwordx4 v1, s[4:7], s57 offen offset:3072 sc1 lds
  s_add_u32 m0, s51, 49152
  s_add_u32 s57, s56, 36864
  buffer_load_dwordx4 v1, s[4:7], s57 offen offset:0 sc1 lds
  buffer_load_dwordx4 v1, s[4:7], s57 offen offset:1024 sc1 lds
  buffer_load_dwordx4 v1, s[4:7], s57 offen offset:2048 sc1 lds
  buffer_load_dwordx4 v1, s[4:7], s57 offen offset:3072 sc1 lds
  s_cmp_lt_u32 s41, 64
  s_cbranch_scc1 T_att
  s_waitcnt vmcnt(0)
  s_barrier
  s_mov_b64 exec, 1
  v_mov_b32 v9, s45
  buffer_store_dword v9, off, s[4:7], s49
  s_mov_b64 exec, -1
  s_mov_b32 s49, s48
  s_branch T_g
T_att:
  v_mfma_f32_16x16x32_bf16 v[144:147], v[80:83], v[64:67], v[12:15]
  v_lshlrev_b32 v212, 16, v188
  v_and_b32 v213, s34, v188
  v_mfma_f32_16x16x32_bf16 v[148:151], v[96:99], v[64:67], v[16:19]
  v_lshlrev_b32 v214, 16, v189
  v_and_b32 v215, s34, v189
  v_mfma_f32_16x16x32_bf16 v[144:147], v[84:87], v[68:71], v[144:147]
  v_lshlrev_b32 v216, 16, v190
  v_and_b32 v217, s34, v190
  v_mfma_f32_16x16x32_bf16 v[148:151], v[100:103], v[68:71], v[148:151]
  v_lshlrev_b32 v218, 16, v191
  v_and_b32 v219, s34, v191
  v_mfma_f32_16x16x32_bf16 v[144:147], v[88:91], v[72:75], v[144:147]
  v_lshlrev_b32 v220, 16, v192
  v_and_b32 v221, s34, v192
  v_mfma_f32_16x16x32_bf16 v[148:151], v[104:107], v[72:75], v[148:151]
  v_lshlrev_b32 v222, 16, v193
  v_and_b32 v223, s34, v193
  v_mfma_f32_16x16x32_bf16 v[144:147], v[92:95], v[76:79], v[144:147]
  v_lshlrev_b32 v224, 16, v194
  v_and_b32 v225, s34, v194
  v_mfma_f32_16x16x32_bf16 v[148:151], v[108:111], v[76:79], v[148:151]
  v_lshlrev_b32 v226, 16, v195
  v_and_b32 v227, s34, v195
  v_mul_f32 v174, v212, v28
  v_mul_f32 v175, v213, v29
  v_fmac_f32 v174, v214, v30
  v_fmac_f32 v175, v215, v31
  v_fmac_f32 v174, v216, v32
  v_fmac_f32 v175, v217, v33
  v_fmac_f32 v174, v218, v34
  v_fmac_f32 v175, v219, v35
  v_fmac_f32 v174, v220, v36
  v_fmac_f32 v175, v221, v37
  v_fmac_f32 v174, v222, v38
  v_fmac_f32 v175, v223, v39
  v_fmac_f32 v174, v224, v40
  v_fmac_f32 v175, v225, v41
  v_fmac_f32 v174, v226, v42
  v_fmac_f32 v175, v227, v43
  v_add_f32 v174, v174, v175
  v_max3_f32 v172, v144, v145, v146
  v_max3_f32 v173, v147, v148, v149
  v_max3_f32 v172, v172, v150, v151
  v_max_f32 v172, v172, v173
  v_mov_b32 v164, 0
  v_mov_b32 v161, 0
  s_or_b32 s42, s42, s46
  s_and_b32 s62, s42, 3
  s_cbranch_scc0 fe_69
fw_68:
  s_mov_b64 exec, 0x3
  buffer_load_dword v60, v22, s[4:7], 0 offen sc1
  s_mov_b64 exec, -1
  s_andn2_b32 s42, s42, 3
  s_waitcnt vmcnt(0)
  v_cmp_lt_u32 vcc, v60, v23
  s_nop 0
  s_and_b32 s62, vcc_lo, 3
  s_cbranch_scc0 fd_70
  s_sleep 1
  s_sub_u32 s94, s94, 1
  s_cbranch_scc0 fw_68
  s_mov_b32 s94, 0
fd_70:
  s_lshl_b32 s60, s37, 5
  s_add_u32 s60, s60, s29
  s_lshl_b32 s60, s60, 13
  s_add_u32 s60, s60, 8388608
  s_lshl_b32 s61, s30, 10
  s_add_u32 s61, s61, s60
  s_add_u32 s62, s61, 4096
  buffer_load_dwordx2 v[184:185], v1, s[4:7], s61 offen offset:8
  buffer_load_dwordx2 v[186:187], v1, s[4:7], s62 offen offset:8
  s_lshl_b32 s61, s36, 11
  s_add_u32 s61, s61, s60
  s_add_u32 s62, s61, 4096
  buffer_load_dwordx2 v[176:177], v1, s[4:7], s61 offen offset:0
  buffer_load_dwordx2 v[178:179], v1, s[4:7], s62 offen offset:0
  buffer_load_dwordx2 v[180:181], v1, s[4:7], s61 offen offset:1024
  buffer_load_dwordx2 v[182:183], v1, s[4:7], s62 offen offset:1024
  s_waitcnt vmcnt(0)
fe_69:
  s_cmp_lg_u32 s37, 63
  s_cbranch_scc1 dq_66
dp_65:
  s_waitcnt vmcnt(0)
  v_max3_u32 v10, v184, v186, v176
  v_max3_u32 v11, v178, v180, v182
  v_max_u32 v10, v10, v11
  v_cmp_eq_u32 vcc, -1, v10
  s_nop 0
  s_cbranch_vccz dq_66
  s_lshl_b32 s60, s37, 5
  s_add_u32 s60, s60, s29
  s_lshl_b32 s60, s60, 13
  s_add_u32 s60, s60, 8388608
  s_lshl_b32 s61, s30, 10
  s_add_u32 s61, s61, s60
  s_add_u32 s62, s61, 4096
  buffer_load_dwordx2 v[184:185], v1, s[4:7], s61 offen offset:8 sc1
  buffer_load_dwordx2 v[186:187], v1, s[4:7], s62 offen offset:8 sc1
  s_lshl_b32 s61, s36, 11
  s_add_u32 s61, s61, s60
  s_add_u32 s62, s61, 4096
  buffer_load_dwordx2 v[176:177], v1, s[4:7], s61 offen offset:0 sc1
  buffer_load_dwordx2 v[178:179], v1, s[4:7], s62 offen offset:0 sc1
  buffer_load_dwordx2 v[180:181], v1, s[4:7], s61 offen offset:1024 sc1
  buffer_load_dwordx2 v[182:183], v1, s[4:7], s62 offen offset:1024 sc1
  s_sub_u32 s94, s94, 1
  s_cbranch_scc0 dp_65
  s_mov_b32 s94, 0
  s_waitcnt vmcnt(0)
dq_66:
  ds_write2_b32 v20, v184, v186 offset0:0 offset1:1
  ds_write2_b32 v20, v185, v187 offset0:128 offset1:129
  s_waitcnt vmcnt(16) lgkmcnt(0)
  s_barrier
  ds_read_b64_tr_b16 v[128:129], v21 offset:0
  ds_read_b64_tr_b16 v[130:131], v21 offset:512
  ds_read_b64_tr_b16 v[132:133], v21 offset:1024
  ds_read_b64_tr_b16 v[134:135], v21 offset:1536
  ds_read_b64_tr_b16 v[136:137], v21 offset:2048
  ds_read_b64_tr_b16 v[138:139], v21 offset:2560
  ds_read_b64_tr_b16 v[140:141], v21 offset:3072
  ds_read_b64_tr_b16 v[142:143], v21 offset:3584
  s_mov_b64 exec, 1
  v_mov_b32 v9, s45
  buffer_store_dword v9, off, s[4:7], s49
  s_mov_b64 exec, -1
  s_mov_b32 s49, s48
  v_add_f32_dpp v174, v174, v174 row_ror:8 row_mask:0xf bank_mask:0xf
  s_waitcnt lgkmcnt(6)
  v_mfma_f32_16x16x32_bf16 v[152:155], v[128:131], v[64:67], 0
  v_add_f32_dpp v174, v174, v174 row_ror:4 row_mask:0xf bank_mask:0xf
  s_waitcnt lgkmcnt(4)
  v_mfma_f32_16x16x32_bf16 v[152:155], v[132:135], v[68:71], v[152:155]
  v_add_f32_dpp v174, v174, v174 row_ror:2 row_mask:0xf bank_mask:0xf
  s_waitcnt lgkmcnt(2)
  v_mfma_f32_16x16x32_bf16 v[152:155], v[136:139], v[72:75], v[152:155]
  v_add_f32_dpp v174, v174, v174 row_ror:1 row_mask:0xf bank_mask:0xf
  s_waitcnt lgkmcnt(0)
  v_mfma_f32_16x16x32_bf16 v[152:155], v[140:143], v[76:79], v[152:155]
  v_mov_b32 v175, v174
  s_nop 1
  v_permlane16_swap_b32 v174, v175
  v_add_f32 v174, v174, v175
  v_mov_b32 v175, v174
  s_nop 1
  v_permlane32_swap_b32 v174, v175
  v_add_f32 v174, v174, v175
  v_add_f32 v152, v152, v154
  v_add_f32 v153, v153, v155
  v_max3_f32 v172, v172, v152, v153
  v_mov_b32 v173, v172
  s_nop 1
  v_permlane16_swap_b32 v172, v173
  v_max_f32 v172, v172, v173
  v_mov_b32 v173, v172
  s_nop 1
  v_permlane32_swap_b32 v172, v173
  v_max_f32 v172, v172, v173
  v_mul_f32 v172, s33, v172
  v_fma_f32 v144, v144, s33, -v172
  v_fma_f32 v145, v145, s33, -v172
  v_fma_f32 v146, v146, s33, -v172
  v_fma_f32 v147, v147, s33, -v172
  v_fma_f32 v148, v148, s33, -v172
  v_fma_f32 v149, v149, s33, -v172
  v_fma_f32 v150, v150, s33, -v172
  v_fma_f32 v151, v151, s33, -v172
  v_fma_f32 v152, v152, s33, -v172
  v_fma_f32 v153, v153, s33, -v172
  v_exp_f32 v144, v144
  v_exp_f32 v145, v145
  v_exp_f32 v146, v146
  v_exp_f32 v147, v147
  v_exp_f32 v148, v148
  v_exp_f32 v149, v149
  v_exp_f32 v150, v150
  v_exp_f32 v151, v151
  v_exp_f32 v152, v152
  v_exp_f32 v153, v153
  v_cvt_pk_bf16_f32 v156, v144, v145
  v_cvt_pk_bf16_f32 v157, v146, v147
  v_cvt_pk_bf16_f32 v158, v148, v149
  v_cvt_pk_bf16_f32 v159, v150, v151
  v_cvt_pk_bf16_f32 v160, v152, v153
  v_mov_b32 v165, v160
  v_mfma_f32_16x16x32_bf16 v[168:171], v[24:27], v[156:159], 0
  v_mov_b64 v[162:163], v[160:161]
  v_mov_b64 v[166:167], v[164:165]
  v_mfma_f32_16x16x32_bf16 v[196:199], v[112:115], v[156:159], 0
  v_mul_f32 v174, 0xbfb8aa3b, v174
  v_mfma_f32_16x16x32_bf16 v[196:199], v[176:179], v[160:163], v[196:199]
  v_exp_f32 v174, v174
  v_mfma_f32_16x16x32_bf16 v[200:203], v[116:119], v[156:159], 0
  v_mfma_f32_16x16x16_bf16 v[168:171], v[24:25], v[160:161], v[168:171]
  v_add_f32 v174, 1.0, v174
  v_mfma_f32_16x16x32_bf16 v[200:203], v[176:179], v[164:167], v[200:203]
  v_rcp_f32 v174, v174
  v_mfma_f32_16x16x32_bf16 v[204:207], v[120:123], v[156:159], 0
  v_mfma_f32_16x16x32_bf16 v[204:207], v[180:183], v[160:163], v[204:207]
  v_mfma_f32_16x16x32_bf16 v[208:211], v[124:127], v[156:159], 0
  v_mfma_f32_16x16x32_bf16 v[208:211], v[180:183], v[164:167], v[208:211]
  s_lshl_b32 s56, s37, 5
  s_add_u32 s56, s56, s29
  s_lshl_b32 s56, s56, 2
  s_add_u32 s56, s56, s38
  v_rcp_f32 v172, v168
  s_lshl_b32 s58, s37, 18
  s_add_u32 s58, s58, s40
  s_mov_b32 s43, s39
  v_mul_f32 v196, v172, v196
  v_mul_f32 v197, v172, v197
  v_mul_f32 v198, v172, v198
  v_mul_f32 v199, v172, v199
  v_mul_f32 v200, v172, v200
  v_mul_f32 v201, v172, v201
  v_mul_f32 v202, v172, v202
  v_mul_f32 v203, v172, v203
  v_cvt_pk_bf16_f32 v144, v196, v197
  v_cvt_pk_bf16_f32 v145, v198, v199
  v_cvt_pk_bf16_f32 v146, v200, v201
  v_cvt_pk_bf16_f32 v147, v202, v203
  s_cmp_eq_u32 s47, 3
  s_cselect_b32 s59, -1, s37
  s_cmp_ge_i32 s59, 40
  s_cbranch_scc1 o1_71
  buffer_store_dwordx4 v[144:147], v1, s[4:7], s58 offen offset:0
  s_branch o2_72
o1_71:
  buffer_store_dwordx4 v[144:147], v1, s[4:7], s58 offen offset:0 sc1
o2_72:
  v_mul_f32 v204, v172, v204
  v_mul_f32 v205, v172, v205
  v_mul_f32 v206, v172, v206
  v_mul_f32 v207, v172, v207
  v_mul_f32 v208, v172, v208
  v_mul_f32 v209, v172, v209
  v_mul_f32 v210, v172, v210
  v_mul_f32 v211, v172, v211
  v_cvt_pk_bf16_f32 v148, v204, v205
  v_cvt_pk_bf16_f32 v149, v206, v207
  v_cvt_pk_bf16_f32 v150, v208, v209
  v_cvt_pk_bf16_f32 v151, v210, v211
  s_cmp_eq_u32 s47, 3
  s_cselect_b32 s59, -1, s37
  s_cmp_ge_i32 s59, 40
  s_cbranch_scc1 o1_73
  buffer_store_dwordx4 v[148:151], v1, s[4:7], s58 offen offset:1024
  s_mov_b64 exec, 1
  buffer_store_dword v174, off, s[4:7], s56
  s_mov_b64 exec, -1
  s_branch o2_74
o1_73:
  buffer_store_dwordx4 v[148:151], v1, s[4:7], s58 offen offset:1024 sc1
  s_mov_b64 exec, 1
  buffer_store_dword v174, off, s[4:7], s56 sc1
  s_mov_b64 exec, -1
o2_74:
  s_add_u32 s44, s44, 1
  s_mov_b32 s37, s41
  s_mov_b32 s46, 3
  s_add_u32 s56, s37, 1
  s_min_u32 s56, s56, 63
  v_writelane_b32 v23, s56, 0
  v_writelane_b32 v23, s56, 1
  s_or_b32 s42, s42, 3
  s_cmp_eq_u32 s47, 2
  s_cbranch_scc1 T_pre
  s_waitcnt vmcnt(0)
  s_barrier
  s_mov_b64 exec, 1
  v_mov_b32 v9, s44
  buffer_store_dword v9, off, s[4:7], s43
  s_mov_b64 exec, -1
  s_mov_b32 s43, s48
  s_add_u32 s47, s47, 1
  s_cmp_eq_u32 s47, 1
  s_cbranch_scc1 T_pre
T_last:
  s_and_b32 s62, s42, 65280
  s_cbranch_scc0 fe_76
fw_75:
  s_mov_b64 exec, 0xff00
  buffer_load_dword v60, v22, s[4:7], 0 offen sc1
  s_mov_b64 exec, -1
  s_andn2_b32 s42, s42, 65280
  s_waitcnt vmcnt(0)
  v_cmp_lt_u32 vcc, v60, v23
  s_nop 0
  s_and_b32 s62, vcc_lo, 65280
  s_cbranch_scc0 fd_77
  s_sleep 1
  s_sub_u32 s94, s94, 1
  s_cbranch_scc0 fw_75
  s_mov_b32 s94, 0
fd_77:
fe_76:
  s_xor_b32 s51, s51, 0x10000
  v_xor_b32 v5, 0x10000, v5
  s_lshl_b32 s56, s32, 18
  s_add_u32 s56, s56, s53
  s_add_u32 m0, s51, 0
  s_add_u32 s57, s56, 0
  buffer_load_dwordx4 v1, s[4:7], s57 offen offset:0 sc1 lds
  buffer_load_dwordx4 v1, s[4:7], s57 offen offset:1024 sc1 lds
  buffer_load_dwordx4 v1, s[4:7], s57 offen offset:2048 sc1 lds
  buffer_load_dwordx4 v1, s[4:7], s57 offen offset:3072 sc1 lds
  s_add_u32 m0, s51, 16384
  s_add_u32 s57, s56, 32768
  buffer_load_dwordx4 v1, s[4:7], s57 offen offset:0 sc1 lds
  buffer_load_dwordx4 v1, s[4:7], s57 offen offset:1024 sc1 lds
  buffer_load_dwordx4 v1, s[4:7], s57 offen offset:2048 sc1 lds
  buffer_load_dwordx4 v1, s[4:7], s57 offen offset:3072 sc1 lds
  s_add_u32 m0, s51, 32768
  s_add_u32 s57, s56, 4096
  buffer_load_dwordx4 v1, s[4:7], s57 offen offset:0 sc1 lds
  buffer_load_dwordx4 v1, s[4:7], s57 offen offset:1024 sc1 lds
  buffer_load_dwordx4 v1, s[4:7], s57 offen offset:2048 sc1 lds
  buffer_load_dwordx4 v1, s[4:7], s57 offen offset:3072 sc1 lds
  s_add_u32 m0, s51, 49152
  s_add_u32 s57, s56, 36864
  buffer_load_dwordx4 v1, s[4:7], s57 offen offset:0 sc1 lds
  buffer_load_dwordx4 v1, s[4:7], s57 offen offset:1024 sc1 lds
  buffer_load_dwordx4 v1, s[4:7], s57 offen offset:2048 sc1 lds
  buffer_load_dwordx4 v1, s[4:7], s57 offen offset:3072 sc1 lds
  s_lshl_b32 s63, s32, 18
  s_add_u32 s63, s63, s52
  s_mov_b32 s49, s54
  s_mov_b32 s55, s32
  s_add_u32 s45, s45, 1
  s_waitcnt vmcnt(12)
  s_barrier
  ds_read_b128 v[128:131], v5 offset:0
  ds_read_b128 v[132:135], v5 offset:1024
  ds_read_b128 v[136:139], v5 offset:2048
  ds_read_b128 v[140:143], v5 offset:3072
  ds_read_b128 v[144:147], v5 offset:4096
  ds_read_b128 v[148:151], v5 offset:5120
  s_waitcnt lgkmcnt(5)
  v_mfma_f32_16x16x32_bf16 v[44:47], a[0:3], v[128:131], 0
  v_mfma_f32_16x16x32_bf16 v[48:51], a[4:7], v[128:131], 0
  ds_read_b128 v[152:155], v5 offset:6144
  s_waitcnt lgkmcnt(5)
  v_mfma_f32_16x16x32_bf16 v[44:47], a[8:11], v[132:135], v[44:47]
  v_mfma_f32_16x16x32_bf16 v[48:51], a[12:15], v[132:135], v[48:51]
  ds_read_b128 v[156:159], v5 offset:7168
  s_waitcnt lgkmcnt(5)
  v_mfma_f32_16x16x32_bf16 v[44:47], a[16:19], v[136:139], v[44:47]
  v_mfma_f32_16x16x32_bf16 v[48:51], a[20:23], v[136:139], v[48:51]
  ds_read_b128 v[128:131], v5 offset:8192
  s_waitcnt lgkmcnt(5)
  v_mfma_f32_16x16x32_bf16 v[44:47], a[24:27], v[140:143], v[44:47]
  v_mfma_f32_16x16x32_bf16 v[48:51], a[28:31], v[140:143], v[48:51]
  ds_read_b128 v[132:135], v5 offset:9216
  s_waitcnt lgkmcnt(5)
  v_mfma_f32_16x16x32_bf16 v[44:47], a[32:35], v[144:147], v[44:47]
  v_mfma_f32_16x16x32_bf16 v[48:51], a[36:39], v[144:147], v[48:51]
  ds_read_b128 v[136:139], v5 offset:10240
  s_waitcnt lgkmcnt(5)
  v_mfma_f32_16x16x32_bf16 v[44:47], a[40:43], v[148:151], v[44:47]
  v_mfma_f32_16x16x32_bf16 v[48:51], a[44:47], v[148:151], v[48:51]
  ds_read_b128 v[140:143], v5 offset:11264
  s_waitcnt lgkmcnt(5)
  v_mfma_f32_16x16x32_bf16 v[44:47], a[48:51], v[152:155], v[44:47]
  v_mfma_f32_16x16x32_bf16 v[48:51], a[52:55], v[152:155], v[48:51]
  ds_read_b128 v[144:147], v5 offset:12288
  s_waitcnt lgkmcnt(5)
  v_mfma_f32_16x16x32_bf16 v[44:47], a[56:59], v[156:159], v[44:47]
  v_mfma_f32_16x16x32_bf16 v[48:51], a[60:63], v[156:159], v[48:51]
  ds_read_b128 v[148:151], v5 offset:13312
  s_waitcnt lgkmcnt(5)
  v_mfma_f32_16x16x32_bf16 v[44:47], a[64:67], v[128:131], v[44:47]
  v_mfma_f32_16x16x32_bf16 v[48:51], a[68:71], v[128:131], v[48:51]
  ds_read_b128 v[152:155], v5 offset:14336
  s_waitcnt lgkmcnt(5)
  v_mfma_f32_16x16x32_bf16 v[44:47], a[72:75], v[132:135], v[44:47]
  v_mfma_f32_16x16x32_bf16 v[48:51], a[76:79], v[132:135], v[48:51]
  ds_read_b128 v[156:159], v5 offset:15360
  s_waitcnt lgkmcnt(5)
  v_mfma_f32_16x16x32_bf16 v[44:47], a[80:83], v[136:139], v[44:47]
  v_mfma_f32_16x16x32_bf16 v[48:51], a[84:87], v[136:139], v[48:51]
  s_waitcnt vmcnt(8)
  s_barrier
  ds_read_b128 v[128:131], v5 offset:16384
  s_waitcnt lgkmcnt(5)
  v_mfma_f32_16x16x32_bf16 v[44:47], a[88:91], v[140:143], v[44:47]
  v_mfma_f32_16x16x32_bf16 v[48:51], a[92:95], v[140:143], v[48:51]
  ds_read_b128 v[132:135], v5 offset:17408
  s_waitcnt lgkmcnt(5)
  v_mfma_f32_16x16x32_bf16 v[44:47], a[96:99], v[144:147], v[44:47]
  v_mfma_f32_16x16x32_bf16 v[48:51], a[100:103], v[144:147], v[48:51]
  ds_read_b128 v[136:139], v5 offset:18432
  s_waitcnt lgkmcnt(5)
  v_mfma_f32_16x16x32_bf16 v[44:47], a[104:107], v[148:151], v[44:47]
  v_mfma_f32_16x16x32_bf16 v[48:51], a[108:111], v[148:151], v[48:51]
  ds_read_b128 v[140:143], v5 offset:19456
  s_waitcnt lgkmcnt(5)
  v_mfma_f32_16x16x32_bf16 v[44:47], a[112:115], v[152:155], v[44:47]
  v_mfma_f32_16x16x32_bf16 v[48:51], a[116:119], v[152:155], v[48:51]
  ds_read_b128 v[144:147], v5 offset:20480
  s_waitcnt lgkmcnt(5)
  v_mfma_f32_16x16x32_bf16 v[44:47], a[120:123], v[156:159], v[44:47]
  v_mfma_f32_16x16x32_bf16 v[48:51], a[124:127], v[156:159], v[48:51]
  ds_read_b128 v[148:151], v5 offset:21504
  s_waitcnt lgkmcnt(5)
  v_mfma_f32_16x16x32_bf16 v[44:47], a[128:131], v[128:131], v[44:47]
  v_mfma_f32_16x16x32_bf16 v[48:51], a[132:135], v[128:131], v[48:51]
  ds_read_b128 v[152:155], v5 offset:22528
  s_waitcnt lgkmcnt(5)
  v_mfma_f32_16x16x32_bf16 v[44:47], a[136:139], v[132:135], v[44:47]
  v_mfma_f32_16x16x32_bf16 v[48:51], a[140:143], v[132:135], v[48:51]
  ds_read_b128 v[156:159], v5 offset:23552
  s_waitcnt lgkmcnt(5)
  v_mfma_f32_16x16x32_bf16 v[44:47], a[144:147], v[136:139], v[44:47]
  v_mfma_f32_16x16x32_bf16 v[48:51], a[148:151], v[136:139], v[48:51]
  ds_read_b128 v[128:131], v5 offset:24576
  s_waitcnt lgkmcnt(5)
  v_mfma_f32_16x16x32_bf16 v[44:47], a[152:155], v[140:143], v[44:47]
  v_mfma_f32_16x16x32_bf16 v[48:51], a[156:159], v[140:143], v[48:51]
  ds_read_b128 v[132:135], v5 offset:25600
  s_waitcnt lgkmcnt(5)
  v_mfma_f32_16x16x32_bf16 v[44:47], a[160:163], v[144:147], v[44:47]
  v_mfma_f32_16x16x32_bf16 v[48:51], a[164:167], v[144:147], v[48:51]
  ds_read_b128 v[136:139], v5 offset:26624
  s_waitcnt lgkmcnt(5)
  v_mfma_f32_16x16x32_bf16 v[44:47], a[168:171], v[148:151], v[44:47]
  v_mfma_f32_16x16x32_bf16 v[48:51], a[172:175], v[148:151], v[48:51]
  ds_read_b128 v[140:143], v5 offset:27648
  s_waitcnt lgkmcnt(5)
  v_mfma_f32_16x16x32_bf16 v[44:47], a[176:179], v[152:155], v[44:47]
  v_mfma_f32_16x16x32_bf16 v[48:51], a[180:183], v[152:155], v[48:51]
  ds_read_b128 v[144:147], v5 offset:28672
  s_waitcnt lgkmcnt(5)
  v_mfma_f32_16x16x32_bf16 v[44:47], a[184:187], v[156:159], v[44:47]
  v_mfma_f32_16x16x32_bf16 v[48:51], a[188:191], v[156:159], v[48:51]
  ds_read_b128 v[148:151], v5 offset:29696
  s_waitcnt lgkmcnt(5)
  v_mfma_f32_16x16x32_bf16 v[44:47], a[192:195], v[128:131], v[44:47]
  v_mfma_f32_16x16x32_bf16 v[48:51], a[196:199], v[128:131], v[48:51]
  ds_read_b128 v[152:155], v5 offset:30720
  s_waitcnt lgkmcnt(5)
  v_mfma_f32_16x16x32_bf16 v[44:47], a[200:203], v[132:135], v[44:47]
  v_mfma_f32_16x16x32_bf16 v[48:51], a[204:207], v[132:135], v[48:51]
  ds_read_b128 v[156:159], v5 offset:31744
  s_waitcnt lgkmcnt(5)
  v_mfma_f32_16x16x32_bf16 v[44:47], a[208:211], v[136:139], v[44:47]
  v_mfma_f32_16x16x32_bf16 v[48:51], a[212:215], v[136:139], v[48:51]
  s_waitcnt vmcnt(4)
  s_barrier
  ds_read_b128 v[128:131], v5 offset:32768
  s_waitcnt lgkmcnt(5)
  v_mfma_f32_16x16x32_bf16 v[44:47], a[216:219], v[140:143], v[44:47]
  v_mfma_f32_16x16x32_bf16 v[48:51], a[220:223], v[140:143], v[48:51]
  ds_read_b128 v[132:135], v5 offset:33792
  s_waitcnt lgkmcnt(5)
  v_mfma_f32_16x16x32_bf16 v[44:47], a[224:227], v[144:147], v[44:47]
  v_mfma_f32_16x16x32_bf16 v[48:51], a[228:231], v[144:147], v[48:51]
  ds_read_b128 v[136:139], v5 offset:34816
  s_waitcnt lgkmcnt(5)
  v_mfma_f32_16x16x32_bf16 v[44:47], a[232:235], v[148:151], v[44:47]
  v_mfma_f32_16x16x32_bf16 v[48:51], a[236:239], v[148:151], v[48:51]
  ds_read_b128 v[140:143], v5 offset:35840
  s_waitcnt lgkmcnt(5)
  v_mfma_f32_16x16x32_bf16 v[44:47], a[240:243], v[152:155], v[44:47]
  v_mfma_f32_16x16x32_bf16 v[48:51], a[244:247], v[152:155], v[48:51]
  ds_read_b128 v[144:147], v5 offset:36864
  s_waitcnt lgkmcnt(5)
  v_mfma_f32_16x16x32_bf16 v[44:47], a[248:251], v[156:159], v[44:47]
  v_mfma_f32_16x16x32_bf16 v[48:51], a[252:255], v[156:159], v[48:51]
  ds_read_b128 v[148:151], v5 offset:37888
  s_waitcnt lgkmcnt(5)
  v_mfma_f32_16x16x32_bf16 v[52:55], a[0:3], v[128:131], 0
  v_mfma_f32_16x16x32_bf16 v[56:59], a[4:7], v[128:131], 0
  ds_read_b128 v[152:155], v5 offset:38912
  s_waitcnt lgkmcnt(5)
  v_mfma_f32_16x16x32_bf16 v[52:55], a[8:11], v[132:135], v[52:55]
  v_mfma_f32_16x16x32_bf16 v[56:59], a[12:15], v[132:135], v[56:59]
  ds_read_b128 v[156:159], v5 offset:39936
  s_waitcnt lgkmcnt(5)
  v_mfma_f32_16x16x32_bf16 v[52:55], a[16:19], v[136:139], v[52:55]
  v_mfma_f32_16x16x32_bf16 v[56:59], a[20:23], v[136:139], v[56:59]
  ds_read_b128 v[128:131], v5 offset:40960
  s_waitcnt lgkmcnt(5)
  v_mfma_f32_16x16x32_bf16 v[52:55], a[24:27], v[140:143], v[52:55]
  v_mfma_f32_16x16x32_bf16 v[56:59], a[28:31], v[140:143], v[56:59]
  ds_read_b128 v[132:135], v5 offset:41984
  s_waitcnt lgkmcnt(5)
  v_mfma_f32_16x16x32_bf16 v[52:55], a[32:35], v[144:147], v[52:55]
  v_mfma_f32_16x16x32_bf16 v[56:59], a[36:39], v[144:147], v[56:59]
  ds_read_b128 v[136:139], v5 offset:43008
  s_waitcnt lgkmcnt(5)
  v_mfma_f32_16x16x32_bf16 v[52:55], a[40:43], v[148:151], v[52:55]
  v_mfma_f32_16x16x32_bf16 v[56:59], a[44:47], v[148:151], v[56:59]
  ds_read_b128 v[140:143], v5 offset:44032
  s_waitcnt lgkmcnt(5)
  v_mfma_f32_16x16x32_bf16 v[52:55], a[48:51], v[152:155], v[52:55]
  v_mfma_f32_16x16x32_bf16 v[56:59], a[52:55], v[152:155], v[56:59]
  ds_read_b128 v[144:147], v5 offset:45056
  s_waitcnt lgkmcnt(5)
  v_mfma_f32_16x16x32_bf16 v[52:55], a[56:59], v[156:159], v[52:55]
  v_mfma_f32_16x16x32_bf16 v[56:59], a[60:63], v[156:159], v[56:59]
  ds_read_b128 v[148:151], v5 offset:46080
  s_waitcnt lgkmcnt(5)
  v_mfma_f32_16x16x32_bf16 v[52:55], a[64:67], v[128:131], v[52:55]
  v_mfma_f32_16x16x32_bf16 v[56:59], a[68:71], v[128:131], v[56:59]
  ds_read_b128 v[152:155], v5 offset:47104
  s_waitcnt lgkmcnt(5)
  v_mfma_f32_16x16x32_bf16 v[52:55], a[72:75], v[132:135], v[52:55]
  v_mfma_f32_16x16x32_bf16 v[56:59], a[76:79], v[132:135], v[56:59]
  ds_read_b128 v[156:159], v5 offset:48128
  s_waitcnt lgkmcnt(5)
  v_mfma_f32_16x16x32_bf16 v[52:55], a[80:83], v[136:139], v[52:55]
  v_mfma_f32_16x16x32_bf16 v[56:59], a[84:87], v[136:139], v[56:59]
  s_waitcnt vmcnt(0)
  s_barrier
  ds_read_b128 v[128:131], v5 offset:49152
  s_waitcnt lgkmcnt(5)
  v_mfma_f32_16x16x32_bf16 v[52:55], a[88:91], v[140:143], v[52:55]
  v_mfma_f32_16x16x32_bf16 v[56:59], a[92:95], v[140:143], v[56:59]
  ds_read_b128 v[132:135], v5 offset:50176
  s_waitcnt lgkmcnt(5)
  v_mfma_f32_16x16x32_bf16 v[52:55], a[96:99], v[144:147], v[52:55]
  v_mfma_f32_16x16x32_bf16 v[56:59], a[100:103], v[144:147], v[56:59]
  v_cvt_pk_bf16_f32 v160, v44, v45
  v_cvt_pk_bf16_f32 v161, v46, v47
  v_cvt_pk_bf16_f32 v162, v48, v49
  v_cvt_pk_bf16_f32 v163, v50, v51
  buffer_store_dwordx4 v[160:163], v1, s[4:7], s63 offen offset:0
  ds_read_b128 v[136:139], v5 offset:51200
  s_waitcnt lgkmcnt(5)
  v_mfma_f32_16x16x32_bf16 v[52:55], a[104:107], v[148:151], v[52:55]
  v_mfma_f32_16x16x32_bf16 v[56:59], a[108:111], v[148:151], v[56:59]
  ds_read_b128 v[140:143], v5 offset:52224
  s_waitcnt lgkmcnt(5)
  v_mfma_f32_16x16x32_bf16 v[52:55], a[112:115], v[152:155], v[52:55]
  v_mfma_f32_16x16x32_bf16 v[56:59], a[116:119], v[152:155], v[56:59]
  ds_read_b128 v[144:147], v5 offset:53248
  s_waitcnt lgkmcnt(5)
  v_mfma_f32_16x16x32_bf16 v[52:55], a[120:123], v[156:159], v[52:55]
  v_mfma_f32_16x16x32_bf16 v[56:59], a[124:127], v[156:159], v[56:59]
  ds_read_b128 v[148:151], v5 offset:54272
  s_waitcnt lgkmcnt(5)
  v_mfma_f32_16x16x32_bf16 v[52:55], a[128:131], v[128:131], v[52:55]
  v_mfma_f32_16x16x32_bf16 v[56:59], a[132:135], v[128:131], v[56:59]
  ds_read_b128 v[152:155], v5 offset:55296
  s_waitcnt lgkmcnt(5)
  v_mfma_f32_16x16x32_bf16 v[52:55], a[136:139], v[132:135], v[52:55]
  v_mfma_f32_16x16x32_bf16 v[56:59], a[140:143], v[132:135], v[56:59]
  ds_read_b128 v[156:159], v5 offset:56320
  s_waitcnt lgkmcnt(5)
  v_mfma_f32_16x16x32_bf16 v[52:55], a[144:147], v[136:139], v[52:55]
  v_mfma_f32_16x16x32_bf16 v[56:59], a[148:151], v[136:139], v[56:59]
  ds_read_b128 v[128:131], v5 offset:57344
  s_waitcnt lgkmcnt(5)
  v_mfma_f32_16x16x32_bf16 v[52:55], a[152:155], v[140:143], v[52:55]
  v_mfma_f32_16x16x32_bf16 v[56:59], a[156:159], v[140:143], v[56:59]
  ds_read_b128 v[132:135], v5 offset:58368
  s_waitcnt lgkmcnt(5)
  v_mfma_f32_16x16x32_bf16 v[52:55], a[160:163], v[144:147], v[52:55]
  v_mfma_f32_16x16x32_bf16 v[56:59], a[164:167], v[144:147], v[56:59]
  ds_read_b128 v[136:139], v5 offset:59392
  s_waitcnt lgkmcnt(5)
  v_mfma_f32_16x16x32_bf16 v[52:55], a[168:171], v[148:151], v[52:55]
  v_mfma_f32_16x16x32_bf16 v[56:59], a[172:175], v[148:151], v[56:59]
  ds_read_b128 v[140:143], v5 offset:60416
  s_waitcnt lgkmcnt(5)
  v_mfma_f32_16x16x32_bf16 v[52:55], a[176:179], v[152:155], v[52:55]
  v_mfma_f32_16x16x32_bf16 v[56:59], a[180:183], v[152:155], v[56:59]
  ds_read_b128 v[144:147], v5 offset:61440
  s_waitcnt lgkmcnt(5)
  v_mfma_f32_16x16x32_bf16 v[52:55], a[184:187], v[156:159], v[52:55]
  v_mfma_f32_16x16x32_bf16 v[56:59], a[188:191], v[156:159], v[56:59]
  ds_read_b128 v[148:151], v5 offset:62464
  s_waitcnt lgkmcnt(5)
  v_mfma_f32_16x16x32_bf16 v[52:55], a[192:195], v[128:131], v[52:55]
  v_mfma_f32_16x16x32_bf16 v[56:59], a[196:199], v[128:131], v[56:59]
  ds_read_b128 v[152:155], v5 offset:63488
  s_waitcnt lgkmcnt(5)
  v_mfma_f32_16x16x32_bf16 v[52:55], a[200:203], v[132:135], v[52:55]
  v_mfma_f32_16x16x32_bf16 v[56:59], a[204:207], v[132:135], v[56:59]
  ds_read_b128 v[156:159], v5 offset:64512
  s_waitcnt lgkmcnt(5)
  v_mfma_f32_16x16x32_bf16 v[52:55], a[208:211], v[136:139], v[52:55]
  v_mfma_f32_16x16x32_bf16 v[56:59], a[212:215], v[136:139], v[56:59]
  s_waitcnt lgkmcnt(4)
  v_mfma_f32_16x16x32_bf16 v[52:55], a[216:219], v[140:143], v[52:55]
  v_mfma_f32_16x16x32_bf16 v[56:59], a[220:223], v[140:143], v[56:59]
  s_waitcnt lgkmcnt(3)
  v_mfma_f32_16x16x32_bf16 v[52:55], a[224:227], v[144:147], v[52:55]
  v_mfma_f32_16x16x32_bf16 v[56:59], a[228:231], v[144:147], v[56:59]
  s_waitcnt lgkmcnt(2)
  v_mfma_f32_16x16x32_bf16 v[52:55], a[232:235], v[148:151], v[52:55]
  v_mfma_f32_16x16x32_bf16 v[56:59], a[236:239], v[148:151], v[56:59]
  s_waitcnt lgkmcnt(1)
  v_mfma_f32_16x16x32_bf16 v[52:55], a[240:243], v[152:155], v[52:55]
  v_mfma_f32_16x16x32_bf16 v[56:59], a[244:247], v[152:155], v[56:59]
  s_waitcnt lgkmcnt(0)
  v_mfma_f32_16x16x32_bf16 v[52:55], a[248:251], v[156:159], v[52:55]
  v_mfma_f32_16x16x32_bf16 v[56:59], a[252:255], v[156:159], v[56:59]
  s_nop 6
  v_cvt_pk_bf16_f32 v164, v52, v53
  v_cvt_pk_bf16_f32 v165, v54, v55
  v_cvt_pk_bf16_f32 v166, v56, v57
  v_cvt_pk_bf16_f32 v167, v58, v59
  buffer_store_dwordx4 v[164:167], v1, s[4:7], s63 offen offset:1024
  s_waitcnt vmcnt(0)
  s_barrier
  s_mov_b64 exec, 1
  v_mov_b32 v9, s45
  buffer_store_dword v9, off, s[4:7], s49
  s_mov_b64 exec, -1
  s_mov_b32 s49, s48
  s_and_b32 s62, s42, 983040
  s_cbranch_scc0 fe_79
fw_78:
  s_mov_b64 exec, 0xf0000
  buffer_load_dword v60, v22, s[4:7], 0 offen sc1
  s_mov_b64 exec, -1
  s_andn2_b32 s42, s42, 983040
  s_waitcnt vmcnt(0)
  v_cmp_lt_u32 vcc, v60, v23
  s_nop 0
  s_and_b32 s62, vcc_lo, 983040
  s_cbranch_scc0 fd_80
  s_sleep 1
  s_sub_u32 s94, s94, 1
  s_cbranch_scc0 fw_78
  s_mov_b32 s94, 0
fd_80:
fe_79:
  s_lshl_b32 s58, s50, 16
  s_lshl_b32 s59, s50, 7
  s_lshl_b32 s56, s50, 18
  s_min_u32 s56, s56, s48
  s_add_u32 s57, s56, 33554432
  buffer_load_dwordx2 v[236:237], v7, s[4:7], s57 offen sc1
  s_add_u32 s57, s56, 33619968
  buffer_load_dwordx2 v[238:239], v7, s[4:7], s57 offen sc1
  s_add_u32 s57, s56, 33685504
  buffer_load_dwordx2 v[240:241], v7, s[4:7], s57 offen sc1
  s_add_u32 s57, s56, 33751040
  buffer_load_dwordx2 v[242:243], v7, s[4:7], s57 offen sc1
  buffer_load_dword v244, v6, s[4:7], s59 offen sc1
  s_waitcnt vmcnt(0)
  v_lshlrev_b32 v128, 16, v228
  v_and_b32 v129, s34, v228
  v_lshlrev_b32 v130, 16, v229
  v_and_b32 v131, s34, v229
  v_lshlrev_b32 v132, 16, v230
  v_and_b32 v133, s34, v230
  v_lshlrev_b32 v134, 16, v231
  v_and_b32 v135, s34, v231
  v_lshlrev_b32 v136, 16, v232
  v_and_b32 v137, s34, v232
  v_lshlrev_b32 v138, 16, v233
  v_and_b32 v139, s34, v233
  v_lshlrev_b32 v140, 16, v234
  v_and_b32 v141, s34, v234
  v_lshlrev_b32 v142, 16, v235
  v_and_b32 v143, s34, v235
  v_lshlrev_b32 v144, 16, v236
  v_and_b32 v145, s34, v236
  v_lshlrev_b32 v146, 16, v237
  v_and_b32 v147, s34, v237
  v_lshlrev_b32 v148, 16, v238
  v_and_b32 v149, s34, v238
  v_lshlrev_b32 v150, 16, v239
  v_and_b32 v151, s34, v239
  v_lshlrev_b32 v152, 16, v240
  v_and_b32 v153, s34, v240
  v_lshlrev_b32 v154, 16, v241
  v_and_b32 v155, s34, v241
  v_lshlrev_b32 v156, 16, v242
  v_and_b32 v157, s34, v242
  v_lshlrev_b32 v158, 16, v243
  v_and_b32 v159, s34, v243
  v_add_f32 v128, v128, v132
  v_add_f32 v136, v136, v140
  v_add_f32 v129, v129, v133
  v_add_f32 v137, v137, v141
  v_add_f32 v130, v130, v134
  v_add_f32 v138, v138, v142
  v_add_f32 v131, v131, v135
  v_add_f32 v139, v139, v143
  v_add_f32 v128, v128, v136
  v_add_f32 v129, v129, v137
  v_add_f32 v130, v130, v138
  v_add_f32 v131, v131, v139
  v_add_f32 v144, v144, v148
  v_add_f32 v152, v152, v156
  v_add_f32 v145, v145, v149
  v_add_f32 v153, v153, v157
  v_add_f32 v146, v146, v150
  v_add_f32 v154, v154, v158
  v_add_f32 v147, v147, v151
  v_add_f32 v155, v155, v159
  v_add_f32 v144, v144, v152
  v_add_f32 v145, v145, v153
  v_add_f32 v146, v146, v154
  v_add_f32 v147, v147, v155
  v_sub_f32 v144, v144, v128
  v_sub_f32 v145, v145, v129
  v_sub_f32 v146, v146, v130
  v_sub_f32 v147, v147, v131
  v_fma_f32 v128, v144, v244, v128
  v_fma_f32 v129, v145, v244, v129
  v_fma_f32 v130, v146, v244, v130
  v_fma_f32 v131, v147, v244, v131
  v_cvt_pk_bf16_f32 v128, v128, v129
  v_cvt_pk_bf16_f32 v129, v130, v131
  buffer_store_dwordx2 v[128:129], v3, s[24:27], s58 offen
  s_branch T_end
T_g:
  s_lshl_b32 s63, s32, 18
  s_add_u32 s63, s63, s52
  s_mov_b32 s49, s54
  s_mov_b32 s55, s32
  s_add_u32 s45, s45, 1
  v_readlane_b32 s32, v61, s45
  s_mov_b64 exec, 65280
  v_add_u32 v23, 1, v23
  s_mov_b64 exec, -1
  s_or_b32 s42, s42, 65280
  s_waitcnt vmcnt(22)
  s_barrier
  ds_read_b128 v[128:131], v5 offset:0
  ds_read_b128 v[132:135], v5 offset:1024
  ds_read_b128 v[136:139], v5 offset:2048
  ds_read_b128 v[140:143], v5 offset:3072
  ds_read_b128 v[144:147], v5 offset:4096
  ds_read_b128 v[148:151], v5 offset:5120
  s_waitcnt lgkmcnt(5)
  v_mfma_f32_16x16x32_bf16 v[44:47], a[0:3], v[128:131], 0
  v_mfma_f32_16x16x32_bf16 v[48:51], a[4:7], v[128:131], 0
  ds_read_b128 v[152:155], v5 offset:6144
  s_waitcnt lgkmcnt(5)
  v_mfma_f32_16x16x32_bf16 v[44:47], a[8:11], v[132:135], v[44:47]
  v_mfma_f32_16x16x32_bf16 v[48:51], a[12:15], v[132:135], v[48:51]
  ds_read_b128 v[156:159], v5 offset:7168
  s_waitcnt lgkmcnt(5)
  v_mfma_f32_16x16x32_bf16 v[44:47], a[16:19], v[136:139], v[44:47]
  v_mfma_f32_16x16x32_bf16 v[48:51], a[20:23], v[136:139], v[48:51]
  ds_read_b128 v[128:131], v5 offset:8192
  s_waitcnt lgkmcnt(5)
  v_mfma_f32_16x16x32_bf16 v[44:47], a[24:27], v[140:143], v[44:47]
  v_mfma_f32_16x16x32_bf16 v[48:51], a[28:31], v[140:143], v[48:51]
  ds_read_b128 v[132:135], v5 offset:9216
  s_waitcnt lgkmcnt(5)
  v_mfma_f32_16x16x32_bf16 v[44:47], a[32:35], v[144:147], v[44:47]
  v_mfma_f32_16x16x32_bf16 v[48:51], a[36:39], v[144:147], v[48:51]
  ds_read_b128 v[136:139], v5 offset:10240
  s_waitcnt lgkmcnt(5)
  v_mfma_f32_16x16x32_bf16 v[44:47], a[40:43], v[148:151], v[44:47]
  v_mfma_f32_16x16x32_bf16 v[48:51], a[44:47], v[148:151], v[48:51]
  ds_read_b128 v[140:143], v5 offset:11264
  s_waitcnt lgkmcnt(5)
  v_mfma_f32_16x16x32_bf16 v[44:47], a[48:51], v[152:155], v[44:47]
  v_mfma_f32_16x16x32_bf16 v[48:51], a[52:55], v[152:155], v[48:51]
  ds_read_b128 v[144:147], v5 offset:12288
  s_waitcnt lgkmcnt(5)
  v_mfma_f32_16x16x32_bf16 v[44:47], a[56:59], v[156:159], v[44:47]
  v_mfma_f32_16x16x32_bf16 v[48:51], a[60:63], v[156:159], v[48:51]
  ds_read_b128 v[148:151], v5 offset:13312
  s_waitcnt lgkmcnt(5)
  v_mfma_f32_16x16x32_bf16 v[44:47], a[64:67], v[128:131], v[44:47]
  v_mfma_f32_16x16x32_bf16 v[48:51], a[68:71], v[128:131], v[48:51]
  ds_read_b128 v[152:155], v5 offset:14336
  s_waitcnt lgkmcnt(5)
  v_mfma_f32_16x16x32_bf16 v[44:47], a[72:75], v[132:135], v[44:47]
  v_mfma_f32_16x16x32_bf16 v[48:51], a[76:79], v[132:135], v[48:51]
  ds_read_b128 v[156:159], v5 offset:15360
  s_waitcnt lgkmcnt(5)
  v_mfma_f32_16x16x32_bf16 v[44:47], a[80:83], v[136:139], v[44:47]
  v_mfma_f32_16x16x32_bf16 v[48:51], a[84:87], v[136:139], v[48:51]
  s_waitcnt vmcnt(18)
  s_barrier
  s_mov_b64 exec, 1
  v_mov_b32 v9, s44
  buffer_store_dword v9, off, s[4:7], s43
  s_mov_b64 exec, -1
  s_mov_b32 s43, s48
  s_mov_b64 exec, 0xfff1f
  buffer_load_dword v60, v22, s[4:7], 0 offen sc1
  s_mov_b64 exec, -1
  ds_read_b128 v[128:131], v5 offset:16384
  s_waitcnt lgkmcnt(5)
  v_mfma_f32_16x16x32_bf16 v[44:47], a[88:91], v[140:143], v[44:47]
  v_mfma_f32_16x16x32_bf16 v[48:51], a[92:95], v[140:143], v[48:51]
  ds_read_b128 v[132:135], v5 offset:17408
  s_waitcnt lgkmcnt(5)
  v_mfma_f32_16x16x32_bf16 v[44:47], a[96:99], v[144:147], v[44:47]
  v_mfma_f32_16x16x32_bf16 v[48:51], a[100:103], v[144:147], v[48:51]
  ds_read_b128 v[136:139], v5 offset:18432
  s_waitcnt lgkmcnt(5)
  v_mfma_f32_16x16x32_bf16 v[44:47], a[104:107], v[148:151], v[44:47]
  v_mfma_f32_16x16x32_bf16 v[48:51], a[108:111], v[148:151], v[48:51]
  ds_read_b128 v[140:143], v5 offset:19456
  s_waitcnt lgkmcnt(5)
  v_mfma_f32_16x16x32_bf16 v[44:47], a[112:115], v[152:155], v[44:47]
  v_mfma_f32_16x16x32_bf16 v[48:51], a[116:119], v[152:155], v[48:51]
  ds_read_b128 v[144:147], v5 offset:20480
  s_waitcnt lgkmcnt(5)
  v_mfma_f32_16x16x32_bf16 v[44:47], a[120:123], v[156:159], v[44:47]
  v_mfma_f32_16x16x32_bf16 v[48:51], a[124:127], v[156:159], v[48:51]
  ds_read_b128 v[148:151], v5 offset:21504
  s_waitcnt lgkmcnt(5)
  v_mfma_f32_16x16x32_bf16 v[44:47], a[128:131], v[128:131], v[44:47]
  v_mfma_f32_16x16x32_bf16 v[48:51], a[132:135], v[128:131], v[48:51]
  ds_read_b128 v[152:155], v5 offset:22528
  s_waitcnt lgkmcnt(5)
  v_mfma_f32_16x16x32_bf16 v[44:47], a[136:139], v[132:135], v[44:47]
  v_mfma_f32_16x16x32_bf16 v[48:51], a[140:143], v[132:135], v[48:51]
  ds_read_b128 v[156:159], v5 offset:23552
  s_waitcnt lgkmcnt(5)
  v_mfma_f32_16x16x32_bf16 v[44:47], a[144:147], v[136:139], v[44:47]
  v_mfma_f32_16x16x32_bf16 v[48:51], a[148:151], v[136:139], v[48:51]
  ds_read_b128 v[128:131], v5 offset:24576
  s_waitcnt lgkmcnt(5)
  v_mfma_f32_16x16x32_bf16 v[44:47], a[152:155], v[140:143], v[44:47]
  v_mfma_f32_16x16x32_bf16 v[48:51], a[156:159], v[140:143], v[48:51]
  ds_read_b128 v[132:135], v5 offset:25600
  s_waitcnt lgkmcnt(5)
  v_mfma_f32_16x16x32_bf16 v[44:47], a[160:163], v[144:147], v[44:47]
  v_mfma_f32_16x16x32_bf16 v[48:51], a[164:167], v[144:147], v[48:51]
  ds_read_b128 v[136:139], v5 offset:26624
  s_waitcnt lgkmcnt(5)
  v_mfma_f32_16x16x32_bf16 v[44:47], a[168:171], v[148:151], v[44:47]
  v_mfma_f32_16x16x32_bf16 v[48:51], a[172:175], v[148:151], v[48:51]
  ds_read_b128 v[140:143], v5 offset:27648
  s_waitcnt lgkmcnt(5)
  v_mfma_f32_16x16x32_bf16 v[44:47], a[176:179], v[152:155], v[44:47]
  v_mfma_f32_16x16x32_bf16 v[48:51], a[180:183], v[152:155], v[48:51]
  ds_read_b128 v[144:147], v5 offset:28672
  s_waitcnt lgkmcnt(5)
  v_mfma_f32_16x16x32_bf16 v[44:47], a[184:187], v[156:159], v[44:47]
  v_mfma_f32_16x16x32_bf16 v[48:51], a[188:191], v[156:159], v[48:51]
  ds_read_b128 v[148:151], v5 offset:29696
  s_waitcnt lgkmcnt(5)
  v_mfma_f32_16x16x32_bf16 v[44:47], a[192:195], v[128:131], v[44:47]
  v_mfma_f32_16x16x32_bf16 v[48:51], a[196:199], v[128:131], v[48:51]
  ds_read_b128 v[152:155], v5 offset:30720
  s_waitcnt lgkmcnt(5)
  v_mfma_f32_16x16x32_bf16 v[44:47], a[200:203], v[132:135], v[44:47]
  v_mfma_f32_16x16x32_bf16 v[48:51], a[204:207], v[132:135], v[48:51]
  ds_read_b128 v[156:159], v5 offset:31744
  s_waitcnt lgkmcnt(5)
  v_mfma_f32_16x16x32_bf16 v[44:47], a[208:211], v[136:139], v[44:47]
  v_mfma_f32_16x16x32_bf16 v[48:51], a[212:215], v[136:139], v[48:51]
  ds_read_b128 v[128:131], v5 offset:32768
  s_waitcnt lgkmcnt(5)
  v_mfma_f32_16x16x32_bf16 v[44:47], a[216:219], v[140:143], v[44:47]
  v_mfma_f32_16x16x32_bf16 v[48:51], a[220:223], v[140:143], v[48:51]
  ds_read_b128 v[132:135], v5 offset:33792
  s_waitcnt lgkmcnt(5)
  v_mfma_f32_16x16x32_bf16 v[44:47], a[224:227], v[144:147], v[44:47]
  v_mfma_f32_16x16x32_bf16 v[48:51], a[228:231], v[144:147], v[48:51]
  ds_read_b128 v[136:139], v5 offset:34816
  s_waitcnt lgkmcnt(5)
  v_mfma_f32_16x16x32_bf16 v[44:47], a[232:235], v[148:151], v[44:47]
  v_mfma_f32_16x16x32_bf16 v[48:51], a[236:239], v[148:151], v[48:51]
  ds_read_b128 v[140:143], v5 offset:35840
  s_waitcnt lgkmcnt(5)
  v_mfma_f32_16x16x32_bf16 v[44:47], a[240:243], v[152:155], v[44:47]
  v_mfma_f32_16x16x32_bf16 v[48:51], a[244:247], v[152:155], v[48:51]
  ds_read_b128 v[144:147], v5 offset:36864
  s_waitcnt lgkmcnt(5)
  v_mfma_f32_16x16x32_bf16 v[44:47], a[248:251], v[156:159], v[44:47]
  v_mfma_f32_16x16x32_bf16 v[48:51], a[252:255], v[156:159], v[48:51]
  ds_read_b128 v[148:151], v5 offset:37888
  s_waitcnt lgkmcnt(5)
  v_mfma_f32_16x16x32_bf16 v[52:55], a[0:3], v[128:131], 0
  v_mfma_f32_16x16x32_bf16 v[56:59], a[4:7], v[128:131], 0
  ds_read_b128 v[152:155], v5 offset:38912
  s_waitcnt lgkmcnt(5)
  v_mfma_f32_16x16x32_bf16 v[52:55], a[8:11], v[132:135], v[52:55]
  v_mfma_f32_16x16x32_bf16 v[56:59], a[12:15], v[132:135], v[56:59]
  ds_read_b128 v[156:159], v5 offset:39936
  s_waitcnt lgkmcnt(5)
  v_mfma_f32_16x16x32_bf16 v[52:55], a[16:19], v[136:139], v[52:55]
  v_mfma_f32_16x16x32_bf16 v[56:59], a[20:23], v[136:139], v[56:59]
  s_waitcnt vmcnt(0)
  v_cmp_lt_u32 vcc, v60, v23
  s_nop 0
  s_mov_b32 s42, vcc_lo
  s_and_b32 s62, s42, 983056
  s_cbranch_scc0 fe_82
fw_81:
  s_mov_b64 exec, 0xf0010
  buffer_load_dword v60, v22, s[4:7], 0 offen sc1
  s_mov_b64 exec, -1
  s_andn2_b32 s42, s42, 983056
  s_waitcnt vmcnt(0)
  v_cmp_lt_u32 vcc, v60, v23
  s_nop 0
  s_and_b32 s62, vcc_lo, 983056
  s_cbranch_scc0 fd_83
  s_sleep 1
  s_sub_u32 s94, s94, 1
  s_cbranch_scc0 fw_81
  s_mov_b32 s94, 0
fd_83:
fe_82:
  s_lshl_b32 s58, s50, 16
  s_lshl_b32 s59, s50, 7
  s_lshl_b32 s56, s50, 18
  s_min_u32 s56, s56, s48
  s_add_u32 s57, s58, 117440512
  buffer_load_dwordx2 v[228:229], v7, s[4:7], s57 offen
  s_add_u32 s57, s58, 121634816
  buffer_load_dwordx2 v[230:231], v7, s[4:7], s57 offen
  s_add_u32 s57, s58, 125829120
  buffer_load_dwordx2 v[232:233], v7, s[4:7], s57 offen
  s_add_u32 s57, s58, 130023424
  buffer_load_dwordx2 v[234:235], v7, s[4:7], s57 offen
  s_add_u32 s57, s56, 33554432
  buffer_load_dwordx2 v[236:237], v7, s[4:7], s57 offen sc1
  s_add_u32 s57, s56, 33619968
  buffer_load_dwordx2 v[238:239], v7, s[4:7], s57 offen sc1
  s_add_u32 s57, s56, 33685504
  buffer_load_dwordx2 v[240:241], v7, s[4:7], s57 offen sc1
  s_add_u32 s57, s56, 33751040
  buffer_load_dwordx2 v[242:243], v7, s[4:7], s57 offen sc1
  buffer_load_dword v244, v6, s[4:7], s59 offen sc1
  s_lshl_b32 s60, s37, 5
  s_add_u32 s60, s60, s29
  s_lshl_b32 s60, s60, 13
  s_add_u32 s60, s60, 8388608
  s_and_b32 s61, s42, 3
  s_cselect_b32 s60, s48, s60
  s_lshl_b32 s61, s30, 10
  s_add_u32 s61, s61, s60
  s_add_u32 s62, s61, 4096
  buffer_load_dwordx2 v[184:185], v1, s[4:7], s61 offen offset:8
  buffer_load_dwordx2 v[186:187], v1, s[4:7], s62 offen offset:8
  s_lshl_b32 s61, s36, 11
  s_add_u32 s61, s61, s60
  s_add_u32 s62, s61, 4096
  buffer_load_dwordx2 v[176:177], v1, s[4:7], s61 offen offset:0
  buffer_load_dwordx2 v[178:179], v1, s[4:7], s62 offen offset:0
  buffer_load_dwordx2 v[180:181], v1, s[4:7], s61 offen offset:1024
  buffer_load_dwordx2 v[182:183], v1, s[4:7], s62 offen offset:1024
  s_and_b32 s46, s42, 3
  ds_read_b128 v[128:131], v5 offset:40960
  s_waitcnt lgkmcnt(5)
  v_mfma_f32_16x16x32_bf16 v[52:55], a[24:27], v[140:143], v[52:55]
  v_mfma_f32_16x16x32_bf16 v[56:59], a[28:31], v[140:143], v[56:59]
  ds_read_b128 v[132:135], v5 offset:41984
  s_waitcnt lgkmcnt(5)
  v_mfma_f32_16x16x32_bf16 v[52:55], a[32:35], v[144:147], v[52:55]
  v_mfma_f32_16x16x32_bf16 v[56:59], a[36:39], v[144:147], v[56:59]
  ds_read_b128 v[136:139], v5 offset:43008
  s_waitcnt lgkmcnt(5)
  v_mfma_f32_16x16x32_bf16 v[52:55], a[40:43], v[148:151], v[52:55]
  v_mfma_f32_16x16x32_bf16 v[56:59], a[44:47], v[148:151], v[56:59]
  ds_read_b128 v[140:143], v5 offset:44032
  s_waitcnt lgkmcnt(5)
  v_mfma_f32_16x16x32_bf16 v[52:55], a[48:51], v[152:155], v[52:55]
  v_mfma_f32_16x16x32_bf16 v[56:59], a[52:55], v[152:155], v[56:59]
  ds_read_b128 v[144:147], v5 offset:45056
  s_waitcnt lgkmcnt(5)
  v_mfma_f32_16x16x32_bf16 v[52:55], a[56:59], v[156:159], v[52:55]
  v_mfma_f32_16x16x32_bf16 v[56:59], a[60:63], v[156:159], v[56:59]
  ds_read_b128 v[148:151], v5 offset:46080
  s_waitcnt lgkmcnt(5)
  v_mfma_f32_16x16x32_bf16 v[52:55], a[64:67], v[128:131], v[52:55]
  v_mfma_f32_16x16x32_bf16 v[56:59], a[68:71], v[128:131], v[56:59]
  ds_read_b128 v[152:155], v5 offset:47104
  s_waitcnt lgkmcnt(5)
  v_mfma_f32_16x16x32_bf16 v[52:55], a[72:75], v[132:135], v[52:55]
  v_mfma_f32_16x16x32_bf16 v[56:59], a[76:79], v[132:135], v[56:59]
  ds_read_b128 v[156:159], v5 offset:48128
  s_waitcnt lgkmcnt(5)
  v_mfma_f32_16x16x32_bf16 v[52:55], a[80:83], v[136:139], v[52:55]
  v_mfma_f32_16x16x32_bf16 v[56:59], a[84:87], v[136:139], v[56:59]
  ds_read_b128 v[128:131], v5 offset:49152
  s_waitcnt lgkmcnt(5)
  v_mfma_f32_16x16x32_bf16 v[52:55], a[88:91], v[140:143], v[52:55]
  v_mfma_f32_16x16x32_bf16 v[56:59], a[92:95], v[140:143], v[56:59]
  ds_read_b128 v[132:135], v5 offset:50176
  s_waitcnt lgkmcnt(5)
  v_mfma_f32_16x16x32_bf16 v[52:55], a[96:99], v[144:147], v[52:55]
  v_mfma_f32_16x16x32_bf16 v[56:59], a[100:103], v[144:147], v[56:59]
  ds_read_b128 v[136:139], v5 offset:51200
  s_waitcnt lgkmcnt(5)
  v_mfma_f32_16x16x32_bf16 v[52:55], a[104:107], v[148:151], v[52:55]
  v_mfma_f32_16x16x32_bf16 v[56:59], a[108:111], v[148:151], v[56:59]
  ds_read_b128 v[140:143], v5 offset:52224
  s_waitcnt lgkmcnt(5)
  v_mfma_f32_16x16x32_bf16 v[52:55], a[112:115], v[152:155], v[52:55]
  v_mfma_f32_16x16x32_bf16 v[56:59], a[116:119], v[152:155], v[56:59]
  ds_read_b128 v[144:147], v5 offset:53248
  s_waitcnt lgkmcnt(5)
  v_mfma_f32_16x16x32_bf16 v[52:55], a[120:123], v[156:159], v[52:55]
  v_mfma_f32_16x16x32_bf16 v[56:59], a[124:127], v[156:159], v[56:59]
  ds_read_b128 v[148:151], v5 offset:54272
  s_waitcnt lgkmcnt(5)
  v_mfma_f32_16x16x32_bf16 v[52:55], a[128:131], v[128:131], v[52:55]
  v_mfma_f32_16x16x32_bf16 v[56:59], a[132:135], v[128:131], v[56:59]
  ds_read_b128 v[152:155], v5 offset:55296
  s_waitcnt lgkmcnt(5)
  v_mfma_f32_16x16x32_bf16 v[52:55], a[136:139], v[132:135], v[52:55]
  v_mfma_f32_16x16x32_bf16 v[56:59], a[140:143], v[132:135], v[56:59]
  ds_read_b128 v[156:159], v5 offset:56320
  s_waitcnt lgkmcnt(5)
  v_mfma_f32_16x16x32_bf16 v[52:55], a[144:147], v[136:139], v[52:55]
  v_mfma_f32_16x16x32_bf16 v[56:59], a[148:151], v[136:139], v[56:59]
  ds_read_b128 v[128:131], v5 offset:57344
  s_waitcnt lgkmcnt(5)
  v_mfma_f32_16x16x32_bf16 v[52:55], a[152:155], v[140:143], v[52:55]
  v_mfma_f32_16x16x32_bf16 v[56:59], a[156:159], v[140:143], v[56:59]
  ds_read_b128 v[132:135], v5 offset:58368
  s_waitcnt lgkmcnt(5)
  v_mfma_f32_16x16x32_bf16 v[52:55], a[160:163], v[144:147], v[52:55]
  v_mfma_f32_16x16x32_bf16 v[56:59], a[164:167], v[144:147], v[56:59]
  s_mov_b64 exec, 0xfff1f
  buffer_load_dword v60, v22, s[4:7], 0 offen sc1
  s_mov_b64 exec, -1
  ds_read_b128 v[136:139], v5 offset:59392
  s_waitcnt lgkmcnt(5)
  v_mfma_f32_16x16x32_bf16 v[52:55], a[168:171], v[148:151], v[52:55]
  v_mfma_f32_16x16x32_bf16 v[56:59], a[172:175], v[148:151], v[56:59]
  ds_read_b128 v[140:143], v5 offset:60416
  s_waitcnt lgkmcnt(5)
  v_mfma_f32_16x16x32_bf16 v[52:55], a[176:179], v[152:155], v[52:55]
  v_mfma_f32_16x16x32_bf16 v[56:59], a[180:183], v[152:155], v[56:59]
  ds_read_b128 v[144:147], v5 offset:61440
  s_waitcnt lgkmcnt(5)
  v_mfma_f32_16x16x32_bf16 v[52:55], a[184:187], v[156:159], v[52:55]
  v_mfma_f32_16x16x32_bf16 v[56:59], a[188:191], v[156:159], v[56:59]
  ds_read_b128 v[148:151], v5 offset:62464
  s_waitcnt lgkmcnt(5)
  v_mfma_f32_16x16x32_bf16 v[52:55], a[192:195], v[128:131], v[52:55]
  v_mfma_f32_16x16x32_bf16 v[56:59], a[196:199], v[128:131], v[56:59]
  ds_read_b128 v[152:155], v5 offset:63488
  s_waitcnt lgkmcnt(5)
  v_mfma_f32_16x16x32_bf16 v[52:55], a[200:203], v[132:135], v[52:55]
  v_mfma_f32_16x16x32_bf16 v[56:59], a[204:207], v[132:135], v[56:59]
  ds_read_b128 v[156:159], v5 offset:64512
  s_waitcnt lgkmcnt(5)
  v_mfma_f32_16x16x32_bf16 v[52:55], a[208:211], v[136:139], v[52:55]
  v_mfma_f32_16x16x32_bf16 v[56:59], a[212:215], v[136:139], v[56:59]
  s_waitcnt lgkmcnt(4)
  v_mfma_f32_16x16x32_bf16 v[52:55], a[216:219], v[140:143], v[52:55]
  v_mfma_f32_16x16x32_bf16 v[56:59], a[220:223], v[140:143], v[56:59]
  s_waitcnt lgkmcnt(3)
  v_mfma_f32_16x16x32_bf16 v[52:55], a[224:227], v[144:147], v[52:55]
  v_mfma_f32_16x16x32_bf16 v[56:59], a[228:231], v[144:147], v[56:59]
  s_waitcnt lgkmcnt(2)
  v_mfma_f32_16x16x32_bf16 v[52:55], a[232:235], v[148:151], v[52:55]
  v_mfma_f32_16x16x32_bf16 v[56:59], a[236:239], v[148:151], v[56:59]
  s_waitcnt lgkmcnt(1)
  v_mfma_f32_16x16x32_bf16 v[52:55], a[240:243], v[152:155], v[52:55]
  v_mfma_f32_16x16x32_bf16 v[56:59], a[244:247], v[152:155], v[56:59]
  s_waitcnt lgkmcnt(0)
  v_mfma_f32_16x16x32_bf16 v[52:55], a[248:251], v[156:159], v[52:55]
  v_mfma_f32_16x16x32_bf16 v[56:59], a[252:255], v[156:159], v[56:59]
  v_cvt_pk_bf16_f32 v160, v44, v45
  v_cvt_pk_bf16_f32 v161, v46, v47
  v_cvt_pk_bf16_f32 v162, v48, v49
  v_cvt_pk_bf16_f32 v163, v50, v51
  s_cmp_ge_u32 s55, 40
  s_cbranch_scc1 p1_84
  buffer_store_dwordx4 v[160:163], v1, s[4:7], s63 offen offset:0
  s_branch p2_85
p1_84:
  buffer_store_dwordx4 v[160:163], v1, s[4:7], s63 offen offset:0 sc1
p2_85:
  v_cvt_pk_bf16_f32 v164, v52, v53
  v_cvt_pk_bf16_f32 v165, v54, v55
  v_cvt_pk_bf16_f32 v166, v56, v57
  v_cvt_pk_bf16_f32 v167, v58, v59
  s_cmp_ge_u32 s55, 40
  s_cbranch_scc1 p1_86
  buffer_store_dwordx4 v[164:167], v1, s[4:7], s63 offen offset:1024
  s_branch p2_87
p1_86:
  buffer_store_dwordx4 v[164:167], v1, s[4:7], s63 offen offset:1024 sc1
p2_87:
  s_waitcnt vmcnt(2)
  v_cmp_lt_u32 vcc, v60, v23
  s_nop 0
  s_mov_b32 s42, vcc_lo
  v_lshlrev_b32 v128, 16, v228
  v_and_b32 v129, s34, v228
  v_lshlrev_b32 v130, 16, v229
  v_and_b32 v131, s34, v229
  v_lshlrev_b32 v132, 16, v230
  v_and_b32 v133, s34, v230
  v_lshlrev_b32 v134, 16, v231
  v_and_b32 v135, s34, v231
  v_lshlrev_b32 v136, 16, v232
  v_and_b32 v137, s34, v232
  v_lshlrev_b32 v138, 16, v233
  v_and_b32 v139, s34, v233
  v_lshlrev_b32 v140, 16, v234
  v_and_b32 v141, s34, v234
  v_lshlrev_b32 v142, 16, v235
  v_and_b32 v143, s34, v235
  v_lshlrev_b32 v144, 16, v236
  v_and_b32 v145, s34, v236
  v_lshlrev_b32 v146, 16, v237
  v_and_b32 v147, s34, v237
  v_lshlrev_b32 v148, 16, v238
  v_and_b32 v149, s34, v238
  v_lshlrev_b32 v150, 16, v239
  v_and_b32 v151, s34, v239
  v_lshlrev_b32 v152, 16, v240
  v_and_b32 v153, s34, v240
  v_lshlrev_b32 v154, 16, v241
  v_and_b32 v155, s34, v241
  v_lshlrev_b32 v156, 16, v242
  v_and_b32 v157, s34, v242
  v_lshlrev_b32 v158, 16, v243
  v_and_b32 v159, s34, v243
  v_add_f32 v128, v128, v132
  v_add_f32 v136, v136, v140
  v_add_f32 v129, v129, v133
  v_add_f32 v137, v137, v141
  v_add_f32 v130, v130, v134
  v_add_f32 v138, v138, v142
  v_add_f32 v131, v131, v135
  v_add_f32 v139, v139, v143
  v_add_f32 v128, v128, v136
  v_add_f32 v129, v129, v137
  v_add_f32 v130, v130, v138
  v_add_f32 v131, v131, v139
  v_add_f32 v144, v144, v148
  v_add_f32 v152, v152, v156
  v_add_f32 v145, v145, v149
  v_add_f32 v153, v153, v157
  v_add_f32 v146, v146, v150
  v_add_f32 v154, v154, v158
  v_add_f32 v147, v147, v151
  v_add_f32 v155, v155, v159
  v_add_f32 v144, v144, v152
  v_add_f32 v145, v145, v153
  v_add_f32 v146, v146, v154
  v_add_f32 v147, v147, v155
  v_sub_f32 v144, v144, v128
  v_sub_f32 v145, v145, v129
  v_sub_f32 v146, v146, v130
  v_sub_f32 v147, v147, v131
  v_fma_f32 v128, v144, v244, v128
  v_fma_f32 v129, v145, v244, v129
  v_fma_f32 v130, v146, v244, v130
  v_fma_f32 v131, v147, v244, v131
  v_cvt_pk_bf16_f32 v128, v128, v129
  v_cvt_pk_bf16_f32 v129, v130, v131
  buffer_store_dwordx2 v[128:129], v3, s[24:27], s58 offen
  s_mov_b32 s50, s55
  s_lshr_b32 s62, s50, 3
  s_lshl_b32 s62, s62, 7
  s_add_u32 s62, s62, 2628608
  v_writelane_b32 v22, s62, 4
  v_writelane_b32 v23, 16, 4
  s_mov_b64 exec, 0xf0000
  v_add_u32 v23, 1, v23
  s_mov_b64 exec, -1
  s_or_b32 s42, s42, 983056
  s_cmp_lg_u32 s45, s44
  s_cbranch_scc1 T_loop
  s_mov_b32 s47, 3
T_fb:
  s_waitcnt vmcnt(0)
  s_barrier
  s_mov_b64 exec, 1
  v_mov_b32 v9, s45
  buffer_store_dword v9, off, s[4:7], s49
  s_mov_b64 exec, -1
  s_mov_b32 s49, s48
  s_and_b32 s62, s42, 983056
  s_cbranch_scc0 fe_89
fw_88:
  s_mov_b64 exec, 0xf0010
  buffer_load_dword v60, v22, s[4:7], 0 offen sc1
  s_mov_b64 exec, -1
  s_andn2_b32 s42, s42, 983056
  s_waitcnt vmcnt(0)
  v_cmp_lt_u32 vcc, v60, v23
  s_nop 0
  s_and_b32 s62, vcc_lo, 983056
  s_cbranch_scc0 fd_90
  s_sleep 1
  s_sub_u32 s94, s94, 1
  s_cbranch_scc0 fw_88
  s_mov_b32 s94, 0
fd_90:
fe_89:
  s_lshl_b32 s58, s50, 16
  s_lshl_b32 s59, s50, 7
  s_lshl_b32 s56, s50, 18
  s_min_u32 s56, s56, s48
  s_add_u32 s57, s58, 117440512
  buffer_load_dwordx2 v[228:229], v7, s[4:7], s57 offen
  s_add_u32 s57, s58, 121634816
  buffer_load_dwordx2 v[230:231], v7, s[4:7], s57 offen
  s_add_u32 s57, s58, 125829120
  buffer_load_dwordx2 v[232:233], v7, s[4:7], s57 offen
  s_add_u32 s57, s58, 130023424
  buffer_load_dwordx2 v[234:235], v7, s[4:7], s57 offen
  s_add_u32 s57, s56, 33554432
  buffer_load_dwordx2 v[236:237], v7, s[4:7], s57 offen sc1
  s_add_u32 s57, s56, 33619968
  buffer_load_dwordx2 v[238:239], v7, s[4:7], s57 offen sc1
  s_add_u32 s57, s56, 33685504
  buffer_load_dwordx2 v[240:241], v7, s[4:7], s57 offen sc1
  s_add_u32 s57, s56, 33751040
  buffer_load_dwordx2 v[242:243], v7, s[4:7], s57 offen sc1
  buffer_load_dword v244, v6, s[4:7], s59 offen sc1
  s_waitcnt vmcnt(0)
  v_lshlrev_b32 v128, 16, v228
  v_and_b32 v129, s34, v228
  v_lshlrev_b32 v130, 16, v229
  v_and_b32 v131, s34, v229
  v_lshlrev_b32 v132, 16, v230
  v_and_b32 v133, s34, v230
  v_lshlrev_b32 v134, 16, v231
  v_and_b32 v135, s34, v231
  v_lshlrev_b32 v136, 16, v232
  v_and_b32 v137, s34, v232
  v_lshlrev_b32 v138, 16, v233
  v_and_b32 v139, s34, v233
  v_lshlrev_b32 v140, 16, v234
  v_and_b32 v141, s34, v234
  v_lshlrev_b32 v142, 16, v235
  v_and_b32 v143, s34, v235
  v_lshlrev_b32 v144, 16, v236
  v_and_b32 v145, s34, v236
  v_lshlrev_b32 v146, 16, v237
  v_and_b32 v147, s34, v237
  v_lshlrev_b32 v148, 16, v238
  v_and_b32 v149, s34, v238
  v_lshlrev_b32 v150, 16, v239
  v_and_b32 v151, s34, v239
  v_lshlrev_b32 v152, 16, v240
  v_and_b32 v153, s34, v240
  v_lshlrev_b32 v154, 16, v241
  v_and_b32 v155, s34, v241
  v_lshlrev_b32 v156, 16, v242
  v_and_b32 v157, s34, v242
  v_lshlrev_b32 v158, 16, v243
  v_and_b32 v159, s34, v243
  v_add_f32 v128, v128, v132
  v_add_f32 v136, v136, v140
  v_add_f32 v129, v129, v133
  v_add_f32 v137, v137, v141
  v_add_f32 v130, v130, v134
  v_add_f32 v138, v138, v142
  v_add_f32 v131, v131, v135
  v_add_f32 v139, v139, v143
  v_add_f32 v128, v128, v136
  v_add_f32 v129, v129, v137
  v_add_f32 v130, v130, v138
  v_add_f32 v131, v131, v139
  v_add_f32 v144, v144, v148
  v_add_f32 v152, v152, v156
  v_add_f32 v145, v145, v149
  v_add_f32 v153, v153, v157
  v_add_f32 v146, v146, v150
  v_add_f32 v154, v154, v158
  v_add_f32 v147, v147, v151
  v_add_f32 v155, v155, v159
  v_add_f32 v144, v144, v152
  v_add_f32 v145, v145, v153
  v_add_f32 v146, v146, v154
  v_add_f32 v147, v147, v155
  v_sub_f32 v144, v144, v128
  v_sub_f32 v145, v145, v129
  v_sub_f32 v146, v146, v130
  v_sub_f32 v147, v147, v131
  v_fma_f32 v128, v144, v244, v128
  v_fma_f32 v129, v145, v244, v129
  v_fma_f32 v130, v146, v244, v130
  v_fma_f32 v131, v147, v244, v131
  v_cvt_pk_bf16_f32 v128, v128, v129
  v_cvt_pk_bf16_f32 v129, v130, v131
  buffer_store_dwordx2 v[128:129], v3, s[24:27], s58 offen
  s_mov_b32 s50, s37
  s_lshr_b32 s62, s50, 3
  s_lshl_b32 s62, s62, 7
  s_add_u32 s62, s62, 2628608
  v_writelane_b32 v22, s62, 4
  v_writelane_b32 v23, 16, 4
  s_mov_b64 exec, 0xf0000
  v_add_u32 v23, 1, v23
  s_mov_b64 exec, -1
  s_or_b32 s42, s42, 983056
  s_and_b32 s62, s42, 16
  s_cbranch_scc0 fe_92
fw_91:
  s_mov_b64 exec, 0x10
  buffer_load_dword v60, v22, s[4:7], 0 offen sc1
  s_mov_b64 exec, -1
  s_andn2_b32 s42, s42, 16
  s_waitcnt vmcnt(0)
  v_cmp_lt_u32 vcc, v60, v23
  s_nop 0
  s_and_b32 s62, vcc_lo, 16
  s_cbranch_scc0 fd_93
  s_sleep 1
  s_sub_u32 s94, s94, 1
  s_cbranch_scc0 fw_91
  s_mov_b32 s94, 0
fd_93:
fe_92:
  s_lshl_b32 s58, s50, 16
  s_lshl_b32 s59, s50, 7
  s_lshl_b32 s56, s50, 18
  s_min_u32 s56, s56, s48
  s_add_u32 s57, s58, 117440512
  buffer_load_dwordx2 v[228:229], v7, s[4:7], s57 offen
  s_add_u32 s57, s58, 121634816
  buffer_load_dwordx2 v[230:231], v7, s[4:7], s57 offen
  s_add_u32 s57, s58, 125829120
  buffer_load_dwordx2 v[232:233], v7, s[4:7], s57 offen
  s_add_u32 s57, s58, 130023424
  buffer_load_dwordx2 v[234:235], v7, s[4:7], s57 offen
  s_branch T_att
ST_pre:
  s_and_b32 s62, s42, 12
  s_cbranch_scc0 fe_95
fw_94:
  s_mov_b64 exec, 0xc
  buffer_load_dword v60, v22, s[4:7], 0 offen sc1
  s_mov_b64 exec, -1
  s_andn2_b32 s42, s42, 12
  s_waitcnt vmcnt(0)
  v_cmp_lt_u32 vcc, v60, v23
  s_nop 0
  s_and_b32 s62, vcc_lo, 12
  s_cbranch_scc0 fd_96
  s_sleep 1
  s_sub_u32 s94, s94, 1
  s_cbranch_scc0 fw_94
  s_mov_b32 s94, 0
fd_96:
fe_95:
  s_lshl_b32 s56, s41, 5
  s_add_u32 s56, s56, s29
  s_lshl_b32 s57, s56, 13
  s_lshl_b32 s58, s35, 12
  s_add_u32 s58, s58, s57
  s_add_u32 s58, s58, 67108864
  buffer_load_dwordx4 v[64:67], v1, s[4:7], s58 offen offset:0
  buffer_load_dwordx4 v[68:71], v1, s[4:7], s58 offen offset:1024
  buffer_load_dwordx4 v[72:75], v1, s[4:7], s58 offen offset:2048
  buffer_load_dwordx4 v[76:79], v1, s[4:7], s58 offen offset:3072
  s_add_u32 s58, s57, 33554432
  s_add_u32 s59, s58, 4096
  buffer_load_dwordx4 v[80:83], v1, s[4:7], s58 offen offset:0
  buffer_load_dwordx4 v[96:99], v1, s[4:7], s59 offen offset:0
  buffer_load_dwordx4 v[84:87], v1, s[4:7], s58 offen offset:1024
  buffer_load_dwordx4 v[100:103], v1, s[4:7], s59 offen offset:1024
  buffer_load_dwordx4 v[88:91], v1, s[4:7], s58 offen offset:2048
  buffer_load_dwordx4 v[104:107], v1, s[4:7], s59 offen offset:2048
  buffer_load_dwordx4 v[92:95], v1, s[4:7], s58 offen offset:3072
  buffer_load_dwordx4 v[108:111], v1, s[4:7], s59 offen offset:3072
  s_lshl_b32 s58, s36, 12
  s_add_u32 s58, s58, s57
  s_add_u32 s58, s58, 50331648
  buffer_load_dwordx4 v[112:115], v1, s[4:7], s58 offen offset:0
  buffer_load_dwordx4 v[116:119], v1, s[4:7], s58 offen offset:1024
  buffer_load_dwordx4 v[120:123], v1, s[4:7], s58 offen offset:2048
  buffer_load_dwordx4 v[124:127], v1, s[4:7], s58 offen offset:3072
  s_lshl_b32 s56, s56, 11
  buffer_load_dwordx4 v[188:191], v8, s[8:11], s56 offen
  buffer_load_dwordx4 v[192:195], v8, s[8:11], s56 offen offset:16
  s_add_u32 s56, s44, 1
  v_readlane_b32 s41, v61, s56
  s_nop 0
  s_lshr_b32 s56, s41, 3
  s_lshl_b32 s57, s56, 7
  s_add_u32 s57, s57, 2623488
  s_add_u32 s56, s56, 1
  s_lshr_b32 s58, s41, 2
  s_cmp_lt_u32 s41, 8
  s_cselect_b32 s56, s58, s56
  s_cselect_b32 s58, 64, 32
  s_lshl_b32 s56, s56, 7
  s_add_u32 s56, s56, 2621440
  v_writelane_b32 v22, s57, 2
  v_writelane_b32 v22, s56, 3
  v_writelane_b32 v23, s58, 3
  s_or_b32 s42, s42, 12
  s_cmp_eq_u32 s47, 2
  s_cbranch_scc1 ST_g
  s_waitcnt vmcnt(0)
  s_cmp_eq_u32 s47, 0
  s_cbranch_scc1 ST_att
  s_mov_b32 s47, 2
ST_loop:
  s_and_b32 s62, s42, 65280
  s_cbranch_scc0 fe_98
fw_97:
  s_mov_b64 exec, 0xff00
  buffer_load_dword v60, v22, s[4:7], 0 offen sc1
  s_mov_b64 exec, -1
  s_andn2_b32 s42, s42, 65280
  s_waitcnt vmcnt(0)
  v_cmp_lt_u32 vcc, v60, v23
  s_nop 0
  s_and_b32 s62, vcc_lo, 65280
  s_cbranch_scc0 fd_99
  s_sleep 1
  s_sub_u32 s94, s94, 1
  s_cbranch_scc0 fw_97
  s_mov_b32 s94, 0
fd_99:
fe_98:
  s_xor_b32 s51, s51, 0x10000
  v_xor_b32 v5, 0x10000, v5
  s_lshl_b32 s56, s32, 18
  s_add_u32 s56, s56, s53
  s_add_u32 m0, s51, 0
  s_add_u32 s57, s56, 0
  buffer_load_dwordx4 v1, s[4:7], s57 offen offset:0 sc1 lds
  buffer_load_dwordx4 v1, s[4:7], s57 offen offset:1024 sc1 lds
  buffer_load_dwordx4 v1, s[4:7], s57 offen offset:2048 sc1 lds
  buffer_load_dwordx4 v1, s[4:7], s57 offen offset:3072 sc1 lds
  s_add_u32 m0, s51, 16384
  s_add_u32 s57, s56, 32768
  buffer_load_dwordx4 v1, s[4:7], s57 offen offset:0 sc1 lds
  buffer_load_dwordx4 v1, s[4:7], s57 offen offset:1024 sc1 lds
  buffer_load_dwordx4 v1, s[4:7], s57 offen offset:2048 sc1 lds
  buffer_load_dwordx4 v1, s[4:7], s57 offen offset:3072 sc1 lds
  s_add_u32 m0, s51, 32768
  s_add_u32 s57, s56, 4096
  buffer_load_dwordx4 v1, s[4:7], s57 offen offset:0 sc1 lds
  buffer_load_dwordx4 v1, s[4:7], s57 offen offset:1024 sc1 lds
  buffer_load_dwordx4 v1, s[4:7], s57 offen offset:2048 sc1 lds
  buffer_load_dwordx4 v1, s[4:7], s57 offen offset:3072 sc1 lds
  s_add_u32 m0, s51, 49152
  s_add_u32 s57, s56, 36864
  buffer_load_dwordx4 v1, s[4:7], s57 offen offset:0 sc1 lds
  buffer_load_dwordx4 v1, s[4:7], s57 offen offset:1024 sc1 lds
  buffer_load_dwordx4 v1, s[4:7], s57 offen offset:2048 sc1 lds
  buffer_load_dwordx4 v1, s[4:7], s57 offen offset:3072 sc1 lds
  s_cmp_lt_u32 s41, 64
  s_cbranch_scc1 ST_att
  s_waitcnt vmcnt(0)
  s_barrier
  s_mov_b64 exec, 1
  v_mov_b32 v9, s45
  buffer_store_dword v9, off, s[4:7], s49 sc1
  s_mov_b64 exec, -1
  s_mov_b32 s49, s48
  s_branch ST_g
ST_att:
  v_mfma_f32_16x16x32_bf16 v[144:147], v[80:83], v[64:67], v[12:15]
  v_lshlrev_b32 v212, 16, v188
  v_and_b32 v213, s34, v188
  v_mfma_f32_16x16x32_bf16 v[148:151], v[96:99], v[64:67], v[16:19]
  v_lshlrev_b32 v214, 16, v189
  v_and_b32 v215, s34, v189
  v_mfma_f32_16x16x32_bf16 v[144:147], v[84:87], v[68:71], v[144:147]
  v_lshlrev_b32 v216, 16, v190
  v_and_b32 v217, s34, v190
  v_mfma_f32_16x16x32_bf16 v[148:151], v[100:103], v[68:71], v[148:151]
  v_lshlrev_b32 v218, 16, v191
  v_and_b32 v219, s34, v191
  v_mfma_f32_16x16x32_bf16 v[144:147], v[88:91], v[72:75], v[144:147]
  v_lshlrev_b32 v220, 16, v192
  v_and_b32 v221, s34, v192
  v_mfma_f32_16x16x32_bf16 v[148:151], v[104:107], v[72:75], v[148:151]
  v_lshlrev_b32 v222, 16, v193
  v_and_b32 v223, s34, v193
  v_mfma_f32_16x16x32_bf16 v[144:147], v[92:95], v[76:79], v[144:147]
  v_lshlrev_b32 v224, 16, v194
  v_and_b32 v225, s34, v194
  v_mfma_f32_16x16x32_bf16 v[148:151], v[108:111], v[76:79], v[148:151]
  v_lshlrev_b32 v226, 16, v195
  v_and_b32 v227, s34, v195
  v_mul_f32 v174, v212, v28
  v_mul_f32 v175, v213, v29
  v_fmac_f32 v174, v214, v30
  v_fmac_f32 v175, v215, v31
  v_fmac_f32 v174, v216, v32
  v_fmac_f32 v175, v217, v33
  v_fmac_f32 v174, v218, v34
  v_fmac_f32 v175, v219, v35
  v_fmac_f32 v174, v220, v36
  v_fmac_f32 v175, v221, v37
  v_fmac_f32 v174, v222, v38
  v_fmac_f32 v175, v223, v39
  v_fmac_f32 v174, v224, v40
  v_fmac_f32 v175, v225, v41
  v_fmac_f32 v174, v226, v42
  v_fmac_f32 v175, v227, v43
  v_add_f32 v174, v174, v175
  v_max3_f32 v172, v144, v145, v146
  v_max3_f32 v173, v147, v148, v149
  v_max3_f32 v172, v172, v150, v151
  v_max_f32 v172, v172, v173
  v_mov_b32 v164, 0
  v_mov_b32 v161, 0
  s_or_b32 s42, s42, s46
  s_and_b32 s62, s42, 3
  s_cbranch_scc0 fe_104
fw_103:
  s_mov_b64 exec, 0x3
  buffer_load_dword v60, v22, s[4:7], 0 offen sc1
  s_mov_b64 exec, -1
  s_andn2_b32 s42, s42, 3
  s_waitcnt vmcnt(0)
  v_cmp_lt_u32 vcc, v60, v23
  s_nop 0
  s_and_b32 s62, vcc_lo, 3
  s_cbranch_scc0 fd_105
  s_sleep 1
  s_sub_u32 s94, s94, 1
  s_cbranch_scc0 fw_103
  s_mov_b32 s94, 0
fd_105:
  s_lshl_b32 s60, s37, 5
  s_add_u32 s60, s60, s29
  s_lshl_b32 s60, s60, 13
  s_add_u32 s60, s60, 8388608
  s_lshl_b32 s61, s30, 10
  s_add_u32 s61, s61, s60
  s_add_u32 s62, s61, 4096
  buffer_load_dwordx2 v[184:185], v1, s[4:7], s61 offen offset:8
  buffer_load_dwordx2 v[186:187], v1, s[4:7], s62 offen offset:8
  s_lshl_b32 s61, s36, 11
  s_add_u32 s61, s61, s60
  s_add_u32 s62, s61, 4096
  buffer_load_dwordx2 v[176:177], v1, s[4:7], s61 offen offset:0
  buffer_load_dwordx2 v[178:179], v1, s[4:7], s62 offen offset:0
  buffer_load_dwordx2 v[180:181], v1, s[4:7], s61 offen offset:1024
  buffer_load_dwordx2 v[182:183], v1, s[4:7], s62 offen offset:1024
  s_waitcnt vmcnt(0)
fe_104:
  s_cmp_lg_u32 s37, 63
  s_cbranch_scc1 dq_101
dp_100:
  s_waitcnt vmcnt(0)
  v_max3_u32 v10, v184, v186, v176
  v_max3_u32 v11, v178, v180, v182
  v_max_u32 v10, v10, v11
  v_cmp_eq_u32 vcc, -1, v10
  s_nop 0
  s_cbranch_vccz dq_101
  s_lshl_b32 s60, s37, 5
  s_add_u32 s60, s60, s29
  s_lshl_b32 s60, s60, 13
  s_add_u32 s60, s60, 8388608
  s_lshl_b32 s61, s30, 10
  s_add_u32 s61, s61, s60
  s_add_u32 s62, s61, 4096
  buffer_load_dwordx2 v[184:185], v1, s[4:7], s61 offen offset:8 sc1
  buffer_load_dwordx2 v[186:187], v1, s[4:7], s62 offen offset:8 sc1
  s_lshl_b32 s61, s36, 11
  s_add_u32 s61, s61, s60
  s_add_u32 s62, s61, 4096
  buffer_load_dwordx2 v[176:177], v1, s[4:7], s61 offen offset:0 sc1
  buffer_load_dwordx2 v[178:179], v1, s[4:7], s62 offen offset:0 sc1
  buffer_load_dwordx2 v[180:181], v1, s[4:7], s61 offen offset:1024 sc1
  buffer_load_dwordx2 v[182:183], v1, s[4:7], s62 offen offset:1024 sc1
  s_sub_u32 s94, s94, 1
  s_cbranch_scc0 dp_100
  s_mov_b32 s94, 0
  s_waitcnt vmcnt(0)
dq_101:
  ds_write2_b32 v20, v184, v186 offset0:0 offset1:1
  ds_write2_b32 v20, v185, v187 offset0:128 offset1:129
  s_waitcnt vmcnt(16) lgkmcnt(0)
  s_barrier
  ds_read_b64_tr_b16 v[128:129], v21 offset:0
  ds_read_b64_tr_b16 v[130:131], v21 offset:512
  ds_read_b64_tr_b16 v[132:133], v21 offset:1024
  ds_read_b64_tr_b16 v[134:135], v21 offset:1536
  ds_read_b64_tr_b16 v[136:137], v21 offset:2048
  ds_read_b64_tr_b16 v[138:139], v21 offset:2560
  ds_read_b64_tr_b16 v[140:141], v21 offset:3072
  ds_read_b64_tr_b16 v[142:143], v21 offset:3584
  s_mov_b64 exec, 1
  v_mov_b32 v9, s45
  buffer_store_dword v9, off, s[4:7], s49 sc1
  s_mov_b64 exec, -1
  s_mov_b32 s49, s48
  v_add_f32_dpp v174, v174, v174 row_ror:8 row_mask:0xf bank_mask:0xf
  s_waitcnt lgkmcnt(6)
  v_mfma_f32_16x16x32_bf16 v[152:155], v[128:131], v[64:67], 0
  v_add_f32_dpp v174, v174, v174 row_ror:4 row_mask:0xf bank_mask:0xf
  s_waitcnt lgkmcnt(4)
  v_mfma_f32_16x16x32_bf16 v[152:155], v[132:135], v[68:71], v[152:155]
  v_add_f32_dpp v174, v174, v174 row_ror:2 row_mask:0xf bank_mask:0xf
  s_waitcnt lgkmcnt(2)
  v_mfma_f32_16x16x32_bf16 v[152:155], v[136:139], v[72:75], v[152:155]
  v_add_f32_dpp v174, v174, v174 row_ror:1 row_mask:0xf bank_mask:0xf
  s_waitcnt lgkmcnt(0)
  v_mfma_f32_16x16x32_bf16 v[152:155], v[140:143], v[76:79], v[152:155]
  v_mov_b32 v175, v174
  s_nop 1
  v_permlane16_swap_b32 v174, v175
  v_add_f32 v174, v174, v175
  v_mov_b32 v175, v174
  s_nop 1
  v_permlane32_swap_b32 v174, v175
  v_add_f32 v174, v174, v175
  v_add_f32 v152, v152, v154
  v_add_f32 v153, v153, v155
  v_max3_f32 v172, v172, v152, v153
  v_mov_b32 v173, v172
  s_nop 1
  v_permlane16_swap_b32 v172, v173
  v_max_f32 v172, v172, v173
  v_mov_b32 v173, v172
  s_nop 1
  v_permlane32_swap_b32 v172, v173
  v_max_f32 v172, v172, v173
  v_mul_f32 v172, s33, v172
  v_fma_f32 v144, v144, s33, -v172
  v_fma_f32 v145, v145, s33, -v172
  v_fma_f32 v146, v146, s33, -v172
  v_fma_f32 v147, v147, s33, -v172
  v_fma_f32 v148, v148, s33, -v172
  v_fma_f32 v149, v149, s33, -v172
  v_fma_f32 v150, v150, s33, -v172
  v_fma_f32 v151, v151, s33, -v172
  v_fma_f32 v152, v152, s33, -v172
  v_fma_f32 v153, v153, s33, -v172
  v_exp_f32 v144, v144
  v_exp_f32 v145, v145
  v_exp_f32 v146, v146
  v_exp_f32 v147, v147
  v_exp_f32 v148, v148
  v_exp_f32 v149, v149
  v_exp_f32 v150, v150
  v_exp_f32 v151, v151
  v_exp_f32 v152, v152
  v_exp_f32 v153, v153
  v_cvt_pk_bf16_f32 v156, v144, v145
  v_cvt_pk_bf16_f32 v157, v146, v147
  v_cvt_pk_bf16_f32 v158, v148, v149
  v_cvt_pk_bf16_f32 v159, v150, v151
  v_cvt_pk_bf16_f32 v160, v152, v153
  v_mov_b32 v165, v160
  v_mfma_f32_16x16x32_bf16 v[168:171], v[24:27], v[156:159], 0
  v_mov_b64 v[162:163], v[160:161]
  v_mov_b64 v[166:167], v[164:165]
  v_mfma_f32_16x16x32_bf16 v[196:199], v[112:115], v[156:159], 0
  v_mul_f32 v174, 0xbfb8aa3b, v174
  v_mfma_f32_16x16x32_bf16 v[196:199], v[176:179], v[160:163], v[196:199]
  v_exp_f32 v174, v174
  v_mfma_f32_16x16x32_bf16 v[200:203], v[116:119], v[156:159], 0
  v_mfma_f32_16x16x16_bf16 v[168:171], v[24:25], v[160:161], v[168:171]
  v_add_f32 v174, 1.0, v174
  v_mfma_f32_16x16x32_bf16 v[200:203], v[176:179], v[164:167], v[200:203]
  v_rcp_f32 v174, v174
  v_mfma_f32_16x16x32_bf16 v[204:207], v[120:123], v[156:159], 0
  v_mfma_f32_16x16x32_bf16 v[204:207], v[180:183], v[160:163], v[204:207]
  v_mfma_f32_16x16x32_bf16 v[208:211], v[124:127], v[156:159], 0
  v_mfma_f32_16x16x32_bf16 v[208:211], v[180:183], v[164:167], v[208:211]
  s_lshl_b32 s56, s37, 5
  s_add_u32 s56, s56, s29
  s_lshl_b32 s56, s56, 2
  s_add_u32 s56, s56, s38
  v_rcp_f32 v172, v168
  s_lshl_b32 s58, s37, 18
  s_add_u32 s58, s58, s40
  s_mov_b32 s43, s39
  v_mul_f32 v196, v172, v196
  v_mul_f32 v197, v172, v197
  v_mul_f32 v198, v172, v198
  v_mul_f32 v199, v172, v199
  v_mul_f32 v200, v172, v200
  v_mul_f32 v201, v172, v201
  v_mul_f32 v202, v172, v202
  v_mul_f32 v203, v172, v203
  v_cvt_pk_bf16_f32 v144, v196, v197
  v_cvt_pk_bf16_f32 v145, v198, v199
  v_cvt_pk_bf16_f32 v146, v200, v201
  v_cvt_pk_bf16_f32 v147, v202, v203
  buffer_store_dwordx4 v[144:147], v1, s[4:7], s58 offen offset:0 sc1
  v_mul_f32 v204, v172, v204
  v_mul_f32 v205, v172, v205
  v_mul_f32 v206, v172, v206
  v_mul_f32 v207, v172, v207
  v_mul_f32 v208, v172, v208
  v_mul_f32 v209, v172, v209
  v_mul_f32 v210, v172, v210
  v_mul_f32 v211, v172, v211
  v_cvt_pk_bf16_f32 v148, v204, v205
  v_cvt_pk_bf16_f32 v149, v206, v207
  v_cvt_pk_bf16_f32 v150, v208, v209
  v_cvt_pk_bf16_f32 v151, v210, v211
  buffer_store_dwordx4 v[148:151], v1, s[4:7], s58 offen offset:1024 sc1
  s_mov_b64 exec, 1
  buffer_store_dword v174, off, s[4:7], s56 sc1
  s_mov_b64 exec, -1
  s_add_u32 s44, s44, 1
  s_mov_b32 s37, s41
  s_mov_b32 s46, 3
  s_add_u32 s56, s37, 1
  s_min_u32 s56, s56, 63
  v_writelane_b32 v23, s56, 0
  v_writelane_b32 v23, s56, 1
  s_or_b32 s42, s42, 3
  s_cmp_eq_u32 s47, 2
  s_cbranch_scc1 ST_pre
  s_waitcnt vmcnt(0)
  s_barrier
  s_mov_b64 exec, 1
  v_mov_b32 v9, s44
  buffer_store_dword v9, off, s[4:7], s43 sc1
  s_mov_b64 exec, -1
  s_mov_b32 s43, s48
  s_add_u32 s47, s47, 1
  s_cmp_eq_u32 s47, 1
  s_cbranch_scc1 ST_pre
ST_last:
  s_and_b32 s62, s42, 65280
  s_cbranch_scc0 fe_107
fw_106:
  s_mov_b64 exec, 0xff00
  buffer_load_dword v60, v22, s[4:7], 0 offen sc1
  s_mov_b64 exec, -1
  s_andn2_b32 s42, s42, 65280
  s_waitcnt vmcnt(0)
  v_cmp_lt_u32 vcc, v60, v23
  s_nop 0
  s_and_b32 s62, vcc_lo, 65280
  s_cbranch_scc0 fd_108
  s_sleep 1
  s_sub_u32 s94, s94, 1
  s_cbranch_scc0 fw_106
  s_mov_b32 s94, 0
fd_108:
fe_107:
  s_xor_b32 s51, s51, 0x10000
  v_xor_b32 v5, 0x10000, v5
  s_lshl_b32 s56, s32, 18
  s_add_u32 s56, s56, s53
  s_add_u32 m0, s51, 0
  s_add_u32 s57, s56, 0
  buffer_load_dwordx4 v1, s[4:7], s57 offen offset:0 sc1 lds
  buffer_load_dwordx4 v1, s[4:7], s57 offen offset:1024 sc1 lds
  buffer_load_dwordx4 v1, s[4:7], s57 offen offset:2048 sc1 lds
  buffer_load_dwordx4 v1, s[4:7], s57 offen offset:3072 sc1 lds
  s_add_u32 m0, s51, 16384
  s_add_u32 s57, s56, 32768
  buffer_load_dwordx4 v1, s[4:7], s57 offen offset:0 sc1 lds
  buffer_load_dwordx4 v1, s[4:7], s57 offen offset:1024 sc1 lds
  buffer_load_dwordx4 v1, s[4:7], s57 offen offset:2048 sc1 lds
  buffer_load_dwordx4 v1, s[4:7], s57 offen offset:3072 sc1 lds
  s_add_u32 m0, s51, 32768
  s_add_u32 s57, s56, 4096
  buffer_load_dwordx4 v1, s[4:7], s57 offen offset:0 sc1 lds
  buffer_load_dwordx4 v1, s[4:7], s57 offen offset:1024 sc1 lds
  buffer_load_dwordx4 v1, s[4:7], s57 offen offset:2048 sc1 lds
  buffer_load_dwordx4 v1, s[4:7], s57 offen offset:3072 sc1 lds
  s_add_u32 m0, s51, 49152
  s_add_u32 s57, s56, 36864
  buffer_load_dwordx4 v1, s[4:7], s57 offen offset:0 sc1 lds
  buffer_load_dwordx4 v1, s[4:7], s57 offen offset:1024 sc1 lds
  buffer_load_dwordx4 v1, s[4:7], s57 offen offset:2048 sc1 lds
  buffer_load_dwordx4 v1, s[4:7], s57 offen offset:3072 sc1 lds
  s_lshl_b32 s63, s32, 18
  s_add_u32 s63, s63, s52
  s_mov_b32 s49, s54
  s_mov_b32 s55, s32
  s_add_u32 s45, s45, 1
  s_waitcnt vmcnt(12)
  s_barrier
  ds_read_b128 v[128:131], v5 offset:0
  ds_read_b128 v[132:135], v5 offset:1024
  ds_read_b128 v[136:139], v5 offset:2048
  ds_read_b128 v[140:143], v5 offset:3072
  ds_read_b128 v[144:147], v5 offset:4096
  ds_read_b128 v[148:151], v5 offset:5120
  s_waitcnt lgkmcnt(5)
  v_mfma_f32_16x16x32_bf16 v[44:47], a[0:3], v[128:131], 0
  v_mfma_f32_16x16x32_bf16 v[48:51], a[4:7], v[128:131], 0
  ds_read_b128 v[152:155], v5 offset:6144
  s_waitcnt lgkmcnt(5)
  v_mfma_f32_16x16x32_bf16 v[44:47], a[8:11], v[132:135], v[44:47]
  v_mfma_f32_16x16x32_bf16 v[48:51], a[12:15], v[132:135], v[48:51]
  ds_read_b128 v[156:159], v5 offset:7168
  s_waitcnt lgkmcnt(5)
  v_mfma_f32_16x16x32_bf16 v[44:47], a[16:19], v[136:139], v[44:47]
  v_mfma_f32_16x16x32_bf16 v[48:51], a[20:23], v[136:139], v[48:51]
  ds_read_b128 v[128:131], v5 offset:8192
  s_waitcnt lgkmcnt(5)
  v_mfma_f32_16x16x32_bf16 v[44:47], a[24:27], v[140:143], v[44:47]
  v_mfma_f32_16x16x32_bf16 v[48:51], a[28:31], v[140:143], v[48:51]
  ds_read_b128 v[132:135], v5 offset:9216
  s_waitcnt lgkmcnt(5)
  v_mfma_f32_16x16x32_bf16 v[44:47], a[32:35], v[144:147], v[44:47]
  v_mfma_f32_16x16x32_bf16 v[48:51], a[36:39], v[144:147], v[48:51]
  ds_read_b128 v[136:139], v5 offset:10240
  s_waitcnt lgkmcnt(5)
  v_mfma_f32_16x16x32_bf16 v[44:47], a[40:43], v[148:151], v[44:47]
  v_mfma_f32_16x16x32_bf16 v[48:51], a[44:47], v[148:151], v[48:51]
  ds_read_b128 v[140:143], v5 offset:11264
  s_waitcnt lgkmcnt(5)
  v_mfma_f32_16x16x32_bf16 v[44:47], a[48:51], v[152:155], v[44:47]
  v_mfma_f32_16x16x32_bf16 v[48:51], a[52:55], v[152:155], v[48:51]
  ds_read_b128 v[144:147], v5 offset:12288
  s_waitcnt lgkmcnt(5)
  v_mfma_f32_16x16x32_bf16 v[44:47], a[56:59], v[156:159], v[44:47]
  v_mfma_f32_16x16x32_bf16 v[48:51], a[60:63], v[156:159], v[48:51]
  ds_read_b128 v[148:151], v5 offset:13312
  s_waitcnt lgkmcnt(5)
  v_mfma_f32_16x16x32_bf16 v[44:47], a[64:67], v[128:131], v[44:47]
  v_mfma_f32_16x16x32_bf16 v[48:51], a[68:71], v[128:131], v[48:51]
  ds_read_b128 v[152:155], v5 offset:14336
  s_waitcnt lgkmcnt(5)
  v_mfma_f32_16x16x32_bf16 v[44:47], a[72:75], v[132:135], v[44:47]
  v_mfma_f32_16x16x32_bf16 v[48:51], a[76:79], v[132:135], v[48:51]
  ds_read_b128 v[156:159], v5 offset:15360
  s_waitcnt lgkmcnt(5)
  v_mfma_f32_16x16x32_bf16 v[44:47], a[80:83], v[136:139], v[44:47]
  v_mfma_f32_16x16x32_bf16 v[48:51], a[84:87], v[136:139], v[48:51]
  s_waitcnt vmcnt(8)
  s_barrier
  ds_read_b128 v[128:131], v5 offset:16384
  s_waitcnt lgkmcnt(5)
  v_mfma_f32_16x16x32_bf16 v[44:47], a[88:91], v[140:143], v[44:47]
  v_mfma_f32_16x16x32_bf16 v[48:51], a[92:95], v[140:143], v[48:51]
  ds_read_b128 v[132:135], v5 offset:17408
  s_waitcnt lgkmcnt(5)
  v_mfma_f32_16x16x32_bf16 v[44:47], a[96:99], v[144:147], v[44:47]
  v_mfma_f32_16x16x32_bf16 v[48:51], a[100:103], v[144:147], v[48:51]
  ds_read_b128 v[136:139], v5 offset:18432
  s_waitcnt lgkmcnt(5)
  v_mfma_f32_16x16x32_bf16 v[44:47], a[104:107], v[148:151], v[44:47]
  v_mfma_f32_16x16x32_bf16 v[48:51], a[108:111], v[148:151], v[48:51]
  ds_read_b128 v[140:143], v5 offset:19456
  s_waitcnt lgkmcnt(5)
  v_mfma_f32_16x16x32_bf16 v[44:47], a[112:115], v[152:155], v[44:47]
  v_mfma_f32_16x16x32_bf16 v[48:51], a[116:119], v[152:155], v[48:51]
  ds_read_b128 v[144:147], v5 offset:20480
  s_waitcnt lgkmcnt(5)
  v_mfma_f32_16x16x32_bf16 v[44:47], a[120:123], v[156:159], v[44:47]
  v_mfma_f32_16x16x32_bf16 v[48:51], a[124:127], v[156:159], v[48:51]
  ds_read_b128 v[148:151], v5 offset:21504
  s_waitcnt lgkmcnt(5)
  v_mfma_f32_16x16x32_bf16 v[44:47], a[128:131], v[128:131], v[44:47]
  v_mfma_f32_16x16x32_bf16 v[48:51], a[132:135], v[128:131], v[48:51]
  ds_read_b128 v[152:155], v5 offset:22528
  s_waitcnt lgkmcnt(5)
  v_mfma_f32_16x16x32_bf16 v[44:47], a[136:139], v[132:135], v[44:47]
  v_mfma_f32_16x16x32_bf16 v[48:51], a[140:143], v[132:135], v[48:51]
  ds_read_b128 v[156:159], v5 offset:23552
  s_waitcnt lgkmcnt(5)
  v_mfma_f32_16x16x32_bf16 v[44:47], a[144:147], v[136:139], v[44:47]
  v_mfma_f32_16x16x32_bf16 v[48:51], a[148:151], v[136:139], v[48:51]
  ds_read_b128 v[128:131], v5 offset:24576
  s_waitcnt lgkmcnt(5)
  v_mfma_f32_16x16x32_bf16 v[44:47], a[152:155], v[140:143], v[44:47]
  v_mfma_f32_16x16x32_bf16 v[48:51], a[156:159], v[140:143], v[48:51]
  ds_read_b128 v[132:135], v5 offset:25600
  s_waitcnt lgkmcnt(5)
  v_mfma_f32_16x16x32_bf16 v[44:47], a[160:163], v[144:147], v[44:47]
  v_mfma_f32_16x16x32_bf16 v[48:51], a[164:167], v[144:147], v[48:51]
  ds_read_b128 v[136:139], v5 offset:26624
  s_waitcnt lgkmcnt(5)
  v_mfma_f32_16x16x32_bf16 v[44:47], a[168:171], v[148:151], v[44:47]
  v_mfma_f32_16x16x32_bf16 v[48:51], a[172:175], v[148:151], v[48:51]
  ds_read_b128 v[140:143], v5 offset:27648
  s_waitcnt lgkmcnt(5)
  v_mfma_f32_16x16x32_bf16 v[44:47], a[176:179], v[152:155], v[44:47]
  v_mfma_f32_16x16x32_bf16 v[48:51], a[180:183], v[152:155], v[48:51]
  ds_read_b128 v[144:147], v5 offset:28672
  s_waitcnt lgkmcnt(5)
  v_mfma_f32_16x16x32_bf16 v[44:47], a[184:187], v[156:159], v[44:47]
  v_mfma_f32_16x16x32_bf16 v[48:51], a[188:191], v[156:159], v[48:51]
  ds_read_b128 v[148:151], v5 offset:29696
  s_waitcnt lgkmcnt(5)
  v_mfma_f32_16x16x32_bf16 v[44:47], a[192:195], v[128:131], v[44:47]
  v_mfma_f32_16x16x32_bf16 v[48:51], a[196:199], v[128:131], v[48:51]
  ds_read_b128 v[152:155], v5 offset:30720
  s_waitcnt lgkmcnt(5)
  v_mfma_f32_16x16x32_bf16 v[44:47], a[200:203], v[132:135], v[44:47]
  v_mfma_f32_16x16x32_bf16 v[48:51], a[204:207], v[132:135], v[48:51]
  ds_read_b128 v[156:159], v5 offset:31744
  s_waitcnt lgkmcnt(5)
  v_mfma_f32_16x16x32_bf16 v[44:47], a[208:211], v[136:139], v[44:47]
  v_mfma_f32_16x16x32_bf16 v[48:51], a[212:215], v[136:139], v[48:51]
  s_waitcnt vmcnt(4)
  s_barrier
  ds_read_b128 v[128:131], v5 offset:32768
  s_waitcnt lgkmcnt(5)
  v_mfma_f32_16x16x32_bf16 v[44:47], a[216:219], v[140:143], v[44:47]
  v_mfma_f32_16x16x32_bf16 v[48:51], a[220:223], v[140:143], v[48:51]
  ds_read_b128 v[132:135], v5 offset:33792
  s_waitcnt lgkmcnt(5)
  v_mfma_f32_16x16x32_bf16 v[44:47], a[224:227], v[144:147], v[44:47]
  v_mfma_f32_16x16x32_bf16 v[48:51], a[228:231], v[144:147], v[48:51]
  ds_read_b128 v[136:139], v5 offset:34816
  s_waitcnt lgkmcnt(5)
  v_mfma_f32_16x16x32_bf16 v[44:47], a[232:235], v[148:151], v[44:47]
  v_mfma_f32_16x16x32_bf16 v[48:51], a[236:239], v[148:151], v[48:51]
  ds_read_b128 v[140:143], v5 offset:35840
  s_waitcnt lgkmcnt(5)
  v_mfma_f32_16x16x32_bf16 v[44:47], a[240:243], v[152:155], v[44:47]
  v_mfma_f32_16x16x32_bf16 v[48:51], a[244:247], v[152:155], v[48:51]
  ds_read_b128 v[144:147], v5 offset:36864
  s_waitcnt lgkmcnt(5)
  v_mfma_f32_16x16x32_bf16 v[44:47], a[248:251], v[156:159], v[44:47]
  v_mfma_f32_16x16x32_bf16 v[48:51], a[252:255], v[156:159], v[48:51]
  ds_read_b128 v[148:151], v5 offset:37888
  s_waitcnt lgkmcnt(5)
  v_mfma_f32_16x16x32_bf16 v[52:55], a[0:3], v[128:131], 0
  v_mfma_f32_16x16x32_bf16 v[56:59], a[4:7], v[128:131], 0
  ds_read_b128 v[152:155], v5 offset:38912
  s_waitcnt lgkmcnt(5)
  v_mfma_f32_16x16x32_bf16 v[52:55], a[8:11], v[132:135], v[52:55]
  v_mfma_f32_16x16x32_bf16 v[56:59], a[12:15], v[132:135], v[56:59]
  ds_read_b128 v[156:159], v5 offset:39936
  s_waitcnt lgkmcnt(5)
  v_mfma_f32_16x16x32_bf16 v[52:55], a[16:19], v[136:139], v[52:55]
  v_mfma_f32_16x16x32_bf16 v[56:59], a[20:23], v[136:139], v[56:59]
  ds_read_b128 v[128:131], v5 offset:40960
  s_waitcnt lgkmcnt(5)
  v_mfma_f32_16x16x32_bf16 v[52:55], a[24:27], v[140:143], v[52:55]
  v_mfma_f32_16x16x32_bf16 v[56:59], a[28:31], v[140:143], v[56:59]
  ds_read_b128 v[132:135], v5 offset:41984
  s_waitcnt lgkmcnt(5)
  v_mfma_f32_16x16x32_bf16 v[52:55], a[32:35], v[144:147], v[52:55]
  v_mfma_f32_16x16x32_bf16 v[56:59], a[36:39], v[144:147], v[56:59]
  ds_read_b128 v[136:139], v5 offset:43008
  s_waitcnt lgkmcnt(5)
  v_mfma_f32_16x16x32_bf16 v[52:55], a[40:43], v[148:151], v[52:55]
  v_mfma_f32_16x16x32_bf16 v[56:59], a[44:47], v[148:151], v[56:59]
  ds_read_b128 v[140:143], v5 offset:44032
  s_waitcnt lgkmcnt(5)
  v_mfma_f32_16x16x32_bf16 v[52:55], a[48:51], v[152:155], v[52:55]
  v_mfma_f32_16x16x32_bf16 v[56:59], a[52:55], v[152:155], v[56:59]
  ds_read_b128 v[144:147], v5 offset:45056
  s_waitcnt lgkmcnt(5)
  v_mfma_f32_16x16x32_bf16 v[52:55], a[56:59], v[156:159], v[52:55]
  v_mfma_f32_16x16x32_bf16 v[56:59], a[60:63], v[156:159], v[56:59]
  ds_read_b128 v[148:151], v5 offset:46080
  s_waitcnt lgkmcnt(5)
  v_mfma_f32_16x16x32_bf16 v[52:55], a[64:67], v[128:131], v[52:55]
  v_mfma_f32_16x16x32_bf16 v[56:59], a[68:71], v[128:131], v[56:59]
  ds_read_b128 v[152:155], v5 offset:47104
  s_waitcnt lgkmcnt(5)
  v_mfma_f32_16x16x32_bf16 v[52:55], a[72:75], v[132:135], v[52:55]
  v_mfma_f32_16x16x32_bf16 v[56:59], a[76:79], v[132:135], v[56:59]
  ds_read_b128 v[156:159], v5 offset:48128
  s_waitcnt lgkmcnt(5)
  v_mfma_f32_16x16x32_bf16 v[52:55], a[80:83], v[136:139], v[52:55]
  v_mfma_f32_16x16x32_bf16 v[56:59], a[84:87], v[136:139], v[56:59]
  s_waitcnt vmcnt(0)
  s_barrier
  ds_read_b128 v[128:131], v5 offset:49152
  s_waitcnt lgkmcnt(5)
  v_mfma_f32_16x16x32_bf16 v[52:55], a[88:91], v[140:143], v[52:55]
  v_mfma_f32_16x16x32_bf16 v[56:59], a[92:95], v[140:143], v[56:59]
  ds_read_b128 v[132:135], v5 offset:50176
  s_waitcnt lgkmcnt(5)
  v_mfma_f32_16x16x32_bf16 v[52:55], a[96:99], v[144:147], v[52:55]
  v_mfma_f32_16x16x32_bf16 v[56:59], a[100:103], v[144:147], v[56:59]
  v_cvt_pk_bf16_f32 v160, v44, v45
  v_cvt_pk_bf16_f32 v161, v46, v47
  v_cvt_pk_bf16_f32 v162, v48, v49
  v_cvt_pk_bf16_f32 v163, v50, v51
  buffer_store_dwordx4 v[160:163], v1, s[4:7], s63 offen offset:0 sc1
  ds_read_b128 v[136:139], v5 offset:51200
  s_waitcnt lgkmcnt(5)
  v_mfma_f32_16x16x32_bf16 v[52:55], a[104:107], v[148:151], v[52:55]
  v_mfma_f32_16x16x32_bf16 v[56:59], a[108:111], v[148:151], v[56:59]
  ds_read_b128 v[140:143], v5 offset:52224
  s_waitcnt lgkmcnt(5)
  v_mfma_f32_16x16x32_bf16 v[52:55], a[112:115], v[152:155], v[52:55]
  v_mfma_f32_16x16x32_bf16 v[56:59], a[116:119], v[152:155], v[56:59]
  ds_read_b128 v[144:147], v5 offset:53248
  s_waitcnt lgkmcnt(5)
  v_mfma_f32_16x16x32_bf16 v[52:55], a[120:123], v[156:159], v[52:55]
  v_mfma_f32_16x16x32_bf16 v[56:59], a[124:127], v[156:159], v[56:59]
  ds_read_b128 v[148:151], v5 offset:54272
  s_waitcnt lgkmcnt(5)
  v_mfma_f32_16x16x32_bf16 v[52:55], a[128:131], v[128:131], v[52:55]
  v_mfma_f32_16x16x32_bf16 v[56:59], a[132:135], v[128:131], v[56:59]
  ds_read_b128 v[152:155], v5 offset:55296
  s_waitcnt lgkmcnt(5)
  v_mfma_f32_16x16x32_bf16 v[52:55], a[136:139], v[132:135], v[52:55]
  v_mfma_f32_16x16x32_bf16 v[56:59], a[140:143], v[132:135], v[56:59]
  ds_read_b128 v[156:159], v5 offset:56320
  s_waitcnt lgkmcnt(5)
  v_mfma_f32_16x16x32_bf16 v[52:55], a[144:147], v[136:139], v[52:55]
  v_mfma_f32_16x16x32_bf16 v[56:59], a[148:151], v[136:139], v[56:59]
  ds_read_b128 v[128:131], v5 offset:57344
  s_waitcnt lgkmcnt(5)
  v_mfma_f32_16x16x32_bf16 v[52:55], a[152:155], v[140:143], v[52:55]
  v_mfma_f32_16x16x32_bf16 v[56:59], a[156:159], v[140:143], v[56:59]
  ds_read_b128 v[132:135], v5 offset:58368
  s_waitcnt lgkmcnt(5)
  v_mfma_f32_16x16x32_bf16 v[52:55], a[160:163], v[144:147], v[52:55]
  v_mfma_f32_16x16x32_bf16 v[56:59], a[164:167], v[144:147], v[56:59]
  ds_read_b128 v[136:139], v5 offset:59392
  s_waitcnt lgkmcnt(5)
  v_mfma_f32_16x16x32_bf16 v[52:55], a[168:171], v[148:151], v[52:55]
  v_mfma_f32_16x16x32_bf16 v[56:59], a[172:175], v[148:151], v[56:59]
  ds_read_b128 v[140:143], v5 offset:60416
  s_waitcnt lgkmcnt(5)
  v_mfma_f32_16x16x32_bf16 v[52:55], a[176:179], v[152:155], v[52:55]
  v_mfma_f32_16x16x32_bf16 v[56:59], a[180:183], v[152:155], v[56:59]
  ds_read_b128 v[144:147], v5 offset:61440
  s_waitcnt lgkmcnt(5)
  v_mfma_f32_16x16x32_bf16 v[52:55], a[184:187], v[156:159], v[52:55]
  v_mfma_f32_16x16x32_bf16 v[56:59], a[188:191], v[156:159], v[56:59]
  ds_read_b128 v[148:151], v5 offset:62464
  s_waitcnt lgkmcnt(5)
  v_mfma_f32_16x16x32_bf16 v[52:55], a[192:195], v[128:131], v[52:55]
  v_mfma_f32_16x16x32_bf16 v[56:59], a[196:199], v[128:131], v[56:59]
  ds_read_b128 v[152:155], v5 offset:63488
  s_waitcnt lgkmcnt(5)
  v_mfma_f32_16x16x32_bf16 v[52:55], a[200:203], v[132:135], v[52:55]
  v_mfma_f32_16x16x32_bf16 v[56:59], a[204:207], v[132:135], v[56:59]
  ds_read_b128 v[156:159], v5 offset:64512
  s_waitcnt lgkmcnt(5)
  v_mfma_f32_16x16x32_bf16 v[52:55], a[208:211], v[136:139], v[52:55]
  v_mfma_f32_16x16x32_bf16 v[56:59], a[212:215], v[136:139], v[56:59]
  s_waitcnt lgkmcnt(4)
  v_mfma_f32_16x16x32_bf16 v[52:55], a[216:219], v[140:143], v[52:55]
  v_mfma_f32_16x16x32_bf16 v[56:59], a[220:223], v[140:143], v[56:59]
  s_waitcnt lgkmcnt(3)
  v_mfma_f32_16x16x32_bf16 v[52:55], a[224:227], v[144:147], v[52:55]
  v_mfma_f32_16x16x32_bf16 v[56:59], a[228:231], v[144:147], v[56:59]
  s_waitcnt lgkmcnt(2)
  v_mfma_f32_16x16x32_bf16 v[52:55], a[232:235], v[148:151], v[52:55]
  v_mfma_f32_16x16x32_bf16 v[56:59], a[236:239], v[148:151], v[56:59]
  s_waitcnt lgkmcnt(1)
  v_mfma_f32_16x16x32_bf16 v[52:55], a[240:243], v[152:155], v[52:55]
  v_mfma_f32_16x16x32_bf16 v[56:59], a[244:247], v[152:155], v[56:59]
  s_waitcnt lgkmcnt(0)
  v_mfma_f32_16x16x32_bf16 v[52:55], a[248:251], v[156:159], v[52:55]
  v_mfma_f32_16x16x32_bf16 v[56:59], a[252:255], v[156:159], v[56:59]
  s_nop 6
  v_cvt_pk_bf16_f32 v164, v52, v53
  v_cvt_pk_bf16_f32 v165, v54, v55
  v_cvt_pk_bf16_f32 v166, v56, v57
  v_cvt_pk_bf16_f32 v167, v58, v59
  buffer_store_dwordx4 v[164:167], v1, s[4:7], s63 offen offset:1024 sc1
  s_waitcnt vmcnt(0)
  s_barrier
  s_mov_b64 exec, 1
  v_mov_b32 v9, s45
  buffer_store_dword v9, off, s[4:7], s49 sc1
  s_mov_b64 exec, -1
  s_mov_b32 s49, s48
  s_and_b32 s62, s42, 983040
  s_cbranch_scc0 fe_110
fw_109:
  s_mov_b64 exec, 0xf0000
  buffer_load_dword v60, v22, s[4:7], 0 offen sc1
  s_mov_b64 exec, -1
  s_andn2_b32 s42, s42, 983040
  s_waitcnt vmcnt(0)
  v_cmp_lt_u32 vcc, v60, v23
  s_nop 0
  s_and_b32 s62, vcc_lo, 983040
  s_cbranch_scc0 fd_111
  s_sleep 1
  s_sub_u32 s94, s94, 1
  s_cbranch_scc0 fw_109
  s_mov_b32 s94, 0
fd_111:
fe_110:
  s_lshl_b32 s58, s50, 16
  s_lshl_b32 s59, s50, 7
  s_lshl_b32 s56, s50, 18
  s_min_u32 s56, s56, s48
  s_add_u32 s57, s56, 33554432
  buffer_load_dwordx2 v[236:237], v7, s[4:7], s57 offen sc1
  s_add_u32 s57, s56, 33619968
  buffer_load_dwordx2 v[238:239], v7, s[4:7], s57 offen sc1
  s_add_u32 s57, s56, 33685504
  buffer_load_dwordx2 v[240:241], v7, s[4:7], s57 offen sc1
  s_add_u32 s57, s56, 33751040
  buffer_load_dwordx2 v[242:243], v7, s[4:7], s57 offen sc1
  buffer_load_dword v244, v6, s[4:7], s59 offen sc1
  s_waitcnt vmcnt(0)
  v_lshlrev_b32 v128, 16, v228
  v_and_b32 v129, s34, v228
  v_lshlrev_b32 v130, 16, v229
  v_and_b32 v131, s34, v229
  v_lshlrev_b32 v132, 16, v230
  v_and_b32 v133, s34, v230
  v_lshlrev_b32 v134, 16, v231
  v_and_b32 v135, s34, v231
  v_lshlrev_b32 v136, 16, v232
  v_and_b32 v137, s34, v232
  v_lshlrev_b32 v138, 16, v233
  v_and_b32 v139, s34, v233
  v_lshlrev_b32 v140, 16, v234
  v_and_b32 v141, s34, v234
  v_lshlrev_b32 v142, 16, v235
  v_and_b32 v143, s34, v235
  v_lshlrev_b32 v144, 16, v236
  v_and_b32 v145, s34, v236
  v_lshlrev_b32 v146, 16, v237
  v_and_b32 v147, s34, v237
  v_lshlrev_b32 v148, 16, v238
  v_and_b32 v149, s34, v238
  v_lshlrev_b32 v150, 16, v239
  v_and_b32 v151, s34, v239
  v_lshlrev_b32 v152, 16, v240
  v_and_b32 v153, s34, v240
  v_lshlrev_b32 v154, 16, v241
  v_and_b32 v155, s34, v241
  v_lshlrev_b32 v156, 16, v242
  v_and_b32 v157, s34, v242
  v_lshlrev_b32 v158, 16, v243
  v_and_b32 v159, s34, v243
  v_add_f32 v128, v128, v132
  v_add_f32 v136, v136, v140
  v_add_f32 v129, v129, v133
  v_add_f32 v137, v137, v141
  v_add_f32 v130, v130, v134
  v_add_f32 v138, v138, v142
  v_add_f32 v131, v131, v135
  v_add_f32 v139, v139, v143
  v_add_f32 v128, v128, v136
  v_add_f32 v129, v129, v137
  v_add_f32 v130, v130, v138
  v_add_f32 v131, v131, v139
  v_add_f32 v144, v144, v148
  v_add_f32 v152, v152, v156
  v_add_f32 v145, v145, v149
  v_add_f32 v153, v153, v157
  v_add_f32 v146, v146, v150
  v_add_f32 v154, v154, v158
  v_add_f32 v147, v147, v151
  v_add_f32 v155, v155, v159
  v_add_f32 v144, v144, v152
  v_add_f32 v145, v145, v153
  v_add_f32 v146, v146, v154
  v_add_f32 v147, v147, v155
  v_sub_f32 v144, v144, v128
  v_sub_f32 v145, v145, v129
  v_sub_f32 v146, v146, v130
  v_sub_f32 v147, v147, v131
  v_fma_f32 v128, v144, v244, v128
  v_fma_f32 v129, v145, v244, v129
  v_fma_f32 v130, v146, v244, v130
  v_fma_f32 v131, v147, v244, v131
  v_cvt_pk_bf16_f32 v128, v128, v129
  v_cvt_pk_bf16_f32 v129, v130, v131
  buffer_store_dwordx2 v[128:129], v3, s[24:27], s58 offen
  s_branch T_end
ST_g:
  s_lshl_b32 s63, s32, 18
  s_add_u32 s63, s63, s52
  s_mov_b32 s49, s54
  s_mov_b32 s55, s32
  s_add_u32 s45, s45, 1
  v_readlane_b32 s32, v61, s45
  s_mov_b64 exec, 65280
  v_add_u32 v23, 1, v23
  s_mov_b64 exec, -1
  s_or_b32 s42, s42, 65280
  s_waitcnt vmcnt(22)
  s_barrier
  ds_read_b128 v[128:131], v5 offset:0
  ds_read_b128 v[132:135], v5 offset:1024
  ds_read_b128 v[136:139], v5 offset:2048
  ds_read_b128 v[140:143], v5 offset:3072
  ds_read_b128 v[144:147], v5 offset:4096
  ds_read_b128 v[148:151], v5 offset:5120
  s_waitcnt lgkmcnt(5)
  v_mfma_f32_16x16x32_bf16 v[44:47], a[0:3], v[128:131], 0
  v_mfma_f32_16x16x32_bf16 v[48:51], a[4:7], v[128:131], 0
  ds_read_b128 v[152:155], v5 offset:6144
  s_waitcnt lgkmcnt(5)
  v_mfma_f32_16x16x32_bf16 v[44:47], a[8:11], v[132:135], v[44:47]
  v_mfma_f32_16x16x32_bf16 v[48:51], a[12:15], v[132:135], v[48:51]
  ds_read_b128 v[156:159], v5 offset:7168
  s_waitcnt lgkmcnt(5)
  v_mfma_f32_16x16x32_bf16 v[44:47], a[16:19], v[136:139], v[44:47]
  v_mfma_f32_16x16x32_bf16 v[48:51], a[20:23], v[136:139], v[48:51]
  ds_read_b128 v[128:131], v5 offset:8192
  s_waitcnt lgkmcnt(5)
  v_mfma_f32_16x16x32_bf16 v[44:47], a[24:27], v[140:143], v[44:47]
  v_mfma_f32_16x16x32_bf16 v[48:51], a[28:31], v[140:143], v[48:51]
  ds_read_b128 v[132:135], v5 offset:9216
  s_waitcnt lgkmcnt(5)
  v_mfma_f32_16x16x32_bf16 v[44:47], a[32:35], v[144:147], v[44:47]
  v_mfma_f32_16x16x32_bf16 v[48:51], a[36:39], v[144:147], v[48:51]
  ds_read_b128 v[136:139], v5 offset:10240
  s_waitcnt lgkmcnt(5)
  v_mfma_f32_16x16x32_bf16 v[44:47], a[40:43], v[148:151], v[44:47]
  v_mfma_f32_16x16x32_bf16 v[48:51], a[44:47], v[148:151], v[48:51]
  ds_read_b128 v[140:143], v5 offset:11264
  s_waitcnt lgkmcnt(5)
  v_mfma_f32_16x16x32_bf16 v[44:47], a[48:51], v[152:155], v[44:47]
  v_mfma_f32_16x16x32_bf16 v[48:51], a[52:55], v[152:155], v[48:51]
  ds_read_b128 v[144:147], v5 offset:12288
  s_waitcnt lgkmcnt(5)
  v_mfma_f32_16x16x32_bf16 v[44:47], a[56:59], v[156:159], v[44:47]
  v_mfma_f32_16x16x32_bf16 v[48:51], a[60:63], v[156:159], v[48:51]
  ds_read_b128 v[148:151], v5 offset:13312
  s_waitcnt lgkmcnt(5)
  v_mfma_f32_16x16x32_bf16 v[44:47], a[64:67], v[128:131], v[44:47]
  v_mfma_f32_16x16x32_bf16 v[48:51], a[68:71], v[128:131], v[48:51]
  ds_read_b128 v[152:155], v5 offset:14336
  s_waitcnt lgkmcnt(5)
  v_mfma_f32_16x16x32_bf16 v[44:47], a[72:75], v[132:135], v[44:47]
  v_mfma_f32_16x16x32_bf16 v[48:51], a[76:79], v[132:135], v[48:51]
  ds_read_b128 v[156:159], v5 offset:15360
  s_waitcnt lgkmcnt(5)
  v_mfma_f32_16x16x32_bf16 v[44:47], a[80:83], v[136:139], v[44:47]
  v_mfma_f32_16x16x32_bf16 v[48:51], a[84:87], v[136:139], v[48:51]
  s_waitcnt vmcnt(18)
  s_barrier
  s_mov_b64 exec, 1
  v_mov_b32 v9, s44
  buffer_store_dword v9, off, s[4:7], s43 sc1
  s_mov_b64 exec, -1
  s_mov_b32 s43, s48
  s_mov_b64 exec, 0xfff1f
  buffer_load_dword v60, v22, s[4:7], 0 offen sc1
  s_mov_b64 exec, -1
  ds_read_b128 v[128:131], v5 offset:16384
  s_waitcnt lgkmcnt(5)
  v_mfma_f32_16x16x32_bf16 v[44:47], a[88:91], v[140:143], v[44:47]
  v_mfma_f32_16x16x32_bf16 v[48:51], a[92:95], v[140:143], v[48:51]
  ds_read_b128 v[132:135], v5 offset:17408
  s_waitcnt lgkmcnt(5)
  v_mfma_f32_16x16x32_bf16 v[44:47], a[96:99], v[144:147], v[44:47]
  v_mfma_f32_16x16x32_bf16 v[48:51], a[100:103], v[144:147], v[48:51]
  ds_read_b128 v[136:139], v5 offset:18432
  s_waitcnt lgkmcnt(5)
  v_mfma_f32_16x16x32_bf16 v[44:47], a[104:107], v[148:151], v[44:47]
  v_mfma_f32_16x16x32_bf16 v[48:51], a[108:111], v[148:151], v[48:51]
  ds_read_b128 v[140:143], v5 offset:19456
  s_waitcnt lgkmcnt(5)
  v_mfma_f32_16x16x32_bf16 v[44:47], a[112:115], v[152:155], v[44:47]
  v_mfma_f32_16x16x32_bf16 v[48:51], a[116:119], v[152:155], v[48:51]
  ds_read_b128 v[144:147], v5 offset:20480
  s_waitcnt lgkmcnt(5)
  v_mfma_f32_16x16x32_bf16 v[44:47], a[120:123], v[156:159], v[44:47]
  v_mfma_f32_16x16x32_bf16 v[48:51], a[124:127], v[156:159], v[48:51]
  ds_read_b128 v[148:151], v5 offset:21504
  s_waitcnt lgkmcnt(5)
  v_mfma_f32_16x16x32_bf16 v[44:47], a[128:131], v[128:131], v[44:47]
  v_mfma_f32_16x16x32_bf16 v[48:51], a[132:135], v[128:131], v[48:51]
  ds_read_b128 v[152:155], v5 offset:22528
  s_waitcnt lgkmcnt(5)
  v_mfma_f32_16x16x32_bf16 v[44:47], a[136:139], v[132:135], v[44:47]
  v_mfma_f32_16x16x32_bf16 v[48:51], a[140:143], v[132:135], v[48:51]
  ds_read_b128 v[156:159], v5 offset:23552
  s_waitcnt lgkmcnt(5)
  v_mfma_f32_16x16x32_bf16 v[44:47], a[144:147], v[136:139], v[44:47]
  v_mfma_f32_16x16x32_bf16 v[48:51], a[148:151], v[136:139], v[48:51]
  ds_read_b128 v[128:131], v5 offset:24576
  s_waitcnt lgkmcnt(5)
  v_mfma_f32_16x16x32_bf16 v[44:47], a[152:155], v[140:143], v[44:47]
  v_mfma_f32_16x16x32_bf16 v[48:51], a[156:159], v[140:143], v[48:51]
  ds_read_b128 v[132:135], v5 offset:25600
  s_waitcnt lgkmcnt(5)
  v_mfma_f32_16x16x32_bf16 v[44:47], a[160:163], v[144:147], v[44:47]
  v_mfma_f32_16x16x32_bf16 v[48:51], a[164:167], v[144:147], v[48:51]
  ds_read_b128 v[136:139], v5 offset:26624
  s_waitcnt lgkmcnt(5)
  v_mfma_f32_16x16x32_bf16 v[44:47], a[168:171], v[148:151], v[44:47]
  v_mfma_f32_16x16x32_bf16 v[48:51], a[172:175], v[148:151], v[48:51]
  ds_read_b128 v[140:143], v5 offset:27648
  s_waitcnt lgkmcnt(5)
  v_mfma_f32_16x16x32_bf16 v[44:47], a[176:179], v[152:155], v[44:47]
  v_mfma_f32_16x16x32_bf16 v[48:51], a[180:183], v[152:155], v[48:51]
  ds_read_b128 v[144:147], v5 offset:28672
  s_waitcnt lgkmcnt(5)
  v_mfma_f32_16x16x32_bf16 v[44:47], a[184:187], v[156:159], v[44:47]
  v_mfma_f32_16x16x32_bf16 v[48:51], a[188:191], v[156:159], v[48:51]
  ds_read_b128 v[148:151], v5 offset:29696
  s_waitcnt lgkmcnt(5)
  v_mfma_f32_16x16x32_bf16 v[44:47], a[192:195], v[128:131], v[44:47]
  v_mfma_f32_16x16x32_bf16 v[48:51], a[196:199], v[128:131], v[48:51]
  ds_read_b128 v[152:155], v5 offset:30720
  s_waitcnt lgkmcnt(5)
  v_mfma_f32_16x16x32_bf16 v[44:47], a[200:203], v[132:135], v[44:47]
  v_mfma_f32_16x16x32_bf16 v[48:51], a[204:207], v[132:135], v[48:51]
  ds_read_b128 v[156:159], v5 offset:31744
  s_waitcnt lgkmcnt(5)
  v_mfma_f32_16x16x32_bf16 v[44:47], a[208:211], v[136:139], v[44:47]
  v_mfma_f32_16x16x32_bf16 v[48:51], a[212:215], v[136:139], v[48:51]
  ds_read_b128 v[128:131], v5 offset:32768
  s_waitcnt lgkmcnt(5)
  v_mfma_f32_16x16x32_bf16 v[44:47], a[216:219], v[140:143], v[44:47]
  v_mfma_f32_16x16x32_bf16 v[48:51], a[220:223], v[140:143], v[48:51]
  ds_read_b128 v[132:135], v5 offset:33792
  s_waitcnt lgkmcnt(5)
  v_mfma_f32_16x16x32_bf16 v[44:47], a[224:227], v[144:147], v[44:47]
  v_mfma_f32_16x16x32_bf16 v[48:51], a[228:231], v[144:147], v[48:51]
  ds_read_b128 v[136:139], v5 offset:34816
  s_waitcnt lgkmcnt(5)
  v_mfma_f32_16x16x32_bf16 v[44:47], a[232:235], v[148:151], v[44:47]
  v_mfma_f32_16x16x32_bf16 v[48:51], a[236:239], v[148:151], v[48:51]
  ds_read_b128 v[140:143], v5 offset:35840
  s_waitcnt lgkmcnt(5)
  v_mfma_f32_16x16x32_bf16 v[44:47], a[240:243], v[152:155], v[44:47]
  v_mfma_f32_16x16x32_bf16 v[48:51], a[244:247], v[152:155], v[48:51]
  ds_read_b128 v[144:147], v5 offset:36864
  s_waitcnt lgkmcnt(5)
  v_mfma_f32_16x16x32_bf16 v[44:47], a[248:251], v[156:159], v[44:47]
  v_mfma_f32_16x16x32_bf16 v[48:51], a[252:255], v[156:159], v[48:51]
  ds_read_b128 v[148:151], v5 offset:37888
  s_waitcnt lgkmcnt(5)
  v_mfma_f32_16x16x32_bf16 v[52:55], a[0:3], v[128:131], 0
  v_mfma_f32_16x16x32_bf16 v[56:59], a[4:7], v[128:131], 0
  ds_read_b128 v[152:155], v5 offset:38912
  s_waitcnt lgkmcnt(5)
  v_mfma_f32_16x16x32_bf16 v[52:55], a[8:11], v[132:135], v[52:55]
  v_mfma_f32_16x16x32_bf16 v[56:59], a[12:15], v[132:135], v[56:59]
  ds_read_b128 v[156:159], v5 offset:39936
  s_waitcnt lgkmcnt(5)
  v_mfma_f32_16x16x32_bf16 v[52:55], a[16:19], v[136:139], v[52:55]
  v_mfma_f32_16x16x32_bf16 v[56:59], a[20:23], v[136:139], v[56:59]
  s_waitcnt vmcnt(0)
  v_cmp_lt_u32 vcc, v60, v23
  s_nop 0
  s_mov_b32 s42, vcc_lo
  s_and_b32 s62, s42, 983056
  s_cbranch_scc0 fe_113
fw_112:
  s_mov_b64 exec, 0xf0010
  buffer_load_dword v60, v22, s[4:7], 0 offen sc1
  s_mov_b64 exec, -1
  s_andn2_b32 s42, s42, 983056
  s_waitcnt vmcnt(0)
  v_cmp_lt_u32 vcc, v60, v23
  s_nop 0
  s_and_b32 s62, vcc_lo, 983056
  s_cbranch_scc0 fd_114
  s_sleep 1
  s_sub_u32 s94, s94, 1
  s_cbranch_scc0 fw_112
  s_mov_b32 s94, 0
fd_114:
fe_113:
  s_lshl_b32 s58, s50, 16
  s_lshl_b32 s59, s50, 7
  s_lshl_b32 s56, s50, 18
  s_min_u32 s56, s56, s48
  s_add_u32 s57, s58, 117440512
  buffer_load_dwordx2 v[228:229], v7, s[4:7], s57 offen
  s_add_u32 s57, s58, 121634816
  buffer_load_dwordx2 v[230:231], v7, s[4:7], s57 offen
  s_add_u32 s57, s58, 125829120
  buffer_load_dwordx2 v[232:233], v7, s[4:7], s57 offen
  s_add_u32 s57, s58, 130023424
  buffer_load_dwordx2 v[234:235], v7, s[4:7], s57 offen
  s_add_u32 s57, s56, 33554432
  buffer_load_dwordx2 v[236:237], v7, s[4:7], s57 offen sc1
  s_add_u32 s57, s56, 33619968
  buffer_load_dwordx2 v[238:239], v7, s[4:7], s57 offen sc1
  s_add_u32 s57, s56, 33685504
  buffer_load_dwordx2 v[240:241], v7, s[4:7], s57 offen sc1
  s_add_u32 s57, s56, 33751040
  buffer_load_dwordx2 v[242:243], v7, s[4:7], s57 offen sc1
  buffer_load_dword v244, v6, s[4:7], s59 offen sc1
  s_lshl_b32 s60, s37, 5
  s_add_u32 s60, s60, s29
  s_lshl_b32 s60, s60, 13
  s_add_u32 s60, s60, 8388608
  s_and_b32 s61, s42, 3
  s_cselect_b32 s60, s48, s60
  s_lshl_b32 s61, s30, 10
  s_add_u32 s61, s61, s60
  s_add_u32 s62, s61, 4096
  buffer_load_dwordx2 v[184:185], v1, s[4:7], s61 offen offset:8
  buffer_load_dwordx2 v[186:187], v1, s[4:7], s62 offen offset:8
  s_lshl_b32 s61, s36, 11
  s_add_u32 s61, s61, s60
  s_add_u32 s62, s61, 4096
  buffer_load_dwordx2 v[176:177], v1, s[4:7], s61 offen offset:0
  buffer_load_dwordx2 v[178:179], v1, s[4:7], s62 offen offset:0
  buffer_load_dwordx2 v[180:181], v1, s[4:7], s61 offen offset:1024
  buffer_load_dwordx2 v[182:183], v1, s[4:7], s62 offen offset:1024
  s_and_b32 s46, s42, 3
  ds_read_b128 v[128:131], v5 offset:40960
  s_waitcnt lgkmcnt(5)
  v_mfma_f32_16x16x32_bf16 v[52:55], a[24:27], v[140:143], v[52:55]
  v_mfma_f32_16x16x32_bf16 v[56:59], a[28:31], v[140:143], v[56:59]
  ds_read_b128 v[132:135], v5 offset:41984
  s_waitcnt lgkmcnt(5)
  v_mfma_f32_16x16x32_bf16 v[52:55], a[32:35], v[144:147], v[52:55]
  v_mfma_f32_16x16x32_bf16 v[56:59], a[36:39], v[144:147], v[56:59]
  ds_read_b128 v[136:139], v5 offset:43008
  s_waitcnt lgkmcnt(5)
  v_mfma_f32_16x16x32_bf16 v[52:55], a[40:43], v[148:151], v[52:55]
  v_mfma_f32_16x16x32_bf16 v[56:59], a[44:47], v[148:151], v[56:59]
  ds_read_b128 v[140:143], v5 offset:44032
  s_waitcnt lgkmcnt(5)
  v_mfma_f32_16x16x32_bf16 v[52:55], a[48:51], v[152:155], v[52:55]
  v_mfma_f32_16x16x32_bf16 v[56:59], a[52:55], v[152:155], v[56:59]
  ds_read_b128 v[144:147], v5 offset:45056
  s_waitcnt lgkmcnt(5)
  v_mfma_f32_16x16x32_bf16 v[52:55], a[56:59], v[156:159], v[52:55]
  v_mfma_f32_16x16x32_bf16 v[56:59], a[60:63], v[156:159], v[56:59]
  ds_read_b128 v[148:151], v5 offset:46080
  s_waitcnt lgkmcnt(5)
  v_mfma_f32_16x16x32_bf16 v[52:55], a[64:67], v[128:131], v[52:55]
  v_mfma_f32_16x16x32_bf16 v[56:59], a[68:71], v[128:131], v[56:59]
  ds_read_b128 v[152:155], v5 offset:47104
  s_waitcnt lgkmcnt(5)
  v_mfma_f32_16x16x32_bf16 v[52:55], a[72:75], v[132:135], v[52:55]
  v_mfma_f32_16x16x32_bf16 v[56:59], a[76:79], v[132:135], v[56:59]
  ds_read_b128 v[156:159], v5 offset:48128
  s_waitcnt lgkmcnt(5)
  v_mfma_f32_16x16x32_bf16 v[52:55], a[80:83], v[136:139], v[52:55]
  v_mfma_f32_16x16x32_bf16 v[56:59], a[84:87], v[136:139], v[56:59]
  ds_read_b128 v[128:131], v5 offset:49152
  s_waitcnt lgkmcnt(5)
  v_mfma_f32_16x16x32_bf16 v[52:55], a[88:91], v[140:143], v[52:55]
  v_mfma_f32_16x16x32_bf16 v[56:59], a[92:95], v[140:143], v[56:59]
  ds_read_b128 v[132:135], v5 offset:50176
  s_waitcnt lgkmcnt(5)
  v_mfma_f32_16x16x32_bf16 v[52:55], a[96:99], v[144:147], v[52:55]
  v_mfma_f32_16x16x32_bf16 v[56:59], a[100:103], v[144:147], v[56:59]
  ds_read_b128 v[136:139], v5 offset:51200
  s_waitcnt lgkmcnt(5)
  v_mfma_f32_16x16x32_bf16 v[52:55], a[104:107], v[148:151], v[52:55]
  v_mfma_f32_16x16x32_bf16 v[56:59], a[108:111], v[148:151], v[56:59]
  ds_read_b128 v[140:143], v5 offset:52224
  s_waitcnt lgkmcnt(5)
  v_mfma_f32_16x16x32_bf16 v[52:55], a[112:115], v[152:155], v[52:55]
  v_mfma_f32_16x16x32_bf16 v[56:59], a[116:119], v[152:155], v[56:59]
  ds_read_b128 v[144:147], v5 offset:53248
  s_waitcnt lgkmcnt(5)
  v_mfma_f32_16x16x32_bf16 v[52:55], a[120:123], v[156:159], v[52:55]
  v_mfma_f32_16x16x32_bf16 v[56:59], a[124:127], v[156:159], v[56:59]
  ds_read_b128 v[148:151], v5 offset:54272
  s_waitcnt lgkmcnt(5)
  v_mfma_f32_16x16x32_bf16 v[52:55], a[128:131], v[128:131], v[52:55]
  v_mfma_f32_16x16x32_bf16 v[56:59], a[132:135], v[128:131], v[56:59]
  ds_read_b128 v[152:155], v5 offset:55296
  s_waitcnt lgkmcnt(5)
  v_mfma_f32_16x16x32_bf16 v[52:55], a[136:139], v[132:135], v[52:55]
  v_mfma_f32_16x16x32_bf16 v[56:59], a[140:143], v[132:135], v[56:59]
  ds_read_b128 v[156:159], v5 offset:56320
  s_waitcnt lgkmcnt(5)
  v_mfma_f32_16x16x32_bf16 v[52:55], a[144:147], v[136:139], v[52:55]
  v_mfma_f32_16x16x32_bf16 v[56:59], a[148:151], v[136:139], v[56:59]
  ds_read_b128 v[128:131], v5 offset:57344
  s_waitcnt lgkmcnt(5)
  v_mfma_f32_16x16x32_bf16 v[52:55], a[152:155], v[140:143], v[52:55]
  v_mfma_f32_16x16x32_bf16 v[56:59], a[156:159], v[140:143], v[56:59]
  ds_read_b128 v[132:135], v5 offset:58368
  s_waitcnt lgkmcnt(5)
  v_mfma_f32_16x16x32_bf16 v[52:55], a[160:163], v[144:147], v[52:55]
  v_mfma_f32_16x16x32_bf16 v[56:59], a[164:167], v[144:147], v[56:59]
  s_mov_b64 exec, 0xfff1f
  buffer_load_dword v60, v22, s[4:7], 0 offen sc1
  s_mov_b64 exec, -1
  ds_read_b128 v[136:139], v5 offset:59392
  s_waitcnt lgkmcnt(5)
  v_mfma_f32_16x16x32_bf16 v[52:55], a[168:171], v[148:151], v[52:55]
  v_mfma_f32_16x16x32_bf16 v[56:59], a[172:175], v[148:151], v[56:59]
  ds_read_b128 v[140:143], v5 offset:60416
  s_waitcnt lgkmcnt(5)
  v_mfma_f32_16x16x32_bf16 v[52:55], a[176:179], v[152:155], v[52:55]
  v_mfma_f32_16x16x32_bf16 v[56:59], a[180:183], v[152:155], v[56:59]
  ds_read_b128 v[144:147], v5 offset:61440
  s_waitcnt lgkmcnt(5)
  v_mfma_f32_16x16x32_bf16 v[52:55], a[184:187], v[156:159], v[52:55]
  v_mfma_f32_16x16x32_bf16 v[56:59], a[188:191], v[156:159], v[56:59]
  ds_read_b128 v[148:151], v5 offset:62464
  s_waitcnt lgkmcnt(5)
  v_mfma_f32_16x16x32_bf16 v[52:55], a[192:195], v[128:131], v[52:55]
  v_mfma_f32_16x16x32_bf16 v[56:59], a[196:199], v[128:131], v[56:59]
  ds_read_b128 v[152:155], v5 offset:63488
  s_waitcnt lgkmcnt(5)
  v_mfma_f32_16x16x32_bf16 v[52:55], a[200:203], v[132:135], v[52:55]
  v_mfma_f32_16x16x32_bf16 v[56:59], a[204:207], v[132:135], v[56:59]
  ds_read_b128 v[156:159], v5 offset:64512
  s_waitcnt lgkmcnt(5)
  v_mfma_f32_16x16x32_bf16 v[52:55], a[208:211], v[136:139], v[52:55]
  v_mfma_f32_16x16x32_bf16 v[56:59], a[212:215], v[136:139], v[56:59]
  s_waitcnt lgkmcnt(4)
  v_mfma_f32_16x16x32_bf16 v[52:55], a[216:219], v[140:143], v[52:55]
  v_mfma_f32_16x16x32_bf16 v[56:59], a[220:223], v[140:143], v[56:59]
  s_waitcnt lgkmcnt(3)
  v_mfma_f32_16x16x32_bf16 v[52:55], a[224:227], v[144:147], v[52:55]
  v_mfma_f32_16x16x32_bf16 v[56:59], a[228:231], v[144:147], v[56:59]
  s_waitcnt lgkmcnt(2)
  v_mfma_f32_16x16x32_bf16 v[52:55], a[232:235], v[148:151], v[52:55]
  v_mfma_f32_16x16x32_bf16 v[56:59], a[236:239], v[148:151], v[56:59]
  s_waitcnt lgkmcnt(1)
  v_mfma_f32_16x16x32_bf16 v[52:55], a[240:243], v[152:155], v[52:55]
  v_mfma_f32_16x16x32_bf16 v[56:59], a[244:247], v[152:155], v[56:59]
  s_waitcnt lgkmcnt(0)
  v_mfma_f32_16x16x32_bf16 v[52:55], a[248:251], v[156:159], v[52:55]
  v_mfma_f32_16x16x32_bf16 v[56:59], a[252:255], v[156:159], v[56:59]
  v_cvt_pk_bf16_f32 v160, v44, v45
  v_cvt_pk_bf16_f32 v161, v46, v47
  v_cvt_pk_bf16_f32 v162, v48, v49
  v_cvt_pk_bf16_f32 v163, v50, v51
  buffer_store_dwordx4 v[160:163], v1, s[4:7], s63 offen offset:0 sc1
  s_nop 1
  v_cvt_pk_bf16_f32 v164, v52, v53
  v_cvt_pk_bf16_f32 v165, v54, v55
  v_cvt_pk_bf16_f32 v166, v56, v57
  v_cvt_pk_bf16_f32 v167, v58, v59
  buffer_store_dwordx4 v[164:167], v1, s[4:7], s63 offen offset:1024 sc1
  s_waitcnt vmcnt(2)
  v_cmp_lt_u32 vcc, v60, v23
  s_nop 0
  s_mov_b32 s42, vcc_lo
  v_lshlrev_b32 v128, 16, v228
  v_and_b32 v129, s34, v228
  v_lshlrev_b32 v130, 16, v229
  v_and_b32 v131, s34, v229
  v_lshlrev_b32 v132, 16, v230
  v_and_b32 v133, s34, v230
  v_lshlrev_b32 v134, 16, v231
  v_and_b32 v135, s34, v231
  v_lshlrev_b32 v136, 16, v232
  v_and_b32 v137, s34, v232
  v_lshlrev_b32 v138, 16, v233
  v_and_b32 v139, s34, v233
  v_lshlrev_b32 v140, 16, v234
  v_and_b32 v141, s34, v234
  v_lshlrev_b32 v142, 16, v235
  v_and_b32 v143, s34, v235
  v_lshlrev_b32 v144, 16, v236
  v_and_b32 v145, s34, v236
  v_lshlrev_b32 v146, 16, v237
  v_and_b32 v147, s34, v237
  v_lshlrev_b32 v148, 16, v238
  v_and_b32 v149, s34, v238
  v_lshlrev_b32 v150, 16, v239
  v_and_b32 v151, s34, v239
  v_lshlrev_b32 v152, 16, v240
  v_and_b32 v153, s34, v240
  v_lshlrev_b32 v154, 16, v241
  v_and_b32 v155, s34, v241
  v_lshlrev_b32 v156, 16, v242
  v_and_b32 v157, s34, v242
  v_lshlrev_b32 v158, 16, v243
  v_and_b32 v159, s34, v243
  v_add_f32 v128, v128, v132
  v_add_f32 v136, v136, v140
  v_add_f32 v129, v129, v133
  v_add_f32 v137, v137, v141
  v_add_f32 v130, v130, v134
  v_add_f32 v138, v138, v142
  v_add_f32 v131, v131, v135
  v_add_f32 v139, v139, v143
  v_add_f32 v128, v128, v136
  v_add_f32 v129, v129, v137
  v_add_f32 v130, v130, v138
  v_add_f32 v131, v131, v139
  v_add_f32 v144, v144, v148
  v_add_f32 v152, v152, v156
  v_add_f32 v145, v145, v149
  v_add_f32 v153, v153, v157
  v_add_f32 v146, v146, v150
  v_add_f32 v154, v154, v158
  v_add_f32 v147, v147, v151
  v_add_f32 v155, v155, v159
  v_add_f32 v144, v144, v152
  v_add_f32 v145, v145, v153
  v_add_f32 v146, v146, v154
  v_add_f32 v147, v147, v155
  v_sub_f32 v144, v144, v128
  v_sub_f32 v145, v145, v129
  v_sub_f32 v146, v146, v130
  v_sub_f32 v147, v147, v131
  v_fma_f32 v128, v144, v244, v128
  v_fma_f32 v129, v145, v244, v129
  v_fma_f32 v130, v146, v244, v130
  v_fma_f32 v131, v147, v244, v131
  v_cvt_pk_bf16_f32 v128, v128, v129
  v_cvt_pk_bf16_f32 v129, v130, v131
  buffer_store_dwordx2 v[128:129], v3, s[24:27], s58 offen
  s_mov_b32 s50, s55
  s_lshr_b32 s62, s50, 3
  s_lshl_b32 s62, s62, 7
  s_add_u32 s62, s62, 2628608
  v_writelane_b32 v22, s62, 4
  v_writelane_b32 v23, 16, 4
  s_mov_b64 exec, 0xf0000
  v_add_u32 v23, 1, v23
  s_mov_b64 exec, -1
  s_or_b32 s42, s42, 983056
  s_cmp_lg_u32 s45, s44
  s_cbranch_scc1 ST_loop
  s_mov_b32 s47, 3
ST_fb:
  s_waitcnt vmcnt(0)
  s_barrier
  s_mov_b64 exec, 1
  v_mov_b32 v9, s45
  buffer_store_dword v9, off, s[4:7], s49 sc1
  s_mov_b64 exec, -1
  s_mov_b32 s49, s48
  s_and_b32 s62, s42, 983056
  s_cbranch_scc0 fe_116
fw_115:
  s_mov_b64 exec, 0xf0010
  buffer_load_dword v60, v22, s[4:7], 0 offen sc1
  s_mov_b64 exec, -1
  s_andn2_b32 s42, s42, 983056
  s_waitcnt vmcnt(0)
  v_cmp_lt_u32 vcc, v60, v23
  s_nop 0
  s_and_b32 s62, vcc_lo, 983056
  s_cbranch_scc0 fd_117
  s_sleep 1
  s_sub_u32 s94, s94, 1
  s_cbranch_scc0 fw_115
  s_mov_b32 s94, 0
fd_117:
fe_116:
  s_lshl_b32 s58, s50, 16
  s_lshl_b32 s59, s50, 7
  s_lshl_b32 s56, s50, 18
  s_min_u32 s56, s56, s48
  s_add_u32 s57, s58, 117440512
  buffer_load_dwordx2 v[228:229], v7, s[4:7], s57 offen
  s_add_u32 s57, s58, 121634816
  buffer_load_dwordx2 v[230:231], v7, s[4:7], s57 offen
  s_add_u32 s57, s58, 125829120
  buffer_load_dwordx2 v[232:233], v7, s[4:7], s57 offen
  s_add_u32 s57, s58, 130023424
  buffer_load_dwordx2 v[234:235], v7, s[4:7], s57 offen
  s_add_u32 s57, s56, 33554432
  buffer_load_dwordx2 v[236:237], v7, s[4:7], s57 offen sc1
  s_add_u32 s57, s56, 33619968
  buffer_load_dwordx2 v[238:239], v7, s[4:7], s57 offen sc1
  s_add_u32 s57, s56, 33685504
  buffer_load_dwordx2 v[240:241], v7, s[4:7], s57 offen sc1
  s_add_u32 s57, s56, 33751040
  buffer_load_dwordx2 v[242:243], v7, s[4:7], s57 offen sc1
  buffer_load_dword v244, v6, s[4:7], s59 offen sc1
  s_waitcnt vmcnt(0)
  v_lshlrev_b32 v128, 16, v228
  v_and_b32 v129, s34, v228
  v_lshlrev_b32 v130, 16, v229
  v_and_b32 v131, s34, v229
  v_lshlrev_b32 v132, 16, v230
  v_and_b32 v133, s34, v230
  v_lshlrev_b32 v134, 16, v231
  v_and_b32 v135, s34, v231
  v_lshlrev_b32 v136, 16, v232
  v_and_b32 v137, s34, v232
  v_lshlrev_b32 v138, 16, v233
  v_and_b32 v139, s34, v233
  v_lshlrev_b32 v140, 16, v234
  v_and_b32 v141, s34, v234
  v_lshlrev_b32 v142, 16, v235
  v_and_b32 v143, s34, v235
  v_lshlrev_b32 v144, 16, v236
  v_and_b32 v145, s34, v236
  v_lshlrev_b32 v146, 16, v237
  v_and_b32 v147, s34, v237
  v_lshlrev_b32 v148, 16, v238
  v_and_b32 v149, s34, v238
  v_lshlrev_b32 v150, 16, v239
  v_and_b32 v151, s34, v239
  v_lshlrev_b32 v152, 16, v240
  v_and_b32 v153, s34, v240
  v_lshlrev_b32 v154, 16, v241
  v_and_b32 v155, s34, v241
  v_lshlrev_b32 v156, 16, v242
  v_and_b32 v157, s34, v242
  v_lshlrev_b32 v158, 16, v243
  v_and_b32 v159, s34, v243
  v_add_f32 v128, v128, v132
  v_add_f32 v136, v136, v140
  v_add_f32 v129, v129, v133
  v_add_f32 v137, v137, v141
  v_add_f32 v130, v130, v134
  v_add_f32 v138, v138, v142
  v_add_f32 v131, v131, v135
  v_add_f32 v139, v139, v143
  v_add_f32 v128, v128, v136
  v_add_f32 v129, v129, v137
  v_add_f32 v130, v130, v138
  v_add_f32 v131, v131, v139
  v_add_f32 v144, v144, v148
  v_add_f32 v152, v152, v156
  v_add_f32 v145, v145, v149
  v_add_f32 v153, v153, v157
  v_add_f32 v146, v146, v150
  v_add_f32 v154, v154, v158
  v_add_f32 v147, v147, v151
  v_add_f32 v155, v155, v159
  v_add_f32 v144, v144, v152
  v_add_f32 v145, v145, v153
  v_add_f32 v146, v146, v154
  v_add_f32 v147, v147, v155
  v_sub_f32 v144, v144, v128
  v_sub_f32 v145, v145, v129
  v_sub_f32 v146, v146, v130
  v_sub_f32 v147, v147, v131
  v_fma_f32 v128, v144, v244, v128
  v_fma_f32 v129, v145, v244, v129
  v_fma_f32 v130, v146, v244, v130
  v_fma_f32 v131, v147, v244, v131
  v_cvt_pk_bf16_f32 v128, v128, v129
  v_cvt_pk_bf16_f32 v129, v130, v131
  buffer_store_dwordx2 v[128:129], v3, s[24:27], s58 offen
  s_mov_b32 s50, s37
  s_lshr_b32 s62, s50, 3
  s_lshl_b32 s62, s62, 7
  s_add_u32 s62, s62, 2628608
  v_writelane_b32 v22, s62, 4
  v_writelane_b32 v23, 16, 4
  s_mov_b64 exec, 0xf0000
  v_add_u32 v23, 1, v23
  s_mov_b64 exec, -1
  s_or_b32 s42, s42, 983056
  s_and_b32 s62, s42, 16
  s_cbranch_scc0 fe_119
fw_118:
  s_mov_b64 exec, 0x10
  buffer_load_dword v60, v22, s[4:7], 0 offen sc1
  s_mov_b64 exec, -1
  s_andn2_b32 s42, s42, 16
  s_waitcnt vmcnt(0)
  v_cmp_lt_u32 vcc, v60, v23
  s_nop 0
  s_and_b32 s62, vcc_lo, 16
  s_cbranch_scc0 fd_120
  s_sleep 1
  s_sub_u32 s94, s94, 1
  s_cbranch_scc0 fw_118
  s_mov_b32 s94, 0
fd_120:
fe_119:
  s_lshl_b32 s58, s50, 16
  s_lshl_b32 s59, s50, 7
  s_lshl_b32 s56, s50, 18
  s_min_u32 s56, s56, s48
  s_add_u32 s57, s58, 117440512
  buffer_load_dwordx2 v[228:229], v7, s[4:7], s57 offen
  s_add_u32 s57, s58, 121634816
  buffer_load_dwordx2 v[230:231], v7, s[4:7], s57 offen
  s_add_u32 s57, s58, 125829120
  buffer_load_dwordx2 v[232:233], v7, s[4:7], s57 offen
  s_add_u32 s57, s58, 130023424
  buffer_load_dwordx2 v[234:235], v7, s[4:7], s57 offen
  s_branch ST_att
T_end:
  s_branch L_fin
R_start:
  s_cmp_eq_u32 s28, 2
  s_cselect_b32 s32, 1, 0
  s_mov_b32 s8, s72
  s_mov_b32 s9, s73
  s_mov_b32 s10, 0x800000
  s_mov_b32 s11, 0x20000
  s_mov_b32 s24, s74
  s_mov_b32 s25, s75
  s_mov_b32 s26, 0x800000
  s_mov_b32 s27, 0x20000
  v_mov_b32 v40, -1
  v_mov_b32 v41, -1
  v_mov_b32 v42, -1
  v_mov_b32 v43, -1
  v_lshlrev_b32 v9, 3, v0
  v_lshlrev_b32 v17, 2, v0
  v_lshrrev_b32 v112, 4, v0
  v_and_b32 v113, 1, v112
  s_lshl_b32 s56, s30, 1
  v_or_b32 v113, s56, v113
  v_bfe_u32 v116, v0, 1, 3
  v_xor_b32 v113, v113, v116
  v_lshlrev_b32 v113, 5, v113
  v_and_b32 v116, 1, v0
  v_lshl_add_u32 v113, v116, 4, v113
  s_lshl_b32 s56, s30, 4
  v_add_u32 v112, s56, v112
  s_lshl_b32 s56, s32, 22
  s_lshl_b32 s57, s29, 8
  s_add_u32 s56, s56, s57
  v_lshl_add_u32 v114, v112, 13, v113
  v_add_u32 v114, s56, v114
  s_lshl_b32 s56, s29, 18
  s_lshl_b32 s57, s32, 10
  s_add_u32 s56, s56, s57
  v_lshl_add_u32 v115, v112, 11, v113
  v_add_u32 v115, s56, v115
  s_lshl_b32 s51, s30, 12
  s_add_u32 m0, s51, 0
  s_mov_b32 s56, 0
  buffer_load_dwordx4 v114, s[16:19], s56 offen  lds
  s_add_u32 m0, s51, 1024
  s_mov_b32 s56, 32768
  buffer_load_dwordx4 v114, s[16:19], s56 offen  lds
  s_add_u32 m0, s51, 2048
  s_mov_b32 s56, 65536
  buffer_load_dwordx4 v114, s[16:19], s56 offen  lds
  s_add_u32 m0, s51, 3072
  s_mov_b32 s56, 98304
  buffer_load_dwordx4 v114, s[16:19], s56 offen  lds
  s_add_u32 m0, s51, 16384
  s_mov_b32 s56, 524288
  buffer_load_dwordx4 v114, s[16:19], s56 offen  lds
  s_add_u32 m0, s51, 17408
  s_mov_b32 s56, 557056
  buffer_load_dwordx4 v114, s[16:19], s56 offen  lds
  s_add_u32 m0, s51, 18432
  s_mov_b32 s56, 589824
  buffer_load_dwordx4 v114, s[16:19], s56 offen  lds
  s_add_u32 m0, s51, 19456
  s_mov_b32 s56, 622592
  buffer_load_dwordx4 v114, s[16:19], s56 offen  lds
  s_add_u32 m0, s51, 32768
  s_mov_b32 s56, 1048576
  buffer_load_dwordx4 v114, s[16:19], s56 offen  lds
  s_add_u32 m0, s51, 33792
  s_mov_b32 s56, 1081344
  buffer_load_dwordx4 v114, s[16:19], s56 offen  lds
  s_add_u32 m0, s51, 34816
  s_mov_b32 s56, 1114112
  buffer_load_dwordx4 v114, s[16:19], s56 offen  lds
  s_add_u32 m0, s51, 35840
  s_mov_b32 s56, 1146880
  buffer_load_dwordx4 v114, s[16:19], s56 offen  lds
  s_add_u32 m0, s51, 49152
  s_mov_b32 s56, 1572864
  buffer_load_dwordx4 v114, s[16:19], s56 offen  lds
  s_add_u32 m0, s51, 50176
  s_mov_b32 s56, 1605632
  buffer_load_dwordx4 v114, s[16:19], s56 offen  lds
  s_add_u32 m0, s51, 51200
  s_mov_b32 s56, 1638400
  buffer_load_dwordx4 v114, s[16:19], s56 offen  lds
  s_add_u32 m0, s51, 52224
  s_mov_b32 s56, 1671168
  buffer_load_dwordx4 v114, s[16:19], s56 offen  lds
  s_add_u32 m0, s51, 65536
  s_mov_b32 s56, 2097152
  buffer_load_dwordx4 v114, s[16:19], s56 offen  lds
  s_add_u32 m0, s51, 66560
  s_mov_b32 s56, 2129920
  buffer_load_dwordx4 v114, s[16:19], s56 offen  lds
  s_add_u32 m0, s51, 67584
  s_mov_b32 s56, 2162688
  buffer_load_dwordx4 v114, s[16:19], s56 offen  lds
  s_add_u32 m0, s51, 68608
  s_mov_b32 s56, 2195456
  buffer_load_dwordx4 v114, s[16:19], s56 offen  lds
  s_add_u32 m0, s51, 81920
  s_mov_b32 s56, 2621440
  buffer_load_dwordx4 v114, s[16:19], s56 offen  lds
  s_add_u32 m0, s51, 82944
  s_mov_b32 s56, 2654208
  buffer_load_dwordx4 v114, s[16:19], s56 offen  lds
  s_add_u32 m0, s51, 83968
  s_mov_b32 s56, 2686976
  buffer_load_dwordx4 v114, s[16:19], s56 offen  lds
  s_add_u32 m0, s51, 84992
  s_mov_b32 s56, 2719744
  buffer_load_dwordx4 v114, s[16:19], s56 offen  lds
  s_add_u32 m0, s51, 98304
  s_mov_b32 s56, 3145728
  buffer_load_dwordx4 v114, s[16:19], s56 offen  lds
  s_add_u32 m0, s51, 99328
  s_mov_b32 s56, 3178496
  buffer_load_dwordx4 v114, s[16:19], s56 offen  lds
  s_add_u32 m0, s51, 100352
  s_mov_b32 s56, 3211264
  buffer_load_dwordx4 v114, s[16:19], s56 offen  lds
  s_add_u32 m0, s51, 101376
  s_mov_b32 s56, 3244032
  buffer_load_dwordx4 v114, s[16:19], s56 offen  lds
  s_add_u32 m0, s51, 114688
  s_mov_b32 s56, 3670016
  buffer_load_dwordx4 v114, s[16:19], s56 offen  lds
  s_add_u32 m0, s51, 115712
  s_mov_b32 s56, 3702784
  buffer_load_dwordx4 v114, s[16:19], s56 offen  lds
  s_add_u32 m0, s51, 116736
  s_mov_b32 s56, 3735552
  buffer_load_dwordx4 v114, s[16:19], s56 offen  lds
  s_add_u32 m0, s51, 117760
  s_mov_b32 s56, 3768320
  buffer_load_dwordx4 v114, s[16:19], s56 offen  lds
  s_lshl_b32 s56, s29, 16
  s_lshl_b32 s57, s32, 14
  s_add_u32 s34, s56, s57
  s_xor_b32 s35, s34, 0x4000
  s_lshl_b32 s56, s32, 18
  s_add_u32 s38, s56, 3145728
  s_add_u32 s39, s38, 0x8000
  s_xor_b32 s53, s38, 0x80000
  s_lshl_b32 s56, s29, 2
  s_add_u32 s56, s56, s30
  s_lshl_b32 s57, s56, 11
  v_and_b32 v112, 15, v0
  v_lshrrev_b32 v113, 4, v0
  v_lshlrev_b32 v16, 6, v112
  v_lshl_add_u32 v16, v113, 4, v16
  v_add_u32 v16, s57, v16
  s_lshl_b32 s56, s56, 6
  s_lshl_b32 s57, s32, 13
  s_add_u32 s57, s57, 2097152
  s_add_u32 s63, s57, s56
  s_lshl_b32 s56, s30, 11
  s_add_u32 s62, s57, s56
  s_lshl_b32 s56, s30, 10
  s_add_u32 s56, s56, s35
  s_lshl_b32 s57, s30, 9
  s_add_u32 s57, s57, s35
  s_add_u32 s57, s57, 4096
  s_add_u32 s58, s56, 0
  buffer_store_dwordx4 v[40:43], v1, s[4:7], s58 offen sc1
  s_add_u32 s58, s57, 0
  buffer_store_dwordx2 v[40:41], v9, s[4:7], s58 offen sc1
  s_add_u32 s58, s56, 8192
  buffer_store_dwordx4 v[40:43], v1, s[4:7], s58 offen sc1
  s_add_u32 s58, s57, 8192
  buffer_store_dwordx2 v[40:41], v9, s[4:7], s58 offen sc1
  s_add_u32 s58, s56, 32768
  buffer_store_dwordx4 v[40:43], v1, s[4:7], s58 offen sc1
  s_add_u32 s58, s57, 32768
  buffer_store_dwordx2 v[40:41], v9, s[4:7], s58 offen sc1
  s_add_u32 s58, s56, 40960
  buffer_store_dwordx4 v[40:43], v1, s[4:7], s58 offen sc1
  s_add_u32 s58, s57, 40960
  buffer_store_dwordx2 v[40:41], v9, s[4:7], s58 offen sc1
  buffer_store_dwordx4 v[40:43], v16, s[4:7], s38 offen sc1
  buffer_store_dwordx4 v[40:43], v16, s[4:7], s38 offen offset:1024 sc1
  buffer_store_dwordx4 v[40:43], v16, s[4:7], s53 offen sc1
  buffer_store_dwordx4 v[40:43], v16, s[4:7], s53 offen offset:1024 sc1
  v_lshlrev_b32 v116, 2, v112
  v_lshl_add_u32 v116, v113, 14, v116
  buffer_store_dword v40, v116, s[4:7], s63 offen sc1
  v_and_b32 v116, 2, v112
  v_cmp_eq_u32 vcc, 0, v116
  v_mov_b32 v116, 0x44444444
  v_mov_b32 v117, 0xeeeeeeee
  v_cndmask_b32 v2, v117, v116, vcc
  v_mov_b32 v116, 0xf149f2ca
  v_cndmask_b32_e64 v28, v116, 0, vcc
  v_mov_b32 v29, v28
  v_mov_b32 v30, -1
  v_mov_b32 v32, 0
  v_mov_b32 v36, 0
  v_mov_b32 v44, 0x3f803f80
  v_mov_b32 v33, 0
  v_mov_b32 v37, 0
  v_mov_b32 v45, 0x3f803f80
  v_mov_b32 v34, 0
  v_mov_b32 v38, 0
  v_mov_b32 v46, 0x3f803f80
  v_mov_b32 v35, 0
  v_mov_b32 v39, 0
  v_mov_b32 v47, 0x3f803f80
  v_bfe_u32 v116, v112, 2, 1
  v_lshlrev_b32 v116, 4, v116
  v_mov_b32 v117, 0x3f80
  v_lshlrev_b32 v116, v116, v117
  v_and_b32 v117, 2, v112
  v_lshrrev_b32 v118, 3, v112
  v_add_u32 v117, v117, v118
  v_and_b32 v118, 1, v112
  v_lshlrev_b32 v118, 1, v118
  v_xor_b32 v118, v118, v113
  v_lshl_add_u32 v117, v118, 2, v117
  v_cmp_eq_u32 vcc, 0, v117
  s_nop 1
  v_cndmask_b32 v20, 0, v116, vcc
  v_cmp_eq_u32 vcc, 1, v117
  s_nop 1
  v_cndmask_b32 v21, 0, v116, vcc
  v_cmp_eq_u32 vcc, 2, v117
  s_nop 1
  v_cndmask_b32 v22, 0, v116, vcc
  v_cmp_eq_u32 vcc, 3, v117
  s_nop 1
  v_cndmask_b32 v23, 0, v116, vcc
  v_cmp_eq_u32 vcc, 4, v117
  s_nop 1
  v_cndmask_b32 v24, 0, v116, vcc
  v_cmp_eq_u32 vcc, 5, v117
  s_nop 1
  v_cndmask_b32 v25, 0, v116, vcc
  v_cmp_eq_u32 vcc, 6, v117
  s_nop 1
  v_cndmask_b32 v26, 0, v116, vcc
  v_cmp_eq_u32 vcc, 7, v117
  s_nop 1
  v_cndmask_b32 v27, 0, v116, vcc
  s_lshl_b32 s56, s30, 11
  s_add_u32 s56, s56, 131072
  v_add_u32 v3, s56, v1
  v_xor_b32 v4, 2048, v3
  v_xor_b32 v5, 4096, v3
  v_xor_b32 v6, 6144, v3
  v_lshrrev_b32 v116, 2, v112
  v_xor_b32 v117, v116, v113
  v_lshlrev_b32 v117, 3, v117
  v_lshl_add_u32 v117, v112, 5, v117
  s_lshl_b32 s56, s30, 10
  s_add_u32 s56, s56, 139264
  v_add_u32 v7, s56, v117
  v_and_b32 v117, 3, v0
  v_xor_b32 v118, v117, v113
  v_lshlrev_b32 v118, 3, v118
  v_lshrrev_b32 v119, 2, v0
  v_lshl_add_u32 v118, v119, 5, v118
  v_add_u32 v8, 139264, v118
  v_add_u32 v10, 143360, v9
  s_lshl_b32 s56, s30, 9
  v_add_u32 v11, s56, v10
  v_add_u32 v12, 145408, v1
  ds_write_b128 v12, v[32:35] offset:16384
  v_and_b32 v9, 0x1f0, v1
  v_lshrrev_b32 v14, 5, v0
  v_lshl_add_u32 v9, v14, 3, v9
  v_lshlrev_b32 v14, 7, v0
  s_sub_u32 s56, 3072, s56
  v_add_u32 v118, s56, v14
  v_cmp_gt_u32 vcc, 8, v0
  s_nop 1
  v_cndmask_b32 v14, v118, v14, vcc
  v_lshl_add_u32 v118, v116, 2, v113
  v_lshlrev_b32 v118, 11, v118
  v_lshl_add_u32 v118, v117, 4, v118
  s_lshl_b32 s56, s30, 16
  s_lshl_b32 s57, s29, 6
  s_add_u32 s56, s56, s57
  v_add_u32 v15, s56, v118
  v_and_b32 v118, 1, v113
  v_lshlrev_b32 v120, 5, v118
  v_lshrrev_b32 v118, 1, v113
  v_lshl_add_u32 v120, v118, 2, v120
  v_lshrrev_b32 v118, 1, v116
  v_lshl_add_u32 v120, v118, 4, v120
  v_and_b32 v118, 1, v116
  v_add_u32 v120, v120, v118
  v_lshlrev_b32 v120, 8, v120
  v_lshl_add_u32 v120, v117, 3, v120
  v_bfe_u32 v118, v0, 2, 3
  v_lshl_add_u32 v120, v118, 5, v120
  s_mul_i32 s56, s30, 40960
  v_add_u32 v13, s56, v1
  s_mov_b32 s33, 0
  s_mov_b32 s50, 0x3e0293ee
  s_mov_b32 s55, 0xffff0000
  s_lshl_b32 s56, s29, 13
  s_lshl_b32 s57, s30, 11
  s_add_u32 s56, s56, s57
  s_add_u32 s43, s56, 33554432
  s_add_u32 s44, s56, 50331648
  s_add_u32 s52, s57, 153600
  s_lshl_b32 s56, s29, 1
  s_add_u32 s56, s56, s32
  s_lshl_b32 s57, s56, 7
  s_add_u32 s47, s57, 2629632
  s_cmp_eq_u32 s30, 0
  s_cselect_b32 s47, s47, 0x10000000
  s_mov_b32 s96, 0
  s_add_u32 s42, s63, 0xc000
  s_mov_b32 s41, s63
  s_mov_b32 s40, s62
  s_lshl_b32 s56, s56, 12
  s_lshl_b32 s57, s30, 10
  s_add_u32 s56, s56, s57
  s_add_u32 s46, s56, 8388608
  s_mov_b32 s48, 2621440
  s_mov_b32 s49, 64
  s_add_u32 s56, s46, 16515072
  buffer_store_dwordx4 v[40:43], v1, s[4:7], s56 offen sc1
  s_waitcnt vmcnt(38)
  s_barrier
  s_cmp_lg_u32 s30, 0
  s_cbranch_scc1 wn_122
  v_xor_b32 v116, 0, v120
  ds_read_b64_tr_b16 a[128:129], v116 offset:0
  ds_read_b64_tr_b16 a[130:131], v116 offset:512
  ds_read_b64_tr_b16 a[132:133], v116 offset:2048
  ds_read_b64_tr_b16 a[134:135], v116 offset:2560
  ds_read_b64_tr_b16 a[144:145], v116 offset:16384
  ds_read_b64_tr_b16 a[146:147], v116 offset:16896
  ds_read_b64_tr_b16 a[148:149], v116 offset:18432
  ds_read_b64_tr_b16 a[150:151], v116 offset:18944
  v_xor_b32 v116, 32, v120
  ds_read_b64_tr_b16 a[136:137], v116 offset:0
  ds_read_b64_tr_b16 a[138:139], v116 offset:512
  ds_read_b64_tr_b16 a[140:141], v116 offset:2048
  ds_read_b64_tr_b16 a[142:143], v116 offset:2560
  ds_read_b64_tr_b16 a[152:153], v116 offset:16384
  ds_read_b64_tr_b16 a[154:155], v116 offset:16896
  ds_read_b64_tr_b16 a[156:157], v116 offset:18432
  ds_read_b64_tr_b16 a[158:159], v116 offset:18944
  s_branch wl_121
wn_122:
  s_cmp_lg_u32 s30, 1
  s_cbranch_scc1 wn_123
  v_xor_b32 v116, 64, v120
  ds_read_b64_tr_b16 a[160:161], v116 offset:0
  ds_read_b64_tr_b16 a[162:163], v116 offset:512
  ds_read_b64_tr_b16 a[164:165], v116 offset:2048
  ds_read_b64_tr_b16 a[166:167], v116 offset:2560
  ds_read_b64_tr_b16 a[176:177], v116 offset:16384
  ds_read_b64_tr_b16 a[178:179], v116 offset:16896
  ds_read_b64_tr_b16 a[180:181], v116 offset:18432
  ds_read_b64_tr_b16 a[182:183], v116 offset:18944
  v_xor_b32 v116, 96, v120
  ds_read_b64_tr_b16 a[168:169], v116 offset:0
  ds_read_b64_tr_b16 a[170:171], v116 offset:512
  ds_read_b64_tr_b16 a[172:173], v116 offset:2048
  ds_read_b64_tr_b16 a[174:175], v116 offset:2560
  ds_read_b64_tr_b16 a[184:185], v116 offset:16384
  ds_read_b64_tr_b16 a[186:187], v116 offset:16896
  ds_read_b64_tr_b16 a[188:189], v116 offset:18432
  ds_read_b64_tr_b16 a[190:191], v116 offset:18944
  s_branch wl_121
wn_123:
  s_cmp_lg_u32 s30, 2
  s_cbranch_scc1 wn_124
  v_xor_b32 v116, 128, v120
  ds_read_b64_tr_b16 a[192:193], v116 offset:0
  ds_read_b64_tr_b16 a[194:195], v116 offset:512
  ds_read_b64_tr_b16 a[196:197], v116 offset:2048
  ds_read_b64_tr_b16 a[198:199], v116 offset:2560
  ds_read_b64_tr_b16 a[208:209], v116 offset:16384
  ds_read_b64_tr_b16 a[210:211], v116 offset:16896
  ds_read_b64_tr_b16 a[212:213], v116 offset:18432
  ds_read_b64_tr_b16 a[214:215], v116 offset:18944
  v_xor_b32 v116, 160, v120
  ds_read_b64_tr_b16 a[200:201], v116 offset:0
  ds_read_b64_tr_b16 a[202:203], v116 offset:512
  ds_read_b64_tr_b16 a[204:205], v116 offset:2048
  ds_read_b64_tr_b16 a[206:207], v116 offset:2560
  ds_read_b64_tr_b16 a[216:217], v116 offset:16384
  ds_read_b64_tr_b16 a[218:219], v116 offset:16896
  ds_read_b64_tr_b16 a[220:221], v116 offset:18432
  ds_read_b64_tr_b16 a[222:223], v116 offset:18944
  s_branch wl_121
wn_124:
  s_cmp_lg_u32 s30, 3
  s_cbranch_scc1 wn_125
  v_xor_b32 v116, 192, v120
  ds_read_b64_tr_b16 a[224:225], v116 offset:0
  ds_read_b64_tr_b16 a[226:227], v116 offset:512
  ds_read_b64_tr_b16 a[228:229], v116 offset:2048
  ds_read_b64_tr_b16 a[230:231], v116 offset:2560
  ds_read_b64_tr_b16 a[240:241], v116 offset:16384
  ds_read_b64_tr_b16 a[242:243], v116 offset:16896
  ds_read_b64_tr_b16 a[244:245], v116 offset:18432
  ds_read_b64_tr_b16 a[246:247], v116 offset:18944
  v_xor_b32 v116, 224, v120
  ds_read_b64_tr_b16 a[232:233], v116 offset:0
  ds_read_b64_tr_b16 a[234:235], v116 offset:512
  ds_read_b64_tr_b16 a[236:237], v116 offset:2048
  ds_read_b64_tr_b16 a[238:239], v116 offset:2560
  ds_read_b64_tr_b16 a[248:249], v116 offset:16384
  ds_read_b64_tr_b16 a[250:251], v116 offset:16896
  ds_read_b64_tr_b16 a[252:253], v116 offset:18432
  ds_read_b64_tr_b16 a[254:255], v116 offset:18944
  s_branch wl_121
wn_125:
wl_121:
  s_waitcnt lgkmcnt(0)
  s_barrier
  s_add_u32 m0, s51, 0
  s_mov_b32 s56, 0
  buffer_load_dwordx4 v114, s[12:15], s56 offen  lds
  s_add_u32 m0, s51, 1024
  s_mov_b32 s56, 32768
  buffer_load_dwordx4 v114, s[12:15], s56 offen  lds
  s_add_u32 m0, s51, 2048
  s_mov_b32 s56, 65536
  buffer_load_dwordx4 v114, s[12:15], s56 offen  lds
  s_add_u32 m0, s51, 3072
  s_mov_b32 s56, 98304
  buffer_load_dwordx4 v114, s[12:15], s56 offen  lds
  s_add_u32 m0, s51, 16384
  s_mov_b32 s56, 524288
  buffer_load_dwordx4 v114, s[12:15], s56 offen  lds
  s_add_u32 m0, s51, 17408
  s_mov_b32 s56, 557056
  buffer_load_dwordx4 v114, s[12:15], s56 offen  lds
  s_add_u32 m0, s51, 18432
  s_mov_b32 s56, 589824
  buffer_load_dwordx4 v114, s[12:15], s56 offen  lds
  s_add_u32 m0, s51, 19456
  s_mov_b32 s56, 622592
  buffer_load_dwordx4 v114, s[12:15], s56 offen  lds
  s_waitcnt vmcnt(38)
  s_barrier
  s_cmp_lg_u32 s30, 0
  s_cbranch_scc1 wn_127
  v_xor_b32 v116, 32768, v120
  ds_read_b64_tr_b16 a[160:161], v116 offset:0
  ds_read_b64_tr_b16 a[162:163], v116 offset:512
  ds_read_b64_tr_b16 a[164:165], v116 offset:2048
  ds_read_b64_tr_b16 a[166:167], v116 offset:2560
  ds_read_b64_tr_b16 a[176:177], v116 offset:16384
  ds_read_b64_tr_b16 a[178:179], v116 offset:16896
  ds_read_b64_tr_b16 a[180:181], v116 offset:18432
  ds_read_b64_tr_b16 a[182:183], v116 offset:18944
  v_xor_b32 v116, 32800, v120
  ds_read_b64_tr_b16 a[168:169], v116 offset:0
  ds_read_b64_tr_b16 a[170:171], v116 offset:512
  ds_read_b64_tr_b16 a[172:173], v116 offset:2048
  ds_read_b64_tr_b16 a[174:175], v116 offset:2560
  ds_read_b64_tr_b16 a[184:185], v116 offset:16384
  ds_read_b64_tr_b16 a[186:187], v116 offset:16896
  ds_read_b64_tr_b16 a[188:189], v116 offset:18432
  ds_read_b64_tr_b16 a[190:191], v116 offset:18944
  s_branch wl_126
wn_127:
  s_cmp_lg_u32 s30, 1
  s_cbranch_scc1 wn_128
  v_xor_b32 v116, 32832, v120
  ds_read_b64_tr_b16 a[128:129], v116 offset:0
  ds_read_b64_tr_b16 a[130:131], v116 offset:512
  ds_read_b64_tr_b16 a[132:133], v116 offset:2048
  ds_read_b64_tr_b16 a[134:135], v116 offset:2560
  ds_read_b64_tr_b16 a[144:145], v116 offset:16384
  ds_read_b64_tr_b16 a[146:147], v116 offset:16896
  ds_read_b64_tr_b16 a[148:149], v116 offset:18432
  ds_read_b64_tr_b16 a[150:151], v116 offset:18944
  v_xor_b32 v116, 32864, v120
  ds_read_b64_tr_b16 a[136:137], v116 offset:0
  ds_read_b64_tr_b16 a[138:139], v116 offset:512
  ds_read_b64_tr_b16 a[140:141], v116 offset:2048
  ds_read_b64_tr_b16 a[142:143], v116 offset:2560
  ds_read_b64_tr_b16 a[152:153], v116 offset:16384
  ds_read_b64_tr_b16 a[154:155], v116 offset:16896
  ds_read_b64_tr_b16 a[156:157], v116 offset:18432
  ds_read_b64_tr_b16 a[158:159], v116 offset:18944
  s_branch wl_126
wn_128:
  s_cmp_lg_u32 s30, 2
  s_cbranch_scc1 wn_129
  v_xor_b32 v116, 32896, v120
  ds_read_b64_tr_b16 a[224:225], v116 offset:0
  ds_read_b64_tr_b16 a[226:227], v116 offset:512
  ds_read_b64_tr_b16 a[228:229], v116 offset:2048
  ds_read_b64_tr_b16 a[230:231], v116 offset:2560
  ds_read_b64_tr_b16 a[240:241], v116 offset:16384
  ds_read_b64_tr_b16 a[242:243], v116 offset:16896
  ds_read_b64_tr_b16 a[244:245], v116 offset:18432
  ds_read_b64_tr_b16 a[246:247], v116 offset:18944
  v_xor_b32 v116, 32928, v120
  ds_read_b64_tr_b16 a[232:233], v116 offset:0
  ds_read_b64_tr_b16 a[234:235], v116 offset:512
  ds_read_b64_tr_b16 a[236:237], v116 offset:2048
  ds_read_b64_tr_b16 a[238:239], v116 offset:2560
  ds_read_b64_tr_b16 a[248:249], v116 offset:16384
  ds_read_b64_tr_b16 a[250:251], v116 offset:16896
  ds_read_b64_tr_b16 a[252:253], v116 offset:18432
  ds_read_b64_tr_b16 a[254:255], v116 offset:18944
  s_branch wl_126
wn_129:
  s_cmp_lg_u32 s30, 3
  s_cbranch_scc1 wn_130
  v_xor_b32 v116, 32960, v120
  ds_read_b64_tr_b16 a[192:193], v116 offset:0
  ds_read_b64_tr_b16 a[194:195], v116 offset:512
  ds_read_b64_tr_b16 a[196:197], v116 offset:2048
  ds_read_b64_tr_b16 a[198:199], v116 offset:2560
  ds_read_b64_tr_b16 a[208:209], v116 offset:16384
  ds_read_b64_tr_b16 a[210:211], v116 offset:16896
  ds_read_b64_tr_b16 a[212:213], v116 offset:18432
  ds_read_b64_tr_b16 a[214:215], v116 offset:18944
  v_xor_b32 v116, 32992, v120
  ds_read_b64_tr_b16 a[200:201], v116 offset:0
  ds_read_b64_tr_b16 a[202:203], v116 offset:512
  ds_read_b64_tr_b16 a[204:205], v116 offset:2048
  ds_read_b64_tr_b16 a[206:207], v116 offset:2560
  ds_read_b64_tr_b16 a[216:217], v116 offset:16384
  ds_read_b64_tr_b16 a[218:219], v116 offset:16896
  ds_read_b64_tr_b16 a[220:221], v116 offset:18432
  ds_read_b64_tr_b16 a[222:223], v116 offset:18944
  s_branch wl_126
wn_130:
wl_126:
  s_waitcnt lgkmcnt(0)
  s_barrier
  s_add_u32 m0, s51, 32768
  s_mov_b32 s56, 1048576
  buffer_load_dwordx4 v114, s[12:15], s56 offen  lds
  s_add_u32 m0, s51, 33792
  s_mov_b32 s56, 1081344
  buffer_load_dwordx4 v114, s[12:15], s56 offen  lds
  s_add_u32 m0, s51, 34816
  s_mov_b32 s56, 1114112
  buffer_load_dwordx4 v114, s[12:15], s56 offen  lds
  s_add_u32 m0, s51, 35840
  s_mov_b32 s56, 1146880
  buffer_load_dwordx4 v114, s[12:15], s56 offen  lds
  s_add_u32 m0, s51, 49152
  s_mov_b32 s56, 1572864
  buffer_load_dwordx4 v114, s[12:15], s56 offen  lds
  s_add_u32 m0, s51, 50176
  s_mov_b32 s56, 1605632
  buffer_load_dwordx4 v114, s[12:15], s56 offen  lds
  s_add_u32 m0, s51, 51200
  s_mov_b32 s56, 1638400
  buffer_load_dwordx4 v114, s[12:15], s56 offen  lds
  s_add_u32 m0, s51, 52224
  s_mov_b32 s56, 1671168
  buffer_load_dwordx4 v114, s[12:15], s56 offen  lds
  s_waitcnt vmcnt(38)
  s_barrier
  s_cmp_lg_u32 s30, 0
  s_cbranch_scc1 wn_132
  v_xor_b32 v116, 65536, v120
  ds_read_b64_tr_b16 a[192:193], v116 offset:0
  ds_read_b64_tr_b16 a[194:195], v116 offset:512
  ds_read_b64_tr_b16 a[196:197], v116 offset:2048
  ds_read_b64_tr_b16 a[198:199], v116 offset:2560
  ds_read_b64_tr_b16 a[208:209], v116 offset:16384
  ds_read_b64_tr_b16 a[210:211], v116 offset:16896
  ds_read_b64_tr_b16 a[212:213], v116 offset:18432
  ds_read_b64_tr_b16 a[214:215], v116 offset:18944
  v_xor_b32 v116, 65568, v120
  ds_read_b64_tr_b16 a[200:201], v116 offset:0
  ds_read_b64_tr_b16 a[202:203], v116 offset:512
  ds_read_b64_tr_b16 a[204:205], v116 offset:2048
  ds_read_b64_tr_b16 a[206:207], v116 offset:2560
  ds_read_b64_tr_b16 a[216:217], v116 offset:16384
  ds_read_b64_tr_b16 a[218:219], v116 offset:16896
  ds_read_b64_tr_b16 a[220:221], v116 offset:18432
  ds_read_b64_tr_b16 a[222:223], v116 offset:18944
  s_branch wl_131
wn_132:
  s_cmp_lg_u32 s30, 1
  s_cbranch_scc1 wn_133
  v_xor_b32 v116, 65600, v120
  ds_read_b64_tr_b16 a[224:225], v116 offset:0
  ds_read_b64_tr_b16 a[226:227], v116 offset:512
  ds_read_b64_tr_b16 a[228:229], v116 offset:2048
  ds_read_b64_tr_b16 a[230:231], v116 offset:2560
  ds_read_b64_tr_b16 a[240:241], v116 offset:16384
  ds_read_b64_tr_b16 a[242:243], v116 offset:16896
  ds_read_b64_tr_b16 a[244:245], v116 offset:18432
  ds_read_b64_tr_b16 a[246:247], v116 offset:18944
  v_xor_b32 v116, 65632, v120
  ds_read_b64_tr_b16 a[232:233], v116 offset:0
  ds_read_b64_tr_b16 a[234:235], v116 offset:512
  ds_read_b64_tr_b16 a[236:237], v116 offset:2048
  ds_read_b64_tr_b16 a[238:239], v116 offset:2560
  ds_read_b64_tr_b16 a[248:249], v116 offset:16384
  ds_read_b64_tr_b16 a[250:251], v116 offset:16896
  ds_read_b64_tr_b16 a[252:253], v116 offset:18432
  ds_read_b64_tr_b16 a[254:255], v116 offset:18944
  s_branch wl_131
wn_133:
  s_cmp_lg_u32 s30, 2
  s_cbranch_scc1 wn_134
  v_xor_b32 v116, 65664, v120
  ds_read_b64_tr_b16 a[128:129], v116 offset:0
  ds_read_b64_tr_b16 a[130:131], v116 offset:512
  ds_read_b64_tr_b16 a[132:133], v116 offset:2048
  ds_read_b64_tr_b16 a[134:135], v116 offset:2560
  ds_read_b64_tr_b16 a[144:145], v116 offset:16384
  ds_read_b64_tr_b16 a[146:147], v116 offset:16896
  ds_read_b64_tr_b16 a[148:149], v116 offset:18432
  ds_read_b64_tr_b16 a[150:151], v116 offset:18944
  v_xor_b32 v116, 65696, v120
  ds_read_b64_tr_b16 a[136:137], v116 offset:0
  ds_read_b64_tr_b16 a[138:139], v116 offset:512
  ds_read_b64_tr_b16 a[140:141], v116 offset:2048
  ds_read_b64_tr_b16 a[142:143], v116 offset:2560
  ds_read_b64_tr_b16 a[152:153], v116 offset:16384
  ds_read_b64_tr_b16 a[154:155], v116 offset:16896
  ds_read_b64_tr_b16 a[156:157], v116 offset:18432
  ds_read_b64_tr_b16 a[158:159], v116 offset:18944
  s_branch wl_131
wn_134:
  s_cmp_lg_u32 s30, 3
  s_cbranch_scc1 wn_135
  v_xor_b32 v116, 65728, v120
  ds_read_b64_tr_b16 a[160:161], v116 offset:0
  ds_read_b64_tr_b16 a[162:163], v116 offset:512
  ds_read_b64_tr_b16 a[164:165], v116 offset:2048
  ds_read_b64_tr_b16 a[166:167], v116 offset:2560
  ds_read_b64_tr_b16 a[176:177], v116 offset:16384
  ds_read_b64_tr_b16 a[178:179], v116 offset:16896
  ds_read_b64_tr_b16 a[180:181], v116 offset:18432
  ds_read_b64_tr_b16 a[182:183], v116 offset:18944
  v_xor_b32 v116, 65760, v120
  ds_read_b64_tr_b16 a[168:169], v116 offset:0
  ds_read_b64_tr_b16 a[170:171], v116 offset:512
  ds_read_b64_tr_b16 a[172:173], v116 offset:2048
  ds_read_b64_tr_b16 a[174:175], v116 offset:2560
  ds_read_b64_tr_b16 a[184:185], v116 offset:16384
  ds_read_b64_tr_b16 a[186:187], v116 offset:16896
  ds_read_b64_tr_b16 a[188:189], v116 offset:18432
  ds_read_b64_tr_b16 a[190:191], v116 offset:18944
  s_branch wl_131
wn_135:
wl_131:
  s_waitcnt lgkmcnt(0)
  s_barrier
  s_add_u32 m0, s51, 65536
  s_mov_b32 s56, 2097152
  buffer_load_dwordx4 v114, s[12:15], s56 offen  lds
  s_add_u32 m0, s51, 66560
  s_mov_b32 s56, 2129920
  buffer_load_dwordx4 v114, s[12:15], s56 offen  lds
  s_add_u32 m0, s51, 67584
  s_mov_b32 s56, 2162688
  buffer_load_dwordx4 v114, s[12:15], s56 offen  lds
  s_add_u32 m0, s51, 68608
  s_mov_b32 s56, 2195456
  buffer_load_dwordx4 v114, s[12:15], s56 offen  lds
  s_add_u32 m0, s51, 81920
  s_mov_b32 s56, 2621440
  buffer_load_dwordx4 v114, s[12:15], s56 offen  lds
  s_add_u32 m0, s51, 82944
  s_mov_b32 s56, 2654208
  buffer_load_dwordx4 v114, s[12:15], s56 offen  lds
  s_add_u32 m0, s51, 83968
  s_mov_b32 s56, 2686976
  buffer_load_dwordx4 v114, s[12:15], s56 offen  lds
  s_add_u32 m0, s51, 84992
  s_mov_b32 s56, 2719744
  buffer_load_dwordx4 v114, s[12:15], s56 offen  lds
  s_waitcnt vmcnt(38)
  s_barrier
  s_cmp_lg_u32 s30, 0
  s_cbranch_scc1 wn_137
  v_xor_b32 v116, 98304, v120
  ds_read_b64_tr_b16 a[224:225], v116 offset:0
  ds_read_b64_tr_b16 a[226:227], v116 offset:512
  ds_read_b64_tr_b16 a[228:229], v116 offset:2048
  ds_read_b64_tr_b16 a[230:231], v116 offset:2560
  ds_read_b64_tr_b16 a[240:241], v116 offset:16384
  ds_read_b64_tr_b16 a[242:243], v116 offset:16896
  ds_read_b64_tr_b16 a[244:245], v116 offset:18432
  ds_read_b64_tr_b16 a[246:247], v116 offset:18944
  v_xor_b32 v116, 98336, v120
  ds_read_b64_tr_b16 a[232:233], v116 offset:0
  ds_read_b64_tr_b16 a[234:235], v116 offset:512
  ds_read_b64_tr_b16 a[236:237], v116 offset:2048
  ds_read_b64_tr_b16 a[238:239], v116 offset:2560
  ds_read_b64_tr_b16 a[248:249], v116 offset:16384
  ds_read_b64_tr_b16 a[250:251], v116 offset:16896
  ds_read_b64_tr_b16 a[252:253], v116 offset:18432
  ds_read_b64_tr_b16 a[254:255], v116 offset:18944
  s_branch wl_136
wn_137:
  s_cmp_lg_u32 s30, 1
  s_cbranch_scc1 wn_138
  v_xor_b32 v116, 98368, v120
  ds_read_b64_tr_b16 a[192:193], v116 offset:0
  ds_read_b64_tr_b16 a[194:195], v116 offset:512
  ds_read_b64_tr_b16 a[196:197], v116 offset:2048
  ds_read_b64_tr_b16 a[198:199], v116 offset:2560
  ds_read_b64_tr_b16 a[208:209], v116 offset:16384
  ds_read_b64_tr_b16 a[210:211], v116 offset:16896
  ds_read_b64_tr_b16 a[212:213], v116 offset:18432
  ds_read_b64_tr_b16 a[214:215], v116 offset:18944
  v_xor_b32 v116, 98400, v120
  ds_read_b64_tr_b16 a[200:201], v116 offset:0
  ds_read_b64_tr_b16 a[202:203], v116 offset:512
  ds_read_b64_tr_b16 a[204:205], v116 offset:2048
  ds_read_b64_tr_b16 a[206:207], v116 offset:2560
  ds_read_b64_tr_b16 a[216:217], v116 offset:16384
  ds_read_b64_tr_b16 a[218:219], v116 offset:16896
  ds_read_b64_tr_b16 a[220:221], v116 offset:18432
  ds_read_b64_tr_b16 a[222:223], v116 offset:18944
  s_branch wl_136
wn_138:
  s_cmp_lg_u32 s30, 2
  s_cbranch_scc1 wn_139
  v_xor_b32 v116, 98432, v120
  ds_read_b64_tr_b16 a[160:161], v116 offset:0
  ds_read_b64_tr_b16 a[162:163], v116 offset:512
  ds_read_b64_tr_b16 a[164:165], v116 offset:2048
  ds_read_b64_tr_b16 a[166:167], v116 offset:2560
  ds_read_b64_tr_b16 a[176:177], v116 offset:16384
  ds_read_b64_tr_b16 a[178:179], v116 offset:16896
  ds_read_b64_tr_b16 a[180:181], v116 offset:18432
  ds_read_b64_tr_b16 a[182:183], v116 offset:18944
  v_xor_b32 v116, 98464, v120
  ds_read_b64_tr_b16 a[168:169], v116 offset:0
  ds_read_b64_tr_b16 a[170:171], v116 offset:512
  ds_read_b64_tr_b16 a[172:173], v116 offset:2048
  ds_read_b64_tr_b16 a[174:175], v116 offset:2560
  ds_read_b64_tr_b16 a[184:185], v116 offset:16384
  ds_read_b64_tr_b16 a[186:187], v116 offset:16896
  ds_read_b64_tr_b16 a[188:189], v116 offset:18432
  ds_read_b64_tr_b16 a[190:191], v116 offset:18944
  s_branch wl_136
wn_139:
  s_cmp_lg_u32 s30, 3
  s_cbranch_scc1 wn_140
  v_xor_b32 v116, 98496, v120
  ds_read_b64_tr_b16 a[128:129], v116 offset:0
  ds_read_b64_tr_b16 a[130:131], v116 offset:512
  ds_read_b64_tr_b16 a[132:133], v116 offset:2048
  ds_read_b64_tr_b16 a[134:135], v116 offset:2560
  ds_read_b64_tr_b16 a[144:145], v116 offset:16384
  ds_read_b64_tr_b16 a[146:147], v116 offset:16896
  ds_read_b64_tr_b16 a[148:149], v116 offset:18432
  ds_read_b64_tr_b16 a[150:151], v116 offset:18944
  v_xor_b32 v116, 98528, v120
  ds_read_b64_tr_b16 a[136:137], v116 offset:0
  ds_read_b64_tr_b16 a[138:139], v116 offset:512
  ds_read_b64_tr_b16 a[140:141], v116 offset:2048
  ds_read_b64_tr_b16 a[142:143], v116 offset:2560
  ds_read_b64_tr_b16 a[152:153], v116 offset:16384
  ds_read_b64_tr_b16 a[154:155], v116 offset:16896
  ds_read_b64_tr_b16 a[156:157], v116 offset:18432
  ds_read_b64_tr_b16 a[158:159], v116 offset:18944
  s_branch wl_136
wn_140:
wl_136:
  s_waitcnt lgkmcnt(0)
  s_barrier
  s_add_u32 m0, s51, 98304
  s_mov_b32 s56, 3145728
  buffer_load_dwordx4 v114, s[12:15], s56 offen  lds
  s_add_u32 m0, s51, 99328
  s_mov_b32 s56, 3178496
  buffer_load_dwordx4 v114, s[12:15], s56 offen  lds
  s_add_u32 m0, s51, 100352
  s_mov_b32 s56, 3211264
  buffer_load_dwordx4 v114, s[12:15], s56 offen  lds
  s_add_u32 m0, s51, 101376
  s_mov_b32 s56, 3244032
  buffer_load_dwordx4 v114, s[12:15], s56 offen  lds
  s_add_u32 m0, s51, 114688
  s_mov_b32 s56, 3670016
  buffer_load_dwordx4 v114, s[12:15], s56 offen  lds
  s_add_u32 m0, s51, 115712
  s_mov_b32 s56, 3702784
  buffer_load_dwordx4 v114, s[12:15], s56 offen  lds
  s_add_u32 m0, s51, 116736
  s_mov_b32 s56, 3735552
  buffer_load_dwordx4 v114, s[12:15], s56 offen  lds
  s_add_u32 m0, s51, 117760
  s_mov_b32 s56, 3768320
  buffer_load_dwordx4 v114, s[12:15], s56 offen  lds
  s_waitcnt vmcnt(24)
  s_barrier
  s_cmp_lg_u32 s30, 0
  s_cbranch_scc1 R_na
  v_mov_b32 v18, 1
  s_mov_b64 exec, 1
  buffer_atomic_add v18, off, s[20:23], 0 offset:160
  s_mov_b64 exec, -1
R_na:
  s_cmp_lg_u32 s30, 0
  s_cbranch_scc1 wn_142
  v_xor_b32 v116, 0, v120
  ds_read_b64_tr_b16 a[0:1], v116 offset:0
  ds_read_b64_tr_b16 a[2:3], v116 offset:512
  ds_read_b64_tr_b16 a[4:5], v116 offset:2048
  ds_read_b64_tr_b16 a[6:7], v116 offset:2560
  ds_read_b64_tr_b16 a[16:17], v116 offset:16384
  ds_read_b64_tr_b16 a[18:19], v116 offset:16896
  ds_read_b64_tr_b16 a[20:21], v116 offset:18432
  ds_read_b64_tr_b16 a[22:23], v116 offset:18944
  v_xor_b32 v116, 32, v120
  ds_read_b64_tr_b16 a[8:9], v116 offset:0
  ds_read_b64_tr_b16 a[10:11], v116 offset:512
  ds_read_b64_tr_b16 a[12:13], v116 offset:2048
  ds_read_b64_tr_b16 a[14:15], v116 offset:2560
  ds_read_b64_tr_b16 a[24:25], v116 offset:16384
  ds_read_b64_tr_b16 a[26:27], v116 offset:16896
  ds_read_b64_tr_b16 a[28:29], v116 offset:18432
  ds_read_b64_tr_b16 a[30:31], v116 offset:18944
  s_branch wl_141
wn_142:
  s_cmp_lg_u32 s30, 1
  s_cbranch_scc1 wn_143
  v_xor_b32 v116, 64, v120
  ds_read_b64_tr_b16 a[32:33], v116 offset:0
  ds_read_b64_tr_b16 a[34:35], v116 offset:512
  ds_read_b64_tr_b16 a[36:37], v116 offset:2048
  ds_read_b64_tr_b16 a[38:39], v116 offset:2560
  ds_read_b64_tr_b16 a[48:49], v116 offset:16384
  ds_read_b64_tr_b16 a[50:51], v116 offset:16896
  ds_read_b64_tr_b16 a[52:53], v116 offset:18432
  ds_read_b64_tr_b16 a[54:55], v116 offset:18944
  v_xor_b32 v116, 96, v120
  ds_read_b64_tr_b16 a[40:41], v116 offset:0
  ds_read_b64_tr_b16 a[42:43], v116 offset:512
  ds_read_b64_tr_b16 a[44:45], v116 offset:2048
  ds_read_b64_tr_b16 a[46:47], v116 offset:2560
  ds_read_b64_tr_b16 a[56:57], v116 offset:16384
  ds_read_b64_tr_b16 a[58:59], v116 offset:16896
  ds_read_b64_tr_b16 a[60:61], v116 offset:18432
  ds_read_b64_tr_b16 a[62:63], v116 offset:18944
  s_branch wl_141
wn_143:
  s_cmp_lg_u32 s30, 2
  s_cbranch_scc1 wn_144
  v_xor_b32 v116, 128, v120
  ds_read_b64_tr_b16 a[64:65], v116 offset:0
  ds_read_b64_tr_b16 a[66:67], v116 offset:512
  ds_read_b64_tr_b16 a[68:69], v116 offset:2048
  ds_read_b64_tr_b16 a[70:71], v116 offset:2560
  ds_read_b64_tr_b16 a[80:81], v116 offset:16384
  ds_read_b64_tr_b16 a[82:83], v116 offset:16896
  ds_read_b64_tr_b16 a[84:85], v116 offset:18432
  ds_read_b64_tr_b16 a[86:87], v116 offset:18944
  v_xor_b32 v116, 160, v120
  ds_read_b64_tr_b16 a[72:73], v116 offset:0
  ds_read_b64_tr_b16 a[74:75], v116 offset:512
  ds_read_b64_tr_b16 a[76:77], v116 offset:2048
  ds_read_b64_tr_b16 a[78:79], v116 offset:2560
  ds_read_b64_tr_b16 a[88:89], v116 offset:16384
  ds_read_b64_tr_b16 a[90:91], v116 offset:16896
  ds_read_b64_tr_b16 a[92:93], v116 offset:18432
  ds_read_b64_tr_b16 a[94:95], v116 offset:18944
  s_branch wl_141
wn_144:
  s_cmp_lg_u32 s30, 3
  s_cbranch_scc1 wn_145
  v_xor_b32 v116, 192, v120
  ds_read_b64_tr_b16 a[96:97], v116 offset:0
  ds_read_b64_tr_b16 a[98:99], v116 offset:512
  ds_read_b64_tr_b16 a[100:101], v116 offset:2048
  ds_read_b64_tr_b16 a[102:103], v116 offset:2560
  ds_read_b64_tr_b16 a[112:113], v116 offset:16384
  ds_read_b64_tr_b16 a[114:115], v116 offset:16896
  ds_read_b64_tr_b16 a[116:117], v116 offset:18432
  ds_read_b64_tr_b16 a[118:119], v116 offset:18944
  v_xor_b32 v116, 224, v120
  ds_read_b64_tr_b16 a[104:105], v116 offset:0
  ds_read_b64_tr_b16 a[106:107], v116 offset:512
  ds_read_b64_tr_b16 a[108:109], v116 offset:2048
  ds_read_b64_tr_b16 a[110:111], v116 offset:2560
  ds_read_b64_tr_b16 a[120:121], v116 offset:16384
  ds_read_b64_tr_b16 a[122:123], v116 offset:16896
  ds_read_b64_tr_b16 a[124:125], v116 offset:18432
  ds_read_b64_tr_b16 a[126:127], v116 offset:18944
  s_branch wl_141
wn_145:
wl_141:
  s_waitcnt lgkmcnt(0)
  s_barrier
  s_add_u32 m0, s51, 0
  s_mov_b32 s56, 0
  buffer_load_dwordx4 v115, s[24:27], s56 offen  lds
  s_add_u32 m0, s51, 1024
  s_mov_b32 s56, 8192
  buffer_load_dwordx4 v115, s[24:27], s56 offen  lds
  s_add_u32 m0, s51, 2048
  s_mov_b32 s56, 16384
  buffer_load_dwordx4 v115, s[24:27], s56 offen  lds
  s_add_u32 m0, s51, 3072
  s_mov_b32 s56, 24576
  buffer_load_dwordx4 v115, s[24:27], s56 offen  lds
  s_add_u32 m0, s51, 16384
  s_mov_b32 s56, 131072
  buffer_load_dwordx4 v115, s[24:27], s56 offen  lds
  s_add_u32 m0, s51, 17408
  s_mov_b32 s56, 139264
  buffer_load_dwordx4 v115, s[24:27], s56 offen  lds
  s_add_u32 m0, s51, 18432
  s_mov_b32 s56, 147456
  buffer_load_dwordx4 v115, s[24:27], s56 offen  lds
  s_add_u32 m0, s51, 19456
  s_mov_b32 s56, 155648
  buffer_load_dwordx4 v115, s[24:27], s56 offen  lds
  s_waitcnt vmcnt(24)
  s_barrier
  s_cmp_lg_u32 s30, 0
  s_cbranch_scc1 wn_147
  v_xor_b32 v116, 32768, v120
  ds_read_b64_tr_b16 a[32:33], v116 offset:0
  ds_read_b64_tr_b16 a[34:35], v116 offset:512
  ds_read_b64_tr_b16 a[36:37], v116 offset:2048
  ds_read_b64_tr_b16 a[38:39], v116 offset:2560
  ds_read_b64_tr_b16 a[48:49], v116 offset:16384
  ds_read_b64_tr_b16 a[50:51], v116 offset:16896
  ds_read_b64_tr_b16 a[52:53], v116 offset:18432
  ds_read_b64_tr_b16 a[54:55], v116 offset:18944
  v_xor_b32 v116, 32800, v120
  ds_read_b64_tr_b16 a[40:41], v116 offset:0
  ds_read_b64_tr_b16 a[42:43], v116 offset:512
  ds_read_b64_tr_b16 a[44:45], v116 offset:2048
  ds_read_b64_tr_b16 a[46:47], v116 offset:2560
  ds_read_b64_tr_b16 a[56:57], v116 offset:16384
  ds_read_b64_tr_b16 a[58:59], v116 offset:16896
  ds_read_b64_tr_b16 a[60:61], v116 offset:18432
  ds_read_b64_tr_b16 a[62:63], v116 offset:18944
  s_branch wl_146
wn_147:
  s_cmp_lg_u32 s30, 1
  s_cbranch_scc1 wn_148
  v_xor_b32 v116, 32832, v120
  ds_read_b64_tr_b16 a[0:1], v116 offset:0
  ds_read_b64_tr_b16 a[2:3], v116 offset:512
  ds_read_b64_tr_b16 a[4:5], v116 offset:2048
  ds_read_b64_tr_b16 a[6:7], v116 offset:2560
  ds_read_b64_tr_b16 a[16:17], v116 offset:16384
  ds_read_b64_tr_b16 a[18:19], v116 offset:16896
  ds_read_b64_tr_b16 a[20:21], v116 offset:18432
  ds_read_b64_tr_b16 a[22:23], v116 offset:18944
  v_xor_b32 v116, 32864, v120
  ds_read_b64_tr_b16 a[8:9], v116 offset:0
  ds_read_b64_tr_b16 a[10:11], v116 offset:512
  ds_read_b64_tr_b16 a[12:13], v116 offset:2048
  ds_read_b64_tr_b16 a[14:15], v116 offset:2560
  ds_read_b64_tr_b16 a[24:25], v116 offset:16384
  ds_read_b64_tr_b16 a[26:27], v116 offset:16896
  ds_read_b64_tr_b16 a[28:29], v116 offset:18432
  ds_read_b64_tr_b16 a[30:31], v116 offset:18944
  s_branch wl_146
wn_148:
  s_cmp_lg_u32 s30, 2
  s_cbranch_scc1 wn_149
  v_xor_b32 v116, 32896, v120
  ds_read_b64_tr_b16 a[96:97], v116 offset:0
  ds_read_b64_tr_b16 a[98:99], v116 offset:512
  ds_read_b64_tr_b16 a[100:101], v116 offset:2048
  ds_read_b64_tr_b16 a[102:103], v116 offset:2560
  ds_read_b64_tr_b16 a[112:113], v116 offset:16384
  ds_read_b64_tr_b16 a[114:115], v116 offset:16896
  ds_read_b64_tr_b16 a[116:117], v116 offset:18432
  ds_read_b64_tr_b16 a[118:119], v116 offset:18944
  v_xor_b32 v116, 32928, v120
  ds_read_b64_tr_b16 a[104:105], v116 offset:0
  ds_read_b64_tr_b16 a[106:107], v116 offset:512
  ds_read_b64_tr_b16 a[108:109], v116 offset:2048
  ds_read_b64_tr_b16 a[110:111], v116 offset:2560
  ds_read_b64_tr_b16 a[120:121], v116 offset:16384
  ds_read_b64_tr_b16 a[122:123], v116 offset:16896
  ds_read_b64_tr_b16 a[124:125], v116 offset:18432
  ds_read_b64_tr_b16 a[126:127], v116 offset:18944
  s_branch wl_146
wn_149:
  s_cmp_lg_u32 s30, 3
  s_cbranch_scc1 wn_150
  v_xor_b32 v116, 32960, v120
  ds_read_b64_tr_b16 a[64:65], v116 offset:0
  ds_read_b64_tr_b16 a[66:67], v116 offset:512
  ds_read_b64_tr_b16 a[68:69], v116 offset:2048
  ds_read_b64_tr_b16 a[70:71], v116 offset:2560
  ds_read_b64_tr_b16 a[80:81], v116 offset:16384
  ds_read_b64_tr_b16 a[82:83], v116 offset:16896
  ds_read_b64_tr_b16 a[84:85], v116 offset:18432
  ds_read_b64_tr_b16 a[86:87], v116 offset:18944
  v_xor_b32 v116, 32992, v120
  ds_read_b64_tr_b16 a[72:73], v116 offset:0
  ds_read_b64_tr_b16 a[74:75], v116 offset:512
  ds_read_b64_tr_b16 a[76:77], v116 offset:2048
  ds_read_b64_tr_b16 a[78:79], v116 offset:2560
  ds_read_b64_tr_b16 a[88:89], v116 offset:16384
  ds_read_b64_tr_b16 a[90:91], v116 offset:16896
  ds_read_b64_tr_b16 a[92:93], v116 offset:18432
  ds_read_b64_tr_b16 a[94:95], v116 offset:18944
  s_branch wl_146
wn_150:
wl_146:
  s_waitcnt lgkmcnt(0)
  s_barrier
  s_add_u32 m0, s51, 32768
  s_mov_b32 s56, 256
  buffer_load_dwordx4 v115, s[24:27], s56 offen  lds
  s_add_u32 m0, s51, 33792
  s_mov_b32 s56, 8448
  buffer_load_dwordx4 v115, s[24:27], s56 offen  lds
  s_add_u32 m0, s51, 34816
  s_mov_b32 s56, 16640
  buffer_load_dwordx4 v115, s[24:27], s56 offen  lds
  s_add_u32 m0, s51, 35840
  s_mov_b32 s56, 24832
  buffer_load_dwordx4 v115, s[24:27], s56 offen  lds
  s_add_u32 m0, s51, 49152
  s_mov_b32 s56, 131328
  buffer_load_dwordx4 v115, s[24:27], s56 offen  lds
  s_add_u32 m0, s51, 50176
  s_mov_b32 s56, 139520
  buffer_load_dwordx4 v115, s[24:27], s56 offen  lds
  s_add_u32 m0, s51, 51200
  s_mov_b32 s56, 147712
  buffer_load_dwordx4 v115, s[24:27], s56 offen  lds
  s_add_u32 m0, s51, 52224
  s_mov_b32 s56, 155904
  buffer_load_dwordx4 v115, s[24:27], s56 offen  lds
  s_waitcnt vmcnt(24)
  s_barrier
  s_cmp_lg_u32 s30, 0
  s_cbranch_scc1 wn_152
  v_xor_b32 v116, 65536, v120
  ds_read_b64_tr_b16 a[64:65], v116 offset:0
  ds_read_b64_tr_b16 a[66:67], v116 offset:512
  ds_read_b64_tr_b16 a[68:69], v116 offset:2048
  ds_read_b64_tr_b16 a[70:71], v116 offset:2560
  ds_read_b64_tr_b16 a[80:81], v116 offset:16384
  ds_read_b64_tr_b16 a[82:83], v116 offset:16896
  ds_read_b64_tr_b16 a[84:85], v116 offset:18432
  ds_read_b64_tr_b16 a[86:87], v116 offset:18944
  v_xor_b32 v116, 65568, v120
  ds_read_b64_tr_b16 a[72:73], v116 offset:0
  ds_read_b64_tr_b16 a[74:75], v116 offset:512
  ds_read_b64_tr_b16 a[76:77], v116 offset:2048
  ds_read_b64_tr_b16 a[78:79], v116 offset:2560
  ds_read_b64_tr_b16 a[88:89], v116 offset:16384
  ds_read_b64_tr_b16 a[90:91], v116 offset:16896
  ds_read_b64_tr_b16 a[92:93], v116 offset:18432
  ds_read_b64_tr_b16 a[94:95], v116 offset:18944
  s_branch wl_151
wn_152:
  s_cmp_lg_u32 s30, 1
  s_cbranch_scc1 wn_153
  v_xor_b32 v116, 65600, v120
  ds_read_b64_tr_b16 a[96:97], v116 offset:0
  ds_read_b64_tr_b16 a[98:99], v116 offset:512
  ds_read_b64_tr_b16 a[100:101], v116 offset:2048
  ds_read_b64_tr_b16 a[102:103], v116 offset:2560
  ds_read_b64_tr_b16 a[112:113], v116 offset:16384
  ds_read_b64_tr_b16 a[114:115], v116 offset:16896
  ds_read_b64_tr_b16 a[116:117], v116 offset:18432
  ds_read_b64_tr_b16 a[118:119], v116 offset:18944
  v_xor_b32 v116, 65632, v120
  ds_read_b64_tr_b16 a[104:105], v116 offset:0
  ds_read_b64_tr_b16 a[106:107], v116 offset:512
  ds_read_b64_tr_b16 a[108:109], v116 offset:2048
  ds_read_b64_tr_b16 a[110:111], v116 offset:2560
  ds_read_b64_tr_b16 a[120:121], v116 offset:16384
  ds_read_b64_tr_b16 a[122:123], v116 offset:16896
  ds_read_b64_tr_b16 a[124:125], v116 offset:18432
  ds_read_b64_tr_b16 a[126:127], v116 offset:18944
  s_branch wl_151
wn_153:
  s_cmp_lg_u32 s30, 2
  s_cbranch_scc1 wn_154
  v_xor_b32 v116, 65664, v120
  ds_read_b64_tr_b16 a[0:1], v116 offset:0
  ds_read_b64_tr_b16 a[2:3], v116 offset:512
  ds_read_b64_tr_b16 a[4:5], v116 offset:2048
  ds_read_b64_tr_b16 a[6:7], v116 offset:2560
  ds_read_b64_tr_b16 a[16:17], v116 offset:16384
  ds_read_b64_tr_b16 a[18:19], v116 offset:16896
  ds_read_b64_tr_b16 a[20:21], v116 offset:18432
  ds_read_b64_tr_b16 a[22:23], v116 offset:18944
  v_xor_b32 v116, 65696, v120
  ds_read_b64_tr_b16 a[8:9], v116 offset:0
  ds_read_b64_tr_b16 a[10:11], v116 offset:512
  ds_read_b64_tr_b16 a[12:13], v116 offset:2048
  ds_read_b64_tr_b16 a[14:15], v116 offset:2560
  ds_read_b64_tr_b16 a[24:25], v116 offset:16384
  ds_read_b64_tr_b16 a[26:27], v116 offset:16896
  ds_read_b64_tr_b16 a[28:29], v116 offset:18432
  ds_read_b64_tr_b16 a[30:31], v116 offset:18944
  s_branch wl_151
wn_154:
  s_cmp_lg_u32 s30, 3
  s_cbranch_scc1 wn_155
  v_xor_b32 v116, 65728, v120
  ds_read_b64_tr_b16 a[32:33], v116 offset:0
  ds_read_b64_tr_b16 a[34:35], v116 offset:512
  ds_read_b64_tr_b16 a[36:37], v116 offset:2048
  ds_read_b64_tr_b16 a[38:39], v116 offset:2560
  ds_read_b64_tr_b16 a[48:49], v116 offset:16384
  ds_read_b64_tr_b16 a[50:51], v116 offset:16896
  ds_read_b64_tr_b16 a[52:53], v116 offset:18432
  ds_read_b64_tr_b16 a[54:55], v116 offset:18944
  v_xor_b32 v116, 65760, v120
  ds_read_b64_tr_b16 a[40:41], v116 offset:0
  ds_read_b64_tr_b16 a[42:43], v116 offset:512
  ds_read_b64_tr_b16 a[44:45], v116 offset:2048
  ds_read_b64_tr_b16 a[46:47], v116 offset:2560
  ds_read_b64_tr_b16 a[56:57], v116 offset:16384
  ds_read_b64_tr_b16 a[58:59], v116 offset:16896
  ds_read_b64_tr_b16 a[60:61], v116 offset:18432
  ds_read_b64_tr_b16 a[62:63], v116 offset:18944
  s_branch wl_151
wn_155:
wl_151:
  s_waitcnt lgkmcnt(0)
  s_barrier
  s_add_u32 m0, s51, 65536
  s_mov_b32 s56, 512
  buffer_load_dwordx4 v115, s[24:27], s56 offen  lds
  s_add_u32 m0, s51, 66560
  s_mov_b32 s56, 8704
  buffer_load_dwordx4 v115, s[24:27], s56 offen  lds
  s_add_u32 m0, s51, 67584
  s_mov_b32 s56, 16896
  buffer_load_dwordx4 v115, s[24:27], s56 offen  lds
  s_add_u32 m0, s51, 68608
  s_mov_b32 s56, 25088
  buffer_load_dwordx4 v115, s[24:27], s56 offen  lds
  s_add_u32 m0, s51, 81920
  s_mov_b32 s56, 131584
  buffer_load_dwordx4 v115, s[24:27], s56 offen  lds
  s_add_u32 m0, s51, 82944
  s_mov_b32 s56, 139776
  buffer_load_dwordx4 v115, s[24:27], s56 offen  lds
  s_add_u32 m0, s51, 83968
  s_mov_b32 s56, 147968
  buffer_load_dwordx4 v115, s[24:27], s56 offen  lds
  s_add_u32 m0, s51, 84992
  s_mov_b32 s56, 156160
  buffer_load_dwordx4 v115, s[24:27], s56 offen  lds
  s_waitcnt vmcnt(24)
  s_barrier
  s_cmp_lg_u32 s30, 0
  s_cbranch_scc1 wn_157
  v_xor_b32 v116, 98304, v120
  ds_read_b64_tr_b16 a[96:97], v116 offset:0
  ds_read_b64_tr_b16 a[98:99], v116 offset:512
  ds_read_b64_tr_b16 a[100:101], v116 offset:2048
  ds_read_b64_tr_b16 a[102:103], v116 offset:2560
  ds_read_b64_tr_b16 a[112:113], v116 offset:16384
  ds_read_b64_tr_b16 a[114:115], v116 offset:16896
  ds_read_b64_tr_b16 a[116:117], v116 offset:18432
  ds_read_b64_tr_b16 a[118:119], v116 offset:18944
  v_xor_b32 v116, 98336, v120
  ds_read_b64_tr_b16 a[104:105], v116 offset:0
  ds_read_b64_tr_b16 a[106:107], v116 offset:512
  ds_read_b64_tr_b16 a[108:109], v116 offset:2048
  ds_read_b64_tr_b16 a[110:111], v116 offset:2560
  ds_read_b64_tr_b16 a[120:121], v116 offset:16384
  ds_read_b64_tr_b16 a[122:123], v116 offset:16896
  ds_read_b64_tr_b16 a[124:125], v116 offset:18432
  ds_read_b64_tr_b16 a[126:127], v116 offset:18944
  s_branch wl_156
wn_157:
  s_cmp_lg_u32 s30, 1
  s_cbranch_scc1 wn_158
  v_xor_b32 v116, 98368, v120
  ds_read_b64_tr_b16 a[64:65], v116 offset:0
  ds_read_b64_tr_b16 a[66:67], v116 offset:512
  ds_read_b64_tr_b16 a[68:69], v116 offset:2048
  ds_read_b64_tr_b16 a[70:71], v116 offset:2560
  ds_read_b64_tr_b16 a[80:81], v116 offset:16384
  ds_read_b64_tr_b16 a[82:83], v116 offset:16896
  ds_read_b64_tr_b16 a[84:85], v116 offset:18432
  ds_read_b64_tr_b16 a[86:87], v116 offset:18944
  v_xor_b32 v116, 98400, v120
  ds_read_b64_tr_b16 a[72:73], v116 offset:0
  ds_read_b64_tr_b16 a[74:75], v116 offset:512
  ds_read_b64_tr_b16 a[76:77], v116 offset:2048
  ds_read_b64_tr_b16 a[78:79], v116 offset:2560
  ds_read_b64_tr_b16 a[88:89], v116 offset:16384
  ds_read_b64_tr_b16 a[90:91], v116 offset:16896
  ds_read_b64_tr_b16 a[92:93], v116 offset:18432
  ds_read_b64_tr_b16 a[94:95], v116 offset:18944
  s_branch wl_156
wn_158:
  s_cmp_lg_u32 s30, 2
  s_cbranch_scc1 wn_159
  v_xor_b32 v116, 98432, v120
  ds_read_b64_tr_b16 a[32:33], v116 offset:0
  ds_read_b64_tr_b16 a[34:35], v116 offset:512
  ds_read_b64_tr_b16 a[36:37], v116 offset:2048
  ds_read_b64_tr_b16 a[38:39], v116 offset:2560
  ds_read_b64_tr_b16 a[48:49], v116 offset:16384
  ds_read_b64_tr_b16 a[50:51], v116 offset:16896
  ds_read_b64_tr_b16 a[52:53], v116 offset:18432
  ds_read_b64_tr_b16 a[54:55], v116 offset:18944
  v_xor_b32 v116, 98464, v120
  ds_read_b64_tr_b16 a[40:41], v116 offset:0
  ds_read_b64_tr_b16 a[42:43], v116 offset:512
  ds_read_b64_tr_b16 a[44:45], v116 offset:2048
  ds_read_b64_tr_b16 a[46:47], v116 offset:2560
  ds_read_b64_tr_b16 a[56:57], v116 offset:16384
  ds_read_b64_tr_b16 a[58:59], v116 offset:16896
  ds_read_b64_tr_b16 a[60:61], v116 offset:18432
  ds_read_b64_tr_b16 a[62:63], v116 offset:18944
  s_branch wl_156
wn_159:
  s_cmp_lg_u32 s30, 3
  s_cbranch_scc1 wn_160
  v_xor_b32 v116, 98496, v120
  ds_read_b64_tr_b16 a[0:1], v116 offset:0
  ds_read_b64_tr_b16 a[2:3], v116 offset:512
  ds_read_b64_tr_b16 a[4:5], v116 offset:2048
  ds_read_b64_tr_b16 a[6:7], v116 offset:2560
  ds_read_b64_tr_b16 a[16:17], v116 offset:16384
  ds_read_b64_tr_b16 a[18:19], v116 offset:16896
  ds_read_b64_tr_b16 a[20:21], v116 offset:18432
  ds_read_b64_tr_b16 a[22:23], v116 offset:18944
  v_xor_b32 v116, 98528, v120
  ds_read_b64_tr_b16 a[8:9], v116 offset:0
  ds_read_b64_tr_b16 a[10:11], v116 offset:512
  ds_read_b64_tr_b16 a[12:13], v116 offset:2048
  ds_read_b64_tr_b16 a[14:15], v116 offset:2560
  ds_read_b64_tr_b16 a[24:25], v116 offset:16384
  ds_read_b64_tr_b16 a[26:27], v116 offset:16896
  ds_read_b64_tr_b16 a[28:29], v116 offset:18432
  ds_read_b64_tr_b16 a[30:31], v116 offset:18944
  s_branch wl_156
wn_160:
wl_156:
  s_waitcnt lgkmcnt(0)
  s_barrier
  s_add_u32 m0, s51, 98304
  s_mov_b32 s56, 768
  buffer_load_dwordx4 v115, s[24:27], s56 offen  lds
  s_add_u32 m0, s51, 99328
  s_mov_b32 s56, 8960
  buffer_load_dwordx4 v115, s[24:27], s56 offen  lds
  s_add_u32 m0, s51, 100352
  s_mov_b32 s56, 17152
  buffer_load_dwordx4 v115, s[24:27], s56 offen  lds
  s_add_u32 m0, s51, 101376
  s_mov_b32 s56, 25344
  buffer_load_dwordx4 v115, s[24:27], s56 offen  lds
  s_add_u32 m0, s51, 114688
  s_mov_b32 s56, 131840
  buffer_load_dwordx4 v115, s[24:27], s56 offen  lds
  s_add_u32 m0, s51, 115712
  s_mov_b32 s56, 140032
  buffer_load_dwordx4 v115, s[24:27], s56 offen  lds
  s_add_u32 m0, s51, 116736
  s_mov_b32 s56, 148224
  buffer_load_dwordx4 v115, s[24:27], s56 offen  lds
  s_add_u32 m0, s51, 117760
  s_mov_b32 s56, 156416
  buffer_load_dwordx4 v115, s[24:27], s56 offen  lds
  s_waitcnt vmcnt(24)
  s_barrier
  s_cmp_lg_u32 s30, 0
  s_cbranch_scc1 wn_162
  v_xor_b32 v116, 0, v120
  ds_read_b64_tr_b16 v[128:129], v116 offset:0
  ds_read_b64_tr_b16 v[130:131], v116 offset:512
  ds_read_b64_tr_b16 v[132:133], v116 offset:2048
  ds_read_b64_tr_b16 v[134:135], v116 offset:2560
  ds_read_b64_tr_b16 v[136:137], v116 offset:16384
  ds_read_b64_tr_b16 v[138:139], v116 offset:16896
  ds_read_b64_tr_b16 v[140:141], v116 offset:18432
  ds_read_b64_tr_b16 v[142:143], v116 offset:18944
  v_xor_b32 v116, 32, v120
  ds_read_b64_tr_b16 v[144:145], v116 offset:0
  ds_read_b64_tr_b16 v[146:147], v116 offset:512
  ds_read_b64_tr_b16 v[148:149], v116 offset:2048
  ds_read_b64_tr_b16 v[150:151], v116 offset:2560
  ds_read_b64_tr_b16 v[152:153], v116 offset:16384
  ds_read_b64_tr_b16 v[154:155], v116 offset:16896
  ds_read_b64_tr_b16 v[156:157], v116 offset:18432
  ds_read_b64_tr_b16 v[158:159], v116 offset:18944
  v_xor_b32 v116, 64, v120
  ds_read_b64_tr_b16 v[160:161], v116 offset:0
  ds_read_b64_tr_b16 v[162:163], v116 offset:512
  ds_read_b64_tr_b16 v[164:165], v116 offset:2048
  ds_read_b64_tr_b16 v[166:167], v116 offset:2560
  ds_read_b64_tr_b16 v[168:169], v116 offset:16384
  ds_read_b64_tr_b16 v[170:171], v116 offset:16896
  ds_read_b64_tr_b16 v[172:173], v116 offset:18432
  ds_read_b64_tr_b16 v[174:175], v116 offset:18944
  v_xor_b32 v116, 96, v120
  ds_read_b64_tr_b16 v[176:177], v116 offset:0
  ds_read_b64_tr_b16 v[178:179], v116 offset:512
  ds_read_b64_tr_b16 v[180:181], v116 offset:2048
  ds_read_b64_tr_b16 v[182:183], v116 offset:2560
  ds_read_b64_tr_b16 v[184:185], v116 offset:16384
  ds_read_b64_tr_b16 v[186:187], v116 offset:16896
  ds_read_b64_tr_b16 v[188:189], v116 offset:18432
  ds_read_b64_tr_b16 v[190:191], v116 offset:18944
  v_xor_b32 v116, 128, v120
  ds_read_b64_tr_b16 v[192:193], v116 offset:0
  ds_read_b64_tr_b16 v[194:195], v116 offset:512
  ds_read_b64_tr_b16 v[196:197], v116 offset:2048
  ds_read_b64_tr_b16 v[198:199], v116 offset:2560
  ds_read_b64_tr_b16 v[200:201], v116 offset:16384
  ds_read_b64_tr_b16 v[202:203], v116 offset:16896
  ds_read_b64_tr_b16 v[204:205], v116 offset:18432
  ds_read_b64_tr_b16 v[206:207], v116 offset:18944
  v_xor_b32 v116, 160, v120
  ds_read_b64_tr_b16 v[208:209], v116 offset:0
  ds_read_b64_tr_b16 v[210:211], v116 offset:512
  ds_read_b64_tr_b16 v[212:213], v116 offset:2048
  ds_read_b64_tr_b16 v[214:215], v116 offset:2560
  ds_read_b64_tr_b16 v[216:217], v116 offset:16384
  ds_read_b64_tr_b16 v[218:219], v116 offset:16896
  ds_read_b64_tr_b16 v[220:221], v116 offset:18432
  ds_read_b64_tr_b16 v[222:223], v116 offset:18944
  v_xor_b32 v116, 192, v120
  ds_read_b64_tr_b16 v[224:225], v116 offset:0
  ds_read_b64_tr_b16 v[226:227], v116 offset:512
  ds_read_b64_tr_b16 v[228:229], v116 offset:2048
  ds_read_b64_tr_b16 v[230:231], v116 offset:2560
  ds_read_b64_tr_b16 v[232:233], v116 offset:16384
  ds_read_b64_tr_b16 v[234:235], v116 offset:16896
  ds_read_b64_tr_b16 v[236:237], v116 offset:18432
  ds_read_b64_tr_b16 v[238:239], v116 offset:18944
  v_xor_b32 v116, 224, v120
  ds_read_b64_tr_b16 v[240:241], v116 offset:0
  ds_read_b64_tr_b16 v[242:243], v116 offset:512
  ds_read_b64_tr_b16 v[244:245], v116 offset:2048
  ds_read_b64_tr_b16 v[246:247], v116 offset:2560
  ds_read_b64_tr_b16 v[248:249], v116 offset:16384
  ds_read_b64_tr_b16 v[250:251], v116 offset:16896
  ds_read_b64_tr_b16 v[252:253], v116 offset:18432
  ds_read_b64_tr_b16 v[254:255], v116 offset:18944
  s_branch wl_161
wn_162:
wl_161:
  s_waitcnt lgkmcnt(0)
  s_barrier
  s_add_u32 m0, s51, 0
  s_mov_b32 s56, 0
  buffer_load_dwordx4 v114, s[8:11], s56 offen  lds
  s_add_u32 m0, s51, 1024
  s_mov_b32 s56, 32768
  buffer_load_dwordx4 v114, s[8:11], s56 offen  lds
  s_add_u32 m0, s51, 2048
  s_mov_b32 s56, 65536
  buffer_load_dwordx4 v114, s[8:11], s56 offen  lds
  s_add_u32 m0, s51, 3072
  s_mov_b32 s56, 98304
  buffer_load_dwordx4 v114, s[8:11], s56 offen  lds
  s_add_u32 m0, s51, 16384
  s_mov_b32 s56, 524288
  buffer_load_dwordx4 v114, s[8:11], s56 offen  lds
  s_add_u32 m0, s51, 17408
  s_mov_b32 s56, 557056
  buffer_load_dwordx4 v114, s[8:11], s56 offen  lds
  s_add_u32 m0, s51, 18432
  s_mov_b32 s56, 589824
  buffer_load_dwordx4 v114, s[8:11], s56 offen  lds
  s_add_u32 m0, s51, 19456
  s_mov_b32 s56, 622592
  buffer_load_dwordx4 v114, s[8:11], s56 offen  lds
  s_waitcnt vmcnt(24)
  s_barrier
  s_cmp_lg_u32 s30, 1
  s_cbranch_scc1 wn_164
  v_xor_b32 v116, 32768, v120
  ds_read_b64_tr_b16 v[128:129], v116 offset:0
  ds_read_b64_tr_b16 v[130:131], v116 offset:512
  ds_read_b64_tr_b16 v[132:133], v116 offset:2048
  ds_read_b64_tr_b16 v[134:135], v116 offset:2560
  ds_read_b64_tr_b16 v[136:137], v116 offset:16384
  ds_read_b64_tr_b16 v[138:139], v116 offset:16896
  ds_read_b64_tr_b16 v[140:141], v116 offset:18432
  ds_read_b64_tr_b16 v[142:143], v116 offset:18944
  v_xor_b32 v116, 32800, v120
  ds_read_b64_tr_b16 v[144:145], v116 offset:0
  ds_read_b64_tr_b16 v[146:147], v116 offset:512
  ds_read_b64_tr_b16 v[148:149], v116 offset:2048
  ds_read_b64_tr_b16 v[150:151], v116 offset:2560
  ds_read_b64_tr_b16 v[152:153], v116 offset:16384
  ds_read_b64_tr_b16 v[154:155], v116 offset:16896
  ds_read_b64_tr_b16 v[156:157], v116 offset:18432
  ds_read_b64_tr_b16 v[158:159], v116 offset:18944
  v_xor_b32 v116, 32832, v120
  ds_read_b64_tr_b16 v[160:161], v116 offset:0
  ds_read_b64_tr_b16 v[162:163], v116 offset:512
  ds_read_b64_tr_b16 v[164:165], v116 offset:2048
  ds_read_b64_tr_b16 v[166:167], v116 offset:2560
  ds_read_b64_tr_b16 v[168:169], v116 offset:16384
  ds_read_b64_tr_b16 v[170:171], v116 offset:16896
  ds_read_b64_tr_b16 v[172:173], v116 offset:18432
  ds_read_b64_tr_b16 v[174:175], v116 offset:18944
  v_xor_b32 v116, 32864, v120
  ds_read_b64_tr_b16 v[176:177], v116 offset:0
  ds_read_b64_tr_b16 v[178:179], v116 offset:512
  ds_read_b64_tr_b16 v[180:181], v116 offset:2048
  ds_read_b64_tr_b16 v[182:183], v116 offset:2560
  ds_read_b64_tr_b16 v[184:185], v116 offset:16384
  ds_read_b64_tr_b16 v[186:187], v116 offset:16896
  ds_read_b64_tr_b16 v[188:189], v116 offset:18432
  ds_read_b64_tr_b16 v[190:191], v116 offset:18944
  v_xor_b32 v116, 32896, v120
  ds_read_b64_tr_b16 v[192:193], v116 offset:0
  ds_read_b64_tr_b16 v[194:195], v116 offset:512
  ds_read_b64_tr_b16 v[196:197], v116 offset:2048
  ds_read_b64_tr_b16 v[198:199], v116 offset:2560
  ds_read_b64_tr_b16 v[200:201], v116 offset:16384
  ds_read_b64_tr_b16 v[202:203], v116 offset:16896
  ds_read_b64_tr_b16 v[204:205], v116 offset:18432
  ds_read_b64_tr_b16 v[206:207], v116 offset:18944
  v_xor_b32 v116, 32928, v120
  ds_read_b64_tr_b16 v[208:209], v116 offset:0
  ds_read_b64_tr_b16 v[210:211], v116 offset:512
  ds_read_b64_tr_b16 v[212:213], v116 offset:2048
  ds_read_b64_tr_b16 v[214:215], v116 offset:2560
  ds_read_b64_tr_b16 v[216:217], v116 offset:16384
  ds_read_b64_tr_b16 v[218:219], v116 offset:16896
  ds_read_b64_tr_b16 v[220:221], v116 offset:18432
  ds_read_b64_tr_b16 v[222:223], v116 offset:18944
  v_xor_b32 v116, 32960, v120
  ds_read_b64_tr_b16 v[224:225], v116 offset:0
  ds_read_b64_tr_b16 v[226:227], v116 offset:512
  ds_read_b64_tr_b16 v[228:229], v116 offset:2048
  ds_read_b64_tr_b16 v[230:231], v116 offset:2560
  ds_read_b64_tr_b16 v[232:233], v116 offset:16384
  ds_read_b64_tr_b16 v[234:235], v116 offset:16896
  ds_read_b64_tr_b16 v[236:237], v116 offset:18432
  ds_read_b64_tr_b16 v[238:239], v116 offset:18944
  v_xor_b32 v116, 32992, v120
  ds_read_b64_tr_b16 v[240:241], v116 offset:0
  ds_read_b64_tr_b16 v[242:243], v116 offset:512
  ds_read_b64_tr_b16 v[244:245], v116 offset:2048
  ds_read_b64_tr_b16 v[246:247], v116 offset:2560
  ds_read_b64_tr_b16 v[248:249], v116 offset:16384
  ds_read_b64_tr_b16 v[250:251], v116 offset:16896
  ds_read_b64_tr_b16 v[252:253], v116 offset:18432
  ds_read_b64_tr_b16 v[254:255], v116 offset:18944
  s_branch wl_163
wn_164:
wl_163:
  s_waitcnt lgkmcnt(0)
  s_barrier
  s_add_u32 m0, s51, 32768
  s_mov_b32 s56, 1048576
  buffer_load_dwordx4 v114, s[8:11], s56 offen  lds
  s_add_u32 m0, s51, 33792
  s_mov_b32 s56, 1081344
  buffer_load_dwordx4 v114, s[8:11], s56 offen  lds
  s_add_u32 m0, s51, 34816
  s_mov_b32 s56, 1114112
  buffer_load_dwordx4 v114, s[8:11], s56 offen  lds
  s_add_u32 m0, s51, 35840
  s_mov_b32 s56, 1146880
  buffer_load_dwordx4 v114, s[8:11], s56 offen  lds
  s_add_u32 m0, s51, 49152
  s_mov_b32 s56, 1572864
  buffer_load_dwordx4 v114, s[8:11], s56 offen  lds
  s_add_u32 m0, s51, 50176
  s_mov_b32 s56, 1605632
  buffer_load_dwordx4 v114, s[8:11], s56 offen  lds
  s_add_u32 m0, s51, 51200
  s_mov_b32 s56, 1638400
  buffer_load_dwordx4 v114, s[8:11], s56 offen  lds
  s_add_u32 m0, s51, 52224
  s_mov_b32 s56, 1671168
  buffer_load_dwordx4 v114, s[8:11], s56 offen  lds
  s_waitcnt vmcnt(24)
  s_barrier
  s_cmp_lg_u32 s30, 2
  s_cbranch_scc1 wn_166
  v_xor_b32 v116, 65536, v120
  ds_read_b64_tr_b16 v[128:129], v116 offset:0
  ds_read_b64_tr_b16 v[130:131], v116 offset:512
  ds_read_b64_tr_b16 v[132:133], v116 offset:2048
  ds_read_b64_tr_b16 v[134:135], v116 offset:2560
  ds_read_b64_tr_b16 v[136:137], v116 offset:16384
  ds_read_b64_tr_b16 v[138:139], v116 offset:16896
  ds_read_b64_tr_b16 v[140:141], v116 offset:18432
  ds_read_b64_tr_b16 v[142:143], v116 offset:18944
  v_xor_b32 v116, 65568, v120
  ds_read_b64_tr_b16 v[144:145], v116 offset:0
  ds_read_b64_tr_b16 v[146:147], v116 offset:512
  ds_read_b64_tr_b16 v[148:149], v116 offset:2048
  ds_read_b64_tr_b16 v[150:151], v116 offset:2560
  ds_read_b64_tr_b16 v[152:153], v116 offset:16384
  ds_read_b64_tr_b16 v[154:155], v116 offset:16896
  ds_read_b64_tr_b16 v[156:157], v116 offset:18432
  ds_read_b64_tr_b16 v[158:159], v116 offset:18944
  v_xor_b32 v116, 65600, v120
  ds_read_b64_tr_b16 v[160:161], v116 offset:0
  ds_read_b64_tr_b16 v[162:163], v116 offset:512
  ds_read_b64_tr_b16 v[164:165], v116 offset:2048
  ds_read_b64_tr_b16 v[166:167], v116 offset:2560
  ds_read_b64_tr_b16 v[168:169], v116 offset:16384
  ds_read_b64_tr_b16 v[170:171], v116 offset:16896
  ds_read_b64_tr_b16 v[172:173], v116 offset:18432
  ds_read_b64_tr_b16 v[174:175], v116 offset:18944
  v_xor_b32 v116, 65632, v120
  ds_read_b64_tr_b16 v[176:177], v116 offset:0
  ds_read_b64_tr_b16 v[178:179], v116 offset:512
  ds_read_b64_tr_b16 v[180:181], v116 offset:2048
  ds_read_b64_tr_b16 v[182:183], v116 offset:2560
  ds_read_b64_tr_b16 v[184:185], v116 offset:16384
  ds_read_b64_tr_b16 v[186:187], v116 offset:16896
  ds_read_b64_tr_b16 v[188:189], v116 offset:18432
  ds_read_b64_tr_b16 v[190:191], v116 offset:18944
  v_xor_b32 v116, 65664, v120
  ds_read_b64_tr_b16 v[192:193], v116 offset:0
  ds_read_b64_tr_b16 v[194:195], v116 offset:512
  ds_read_b64_tr_b16 v[196:197], v116 offset:2048
  ds_read_b64_tr_b16 v[198:199], v116 offset:2560
  ds_read_b64_tr_b16 v[200:201], v116 offset:16384
  ds_read_b64_tr_b16 v[202:203], v116 offset:16896
  ds_read_b64_tr_b16 v[204:205], v116 offset:18432
  ds_read_b64_tr_b16 v[206:207], v116 offset:18944
  v_xor_b32 v116, 65696, v120
  ds_read_b64_tr_b16 v[208:209], v116 offset:0
  ds_read_b64_tr_b16 v[210:211], v116 offset:512
  ds_read_b64_tr_b16 v[212:213], v116 offset:2048
  ds_read_b64_tr_b16 v[214:215], v116 offset:2560
  ds_read_b64_tr_b16 v[216:217], v116 offset:16384
  ds_read_b64_tr_b16 v[218:219], v116 offset:16896
  ds_read_b64_tr_b16 v[220:221], v116 offset:18432
  ds_read_b64_tr_b16 v[222:223], v116 offset:18944
  v_xor_b32 v116, 65728, v120
  ds_read_b64_tr_b16 v[224:225], v116 offset:0
  ds_read_b64_tr_b16 v[226:227], v116 offset:512
  ds_read_b64_tr_b16 v[228:229], v116 offset:2048
  ds_read_b64_tr_b16 v[230:231], v116 offset:2560
  ds_read_b64_tr_b16 v[232:233], v116 offset:16384
  ds_read_b64_tr_b16 v[234:235], v116 offset:16896
  ds_read_b64_tr_b16 v[236:237], v116 offset:18432
  ds_read_b64_tr_b16 v[238:239], v116 offset:18944
  v_xor_b32 v116, 65760, v120
  ds_read_b64_tr_b16 v[240:241], v116 offset:0
  ds_read_b64_tr_b16 v[242:243], v116 offset:512
  ds_read_b64_tr_b16 v[244:245], v116 offset:2048
  ds_read_b64_tr_b16 v[246:247], v116 offset:2560
  ds_read_b64_tr_b16 v[248:249], v116 offset:16384
  ds_read_b64_tr_b16 v[250:251], v116 offset:16896
  ds_read_b64_tr_b16 v[252:253], v116 offset:18432
  ds_read_b64_tr_b16 v[254:255], v116 offset:18944
  s_branch wl_165
wn_166:
wl_165:
  s_waitcnt lgkmcnt(0)
  s_barrier
  s_add_u32 m0, s51, 65536
  s_mov_b32 s56, 2097152
  buffer_load_dwordx4 v114, s[8:11], s56 offen  lds
  s_add_u32 m0, s51, 66560
  s_mov_b32 s56, 2129920
  buffer_load_dwordx4 v114, s[8:11], s56 offen  lds
  s_add_u32 m0, s51, 67584
  s_mov_b32 s56, 2162688
  buffer_load_dwordx4 v114, s[8:11], s56 offen  lds
  s_add_u32 m0, s51, 68608
  s_mov_b32 s56, 2195456
  buffer_load_dwordx4 v114, s[8:11], s56 offen  lds
  s_add_u32 m0, s51, 81920
  s_mov_b32 s56, 2621440
  buffer_load_dwordx4 v114, s[8:11], s56 offen  lds
  s_add_u32 m0, s51, 82944
  s_mov_b32 s56, 2654208
  buffer_load_dwordx4 v114, s[8:11], s56 offen  lds
  s_add_u32 m0, s51, 83968
  s_mov_b32 s56, 2686976
  buffer_load_dwordx4 v114, s[8:11], s56 offen  lds
  s_add_u32 m0, s51, 84992
  s_mov_b32 s56, 2719744
  buffer_load_dwordx4 v114, s[8:11], s56 offen  lds
  s_waitcnt vmcnt(24)
  s_barrier
  s_cmp_lg_u32 s30, 3
  s_cbranch_scc1 wn_168
  v_xor_b32 v116, 98304, v120
  ds_read_b64_tr_b16 v[128:129], v116 offset:0
  ds_read_b64_tr_b16 v[130:131], v116 offset:512
  ds_read_b64_tr_b16 v[132:133], v116 offset:2048
  ds_read_b64_tr_b16 v[134:135], v116 offset:2560
  ds_read_b64_tr_b16 v[136:137], v116 offset:16384
  ds_read_b64_tr_b16 v[138:139], v116 offset:16896
  ds_read_b64_tr_b16 v[140:141], v116 offset:18432
  ds_read_b64_tr_b16 v[142:143], v116 offset:18944
  v_xor_b32 v116, 98336, v120
  ds_read_b64_tr_b16 v[144:145], v116 offset:0
  ds_read_b64_tr_b16 v[146:147], v116 offset:512
  ds_read_b64_tr_b16 v[148:149], v116 offset:2048
  ds_read_b64_tr_b16 v[150:151], v116 offset:2560
  ds_read_b64_tr_b16 v[152:153], v116 offset:16384
  ds_read_b64_tr_b16 v[154:155], v116 offset:16896
  ds_read_b64_tr_b16 v[156:157], v116 offset:18432
  ds_read_b64_tr_b16 v[158:159], v116 offset:18944
  v_xor_b32 v116, 98368, v120
  ds_read_b64_tr_b16 v[160:161], v116 offset:0
  ds_read_b64_tr_b16 v[162:163], v116 offset:512
  ds_read_b64_tr_b16 v[164:165], v116 offset:2048
  ds_read_b64_tr_b16 v[166:167], v116 offset:2560
  ds_read_b64_tr_b16 v[168:169], v116 offset:16384
  ds_read_b64_tr_b16 v[170:171], v116 offset:16896
  ds_read_b64_tr_b16 v[172:173], v116 offset:18432
  ds_read_b64_tr_b16 v[174:175], v116 offset:18944
  v_xor_b32 v116, 98400, v120
  ds_read_b64_tr_b16 v[176:177], v116 offset:0
  ds_read_b64_tr_b16 v[178:179], v116 offset:512
  ds_read_b64_tr_b16 v[180:181], v116 offset:2048
  ds_read_b64_tr_b16 v[182:183], v116 offset:2560
  ds_read_b64_tr_b16 v[184:185], v116 offset:16384
  ds_read_b64_tr_b16 v[186:187], v116 offset:16896
  ds_read_b64_tr_b16 v[188:189], v116 offset:18432
  ds_read_b64_tr_b16 v[190:191], v116 offset:18944
  v_xor_b32 v116, 98432, v120
  ds_read_b64_tr_b16 v[192:193], v116 offset:0
  ds_read_b64_tr_b16 v[194:195], v116 offset:512
  ds_read_b64_tr_b16 v[196:197], v116 offset:2048
  ds_read_b64_tr_b16 v[198:199], v116 offset:2560
  ds_read_b64_tr_b16 v[200:201], v116 offset:16384
  ds_read_b64_tr_b16 v[202:203], v116 offset:16896
  ds_read_b64_tr_b16 v[204:205], v116 offset:18432
  ds_read_b64_tr_b16 v[206:207], v116 offset:18944
  v_xor_b32 v116, 98464, v120
  ds_read_b64_tr_b16 v[208:209], v116 offset:0
  ds_read_b64_tr_b16 v[210:211], v116 offset:512
  ds_read_b64_tr_b16 v[212:213], v116 offset:2048
  ds_read_b64_tr_b16 v[214:215], v116 offset:2560
  ds_read_b64_tr_b16 v[216:217], v116 offset:16384
  ds_read_b64_tr_b16 v[218:219], v116 offset:16896
  ds_read_b64_tr_b16 v[220:221], v116 offset:18432
  ds_read_b64_tr_b16 v[222:223], v116 offset:18944
  v_xor_b32 v116, 98496, v120
  ds_read_b64_tr_b16 v[224:225], v116 offset:0
  ds_read_b64_tr_b16 v[226:227], v116 offset:512
  ds_read_b64_tr_b16 v[228:229], v116 offset:2048
  ds_read_b64_tr_b16 v[230:231], v116 offset:2560
  ds_read_b64_tr_b16 v[232:233], v116 offset:16384
  ds_read_b64_tr_b16 v[234:235], v116 offset:16896
  ds_read_b64_tr_b16 v[236:237], v116 offset:18432
  ds_read_b64_tr_b16 v[238:239], v116 offset:18944
  v_xor_b32 v116, 98528, v120
  ds_read_b64_tr_b16 v[240:241], v116 offset:0
  ds_read_b64_tr_b16 v[242:243], v116 offset:512
  ds_read_b64_tr_b16 v[244:245], v116 offset:2048
  ds_read_b64_tr_b16 v[246:247], v116 offset:2560
  ds_read_b64_tr_b16 v[248:249], v116 offset:16384
  ds_read_b64_tr_b16 v[250:251], v116 offset:16896
  ds_read_b64_tr_b16 v[252:253], v116 offset:18432
  ds_read_b64_tr_b16 v[254:255], v116 offset:18944
  s_branch wl_167
wn_168:
wl_167:
  s_waitcnt lgkmcnt(0)
  s_barrier
  s_add_u32 m0, s51, 98304
  s_mov_b32 s56, 3145728
  buffer_load_dwordx4 v114, s[8:11], s56 offen  lds
  s_add_u32 m0, s51, 99328
  s_mov_b32 s56, 3178496
  buffer_load_dwordx4 v114, s[8:11], s56 offen  lds
  s_add_u32 m0, s51, 100352
  s_mov_b32 s56, 3211264
  buffer_load_dwordx4 v114, s[8:11], s56 offen  lds
  s_add_u32 m0, s51, 101376
  s_mov_b32 s56, 3244032
  buffer_load_dwordx4 v114, s[8:11], s56 offen  lds
  s_add_u32 m0, s51, 114688
  s_mov_b32 s56, 3670016
  buffer_load_dwordx4 v114, s[8:11], s56 offen  lds
  s_add_u32 m0, s51, 115712
  s_mov_b32 s56, 3702784
  buffer_load_dwordx4 v114, s[8:11], s56 offen  lds
  s_add_u32 m0, s51, 116736
  s_mov_b32 s56, 3735552
  buffer_load_dwordx4 v114, s[8:11], s56 offen  lds
  s_add_u32 m0, s51, 117760
  s_mov_b32 s56, 3768320
  buffer_load_dwordx4 v114, s[8:11], s56 offen  lds
  s_mov_b32 s12, s66
  s_mov_b32 s13, s67
  s_mov_b32 s14, 0x4000
  s_mov_b32 s15, 0x20000
  v_lshrrev_b32 v116, 2, v112
  v_and_b32 v117, 1, v112
  v_lshl_add_u32 v116, v116, 1, v117
  v_lshlrev_b32 v116, 11, v116
  v_bfe_u32 v117, v112, 1, 1
  v_lshl_add_u32 v116, v117, 5, v116
  v_lshl_add_u32 v116, v113, 3, v116
  s_lshl_b32 s56, s32, 10
  s_lshl_b32 s57, s30, 8
  s_add_u32 s56, s56, s57
  buffer_load_dwordx2 v[48:49], v116, s[12:15], s56 offen offset:0
  buffer_load_dwordx2 v[50:51], v116, s[12:15], s56 offen offset:64
  buffer_load_dwordx2 v[52:53], v116, s[12:15], s56 offen offset:128
  buffer_load_dwordx2 v[54:55], v116, s[12:15], s56 offen offset:192
  buffer_load_dword v100, off, s[20:23], 0 offset:160 sc1
  buffer_load_dword v101, off, s[20:23], 0 offset:144 sc1
  s_lshl_b32 s56, s30, 6
  v_xor_b32 v120, s56, v120
  s_lshl_b32 s56, s30, 13
  v_add_u32 v117, s56, v1
  s_waitcnt vmcnt(30)
  s_barrier
  v_xor_b32 v116, 0, v120
  ds_read_b64_tr_b16 v[64:65], v116 offset:0
  ds_read_b64_tr_b16 v[66:67], v116 offset:512
  ds_read_b64_tr_b16 v[68:69], v116 offset:2048
  ds_read_b64_tr_b16 v[70:71], v116 offset:2560
  ds_read_b64_tr_b16 v[80:81], v116 offset:16384
  ds_read_b64_tr_b16 v[82:83], v116 offset:16896
  ds_read_b64_tr_b16 v[84:85], v116 offset:18432
  ds_read_b64_tr_b16 v[86:87], v116 offset:18944
  v_xor_b32 v116, 32, v120
  ds_read_b64_tr_b16 v[72:73], v116 offset:0
  ds_read_b64_tr_b16 v[74:75], v116 offset:512
  ds_read_b64_tr_b16 v[76:77], v116 offset:2048
  ds_read_b64_tr_b16 v[78:79], v116 offset:2560
  ds_read_b64_tr_b16 v[88:89], v116 offset:16384
  ds_read_b64_tr_b16 v[90:91], v116 offset:16896
  ds_read_b64_tr_b16 v[92:93], v116 offset:18432
  ds_read_b64_tr_b16 v[94:95], v116 offset:18944
  s_waitcnt lgkmcnt(0)
  s_barrier
  ds_write_b128 v117, v[64:67] offset:0
  ds_write_b128 v117, v[68:71] offset:1024
  ds_write_b128 v117, v[72:75] offset:2048
  ds_write_b128 v117, v[76:79] offset:3072
  ds_write_b128 v117, v[80:83] offset:4096
  ds_write_b128 v117, v[84:87] offset:5120
  ds_write_b128 v117, v[88:91] offset:6144
  ds_write_b128 v117, v[92:95] offset:7168
  v_add_u32 v117, 0x8000, v117
  s_waitcnt lgkmcnt(0)
  s_waitcnt vmcnt(22)
  s_barrier
  v_xor_b32 v116, 32768, v120
  ds_read_b64_tr_b16 v[64:65], v116 offset:0
  ds_read_b64_tr_b16 v[66:67], v116 offset:512
  ds_read_b64_tr_b16 v[68:69], v116 offset:2048
  ds_read_b64_tr_b16 v[70:71], v116 offset:2560
  ds_read_b64_tr_b16 v[80:81], v116 offset:16384
  ds_read_b64_tr_b16 v[82:83], v116 offset:16896
  ds_read_b64_tr_b16 v[84:85], v116 offset:18432
  ds_read_b64_tr_b16 v[86:87], v116 offset:18944
  v_xor_b32 v116, 32800, v120
  ds_read_b64_tr_b16 v[72:73], v116 offset:0
  ds_read_b64_tr_b16 v[74:75], v116 offset:512
  ds_read_b64_tr_b16 v[76:77], v116 offset:2048
  ds_read_b64_tr_b16 v[78:79], v116 offset:2560
  ds_read_b64_tr_b16 v[88:89], v116 offset:16384
  ds_read_b64_tr_b16 v[90:91], v116 offset:16896
  ds_read_b64_tr_b16 v[92:93], v116 offset:18432
  ds_read_b64_tr_b16 v[94:95], v116 offset:18944
  s_waitcnt lgkmcnt(0)
  s_barrier
  ds_write_b128 v117, v[64:67] offset:0
  ds_write_b128 v117, v[68:71] offset:1024
  ds_write_b128 v117, v[72:75] offset:2048
  ds_write_b128 v117, v[76:79] offset:3072
  ds_write_b128 v117, v[80:83] offset:4096
  ds_write_b128 v117, v[84:87] offset:5120
  ds_write_b128 v117, v[88:91] offset:6144
  ds_write_b128 v117, v[92:95] offset:7168
  v_add_u32 v117, 0x8000, v117
  s_waitcnt lgkmcnt(0)
  s_waitcnt vmcnt(14)
  s_barrier
  v_xor_b32 v116, 65536, v120
  ds_read_b64_tr_b16 v[64:65], v116 offset:0
  ds_read_b64_tr_b16 v[66:67], v116 offset:512
  ds_read_b64_tr_b16 v[68:69], v116 offset:2048
  ds_read_b64_tr_b16 v[70:71], v116 offset:2560
  ds_read_b64_tr_b16 v[80:81], v116 offset:16384
  ds_read_b64_tr_b16 v[82:83], v116 offset:16896
  ds_read_b64_tr_b16 v[84:85], v116 offset:18432
  ds_read_b64_tr_b16 v[86:87], v116 offset:18944
  v_xor_b32 v116, 65568, v120
  ds_read_b64_tr_b16 v[72:73], v116 offset:0
  ds_read_b64_tr_b16 v[74:75], v116 offset:512
  ds_read_b64_tr_b16 v[76:77], v116 offset:2048
  ds_read_b64_tr_b16 v[78:79], v116 offset:2560
  ds_read_b64_tr_b16 v[88:89], v116 offset:16384
  ds_read_b64_tr_b16 v[90:91], v116 offset:16896
  ds_read_b64_tr_b16 v[92:93], v116 offset:18432
  ds_read_b64_tr_b16 v[94:95], v116 offset:18944
  s_waitcnt lgkmcnt(0)
  s_barrier
  ds_write_b128 v117, v[64:67] offset:0
  ds_write_b128 v117, v[68:71] offset:1024
  ds_write_b128 v117, v[72:75] offset:2048
  ds_write_b128 v117, v[76:79] offset:3072
  ds_write_b128 v117, v[80:83] offset:4096
  ds_write_b128 v117, v[84:87] offset:5120
  ds_write_b128 v117, v[88:91] offset:6144
  ds_write_b128 v117, v[92:95] offset:7168
  v_add_u32 v117, 0x8000, v117
  s_waitcnt lgkmcnt(0)
  s_waitcnt vmcnt(0)
  s_barrier
  v_readfirstlane_b32 s56, v100
  v_readfirstlane_b32 s57, v101
  s_cmp_ge_u32 s56, 96
  s_cselect_b32 s57, s57, 0
  s_cmp_ge_u32 s57, 1
  s_cbranch_scc1 R_rdy
  v_mov_b32 v19, 0xa0
spin_169:
  buffer_load_dword v18, v19, s[20:23], 0 offen sc1
  s_waitcnt vmcnt(0)
  v_readfirstlane_b32 s56, v18
  s_nop 0
  s_cmp_ge_u32 s56, 96
  s_cbranch_scc1 spun_170
  s_sleep 4
  s_sub_u32 s94, s94, 1
  s_cbranch_scc0 spin_169
  s_mov_b32 s94, 0
spun_170:
  v_mov_b32 v19, 0x90
spin_171:
  buffer_load_dword v18, v19, s[20:23], 0 offen sc1
  s_waitcnt vmcnt(0)
  v_readfirstlane_b32 s56, v18
  s_nop 0
  s_cmp_ge_u32 s56, 1
  s_cbranch_scc1 spun_172
  s_sleep 4
  s_sub_u32 s94, s94, 1
  s_cbranch_scc0 spin_171
  s_mov_b32 s94, 0
spun_172:
R_rdy:
  buffer_load_dwordx2 v[104:105], off, s[20:23], 0 offset:176 sc1
  buffer_load_dword v106, off, s[20:23], 0 offset:0 sc1
  buffer_load_dword v107, off, s[20:23], 0 offset:32 sc1
  buffer_load_dword v108, off, s[4:7], s48 sc1
  v_xor_b32 v116, 98304, v120
  ds_read_b64_tr_b16 v[64:65], v116 offset:0
  ds_read_b64_tr_b16 v[66:67], v116 offset:512
  ds_read_b64_tr_b16 v[68:69], v116 offset:2048
  ds_read_b64_tr_b16 v[70:71], v116 offset:2560
  ds_read_b64_tr_b16 v[80:81], v116 offset:16384
  ds_read_b64_tr_b16 v[82:83], v116 offset:16896
  ds_read_b64_tr_b16 v[84:85], v116 offset:18432
  ds_read_b64_tr_b16 v[86:87], v116 offset:18944
  v_xor_b32 v116, 98336, v120
  ds_read_b64_tr_b16 v[72:73], v116 offset:0
  ds_read_b64_tr_b16 v[74:75], v116 offset:512
  ds_read_b64_tr_b16 v[76:77], v116 offset:2048
  ds_read_b64_tr_b16 v[78:79], v116 offset:2560
  ds_read_b64_tr_b16 v[88:89], v116 offset:16384
  ds_read_b64_tr_b16 v[90:91], v116 offset:16896
  ds_read_b64_tr_b16 v[92:93], v116 offset:18432
  ds_read_b64_tr_b16 v[94:95], v116 offset:18944
  s_waitcnt lgkmcnt(0)
  s_barrier
  ds_write_b128 v117, v[64:67] offset:0
  ds_write_b128 v117, v[68:71] offset:1024
  ds_write_b128 v117, v[72:75] offset:2048
  ds_write_b128 v117, v[76:79] offset:3072
  ds_write_b128 v117, v[80:83] offset:4096
  ds_write_b128 v117, v[84:87] offset:5120
  ds_write_b128 v117, v[88:91] offset:6144
  ds_write_b128 v117, v[92:95] offset:7168
  v_add_u32 v117, 0x8000, v117
  s_waitcnt lgkmcnt(0)
  s_waitcnt vmcnt(0)
  v_readfirstlane_b32 s56, v108
  s_nop 0
  s_cmp_ge_u32 s56, 64
  s_cbranch_scc1 R_kv
  v_mov_b32 v19, 0x280000
spin_173:
  buffer_load_dword v18, v19, s[4:7], 0 offen sc1
  s_waitcnt vmcnt(0)
  v_readfirstlane_b32 s56, v18
  s_nop 0
  s_cmp_ge_u32 s56, 64
  s_cbranch_scc1 spun_174
  s_sleep 4
  s_sub_u32 s94, s94, 1
  s_cbranch_scc0 spin_173
  s_mov_b32 s94, 0
spun_174:
R_kv:
  s_lshl_b32 s56, s30, 11
  s_add_u32 s51, s56, 145408
  s_mov_b32 m0, s51
  s_nop 0
  buffer_load_dwordx4 v1, s[4:7], s43 offen sc1 lds
  buffer_load_dwordx4 v1, s[4:7], s43 offen offset:1024 sc1 lds
  s_add_u32 s43, s43, 262144
  v_readfirstlane_b32 s56, v104
  v_readfirstlane_b32 s57, v105
  v_min_u32 v106, v106, v107
  s_cmp_lt_u32 s57, s56
  s_cselect_b32 s56, 8192, 0
  s_add_u32 s34, s34, s56
  s_add_u32 s35, s35, s56
  s_add_u32 s37, s35, 4096
  s_lshl_b32 s56, s30, 9
  s_add_u32 s36, s34, s56
  s_add_u32 s36, s36, 4096
  s_lshl_b32 s56, s30, 10
  s_add_u32 s34, s34, s56
  s_add_u32 s35, s35, s56
  s_xor_b32 s95, s35, 0x8000
  v_readfirstlane_b32 s56, v106
  ds_read_b128 v[96:99], v13 offset:0
  ds_read_b128 v[100:103], v13 offset:1024
  ds_read_b128 v[104:107], v13 offset:2048
  ds_read_b128 v[108:111], v13 offset:3072
  ds_read_b128 v[120:123], v13 offset:4096
  ds_read_b128 v[124:127], v13 offset:5120
  v_mov_b64 v[80:81], 0
  v_mov_b64 v[82:83], 0
  v_mov_b64 v[84:85], 0
  v_mov_b64 v[86:87], 0
  v_mov_b64 v[88:89], 0
  v_mov_b64 v[90:91], 0
  v_mov_b64 v[92:93], 0
  v_mov_b64 v[94:95], 0
  v_mov_b64 v[112:113], 0
  v_mov_b64 v[114:115], 0
  v_mov_b64 v[116:117], 0
  v_mov_b64 v[118:119], 0
  s_waitcnt vmcnt(0)
  v_lshlrev_b32 v31, 5, v0
  s_mov_b32 m0, s52
  v_mov_b32 v18, 0x10000000
  v_cmp_gt_u32 vcc, 12, v0
  s_nop 1
  v_cndmask_b32 v14, v18, v14, vcc
  s_mov_b32 s97, 0x3f80
  s_mov_b32 s99, 0x3f800000
  v_cmp_gt_u32 vcc, 16, v0
  s_nop 1
  v_cndmask_b32 v17, v18, v17, vcc
  s_lshl_b32 s57, s30, 9
  v_lshl_add_u32 v31, v0, 3, s57
  s_cmp_lt_u32 s56, 32
  s_cbranch_scc1 R_slow
  s_branch R_fast
R_fast_top:
  s_bfe_u32 s96, s33, 0x10001
  s_mov_b32 m0, s52
  s_sleep 5
  buffer_load_dwordx4 v[48:51], v1, s[4:7], s40 offen sc1
  buffer_load_dwordx4 v[52:55], v1, s[4:7], s40 offen offset:1024 sc1
R_fast_cw:
  s_waitcnt vmcnt(0)
R_fast:
  ds_write_b128 v3, v[48:51]
  ds_write_b128 v3, v[52:55] offset:1024
  v_smfmac_f32_16x16x64_bf16 v[80:83], v[48:51], a[0:7], v2
  v_max3_u32 v18, v48, v49, v50
  v_max3_u32 v19, v51, v52, v53
  v_smfmac_f32_16x16x64_bf16 v[84:87], v[48:51], a[128:135], v2
  v_max3_u32 v18, v18, v54, v55
  v_max_u32 v18, v18, v19
  v_cmp_eq_u32 vcc, -1, v18
  s_nop 0
  s_cbranch_vccnz fc_175
ec_176:
  v_smfmac_f32_16x16x64_bf16 v[88:91], v[48:51], a[8:15], v2
  v_mov_b32 v19, s33
  s_waitcnt lgkmcnt(0)
  s_barrier
  ds_read_b128 v[56:59], v4 offset:0
  ds_read_b128 v[60:63], v4 offset:1024
  v_smfmac_f32_16x16x64_bf16 v[92:95], v[48:51], a[136:143], v2
  buffer_load_dwordx4 v1, s[4:7], s44 offen sc1 lds
  ds_read_b128 v[64:67], v5 offset:0
  v_smfmac_f32_16x16x64_bf16 v[80:83], v[52:55], a[16:23], v2
  ds_read_b128 v[68:71], v5 offset:1024
  v_smfmac_f32_16x16x64_bf16 v[84:87], v[52:55], a[144:151], v2
  ds_read_b128 v[72:75], v6 offset:0
  v_smfmac_f32_16x16x64_bf16 v[88:91], v[52:55], a[24:31], v2
  ds_read_b128 v[76:79], v6 offset:1024
  v_smfmac_f32_16x16x64_bf16 v[92:95], v[52:55], a[152:159], v2
  buffer_load_dwordx4 v1, s[4:7], s44 offen offset:1024 sc1 lds
  s_waitcnt lgkmcnt(5)
  v_smfmac_f32_16x16x64_bf16 v[80:83], v[56:59], a[32:39], v2
  v_smfmac_f32_16x16x64_bf16 v[84:87], v[56:59], a[160:167], v2
  v_smfmac_f32_16x16x64_bf16 v[88:91], v[56:59], a[40:47], v2
  buffer_store_dword v30, v14, s[4:7], s95 offen offset:4 sc1
  v_smfmac_f32_16x16x64_bf16 v[92:95], v[56:59], a[168:175], v2
  s_waitcnt lgkmcnt(4)
  v_smfmac_f32_16x16x64_bf16 v[80:83], v[60:63], a[48:55], v2
  v_smfmac_f32_16x16x64_bf16 v[84:87], v[60:63], a[176:183], v2
  v_smfmac_f32_16x16x64_bf16 v[88:91], v[60:63], a[56:63], v2
  buffer_store_dword v19, off, s[4:7], s47 sc1
  v_smfmac_f32_16x16x64_bf16 v[92:95], v[60:63], a[184:191], v2
  s_waitcnt lgkmcnt(0)
  v_smfmac_f32_16x16x64_bf16 v[80:83], v[64:67], a[64:71], v2
  v_smfmac_f32_16x16x64_bf16 v[80:83], v[68:71], a[80:87], v2
  v_smfmac_f32_16x16x64_bf16 v[80:83], v[72:75], a[96:103], v2
  v_smfmac_f32_16x16x64_bf16 v[80:83], v[76:79], a[112:119], v2
  v_smfmac_f32_16x16x64_bf16 v[84:87], v[64:67], a[192:199], v2
  s_nop 1
  v_smfmac_f32_16x16x64_bf16 v[84:87], v[68:71], a[208:215], v2
  s_nop 1
  v_smfmac_f32_16x16x64_bf16 v[84:87], v[72:75], a[224:231], v2
  s_nop 1
  v_smfmac_f32_16x16x64_bf16 v[84:87], v[76:79], a[240:247], v2
  v_add_f32 v80, v80, v82
  v_smfmac_f32_16x16x64_bf16 v[88:91], v[64:67], a[72:79], v2
  v_add_f32 v81, v81, v83
  s_nop 0
  v_smfmac_f32_16x16x64_bf16 v[88:91], v[68:71], a[88:95], v2
  s_nop 1
  v_smfmac_f32_16x16x64_bf16 v[88:91], v[72:75], a[104:111], v2
  v_add_f32 v82, v84, v86
  v_smfmac_f32_16x16x64_bf16 v[88:91], v[76:79], a[120:127], v2
  v_add_f32 v83, v85, v87
  v_smfmac_f32_16x16x64_bf16 v[92:95], v[64:67], a[200:207], v2
  v_cvt_pk_bf16_f32 v36, v80, v81
  s_nop 0
  v_smfmac_f32_16x16x64_bf16 v[92:95], v[68:71], a[216:223], v2
  v_cvt_pk_bf16_f32 v38, v82, v83
  v_bfi_b32 v36, 1, s96, v36
  v_smfmac_f32_16x16x64_bf16 v[92:95], v[72:75], a[232:239], v2
  v_add_f32 v88, v88, v90
  v_smfmac_f32_16x16x64_bf16 v[92:95], v[76:79], a[248:255], v2
  v_add_f32 v89, v89, v91
  v_smfmac_f32_16x16x64_bf16 v[112:115], v[48:51], v[96:103], v2
  v_cvt_pk_bf16_f32 v37, v88, v89
  s_nop 0
  v_smfmac_f32_16x16x64_bf16 v[116:119], v[48:51], v[104:111], v2
  s_nop 2
  v_add_f32 v90, v92, v94
  v_add_f32 v91, v93, v95
  v_cvt_pk_bf16_f32 v39, v90, v91
  buffer_store_dwordx4 v[36:39], v1, s[4:7], s34 offen sc1
  ds_read_b128 v[96:99], v13 offset:6144
  ds_read_b128 v[100:103], v13 offset:7168
  v_xor_b32 v13, 32768, v13
  ds_read_b128 v[104:107], v13 offset:0
  ds_read_b128 v[108:111], v13 offset:1024
  s_waitcnt lgkmcnt(4)
  v_smfmac_f32_16x16x64_bf16 v[112:115], v[52:55], v[120:127], v2
  buffer_load_dword v18, off, s[4:7], s48 sc1
  ds_read_b128 v[120:123], v13 offset:2048
  ds_read_b128 v[124:127], v13 offset:3072
  s_waitcnt lgkmcnt(4)
  v_smfmac_f32_16x16x64_bf16 v[116:119], v[52:55], v[96:103], v2
  buffer_store_dword v30, v17, s[4:7], s42 offen
  ds_read_b128 v[96:99], v13 offset:4096
  ds_read_b128 v[100:103], v13 offset:5120
  ds_read_b128 v[48:51], v13 offset:6144
  ds_read_b128 v[52:55], v13 offset:7168
  v_xor_b32 v13, 98304, v13
  s_waitcnt lgkmcnt(6)
  v_smfmac_f32_16x16x64_bf16 v[112:115], v[56:59], v[104:111], v2
  ds_read_b128 v[104:107], v13 offset:0
  ds_read_b128 v[108:111], v13 offset:1024
  s_waitcnt lgkmcnt(6)
  v_smfmac_f32_16x16x64_bf16 v[116:119], v[56:59], v[120:127], v2
  ds_read_b128 v[120:123], v13 offset:2048
  ds_read_b128 v[124:127], v13 offset:3072
  s_waitcnt lgkmcnt(6)
  v_smfmac_f32_16x16x64_bf16 v[112:115], v[60:63], v[96:103], v2
  ds_read_b128 v[96:99], v13 offset:4096
  ds_read_b128 v[100:103], v13 offset:5120
  s_waitcnt lgkmcnt(6)
  v_smfmac_f32_16x16x64_bf16 v[116:119], v[60:63], v[48:55], v2
  ds_read_b128 v[48:51], v13 offset:6144
  ds_read_b128 v[52:55], v13 offset:7168
  v_xor_b32 v13, 32768, v13
  ds_read_b128 v[56:59], v13 offset:0
  ds_read_b128 v[60:63], v13 offset:1024
  s_waitcnt lgkmcnt(8)
  v_smfmac_f32_16x16x64_bf16 v[112:115], v[64:67], v[104:111], v2
  ds_read_b128 v[104:107], v13 offset:2048
  ds_read_b128 v[108:111], v13 offset:3072
  s_waitcnt lgkmcnt(8)
  v_smfmac_f32_16x16x64_bf16 v[116:119], v[64:67], v[120:127], v2
  ds_read_b128 v[120:123], v13 offset:4096
  ds_read_b128 v[124:127], v13 offset:5120
  s_waitcnt lgkmcnt(8)
  v_smfmac_f32_16x16x64_bf16 v[112:115], v[68:71], v[96:103], v2
  ds_read_b128 v[96:99], v13 offset:6144
  ds_read_b128 v[100:103], v13 offset:7168
  v_xor_b32 v13, 98304, v13
  s_waitcnt lgkmcnt(8)
  v_smfmac_f32_16x16x64_bf16 v[116:119], v[68:71], v[48:55], v2
  s_waitcnt lgkmcnt(6)
  v_smfmac_f32_16x16x64_bf16 v[112:115], v[72:75], v[56:63], v2
  buffer_load_dwordx4 v[40:43], v1, s[4:7], s35 offen sc1
  s_waitcnt lgkmcnt(4)
  v_smfmac_f32_16x16x64_bf16 v[116:119], v[72:75], v[104:111], v2
  s_waitcnt lgkmcnt(2)
  v_smfmac_f32_16x16x64_bf16 v[112:115], v[76:79], v[120:127], v2
  s_waitcnt lgkmcnt(0)
  v_smfmac_f32_16x16x64_bf16 v[116:119], v[76:79], v[96:103], v2
  ds_read_b128 v[48:51], v12 offset:0
  ds_read_b128 v[52:55], v12 offset:1024
  ds_read_b128 v[56:59], v12 offset:2048
  ds_read_b128 v[60:63], v12 offset:3072
  s_nop 1
  v_add_f32 v112, v112, v114
  v_add_f32 v113, v113, v115
  v_add_f32 v116, v116, v118
  v_add_f32 v117, v117, v119
  v_cvt_pk_bf16_f32 v36, v112, v113
  v_cvt_pk_bf16_f32 v37, v116, v117
  v_bfi_b32 v120, 1, s96, v36
  v_mov_b32 v121, v37
  ds_write_b64 v11, v[36:37]
  v_permlane32_swap_b32 v120, v122
  v_permlane32_swap_b32 v121, v123
  s_waitcnt vmcnt(4)
  s_mov_b32 exec_hi, 0
  buffer_store_dwordx4 v[120:123], v1, s[4:7], s36 offen sc1
  s_mov_b64 exec, -1
  ds_read_b128 v[64:67], v12 offset:4096
  ds_read_b128 v[68:71], v12 offset:5120
  ds_read_b128 v[72:75], v12 offset:6144
  ds_read_b128 v[76:79], v12 offset:7168
  s_cmp_eq_u32 s33, 63
  s_cbranch_scc1 R_done
  s_mov_b32 m0, s51
  s_sleep 2
  s_nop 7
  buffer_load_dwordx4 v[124:127], v1, s[4:7], s35 offen sc1
  s_waitcnt vmcnt(2)
  v_bitop3_b32 v19, v40, s96, 1 bitop3:0x28
  v_cmp_ne_u32 vcc, 0, v19
  v_dot2_f32_bf16 v112, v40, s97, v80
  v_dot2_f32_bf16 v113, v40, s99, v81
  v_dot2_f32_bf16 v114, v42, s97, v82
  v_dot2_f32_bf16 v115, v42, s99, v83
  v_dot2_f32_bf16 v116, v41, s97, v88
  v_dot2_f32_bf16 v117, v41, s99, v89
  v_dot2_f32_bf16 v118, v43, s97, v90
  v_dot2_f32_bf16 v119, v43, s99, v91
  s_cbranch_vccnz fa_180
ea_181:
  v_cvt_pk_bf16_f32 v84, v112, v113
  v_cvt_pk_bf16_f32 v85, v114, v115
  ds_write_b64 v7, v[84:85]
  v_cvt_pk_bf16_f32 v86, v116, v117
  v_cvt_pk_bf16_f32 v87, v118, v119
  ds_write_b64 v7, v[86:87] offset:512
  buffer_load_dword v19, v31, s[4:7], s37 offen sc1
  v_readfirstlane_b32 s56, v18
  s_mov_b32 vcc_lo, 0x33333333
  s_mov_b32 vcc_hi, 0x33333333
  s_cmp_lt_u32 s56, s49
  s_waitcnt lgkmcnt(0)
  s_barrier
  ds_read_b64_tr_b16 v[80:81], v8 offset:0
  ds_read_b64_tr_b16 v[82:83], v8 offset:512
  ds_read_b64_tr_b16 v[84:85], v8 offset:1024
  ds_read_b64_tr_b16 v[86:87], v8 offset:1536
  ds_read_b64_tr_b16 v[88:89], v8 offset:2048
  ds_read_b64_tr_b16 v[90:91], v8 offset:2560
  ds_read_b64_tr_b16 v[92:93], v8 offset:3072
  ds_read_b64_tr_b16 v[94:95], v8 offset:3584
  s_cbranch_scc1 kvw_184
kvr_185:
  s_waitcnt lgkmcnt(6)
  v_mfma_f32_16x16x32_bf16 v[112:115], v[48:51], v[80:83], 0
  v_mfma_f32_16x16x32_bf16 v[116:119], v[64:67], v[80:83], 0
  v_mfma_f32_16x16x32_bf16 v[120:123], v[80:83], v[80:83], v[26:29]
  buffer_load_dwordx2 v[98:99], v9, s[4:7], s37 offen offset:0 sc1
  s_waitcnt lgkmcnt(4)
  v_mfma_f32_16x16x32_bf16 v[112:115], v[52:55], v[84:87], v[112:115]
  ds_read_b128 v[48:51], v12 offset:8192
  v_mfma_f32_16x16x32_bf16 v[116:119], v[68:71], v[84:87], v[116:119]
  ds_read_b128 v[64:67], v12 offset:12288
  buffer_load_dwordx2 v[102:103], v9, s[4:7], s37 offen offset:512 sc1
  v_mfma_f32_16x16x32_bf16 v[120:123], v[84:87], v[84:87], v[120:123]
  ds_read_b128 v[52:55], v12 offset:9216
  s_waitcnt lgkmcnt(5)
  v_mfma_f32_16x16x32_bf16 v[112:115], v[56:59], v[88:91], v[112:115]
  ds_read_b128 v[68:71], v12 offset:13312
  buffer_load_dwordx2 v[106:107], v9, s[4:7], s37 offen offset:1024 sc1
  v_mfma_f32_16x16x32_bf16 v[116:119], v[72:75], v[88:91], v[116:119]
  ds_read_b128 v[56:59], v12 offset:10240
  v_mfma_f32_16x16x32_bf16 v[120:123], v[88:91], v[88:91], v[120:123]
  ds_read_b128 v[72:75], v12 offset:14336
  buffer_load_dwordx2 v[110:111], v9, s[4:7], s37 offen offset:1536 sc1
  s_waitcnt lgkmcnt(6)
  v_mfma_f32_16x16x32_bf16 v[112:115], v[60:63], v[92:95], v[112:115]
  ds_read_b64 v[96:97], v10 offset:0
  ds_read_b64 v[100:101], v10 offset:512
  v_mfma_f32_16x16x32_bf16 v[116:119], v[76:79], v[92:95], v[116:119]
  ds_read_b128 v[60:63], v12 offset:11264
  v_mfma_f32_16x16x32_bf16 v[120:123], v[92:95], v[92:95], v[120:123]
  ds_read_b128 v[76:79], v12 offset:15360
  ds_read_b64 v[104:105], v10 offset:1024
  ds_read_b64 v[108:109], v10 offset:1536
  s_nop 2
  v_cndmask_b32_dpp v112, v116, v112, vcc quad_perm:[0,1,0,1] row_mask:0xf bank_mask:0xf
  v_cndmask_b32_dpp v113, v117, v113, vcc quad_perm:[0,1,0,1] row_mask:0xf bank_mask:0xf
  v_cndmask_b32_dpp v114, v118, v114, vcc quad_perm:[0,1,0,1] row_mask:0xf bank_mask:0xf
  v_cndmask_b32_dpp v115, v119, v115, vcc quad_perm:[0,1,0,1] row_mask:0xf bank_mask:0xf
  v_max3_f32 v116, v112, v122, v123
  s_not_b64 vcc, vcc
  v_max3_f32 v116, v116, v113, v114
  v_max_f32 v116, v116, v115
  buffer_load_dwordx4 v1, s[4:7], s43 offen offset:0 sc1 lds
  s_nop 0
  v_max_f32_dpp v116, v116, v116 quad_perm:[2,3,0,1] row_mask:0xf bank_mask:0xf
  v_mov_b32 v117, v116
  buffer_load_dwordx4 v1, s[4:7], s43 offen offset:1024 sc1 lds
  s_nop 0
  v_permlane16_swap_b32 v116, v117
  v_max_f32 v116, v116, v117
  v_mov_b32 v117, v116
  buffer_store_dwordx4 v[36:39], v1, s[4:7], s46 offen sc1
  s_waitcnt vmcnt(8)
  v_permlane32_swap_b32 v116, v117
  v_max_f32 v116, v116, v117
  v_mul_f32 v127, s50, v116
  v_fma_f32 v112, v112, s50, -v127
  v_fma_f32 v113, v113, s50, -v127
  v_fma_f32 v114, v114, s50, -v127
  v_fma_f32 v115, v115, s50, -v127
  v_exp_f32 v112, v112
  v_exp_f32 v113, v113
  v_exp_f32 v114, v114
  v_exp_f32 v115, v115
  v_cvt_pk_bf16_f32 v124, v112, v113
  v_cvt_pk_bf16_f32 v125, v114, v115
  v_fma_f32 v122, v122, s50, -v127
  v_cndmask_b32_dpp v32, v124, v32, vcc quad_perm:[0,1,2,3] row_mask:0xf bank_mask:0xf
  v_cndmask_b32_dpp v34, v124, v34, vcc quad_perm:[2,3,2,3] row_mask:0xf bank_mask:0xf
  v_cndmask_b32_dpp v33, v125, v33, vcc quad_perm:[0,1,2,3] row_mask:0xf bank_mask:0xf
  v_cndmask_b32_dpp v35, v125, v35, vcc quad_perm:[2,3,2,3] row_mask:0xf bank_mask:0xf
  v_fma_f32 v123, v123, s50, -v127
  s_waitcnt lgkmcnt(0)
  v_mfma_f32_16x16x32_bf16 v[80:83], v[48:51], v[32:35], 0
  v_exp_f32 v122, v122
  v_mov_b32_dpp v36, v32 quad_perm:[2,3,0,1] row_mask:0xf bank_mask:0xf
  v_mfma_f32_16x16x32_bf16 v[84:87], v[56:59], v[32:35], 0
  v_exp_f32 v123, v123
  v_mov_b32_dpp v38, v34 quad_perm:[2,3,0,1] row_mask:0xf bank_mask:0xf
  v_mfma_f32_16x16x32_bf16 v[116:119], v[44:47], v[32:35], 0
  v_mov_b32_dpp v37, v33 quad_perm:[2,3,0,1] row_mask:0xf bank_mask:0xf
  v_mov_b32_dpp v39, v35 quad_perm:[2,3,0,1] row_mask:0xf bank_mask:0xf
  v_cvt_pk_bf16_f32 v120, v122, v123
  ds_read_b128 v[48:51], v12 offset:16384
  v_mfma_f32_16x16x32_bf16 v[80:83], v[52:55], v[36:39], v[80:83]
  ds_read_b128 v[56:59], v12 offset:16384
  v_mov_b32_dpp v121, v120 quad_perm:[2,3,0,1] row_mask:0xf bank_mask:0xf
  v_mfma_f32_16x16x32_bf16 v[84:87], v[60:63], v[36:39], v[84:87]
  v_mov_b64 v[122:123], v[120:121]
  ds_read_b128 v[52:55], v12 offset:16384
  v_mfma_f32_16x16x32_bf16 v[88:91], v[64:67], v[32:35], 0
  s_waitcnt vmcnt(3)
  v_bitop3_b32 v124, v98, v102, s96 bitop3:0x7e
  v_bitop3_b32 v125, v106, v110, s96 bitop3:0x7e
  v_mfma_f32_16x16x16_bf16 v[116:119], v[44:45], v[120:121], v[116:119]
  ds_read_b128 v[60:63], v12 offset:16384
  v_mfma_f32_16x16x32_bf16 v[92:95], v[72:75], v[32:35], 0
  v_bitop3_b32 v124, v124, v125, 1 bitop3:0xa8
  v_cmp_ne_u32 vcc, 0, v124
  ds_read_b128 v[64:67], v12 offset:16384
  s_cbranch_vccnz fv_187
ev_188:
  v_mfma_f32_16x16x32_bf16 v[80:83], v[96:99], v[120:123], v[80:83]
  ds_read_b128 v[72:75], v12 offset:16384
  v_mfma_f32_16x16x32_bf16 v[84:87], v[100:103], v[120:123], v[84:87]
  v_rcp_f32_dpp v126, v116 quad_perm:[0,1,0,1] row_mask:0xf bank_mask:0xf
  v_mfma_f32_16x16x32_bf16 v[88:91], v[68:71], v[36:39], v[88:91]
  s_nop 1
  v_mfma_f32_16x16x32_bf16 v[92:95], v[76:79], v[36:39], v[92:95]
  ds_read_b128 v[68:71], v12 offset:16384
  v_mul_f32 v80, v126, v80
  v_mul_f32 v81, v126, v81
  v_mul_f32 v82, v126, v82
  v_mul_f32 v83, v126, v83
  v_mfma_f32_16x16x32_bf16 v[88:91], v[104:107], v[120:123], v[88:91]
  ds_read_b128 v[76:79], v12 offset:16384
  v_mul_f32 v84, v126, v84
  v_mul_f32 v85, v126, v85
  v_mul_f32 v86, v126, v86
  v_mul_f32 v87, v126, v87
  v_mfma_f32_16x16x32_bf16 v[92:95], v[108:111], v[120:123], v[92:95]
  v_cvt_pk_bf16_f32 v112, v80, v81
  v_cvt_pk_bf16_f32 v113, v82, v83
  v_cvt_pk_bf16_f32 v114, v84, v85
  v_cvt_pk_bf16_f32 v115, v86, v87
  s_waitcnt lgkmcnt(2)
  s_nop 0
  v_smfmac_f32_16x16x64_bf16 v[48:51], v[112:115], v[128:135], v2
  v_mul_f32 v88, v126, v88
  v_mul_f32 v89, v126, v89
  v_smfmac_f32_16x16x64_bf16 v[52:55], v[112:115], v[144:151], v2
  v_mul_f32 v90, v126, v90
  v_mul_f32 v91, v126, v91
  v_smfmac_f32_16x16x64_bf16 v[56:59], v[112:115], v[160:167], v2
  v_mul_f32 v92, v126, v92
  v_mul_f32 v93, v126, v93
  v_smfmac_f32_16x16x64_bf16 v[60:63], v[112:115], v[176:183], v2
  v_mul_f32 v94, v126, v94
  v_mul_f32 v95, v126, v95
  v_smfmac_f32_16x16x64_bf16 v[64:67], v[112:115], v[192:199], v2
  v_cvt_pk_bf16_f32 v120, v88, v89
  v_cvt_pk_bf16_f32 v121, v90, v91
  s_waitcnt lgkmcnt(0)
  v_smfmac_f32_16x16x64_bf16 v[68:71], v[112:115], v[208:215], v2
  v_cvt_pk_bf16_f32 v122, v92, v93
  v_smfmac_f32_16x16x64_bf16 v[72:75], v[112:115], v[224:231], v2
  v_cvt_pk_bf16_f32 v123, v94, v95
  v_smfmac_f32_16x16x64_bf16 v[76:79], v[112:115], v[240:247], v2
  s_nop 0
  v_smfmac_f32_16x16x64_bf16 v[48:51], v[120:123], v[136:143], v2
  s_nop 1
  v_smfmac_f32_16x16x64_bf16 v[52:55], v[120:123], v[152:159], v2
  s_nop 1
  v_smfmac_f32_16x16x64_bf16 v[56:59], v[120:123], v[168:175], v2
  s_nop 1
  v_smfmac_f32_16x16x64_bf16 v[60:63], v[120:123], v[184:191], v2
  v_add_f32 v48, v48, v50
  v_add_f32 v49, v49, v51
  v_cvt_pk_bf16_f32 v96, v48, v49
  v_bfi_b32 v96, 1, s96, v96
  v_smfmac_f32_16x16x64_bf16 v[64:67], v[120:123], v[200:207], v2
  v_add_f32 v52, v52, v54
  v_add_f32 v53, v53, v55
  v_cvt_pk_bf16_f32 v97, v52, v53
  v_smfmac_f32_16x16x64_bf16 v[68:71], v[120:123], v[216:223], v2
  v_add_f32 v56, v56, v58
  v_add_f32 v57, v57, v59
  v_cvt_pk_bf16_f32 v98, v56, v57
  v_smfmac_f32_16x16x64_bf16 v[72:75], v[120:123], v[232:239], v2
  v_add_f32 v60, v60, v62
  v_add_f32 v61, v61, v63
  v_cvt_pk_bf16_f32 v99, v60, v61
  buffer_store_dwordx4 v[96:99], v15, s[4:7], s38 offen
  v_smfmac_f32_16x16x64_bf16 v[76:79], v[120:123], v[248:255], v2
  v_add_f32 v64, v64, v66
  v_add_f32 v65, v65, v67
  v_cvt_pk_bf16_f32 v100, v64, v65
  v_bfi_b32 v100, 1, s96, v100
  v_add_f32 v68, v68, v70
  v_add_f32 v69, v69, v71
  v_cvt_pk_bf16_f32 v101, v68, v69
  v_add_f32 v72, v72, v74
  v_add_f32 v73, v73, v75
  v_cvt_pk_bf16_f32 v102, v72, v73
  v_add_f32 v76, v76, v78
  v_add_f32 v77, v77, v79
  v_cvt_pk_bf16_f32 v103, v76, v77
  buffer_store_dwordx4 v[100:103], v15, s[4:7], s39 offen
  s_add_u32 s33, s33, 1
  s_add_u32 s46, s46, 0x40000
  s_add_u32 s43, s43, 262144
  s_add_u32 s44, s44, 262144
  s_mov_b32 s95, s35
  s_xor_b32 s34, s34, 0x8000
  s_xor_b32 s35, s35, 0x8000
  s_xor_b32 s36, s36, 0x8000
  s_xor_b32 s37, s37, 0x8000
  s_mov_b32 s53, s38
  s_mov_b32 s54, s94
  s_xor_b32 s38, s38, 0x80000
  s_xor_b32 s39, s39, 0x80000
  ds_read_b128 v[96:99], v13 offset:0
  ds_read_b128 v[100:103], v13 offset:1024
  ds_read_b128 v[104:107], v13 offset:2048
  ds_read_b128 v[108:111], v13 offset:3072
  ds_read_b128 v[120:123], v13 offset:4096
  ds_read_b128 v[124:127], v13 offset:5120
  v_mov_b64 v[80:81], 0
  v_mov_b64 v[82:83], 0
  v_mov_b64 v[84:85], 0
  v_mov_b64 v[86:87], 0
  v_mov_b64 v[88:89], 0
  v_mov_b64 v[90:91], 0
  v_mov_b64 v[92:93], 0
  v_mov_b64 v[94:95], 0
  v_mov_b64 v[112:113], 0
  v_mov_b64 v[114:115], 0
  v_mov_b64 v[116:117], 0
  v_mov_b64 v[118:119], 0
  s_mov_b32 s42, s41
  s_and_b32 s56, s33, 3
  s_lshl_b32 s56, s56, 14
  s_add_u32 s40, s62, s56
  s_add_u32 s41, s63, s56
  s_add_u32 s56, s33, 1
  s_min_u32 s56, s56, 63
  s_lshr_b32 s57, s56, 3
  s_add_u32 s57, s57, 1
  s_lshr_b32 s58, s56, 2
  s_cmp_lt_u32 s56, 8
  s_cselect_b32 s57, s58, s57
  s_cselect_b32 s49, 64, 32
  s_lshl_b32 s57, s57, 7
  s_add_u32 s48, s57, 2621440
  s_nop 7
  buffer_load_dwordx4 v[56:59], v16, s[4:7], s53 offen sc1
  buffer_load_dwordx4 v[60:63], v16, s[4:7], s53 offen offset:1024 sc1
pb_190:
  s_waitcnt vmcnt(0)
  v_mfma_f32_16x16x32_bf16 v[72:75], v[56:59], v[20:23], 0
  v_bitop3_b32 v18, v56, v60, s96 bitop3:0x7e
  v_and_b32 v18, 1, v18
  v_cmp_ne_u32 vcc, 0, v18
  v_mfma_f32_16x16x32_bf16 v[72:75], v[60:63], v[20:23], v[72:75]
  s_cbranch_vccnz fb_191
eb_192:
  v_mfma_f32_16x16x32_bf16 v[76:79], v[56:59], v[24:27], 0
  v_mfma_f32_16x16x32_bf16 v[76:79], v[60:63], v[24:27], v[76:79]
  s_nop 4
  v_add_f32 v72, v72, v73
  v_add_f32 v74, v74, v75
  v_add_f32 v72, v72, v74
  v_pk_add_f32 v[76:77], v[76:77], v[78:79]
  v_add_f32 v76, v76, v77
  s_nop 1
  v_permlane32_swap_b32 v72, v76
  v_add_f32 v72, v72, v76
  v_mov_b32 v76, v72
  s_nop 1
  v_permlane16_swap_b32 v72, v76
  v_add_f32 v72, v72, v76
  v_mov_b32 v76, v72
  s_nop 1
  v_permlane32_swap_b32 v72, v76
  v_cvt_pk_bf16_f32 v19, v72, v76
  buffer_store_dword v19, v17, s[4:7], s41 offen
  s_mov_b64 exec, -1
  s_branch R_fast_top
R_done:
  buffer_store_dwordx4 v[36:39], v1, s[4:7], s46 offen sc1
  s_waitcnt vmcnt(0) lgkmcnt(0)
  s_barrier
  s_cmp_lg_u32 s30, 0
  s_cbranch_scc1 L_fin
  v_mov_b32 v19, 64
  s_mov_b64 exec, 1
  buffer_store_dword v19, off, s[4:7], s47 sc1
  s_mov_b64 exec, -1
  s_branch L_fin
fb_191:
  s_mov_b64 exec, vcc
  buffer_load_dwordx4 v[56:59], v16, s[4:7], s53 offen sc1
  buffer_load_dwordx4 v[60:63], v16, s[4:7], s53 offen offset:1024 sc1
  s_mov_b64 exec, -1
  s_sub_u32 s94, s94, 1
  s_cbranch_scc0 bd_193
  s_mov_b32 s94, 0
  s_branch eb_192
bd_193:
  s_branch pb_190
fv_187:
  s_sub_u32 s94, s94, 1
  s_cbranch_scc0 bd_189
  s_mov_b32 s94, 0
  s_branch ev_188
bd_189:
  buffer_load_dwordx2 v[98:99], v9, s[4:7], s37 offen offset:0 sc1
  buffer_load_dwordx2 v[102:103], v9, s[4:7], s37 offen offset:512 sc1
  buffer_load_dwordx2 v[106:107], v9, s[4:7], s37 offen offset:1024 sc1
  buffer_load_dwordx2 v[110:111], v9, s[4:7], s37 offen offset:1536 sc1
  s_waitcnt vmcnt(0)
  v_bitop3_b32 v124, v98, v102, s96 bitop3:0x7e
  v_bitop3_b32 v125, v106, v110, s96 bitop3:0x7e
  v_bitop3_b32 v124, v124, v125, 1 bitop3:0xa8
  v_cmp_ne_u32 vcc, 0, v124
  s_nop 0
  s_cbranch_vccz ev_188
  s_branch fv_187
fa_180:
  buffer_load_dwordx4 v[40:43], v1, s[4:7], s35 offen sc1
  s_waitcnt vmcnt(1)
sa_182:
  s_sub_u32 s94, s94, 1
  s_cbranch_scc0 bd_183
  s_mov_b32 s94, 0
  s_branch ea_181
bd_183:
  v_bitop3_b32 v19, v124, s96, 1 bitop3:0x28
  v_cmp_ne_u32 vcc, 0, v19
  v_dot2_f32_bf16 v112, v124, s97, v80
  v_dot2_f32_bf16 v113, v124, s99, v81
  v_dot2_f32_bf16 v114, v126, s97, v82
  v_dot2_f32_bf16 v115, v126, s99, v83
  v_dot2_f32_bf16 v116, v125, s97, v88
  v_dot2_f32_bf16 v117, v125, s99, v89
  v_dot2_f32_bf16 v118, v127, s97, v90
  v_dot2_f32_bf16 v119, v127, s99, v91
  s_cbranch_vccz ea_181
  buffer_load_dwordx4 v[124:127], v1, s[4:7], s35 offen sc1
  s_waitcnt vmcnt(1)
  v_bitop3_b32 v19, v40, s96, 1 bitop3:0x28
  v_cmp_ne_u32 vcc, 0, v19
  v_dot2_f32_bf16 v112, v40, s97, v80
  v_dot2_f32_bf16 v113, v40, s99, v81
  v_dot2_f32_bf16 v114, v42, s97, v82
  v_dot2_f32_bf16 v115, v42, s99, v83
  v_dot2_f32_bf16 v116, v41, s97, v88
  v_dot2_f32_bf16 v117, v41, s99, v89
  v_dot2_f32_bf16 v118, v43, s97, v90
  v_dot2_f32_bf16 v119, v43, s99, v91
  s_cbranch_vccz ea_181
  buffer_load_dwordx4 v[40:43], v1, s[4:7], s35 offen sc1
  s_waitcnt vmcnt(1)
  s_branch sa_182
fc_175:
  s_mov_b64 exec, vcc
  buffer_load_dwordx4 v[48:51], v1, s[4:7], s40 offen sc1
  buffer_load_dwordx4 v[52:55], v1, s[4:7], s40 offen offset:1024 sc1
  s_mov_b64 exec, -1
  s_sub_u32 s94, s94, 1
  s_cbranch_scc0 bd_179
  s_mov_b32 s94, 0
  s_branch ec_176
bd_179:
  v_mov_b64 v[80:81], 0
  v_mov_b64 v[82:83], 0
  v_mov_b64 v[84:85], 0
  v_mov_b64 v[86:87], 0
  s_branch R_fast_cw
kvw_184:
  s_waitcnt vmcnt(0)
  v_mov_b32 v19, 0x0
spin_194:
  buffer_load_dword v18, v19, s[4:7], s48 offen sc1
  s_waitcnt vmcnt(0)
  v_readfirstlane_b32 s56, v18
  s_nop 0
  s_cmp_ge_u32 s56, s49
  s_cbranch_scc1 spun_195
  s_sleep 4
  s_sub_u32 s94, s94, 1
  s_cbranch_scc0 spin_194
  s_mov_b32 s94, 0
spun_195:
  s_branch kvr_185
R_slow_top:
  s_bfe_u32 s96, s33, 0x10001
  s_mov_b32 m0, s52
  s_sleep 5
  buffer_load_dwordx4 v[48:51], v1, s[4:7], s40 offen sc1
  buffer_load_dwordx4 v[52:55], v1, s[4:7], s40 offen offset:1024 sc1
R_slow_cw:
  s_waitcnt vmcnt(0)
R_slow:
  ds_write_b128 v3, v[48:51]
  ds_write_b128 v3, v[52:55] offset:1024
  v_smfmac_f32_16x16x64_bf16 v[80:83], v[48:51], a[0:7], v2
  v_max3_u32 v18, v48, v49, v50
  v_max3_u32 v19, v51, v52, v53
  v_smfmac_f32_16x16x64_bf16 v[84:87], v[48:51], a[128:135], v2
  v_max3_u32 v18, v18, v54, v55
  v_max_u32 v18, v18, v19
  v_cmp_eq_u32 vcc, -1, v18
  s_nop 0
  s_cbranch_vccnz fc_196
ec_197:
  v_smfmac_f32_16x16x64_bf16 v[88:91], v[48:51], a[8:15], v2
  v_mov_b32 v19, s33
  s_waitcnt lgkmcnt(0)
  s_barrier
  ds_read_b128 v[56:59], v4 offset:0
  ds_read_b128 v[60:63], v4 offset:1024
  v_smfmac_f32_16x16x64_bf16 v[92:95], v[48:51], a[136:143], v2
  buffer_load_dwordx4 v1, s[4:7], s44 offen sc1 lds
  ds_read_b128 v[64:67], v5 offset:0
  v_smfmac_f32_16x16x64_bf16 v[80:83], v[52:55], a[16:23], v2
  ds_read_b128 v[68:71], v5 offset:1024
  v_smfmac_f32_16x16x64_bf16 v[84:87], v[52:55], a[144:151], v2
  ds_read_b128 v[72:75], v6 offset:0
  v_smfmac_f32_16x16x64_bf16 v[88:91], v[52:55], a[24:31], v2
  ds_read_b128 v[76:79], v6 offset:1024
  v_smfmac_f32_16x16x64_bf16 v[92:95], v[52:55], a[152:159], v2
  buffer_load_dwordx4 v1, s[4:7], s44 offen offset:1024 sc1 lds
  s_waitcnt lgkmcnt(5)
  v_smfmac_f32_16x16x64_bf16 v[80:83], v[56:59], a[32:39], v2
  v_smfmac_f32_16x16x64_bf16 v[84:87], v[56:59], a[160:167], v2
  v_smfmac_f32_16x16x64_bf16 v[88:91], v[56:59], a[40:47], v2
  buffer_store_dword v30, v14, s[4:7], s95 offen offset:4 sc1
  v_smfmac_f32_16x16x64_bf16 v[92:95], v[56:59], a[168:175], v2
  s_waitcnt lgkmcnt(4)
  v_smfmac_f32_16x16x64_bf16 v[80:83], v[60:63], a[48:55], v2
  v_smfmac_f32_16x16x64_bf16 v[84:87], v[60:63], a[176:183], v2
  v_smfmac_f32_16x16x64_bf16 v[88:91], v[60:63], a[56:63], v2
  buffer_store_dword v19, off, s[4:7], s47 sc1
  v_smfmac_f32_16x16x64_bf16 v[92:95], v[60:63], a[184:191], v2
  s_waitcnt lgkmcnt(0)
  v_smfmac_f32_16x16x64_bf16 v[80:83], v[64:67], a[64:71], v2
  v_smfmac_f32_16x16x64_bf16 v[80:83], v[68:71], a[80:87], v2
  v_smfmac_f32_16x16x64_bf16 v[80:83], v[72:75], a[96:103], v2
  v_smfmac_f32_16x16x64_bf16 v[80:83], v[76:79], a[112:119], v2
  v_smfmac_f32_16x16x64_bf16 v[84:87], v[64:67], a[192:199], v2
  s_nop 1
  v_smfmac_f32_16x16x64_bf16 v[84:87], v[68:71], a[208:215], v2
  s_nop 1
  v_smfmac_f32_16x16x64_bf16 v[84:87], v[72:75], a[224:231], v2
  s_nop 1
  v_smfmac_f32_16x16x64_bf16 v[84:87], v[76:79], a[240:247], v2
  v_add_f32 v80, v80, v82
  v_smfmac_f32_16x16x64_bf16 v[88:91], v[64:67], a[72:79], v2
  v_add_f32 v81, v81, v83
  s_nop 0
  v_smfmac_f32_16x16x64_bf16 v[88:91], v[68:71], a[88:95], v2
  s_nop 1
  v_smfmac_f32_16x16x64_bf16 v[88:91], v[72:75], a[104:111], v2
  v_add_f32 v82, v84, v86
  v_smfmac_f32_16x16x64_bf16 v[88:91], v[76:79], a[120:127], v2
  v_add_f32 v83, v85, v87
  v_smfmac_f32_16x16x64_bf16 v[92:95], v[64:67], a[200:207], v2
  v_cvt_pk_bf16_f32 v36, v80, v81
  s_nop 0
  v_smfmac_f32_16x16x64_bf16 v[92:95], v[68:71], a[216:223], v2
  v_cvt_pk_bf16_f32 v38, v82, v83
  v_bfi_b32 v36, 1, s96, v36
  v_smfmac_f32_16x16x64_bf16 v[92:95], v[72:75], a[232:239], v2
  v_add_f32 v88, v88, v90
  v_smfmac_f32_16x16x64_bf16 v[92:95], v[76:79], a[248:255], v2
  v_add_f32 v89, v89, v91
  v_smfmac_f32_16x16x64_bf16 v[112:115], v[48:51], v[96:103], v2
  v_cvt_pk_bf16_f32 v37, v88, v89
  s_nop 0
  v_smfmac_f32_16x16x64_bf16 v[116:119], v[48:51], v[104:111], v2
  s_nop 2
  v_add_f32 v90, v92, v94
  v_add_f32 v91, v93, v95
  v_cvt_pk_bf16_f32 v39, v90, v91
  buffer_store_dwordx4 v[36:39], v1, s[4:7], s34 offen sc1
  ds_read_b128 v[96:99], v13 offset:6144
  ds_read_b128 v[100:103], v13 offset:7168
  v_xor_b32 v13, 32768, v13
  ds_read_b128 v[104:107], v13 offset:0
  ds_read_b128 v[108:111], v13 offset:1024
  s_waitcnt lgkmcnt(4)
  v_smfmac_f32_16x16x64_bf16 v[112:115], v[52:55], v[120:127], v2
  buffer_load_dword v18, off, s[4:7], s48 sc1
  ds_read_b128 v[120:123], v13 offset:2048
  ds_read_b128 v[124:127], v13 offset:3072
  s_waitcnt lgkmcnt(4)
  v_smfmac_f32_16x16x64_bf16 v[116:119], v[52:55], v[96:103], v2
  buffer_store_dword v30, v17, s[4:7], s42 offen sc1
  ds_read_b128 v[96:99], v13 offset:4096
  ds_read_b128 v[100:103], v13 offset:5120
  ds_read_b128 v[48:51], v13 offset:6144
  ds_read_b128 v[52:55], v13 offset:7168
  v_xor_b32 v13, 98304, v13
  s_waitcnt lgkmcnt(6)
  v_smfmac_f32_16x16x64_bf16 v[112:115], v[56:59], v[104:111], v2
  ds_read_b128 v[104:107], v13 offset:0
  ds_read_b128 v[108:111], v13 offset:1024
  s_waitcnt lgkmcnt(6)
  v_smfmac_f32_16x16x64_bf16 v[116:119], v[56:59], v[120:127], v2
  ds_read_b128 v[120:123], v13 offset:2048
  ds_read_b128 v[124:127], v13 offset:3072
  s_waitcnt lgkmcnt(6)
  v_smfmac_f32_16x16x64_bf16 v[112:115], v[60:63], v[96:103], v2
  ds_read_b128 v[96:99], v13 offset:4096
  ds_read_b128 v[100:103], v13 offset:5120
  s_waitcnt lgkmcnt(6)
  v_smfmac_f32_16x16x64_bf16 v[116:119], v[60:63], v[48:55], v2
  ds_read_b128 v[48:51], v13 offset:6144
  ds_read_b128 v[52:55], v13 offset:7168
  v_xor_b32 v13, 32768, v13
  ds_read_b128 v[56:59], v13 offset:0
  ds_read_b128 v[60:63], v13 offset:1024
  s_waitcnt lgkmcnt(8)
  v_smfmac_f32_16x16x64_bf16 v[112:115], v[64:67], v[104:111], v2
  ds_read_b128 v[104:107], v13 offset:2048
  ds_read_b128 v[108:111], v13 offset:3072
  s_waitcnt lgkmcnt(8)
  v_smfmac_f32_16x16x64_bf16 v[116:119], v[64:67], v[120:127], v2
  ds_read_b128 v[120:123], v13 offset:4096
  ds_read_b128 v[124:127], v13 offset:5120
  s_waitcnt lgkmcnt(8)
  v_smfmac_f32_16x16x64_bf16 v[112:115], v[68:71], v[96:103], v2
  ds_read_b128 v[96:99], v13 offset:6144
  ds_read_b128 v[100:103], v13 offset:7168
  v_xor_b32 v13, 98304, v13
  s_waitcnt lgkmcnt(8)
  v_smfmac_f32_16x16x64_bf16 v[116:119], v[68:71], v[48:55], v2
  s_waitcnt lgkmcnt(6)
  v_smfmac_f32_16x16x64_bf16 v[112:115], v[72:75], v[56:63], v2
  buffer_load_dwordx4 v[40:43], v1, s[4:7], s35 offen sc1
  s_waitcnt lgkmcnt(4)
  v_smfmac_f32_16x16x64_bf16 v[116:119], v[72:75], v[104:111], v2
  s_waitcnt lgkmcnt(2)
  v_smfmac_f32_16x16x64_bf16 v[112:115], v[76:79], v[120:127], v2
  s_waitcnt lgkmcnt(0)
  v_smfmac_f32_16x16x64_bf16 v[116:119], v[76:79], v[96:103], v2
  ds_read_b128 v[48:51], v12 offset:0
  ds_read_b128 v[52:55], v12 offset:1024
  ds_read_b128 v[56:59], v12 offset:2048
  ds_read_b128 v[60:63], v12 offset:3072
  s_nop 1
  v_add_f32 v112, v112, v114
  v_add_f32 v113, v113, v115
  v_add_f32 v116, v116, v118
  v_add_f32 v117, v117, v119
  v_cvt_pk_bf16_f32 v36, v112, v113
  v_cvt_pk_bf16_f32 v37, v116, v117
  v_bfi_b32 v120, 1, s96, v36
  v_mov_b32 v121, v37
  ds_write_b64 v11, v[36:37]
  v_permlane32_swap_b32 v120, v122
  v_permlane32_swap_b32 v121, v123
  s_waitcnt vmcnt(4)
  s_mov_b32 exec_hi, 0
  buffer_store_dwordx4 v[120:123], v1, s[4:7], s36 offen sc1
  s_mov_b64 exec, -1
  ds_read_b128 v[64:67], v12 offset:4096
  ds_read_b128 v[68:71], v12 offset:5120
  ds_read_b128 v[72:75], v12 offset:6144
  ds_read_b128 v[76:79], v12 offset:7168
  s_cmp_eq_u32 s33, 63
  s_cbranch_scc1 R_done
  s_mov_b32 m0, s51
  s_sleep 2
  s_nop 7
  buffer_load_dwordx4 v[124:127], v1, s[4:7], s35 offen sc1
  s_waitcnt vmcnt(2)
  v_bitop3_b32 v19, v40, s96, 1 bitop3:0x28
  v_cmp_ne_u32 vcc, 0, v19
  v_dot2_f32_bf16 v112, v40, s97, v80
  v_dot2_f32_bf16 v113, v40, s99, v81
  v_dot2_f32_bf16 v114, v42, s97, v82
  v_dot2_f32_bf16 v115, v42, s99, v83
  v_dot2_f32_bf16 v116, v41, s97, v88
  v_dot2_f32_bf16 v117, v41, s99, v89
  v_dot2_f32_bf16 v118, v43, s97, v90
  v_dot2_f32_bf16 v119, v43, s99, v91
  s_cbranch_vccnz fa_201
ea_202:
  v_cvt_pk_bf16_f32 v84, v112, v113
  v_cvt_pk_bf16_f32 v85, v114, v115
  ds_write_b64 v7, v[84:85]
  v_cvt_pk_bf16_f32 v86, v116, v117
  v_cvt_pk_bf16_f32 v87, v118, v119
  ds_write_b64 v7, v[86:87] offset:512
  buffer_load_dword v19, v31, s[4:7], s37 offen sc1
  v_readfirstlane_b32 s56, v18
  s_mov_b32 vcc_lo, 0x33333333
  s_mov_b32 vcc_hi, 0x33333333
  s_cmp_lt_u32 s56, s49
  s_waitcnt lgkmcnt(0)
  s_barrier
  ds_read_b64_tr_b16 v[80:81], v8 offset:0
  ds_read_b64_tr_b16 v[82:83], v8 offset:512
  ds_read_b64_tr_b16 v[84:85], v8 offset:1024
  ds_read_b64_tr_b16 v[86:87], v8 offset:1536
  ds_read_b64_tr_b16 v[88:89], v8 offset:2048
  ds_read_b64_tr_b16 v[90:91], v8 offset:2560
  ds_read_b64_tr_b16 v[92:93], v8 offset:3072
  ds_read_b64_tr_b16 v[94:95], v8 offset:3584
  s_cbranch_scc1 kvw_205
kvr_206:
  s_waitcnt lgkmcnt(6)
  v_mfma_f32_16x16x32_bf16 v[112:115], v[48:51], v[80:83], 0
  v_mfma_f32_16x16x32_bf16 v[116:119], v[64:67], v[80:83], 0
  v_mfma_f32_16x16x32_bf16 v[120:123], v[80:83], v[80:83], v[26:29]
  buffer_load_dwordx2 v[98:99], v9, s[4:7], s37 offen offset:0 sc1
  s_waitcnt lgkmcnt(4)
  v_mfma_f32_16x16x32_bf16 v[112:115], v[52:55], v[84:87], v[112:115]
  ds_read_b128 v[48:51], v12 offset:8192
  v_mfma_f32_16x16x32_bf16 v[116:119], v[68:71], v[84:87], v[116:119]
  ds_read_b128 v[64:67], v12 offset:12288
  buffer_load_dwordx2 v[102:103], v9, s[4:7], s37 offen offset:512 sc1
  v_mfma_f32_16x16x32_bf16 v[120:123], v[84:87], v[84:87], v[120:123]
  ds_read_b128 v[52:55], v12 offset:9216
  s_waitcnt lgkmcnt(5)
  v_mfma_f32_16x16x32_bf16 v[112:115], v[56:59], v[88:91], v[112:115]
  ds_read_b128 v[68:71], v12 offset:13312
  buffer_load_dwordx2 v[106:107], v9, s[4:7], s37 offen offset:1024 sc1
  v_mfma_f32_16x16x32_bf16 v[116:119], v[72:75], v[88:91], v[116:119]
  ds_read_b128 v[56:59], v12 offset:10240
  v_mfma_f32_16x16x32_bf16 v[120:123], v[88:91], v[88:91], v[120:123]
  ds_read_b128 v[72:75], v12 offset:14336
  buffer_load_dwordx2 v[110:111], v9, s[4:7], s37 offen offset:1536 sc1
  s_waitcnt lgkmcnt(6)
  v_mfma_f32_16x16x32_bf16 v[112:115], v[60:63], v[92:95], v[112:115]
  ds_read_b64 v[96:97], v10 offset:0
  ds_read_b64 v[100:101], v10 offset:512
  v_mfma_f32_16x16x32_bf16 v[116:119], v[76:79], v[92:95], v[116:119]
  ds_read_b128 v[60:63], v12 offset:11264
  v_mfma_f32_16x16x32_bf16 v[120:123], v[92:95], v[92:95], v[120:123]
  ds_read_b128 v[76:79], v12 offset:15360
  ds_read_b64 v[104:105], v10 offset:1024
  ds_read_b64 v[108:109], v10 offset:1536
  s_nop 2
  v_cndmask_b32_dpp v112, v116, v112, vcc quad_perm:[0,1,0,1] row_mask:0xf bank_mask:0xf
  v_cndmask_b32_dpp v113, v117, v113, vcc quad_perm:[0,1,0,1] row_mask:0xf bank_mask:0xf
  v_cndmask_b32_dpp v114, v118, v114, vcc quad_perm:[0,1,0,1] row_mask:0xf bank_mask:0xf
  v_cndmask_b32_dpp v115, v119, v115, vcc quad_perm:[0,1,0,1] row_mask:0xf bank_mask:0xf
  v_max3_f32 v116, v112, v122, v123
  s_not_b64 vcc, vcc
  v_max3_f32 v116, v116, v113, v114
  v_max_f32 v116, v116, v115
  buffer_load_dwordx4 v1, s[4:7], s43 offen offset:0 sc1 lds
  s_nop 0
  v_max_f32_dpp v116, v116, v116 quad_perm:[2,3,0,1] row_mask:0xf bank_mask:0xf
  v_mov_b32 v117, v116
  buffer_load_dwordx4 v1, s[4:7], s43 offen offset:1024 sc1 lds
  s_nop 0
  v_permlane16_swap_b32 v116, v117
  v_max_f32 v116, v116, v117
  v_mov_b32 v117, v116
  buffer_store_dwordx4 v[36:39], v1, s[4:7], s46 offen sc1
  s_waitcnt vmcnt(8)
  v_permlane32_swap_b32 v116, v117
  v_max_f32 v116, v116, v117
  v_mul_f32 v127, s50, v116
  v_fma_f32 v112, v112, s50, -v127
  v_fma_f32 v113, v113, s50, -v127
  v_fma_f32 v114, v114, s50, -v127
  v_fma_f32 v115, v115, s50, -v127
  v_exp_f32 v112, v112
  v_exp_f32 v113, v113
  v_exp_f32 v114, v114
  v_exp_f32 v115, v115
  v_cvt_pk_bf16_f32 v124, v112, v113
  v_cvt_pk_bf16_f32 v125, v114, v115
  v_fma_f32 v122, v122, s50, -v127
  v_cndmask_b32_dpp v32, v124, v32, vcc quad_perm:[0,1,2,3] row_mask:0xf bank_mask:0xf
  v_cndmask_b32_dpp v34, v124, v34, vcc quad_perm:[2,3,2,3] row_mask:0xf bank_mask:0xf
  v_cndmask_b32_dpp v33, v125, v33, vcc quad_perm:[0,1,2,3] row_mask:0xf bank_mask:0xf
  v_cndmask_b32_dpp v35, v125, v35, vcc quad_perm:[2,3,2,3] row_mask:0xf bank_mask:0xf
  v_fma_f32 v123, v123, s50, -v127
  s_waitcnt lgkmcnt(0)
  v_mfma_f32_16x16x32_bf16 v[80:83], v[48:51], v[32:35], 0
  v_exp_f32 v122, v122
  v_mov_b32_dpp v36, v32 quad_perm:[2,3,0,1] row_mask:0xf bank_mask:0xf
  v_mfma_f32_16x16x32_bf16 v[84:87], v[56:59], v[32:35], 0
  v_exp_f32 v123, v123
  v_mov_b32_dpp v38, v34 quad_perm:[2,3,0,1] row_mask:0xf bank_mask:0xf
  v_mfma_f32_16x16x32_bf16 v[116:119], v[44:47], v[32:35], 0
  v_mov_b32_dpp v37, v33 quad_perm:[2,3,0,1] row_mask:0xf bank_mask:0xf
  v_mov_b32_dpp v39, v35 quad_perm:[2,3,0,1] row_mask:0xf bank_mask:0xf
  v_cvt_pk_bf16_f32 v120, v122, v123
  ds_read_b128 v[48:51], v12 offset:16384
  v_mfma_f32_16x16x32_bf16 v[80:83], v[52:55], v[36:39], v[80:83]
  ds_read_b128 v[56:59], v12 offset:16384
  v_mov_b32_dpp v121, v120 quad_perm:[2,3,0,1] row_mask:0xf bank_mask:0xf
  v_mfma_f32_16x16x32_bf16 v[84:87], v[60:63], v[36:39], v[84:87]
  v_mov_b64 v[122:123], v[120:121]
  ds_read_b128 v[52:55], v12 offset:16384
  v_mfma_f32_16x16x32_bf16 v[88:91], v[64:67], v[32:35], 0
  s_waitcnt vmcnt(3)
  v_bitop3_b32 v124, v98, v102, s96 bitop3:0x7e
  v_bitop3_b32 v125, v106, v110, s96 bitop3:0x7e
  v_mfma_f32_16x16x16_bf16 v[116:119], v[44:45], v[120:121], v[116:119]
  ds_read_b128 v[60:63], v12 offset:16384
  v_mfma_f32_16x16x32_bf16 v[92:95], v[72:75], v[32:35], 0
  v_bitop3_b32 v124, v124, v125, 1 bitop3:0xa8
  v_cmp_ne_u32 vcc, 0, v124
  ds_read_b128 v[64:67], v12 offset:16384
  s_cbranch_vccnz fv_208
ev_209:
  v_mfma_f32_16x16x32_bf16 v[80:83], v[96:99], v[120:123], v[80:83]
  ds_read_b128 v[72:75], v12 offset:16384
  v_mfma_f32_16x16x32_bf16 v[84:87], v[100:103], v[120:123], v[84:87]
  v_rcp_f32_dpp v126, v116 quad_perm:[0,1,0,1] row_mask:0xf bank_mask:0xf
  v_mfma_f32_16x16x32_bf16 v[88:91], v[68:71], v[36:39], v[88:91]
  s_nop 1
  v_mfma_f32_16x16x32_bf16 v[92:95], v[76:79], v[36:39], v[92:95]
  ds_read_b128 v[68:71], v12 offset:16384
  v_mul_f32 v80, v126, v80
  v_mul_f32 v81, v126, v81
  v_mul_f32 v82, v126, v82
  v_mul_f32 v83, v126, v83
  v_mfma_f32_16x16x32_bf16 v[88:91], v[104:107], v[120:123], v[88:91]
  ds_read_b128 v[76:79], v12 offset:16384
  v_mul_f32 v84, v126, v84
  v_mul_f32 v85, v126, v85
  v_mul_f32 v86, v126, v86
  v_mul_f32 v87, v126, v87
  v_mfma_f32_16x16x32_bf16 v[92:95], v[108:111], v[120:123], v[92:95]
  v_cvt_pk_bf16_f32 v112, v80, v81
  v_cvt_pk_bf16_f32 v113, v82, v83
  v_cvt_pk_bf16_f32 v114, v84, v85
  v_cvt_pk_bf16_f32 v115, v86, v87
  s_waitcnt lgkmcnt(2)
  s_nop 0
  v_smfmac_f32_16x16x64_bf16 v[48:51], v[112:115], v[128:135], v2
  v_mul_f32 v88, v126, v88
  v_mul_f32 v89, v126, v89
  v_smfmac_f32_16x16x64_bf16 v[52:55], v[112:115], v[144:151], v2
  v_mul_f32 v90, v126, v90
  v_mul_f32 v91, v126, v91
  v_smfmac_f32_16x16x64_bf16 v[56:59], v[112:115], v[160:167], v2
  v_mul_f32 v92, v126, v92
  v_mul_f32 v93, v126, v93
  v_smfmac_f32_16x16x64_bf16 v[60:63], v[112:115], v[176:183], v2
  v_mul_f32 v94, v126, v94
  v_mul_f32 v95, v126, v95
  v_smfmac_f32_16x16x64_bf16 v[64:67], v[112:115], v[192:199], v2
  v_cvt_pk_bf16_f32 v120, v88, v89
  v_cvt_pk_bf16_f32 v121, v90, v91
  s_waitcnt lgkmcnt(0)
  v_smfmac_f32_16x16x64_bf16 v[68:71], v[112:115], v[208:215], v2
  v_cvt_pk_bf16_f32 v122, v92, v93
  v_smfmac_f32_16x16x64_bf16 v[72:75], v[112:115], v[224:231], v2
  v_cvt_pk_bf16_f32 v123, v94, v95
  v_smfmac_f32_16x16x64_bf16 v[76:79], v[112:115], v[240:247], v2
  s_nop 0
  v_smfmac_f32_16x16x64_bf16 v[48:51], v[120:123], v[136:143], v2
  s_nop 1
  v_smfmac_f32_16x16x64_bf16 v[52:55], v[120:123], v[152:159], v2
  s_nop 1
  v_smfmac_f32_16x16x64_bf16 v[56:59], v[120:123], v[168:175], v2
  s_nop 1
  v_smfmac_f32_16x16x64_bf16 v[60:63], v[120:123], v[184:191], v2
  v_add_f32 v48, v48, v50
  v_add_f32 v49, v49, v51
  v_cvt_pk_bf16_f32 v96, v48, v49
  v_bfi_b32 v96, 1, s96, v96
  v_smfmac_f32_16x16x64_bf16 v[64:67], v[120:123], v[200:207], v2
  v_add_f32 v52, v52, v54
  v_add_f32 v53, v53, v55
  v_cvt_pk_bf16_f32 v97, v52, v53
  v_smfmac_f32_16x16x64_bf16 v[68:71], v[120:123], v[216:223], v2
  v_add_f32 v56, v56, v58
  v_add_f32 v57, v57, v59
  v_cvt_pk_bf16_f32 v98, v56, v57
  v_smfmac_f32_16x16x64_bf16 v[72:75], v[120:123], v[232:239], v2
  v_add_f32 v60, v60, v62
  v_add_f32 v61, v61, v63
  v_cvt_pk_bf16_f32 v99, v60, v61
  buffer_store_dwordx4 v[96:99], v15, s[4:7], s38 offen sc1
  v_smfmac_f32_16x16x64_bf16 v[76:79], v[120:123], v[248:255], v2
  v_add_f32 v64, v64, v66
  v_add_f32 v65, v65, v67
  v_cvt_pk_bf16_f32 v100, v64, v65
  v_bfi_b32 v100, 1, s96, v100
  v_add_f32 v68, v68, v70
  v_add_f32 v69, v69, v71
  v_cvt_pk_bf16_f32 v101, v68, v69
  v_add_f32 v72, v72, v74
  v_add_f32 v73, v73, v75
  v_cvt_pk_bf16_f32 v102, v72, v73
  v_add_f32 v76, v76, v78
  v_add_f32 v77, v77, v79
  v_cvt_pk_bf16_f32 v103, v76, v77
  buffer_store_dwordx4 v[100:103], v15, s[4:7], s39 offen sc1
  s_add_u32 s33, s33, 1
  s_add_u32 s46, s46, 0x40000
  s_add_u32 s43, s43, 262144
  s_add_u32 s44, s44, 262144
  s_mov_b32 s95, s35
  s_xor_b32 s34, s34, 0x8000
  s_xor_b32 s35, s35, 0x8000
  s_xor_b32 s36, s36, 0x8000
  s_xor_b32 s37, s37, 0x8000
  s_mov_b32 s53, s38
  s_mov_b32 s54, s94
  s_xor_b32 s38, s38, 0x80000
  s_xor_b32 s39, s39, 0x80000
  ds_read_b128 v[96:99], v13 offset:0
  ds_read_b128 v[100:103], v13 offset:1024
  ds_read_b128 v[104:107], v13 offset:2048
  ds_read_b128 v[108:111], v13 offset:3072
  ds_read_b128 v[120:123], v13 offset:4096
  ds_read_b128 v[124:127], v13 offset:5120
  v_mov_b64 v[80:81], 0
  v_mov_b64 v[82:83], 0
  v_mov_b64 v[84:85], 0
  v_mov_b64 v[86:87], 0
  v_mov_b64 v[88:89], 0
  v_mov_b64 v[90:91], 0
  v_mov_b64 v[92:93], 0
  v_mov_b64 v[94:95], 0
  v_mov_b64 v[112:113], 0
  v_mov_b64 v[114:115], 0
  v_mov_b64 v[116:117], 0
  v_mov_b64 v[118:119], 0
  s_mov_b32 s42, s41
  s_and_b32 s56, s33, 3
  s_lshl_b32 s56, s56, 14
  s_add_u32 s40, s62, s56
  s_add_u32 s41, s63, s56
  s_add_u32 s56, s33, 1
  s_min_u32 s56, s56, 63
  s_lshr_b32 s57, s56, 3
  s_add_u32 s57, s57, 1
  s_lshr_b32 s58, s56, 2
  s_cmp_lt_u32 s56, 8
  s_cselect_b32 s57, s58, s57
  s_cselect_b32 s49, 64, 32
  s_lshl_b32 s57, s57, 7
  s_add_u32 s48, s57, 2621440
  s_nop 7
  buffer_load_dwordx4 v[56:59], v16, s[4:7], s53 offen sc1
  buffer_load_dwordx4 v[60:63], v16, s[4:7], s53 offen offset:1024 sc1
pb_211:
  s_waitcnt vmcnt(0)
  v_mfma_f32_16x16x32_bf16 v[72:75], v[56:59], v[20:23], 0
  v_bitop3_b32 v18, v56, v60, s96 bitop3:0x7e
  v_and_b32 v18, 1, v18
  v_cmp_ne_u32 vcc, 0, v18
  v_mfma_f32_16x16x32_bf16 v[72:75], v[60:63], v[20:23], v[72:75]
  s_cbranch_vccnz fb_212
eb_213:
  v_mfma_f32_16x16x32_bf16 v[76:79], v[56:59], v[24:27], 0
  v_mfma_f32_16x16x32_bf16 v[76:79], v[60:63], v[24:27], v[76:79]
  s_nop 4
  v_add_f32 v72, v72, v73
  v_add_f32 v74, v74, v75
  v_add_f32 v72, v72, v74
  v_pk_add_f32 v[76:77], v[76:77], v[78:79]
  v_add_f32 v76, v76, v77
  s_nop 1
  v_permlane32_swap_b32 v72, v76
  v_add_f32 v72, v72, v76
  v_mov_b32 v76, v72
  s_nop 1
  v_permlane16_swap_b32 v72, v76
  v_add_f32 v72, v72, v76
  v_mov_b32 v76, v72
  s_nop 1
  v_permlane32_swap_b32 v72, v76
  v_cvt_pk_bf16_f32 v19, v72, v76
  buffer_store_dword v19, v17, s[4:7], s41 offen sc1
  s_mov_b64 exec, -1
  s_branch R_slow_top
fc_196:
  s_mov_b64 exec, vcc
  buffer_load_dwordx4 v[48:51], v1, s[4:7], s40 offen sc1
  buffer_load_dwordx4 v[52:55], v1, s[4:7], s40 offen offset:1024 sc1
  s_mov_b64 exec, -1
  s_sub_u32 s94, s94, 1
  s_cbranch_scc0 bd_200
  s_mov_b32 s94, 0
  s_branch ec_197
bd_200:
  v_mov_b64 v[80:81], 0
  v_mov_b64 v[82:83], 0
  v_mov_b64 v[84:85], 0
  v_mov_b64 v[86:87], 0
  s_branch R_slow_cw
fa_201:
  buffer_load_dwordx4 v[40:43], v1, s[4:7], s35 offen sc1
  s_waitcnt vmcnt(1)
sa_203:
  s_sub_u32 s94, s94, 1
  s_cbranch_scc0 bd_204
  s_mov_b32 s94, 0
  s_branch ea_202
bd_204:
  v_bitop3_b32 v19, v124, s96, 1 bitop3:0x28
  v_cmp_ne_u32 vcc, 0, v19
  v_dot2_f32_bf16 v112, v124, s97, v80
  v_dot2_f32_bf16 v113, v124, s99, v81
  v_dot2_f32_bf16 v114, v126, s97, v82
  v_dot2_f32_bf16 v115, v126, s99, v83
  v_dot2_f32_bf16 v116, v125, s97, v88
  v_dot2_f32_bf16 v117, v125, s99, v89
  v_dot2_f32_bf16 v118, v127, s97, v90
  v_dot2_f32_bf16 v119, v127, s99, v91
  s_cbranch_vccz ea_202
  buffer_load_dwordx4 v[124:127], v1, s[4:7], s35 offen sc1
  s_waitcnt vmcnt(1)
  v_bitop3_b32 v19, v40, s96, 1 bitop3:0x28
  v_cmp_ne_u32 vcc, 0, v19
  v_dot2_f32_bf16 v112, v40, s97, v80
  v_dot2_f32_bf16 v113, v40, s99, v81
  v_dot2_f32_bf16 v114, v42, s97, v82
  v_dot2_f32_bf16 v115, v42, s99, v83
  v_dot2_f32_bf16 v116, v41, s97, v88
  v_dot2_f32_bf16 v117, v41, s99, v89
  v_dot2_f32_bf16 v118, v43, s97, v90
  v_dot2_f32_bf16 v119, v43, s99, v91
  s_cbranch_vccz ea_202
  buffer_load_dwordx4 v[40:43], v1, s[4:7], s35 offen sc1
  s_waitcnt vmcnt(1)
  s_branch sa_203
fv_208:
  s_sub_u32 s94, s94, 1
  s_cbranch_scc0 bd_210
  s_mov_b32 s94, 0
  s_branch ev_209
bd_210:
  buffer_load_dwordx2 v[98:99], v9, s[4:7], s37 offen offset:0 sc1
  buffer_load_dwordx2 v[102:103], v9, s[4:7], s37 offen offset:512 sc1
  buffer_load_dwordx2 v[106:107], v9, s[4:7], s37 offen offset:1024 sc1
  buffer_load_dwordx2 v[110:111], v9, s[4:7], s37 offen offset:1536 sc1
  s_waitcnt vmcnt(0)
  v_bitop3_b32 v124, v98, v102, s96 bitop3:0x7e
  v_bitop3_b32 v125, v106, v110, s96 bitop3:0x7e
  v_bitop3_b32 v124, v124, v125, 1 bitop3:0xa8
  v_cmp_ne_u32 vcc, 0, v124
  s_nop 0
  s_cbranch_vccz ev_209
  s_branch fv_208
fb_212:
  s_mov_b64 exec, vcc
  buffer_load_dwordx4 v[56:59], v16, s[4:7], s53 offen sc1
  buffer_load_dwordx4 v[60:63], v16, s[4:7], s53 offen offset:1024 sc1
  s_mov_b64 exec, -1
  s_sub_u32 s94, s94, 1
  s_cbranch_scc0 bd_214
  s_mov_b32 s94, 0
  s_branch eb_213
bd_214:
  s_branch pb_211
kvw_205:
  s_waitcnt vmcnt(0)
  v_mov_b32 v19, 0x0
spin_215:
  buffer_load_dword v18, v19, s[4:7], s48 offen sc1
  s_waitcnt vmcnt(0)
  v_readfirstlane_b32 s56, v18
  s_nop 0
  s_cmp_ge_u32 s56, s49
  s_cbranch_scc1 spun_216
  s_sleep 4
  s_sub_u32 s94, s94, 1
  s_cbranch_scc0 spin_215
  s_mov_b32 s94, 0
spun_216:
  s_branch kvr_206
L_fin:
  s_cmp_lg_u32 s94, 0
  s_cbranch_scc1 L_end
  v_mov_b32 v2, 192
  v_mov_b32 v3, 1
  buffer_atomic_add v3, v2, s[20:23], 0 offen
L_end:
  s_endpgm
.section .rodata,"a"
.p2align 6
.amdhsa_kernel gated_mix__memory_aug_recurrent_mem_tr__geglu_ffn__prompt_kernel
  .amdhsa_next_free_vgpr 512
  .amdhsa_next_free_sgpr 102
  .amdhsa_accum_offset 256
  .amdhsa_group_segment_fixed_size 0
  .amdhsa_kernarg_size 120
  .amdhsa_user_sgpr_count 2
  .amdhsa_user_sgpr_kernarg_segment_ptr 1
  .amdhsa_system_sgpr_workgroup_id_x 1
.end_amdhsa_kernel
```
